```python
import torch

def _softmax(x, axis=-1):
    return torch.softmax(x, dim=axis)
def _gelu(x):
    return torch.nn.functional.gelu(x, approximate="tanh")
def _silu(x):
    return torch.nn.functional.silu(x)
def _sigmoid(x):
    return torch.sigmoid(x)
def _layernorm(x, axis=-1, eps=1e-5):
    m = x.mean(dim=axis, keepdim=True)
    v = x.var(dim=axis, keepdim=True, unbiased=False)
    return (x - m) / torch.sqrt(v + eps)
def _scatter_add(tgt, idx, src, axis=0):
    return tgt.clone().index_add_(axis, idx, src)
def _segment_sum(src, seg, n):
    out = torch.zeros((n,) + src.shape[1:], dtype=src.dtype)
    return out.index_add_(0, seg, src)
def _pad(x, pw):
    flat = tuple(v for pair in reversed(pw) for v in pair)
    return torch.nn.functional.pad(x, flat)

kernel_name = 'concat_heads__compressed_kv_cla__sliding_local_dilated__prompt'

def setup_inputs():

    _w = (lambda a: (lambda t: t.to(torch.bfloat16) if t.is_floating_point() else t)(torch.as_tensor(a)))
    def _A_setup():
        B, H, Sq, Sk, D, M = 1, 32, 2048, 2048, 128, 640
        Dc = 4 * D
        return {
            "x": _w((lambda *s: torch.randn(*s, dtype=torch.bfloat16) * 0.2)(B, Sq, M)),
            "c_kv": _w((lambda *s: torch.randn(*s, dtype=torch.bfloat16) * 1.6)(B, Sk, Dc)),
            "w_q": _w((lambda *s: torch.randn(*s, dtype=torch.bfloat16) * 3.2)(M, H, D) * (M ** -0.5)),
            "w_uk": _w((lambda *s: torch.randn(*s, dtype=torch.bfloat16) * 3.2)(Dc, H, D) * (Dc ** -0.5)),
            "w_uv": _w((lambda *s: torch.randn(*s, dtype=torch.bfloat16) * 1.6)(Dc, H, D) * (Dc ** -0.5)),
            "w_o": _w((lambda *s: torch.randn(*s, dtype=torch.bfloat16) * 1.6)(H, D, M) * ((H * D) ** -0.5)),
        }
    _A_in = _A_setup()

    def _B_setup():
        B, S, D = 1, 2048, 640
        return {
            "x": _w((lambda *s: torch.randn(*s, dtype=torch.bfloat16) * 0.4)(B, S, D)),
            "wqkv": _w((lambda *s: torch.randn(*s, dtype=torch.bfloat16) * 0.4)(D, 3 * D)),
            "wo": _w((lambda *s: torch.randn(*s, dtype=torch.bfloat16) * 0.05)(D, D)),
        }
    _B_in = _B_setup()

    return {
        "A_x": _A_in["x"],
        "A_c_kv": _A_in["c_kv"],
        "A_w_q": _A_in["w_q"],
        "A_w_uk": _A_in["w_uk"],
        "A_w_uv": _A_in["w_uv"],
        "A_w_o": _A_in["w_o"],
        "B_x": _B_in["x"],
        "B_wqkv": _B_in["wqkv"],
        "B_wo": _B_in["wo"],
    }

def reference(A_x, A_c_kv, A_w_q, A_w_uk, A_w_uv, A_w_o, B_x, B_wqkv, B_wo):
    def _A_ref(x, c_kv, w_q, w_uk, w_uv, w_o):
        B, Sq, M = x.shape[0], x.shape[1], x.shape[2]
        Sk = c_kv.shape[1]
        H, D = w_q.shape[1], w_q.shape[2]
        q = torch.einsum("bqm,mhd->bhqd", x, w_q)
        k = torch.einsum("bkc,chd->bhkd", c_kv, w_uk)
        v = torch.einsum("bkc,chd->bhkd", c_kv, w_uv)
        scores = torch.einsum("bhqd,bhkd->bhqk", q, k) * (D ** -0.5)
        off = Sk - Sq
        qi = torch.arange(Sq)[:, None]
        kj = torch.arange(Sk)[None, :]
        cmask = kj <= (qi + off)
        scores = torch.where(cmask[None, None], scores, -1e9)
        p = _softmax(scores, axis=-1)
        ctx = torch.einsum("bhqk,bhkd->bhqd", p, v)
        return torch.einsum("bhqd,hdm->bqm", ctx, w_o)

    def _B_ref(x, wqkv, wo):
        B, S, D = x.shape
        H = 32; Dh = D // H
        W, dil = 8, 2
        qkv = (lambda x, *d: x.permute(*d))((x @ wqkv).reshape(B, S, 3, H, Dh), 2, 0, 3, 1, 4)
        q, k, v = qkv[0], qkv[1], qkv[2]
        scale = Dh ** -0.5
        pos = torch.arange(S)
        off = torch.arange(W) * dil
        idx = pos[:, None] - off[None, :]
        mask = idx >= 0
        idx_c = torch.where(mask, idx, 0).reshape(-1)
        kg = k[:, :, idx_c, :].reshape(B, H, S, W, Dh)
        vg = v[:, :, idx_c, :].reshape(B, H, S, W, Dh)
        logits = torch.einsum("bhsd,bhswd->bhsw", q, kg) * scale
        logits = torch.where(mask[None, None, :, :], logits, -1e9)
        attn = _softmax(logits, axis=-1)
        o = torch.einsum("bhsw,bhswd->bhsd", attn, vg)
        return (lambda x, *d: x.permute(*d))(o, 0, 2, 1, 3).reshape(B, S, D) @ wo

    a = _A_ref(A_x, A_c_kv, A_w_q, A_w_uk, A_w_uv, A_w_o)
    b = _B_ref(B_x, B_wqkv, B_wo)
    return torch.concatenate([a, b], axis=-1)
```

```asm
; @launch grid=(256,1,1) block=(256,1,1) lds=163840
.amdgcn_target "amdgcn-amd-amdhsa--gfx950"
.text
.globl concat_heads__compressed_kv_cla__sliding_local_dilated__prompt_kernel
.p2align 8
.type concat_heads__compressed_kv_cla__sliding_local_dilated__prompt_kernel,@function
concat_heads__compressed_kv_cla__sliding_local_dilated__prompt_kernel:
  s_cmp_ge_u32 s2, 256
  s_cbranch_scc1 L_end
  s_load_dwordx16 s[4:19], s[0:1], 0
  s_load_dwordx8 s[20:27], s[0:1], 64
  v_mov_b32 v35, v0
  s_getpc_b64 s[56:57]
L_pc:
  v_lshlrev_b32 v34, 7, v35
  s_mov_b32 s55, L_codeend - L_pc - 4
  v_min_u32 v33, s55, v34
  global_load_dword a253, v33, s[56:57]
  v_add_u32 v34, 0x8000, v34
  v_min_u32 v33, s55, v34
  global_load_dword a254, v33, s[56:57]
  v_add_u32 v34, 0x8000, v34
  v_min_u32 v33, s55, v34
  global_load_dword a255, v33, s[56:57]
  v_and_b32 v1, 63, v0
  v_lshrrev_b32 v2, 6, v0
  s_and_b32 s54, s2, 7
  v_readfirstlane_b32 s28, v2
  s_lshl_b32 s29, s54, 2
  s_lshr_b32 s31, s2, 3
  s_and_b32 s55, s31, 3
  s_add_u32 s29, s29, s55
  s_lshr_b32 s30, s2, 5
  s_lshl_b32 s51, s28, 13
  s_mov_b32 s48, 0
  s_mov_b32 s49, 0
  s_lshl_b32 s54, s30, 8
  s_lshl_b32 s55, s28, 6
  s_add_u32 s54, s54, s55
  v_lshrrev_b32 v2, 3, v1
  v_add_u32 v2, s54, v2
  v_lshlrev_b32 v2, 10, v2
  v_lshrrev_b32 v3, 4, v1
  v_and_b32 v30, 7, v1
  v_xor_b32 v3, v3, v30
  v_lshl_add_u32 v30, v3, 4, v2
  v_xor_b32 v3, 4, v3
  v_lshl_add_u32 v31, v3, 4, v2
  v_add_u32 v4, 0, v30
  v_add_u32 v5, 7168, v31
  v_add_u32 v6, 14336, v30
  v_add_u32 v7, 21504, v31
  v_add_u32 v8, 32768, v30
  v_add_u32 v9, 39936, v31
  v_add_u32 v10, 47104, v30
  v_add_u32 v11, 54272, v31
  s_and_b32 s54, s28, 1
  s_lshl_b32 s54, s54, 18
  s_lshl_b32 s55, s29, 8
  s_add_u32 s54, s54, s55
  v_lshrrev_b32 v2, 4, v1
  v_lshlrev_b32 v3, 2, v2
  v_lshlrev_b32 v2, 13, v2
  v_add_u32 v2, s54, v2
  v_and_b32 v30, 15, v1
  v_xor_b32 v3, v3, v30
  v_lshl_add_u32 v30, v3, 4, v2
  v_xor_b32 v3, 2, v3
  v_lshl_add_u32 v31, v3, 4, v2
  v_add_u32 v12, 0, v30
  v_add_u32 v13, 31744, v30
  v_add_u32 v14, 63488, v31
  v_add_u32 v15, 95232, v31
  v_add_u32 v16, 131072, v30
  v_add_u32 v17, 162816, v30
  v_add_u32 v18, 194560, v31
  v_add_u32 v19, 226304, v31
  s_waitcnt lgkmcnt(0)
  s_mov_b32 s32, s6
  s_mov_b32 s33, s7
  s_mov_b32 s34, 2097152
  s_mov_b32 s35, 0x20000
  s_cmp_lt_u32 s28, 2
  s_cselect_b32 s36, s10, s12
  s_cselect_b32 s37, s11, s13
  s_mov_b32 s38, 4194304
  s_mov_b32 s39, 0x20000
  s_add_u32 m0, s51, 32768
  s_nop 0
  buffer_load_dwordx4 v12, s[36:39], s49 offen offset:0 nt lds
  buffer_load_dwordx4 v13, s[36:39], s49 offen offset:1024 nt lds
  s_lshr_b32 s54, s28, 1
  s_lshl_b32 s54, s54, 14
  v_and_b32 v2, 15, v1
  v_lshrrev_b32 v3, 1, v2
  v_lshlrev_b32 v2, 7, v2
  v_add_u32 v2, s54, v2
  v_lshrrev_b32 v0, 4, v1
  v_xor_b32 v3, v3, v0
  v_lshl_add_u32 v30, v3, 4, v2
  v_xor_b32 v3, 4, v3
  v_lshl_add_u32 v31, v3, 4, v2
  s_mov_b32 s52, 65536
  v_add_u32 v20, 65536, v30
  v_add_u32 v21, 65536, v31
  s_and_b32 s54, s28, 1
  s_lshl_b32 s54, s54, 14
  s_add_u32 s54, s54, 32768
  v_lshrrev_b32 v2, 4, v1
  v_lshrrev_b32 v3, 2, v1
  v_and_b32 v3, 3, v3
  v_lshl_add_u32 v0, v2, 3, v3
  v_lshlrev_b32 v0, 8, v0
  v_add_u32 v0, s54, v0
  v_and_b32 v32, 1, v1
  v_lshl_add_u32 v0, v32, 3, v0
  v_and_b32 v2, 1, v2
  v_lshlrev_b32 v2, 1, v2
  v_lshl_or_b32 v2, v3, 2, v2
  v_lshrrev_b32 v3, 1, v1
  v_and_b32 v3, 1, v3
  v_xor_b32 v2, v2, v3
  v_xor_b32 v3, 0, v2
  v_lshl_add_u32 v22, v3, 4, v0
  v_xor_b32 v3, 2, v2
  v_lshl_add_u32 v23, v3, 4, v0
  v_xor_b32 v3, 4, v2
  v_lshl_add_u32 v24, v3, 4, v0
  v_xor_b32 v3, 6, v2
  v_lshl_add_u32 v25, v3, 4, v0
  v_xor_b32 v3, 8, v2
  v_lshl_add_u32 v26, v3, 4, v0
  v_xor_b32 v3, 10, v2
  v_lshl_add_u32 v27, v3, 4, v0
  v_xor_b32 v3, 12, v2
  v_lshl_add_u32 v28, v3, 4, v0
  v_xor_b32 v3, 14, v2
  v_lshl_add_u32 v29, v3, 4, v0
  buffer_load_dwordx4 v14, s[36:39], s49 offen offset:2048 nt lds
  buffer_load_dwordx4 v15, s[36:39], s49 offen offset:3072 nt lds
  s_add_u32 m0, s51, 36864
  s_nop 0
  buffer_load_dwordx4 v16, s[36:39], s49 offen offset:0 nt lds
  buffer_load_dwordx4 v17, s[36:39], s49 offen offset:1024 nt lds
  buffer_load_dwordx4 v18, s[36:39], s49 offen offset:2048 nt lds
  buffer_load_dwordx4 v19, s[36:39], s49 offen offset:3072 nt lds
  s_lshl_b32 s94, s31, 2
  s_add_u32 s94, s94, s28
  s_mov_b32 s44, s4
  s_mov_b32 s45, s5
  s_mov_b32 s46, 2621440
  s_mov_b32 s47, 0x20000
  s_mov_b32 s96, s8
  s_mov_b32 s97, s9
  s_mov_b32 s98, 5242880
  s_mov_b32 s99, 0x20000
  s_lshl_b32 s94, s31, 2
  s_add_u32 s94, s94, s28
  s_mul_i32 s92, s94, 20480
  s_mul_i32 s93, s94, 40960
  s_and_b32 s54, s2, 7
  s_lshl_b32 s54, s54, 10
  s_add_u32 s93, s93, s54
  s_sub_u32 s93, s93, 16384
  v_lshlrev_b32 v0, 7, v1
  v_lshrrev_b32 v2, 3, v1
  v_lshlrev_b32 v2, 13, v2
  v_and_b32 v3, 7, v1
  v_lshl_add_u32 v2, v3, 7, v2
  s_lshl_b32 s92, s2, 2
  s_add_u32 s92, s92, s28
  s_mul_i32 s92, s92, 2688
  v_cmp_gt_u32 vcc, 7, v1
  v_mov_b32 v3, 0x40000000
  s_nop 0
  v_cndmask_b32 v0, v3, v0, vcc
  v_cmp_gt_u32 vcc, 16, v1
  v_mov_b32 v3, 0x40000000
  s_nop 0
  v_cndmask_b32 v2, v3, v2, vcc
  s_add_u32 s49, s49, 524288
  s_add_u32 m0, s51, 65536
  s_nop 0
  buffer_load_dwordx4 v4, s[32:35], s48 offen offset:0 lds
  buffer_load_dwordx4 v5, s[32:35], s48 offen offset:1024 lds
  buffer_load_dwordx4 v6, s[32:35], s48 offen offset:2048 lds
  buffer_load_dwordx4 v7, s[32:35], s48 offen offset:3072 lds
  s_add_u32 m0, s51, 69632
  s_nop 0
  buffer_load_dwordx4 v8, s[32:35], s48 offen offset:0 lds
  buffer_load_dwordx4 v9, s[32:35], s48 offen offset:1024 lds
  buffer_load_dwordx4 v10, s[32:35], s48 offen offset:2048 lds
  buffer_load_dwordx4 v11, s[32:35], s48 offen offset:3072 lds
  s_lshl_b32 s54, s2, 2
  s_add_u32 s54, s54, s28
  s_cmp_lg_u32 s54, 0
  s_cbranch_scc1 L_nonce
  s_memrealtime s[54:55]
  s_waitcnt lgkmcnt(0)
  s_or_b32 s54, s54, 1
  v_mov_b32 v2, s54
  v_mov_b32 v3, s55
  v_mov_b32 v0, 0
  s_mov_b64 exec, 1
  global_store_dwordx2 v0, v[2:3], s[24:25] sc1
  s_mov_b64 exec, -1
L_nonce:
  s_add_u32 s48, s48, 128
  s_add_u32 m0, s51, 131072
  s_nop 0
  buffer_load_dwordx4 v4, s[32:35], s48 offen offset:0 lds
  buffer_load_dwordx4 v5, s[32:35], s48 offen offset:1024 lds
  buffer_load_dwordx4 v6, s[32:35], s48 offen offset:2048 lds
  buffer_load_dwordx4 v7, s[32:35], s48 offen offset:3072 lds
  s_add_u32 m0, s51, 135168
  s_nop 0
  buffer_load_dwordx4 v8, s[32:35], s48 offen offset:0 lds
  buffer_load_dwordx4 v9, s[32:35], s48 offen offset:1024 lds
  buffer_load_dwordx4 v10, s[32:35], s48 offen offset:2048 lds
  buffer_load_dwordx4 v11, s[32:35], s48 offen offset:3072 lds
  s_add_u32 s48, s48, 128
  s_add_u32 m0, s51, 98304
  s_nop 0
  buffer_load_dwordx4 v12, s[36:39], s49 offen offset:0 nt lds
  buffer_load_dwordx4 v13, s[36:39], s49 offen offset:1024 nt lds
  buffer_load_dwordx4 v14, s[36:39], s49 offen offset:2048 nt lds
  buffer_load_dwordx4 v15, s[36:39], s49 offen offset:3072 nt lds
  s_add_u32 m0, s51, 102400
  s_nop 0
  buffer_load_dwordx4 v16, s[36:39], s49 offen offset:0 nt lds
  buffer_load_dwordx4 v17, s[36:39], s49 offen offset:1024 nt lds
  buffer_load_dwordx4 v18, s[36:39], s49 offen offset:2048 nt lds
  buffer_load_dwordx4 v19, s[36:39], s49 offen offset:3072 nt lds
  s_add_u32 s49, s49, 524288
  s_waitcnt vmcnt(16)
  s_barrier
  ds_read_b64_tr_b16 a[32:33], v22 offset:0
  ds_read_b64_tr_b16 a[34:35], v22 offset:1024
  ds_read_b64_tr_b16 a[36:37], v22 offset:8192
  ds_read_b64_tr_b16 a[38:39], v22 offset:9216
  ds_read_b64_tr_b16 a[40:41], v23 offset:0
  ds_read_b64_tr_b16 a[42:43], v23 offset:1024
  ds_read_b64_tr_b16 a[44:45], v23 offset:8192
  ds_read_b64_tr_b16 a[46:47], v23 offset:9216
  ds_read_b64_tr_b16 a[48:49], v24 offset:0
  ds_read_b64_tr_b16 a[50:51], v24 offset:1024
  ds_read_b64_tr_b16 a[52:53], v24 offset:8192
  ds_read_b64_tr_b16 a[54:55], v24 offset:9216
  ds_read_b64_tr_b16 a[56:57], v25 offset:0
  ds_read_b64_tr_b16 a[58:59], v25 offset:1024
  ds_read_b64_tr_b16 a[60:61], v25 offset:8192
  ds_read_b64_tr_b16 a[62:63], v25 offset:9216
  ds_read_b64_tr_b16 a[64:65], v26 offset:0
  ds_read_b64_tr_b16 a[66:67], v26 offset:1024
  ds_read_b64_tr_b16 a[68:69], v26 offset:8192
  ds_read_b64_tr_b16 a[70:71], v26 offset:9216
  ds_read_b64_tr_b16 a[72:73], v27 offset:0
  ds_read_b64_tr_b16 a[74:75], v27 offset:1024
  ds_read_b64_tr_b16 a[76:77], v27 offset:8192
  ds_read_b64_tr_b16 a[78:79], v27 offset:9216
  ds_read_b64_tr_b16 a[80:81], v28 offset:0
  ds_read_b64_tr_b16 a[82:83], v28 offset:1024
  ds_read_b64_tr_b16 a[84:85], v28 offset:8192
  ds_read_b64_tr_b16 a[86:87], v28 offset:9216
  ds_read_b64_tr_b16 a[88:89], v29 offset:0
  ds_read_b64_tr_b16 a[90:91], v29 offset:1024
  ds_read_b64_tr_b16 a[92:93], v29 offset:8192
  ds_read_b64_tr_b16 a[94:95], v29 offset:9216
  ds_read_b128 a[160:163], v20 offset:0
  ds_read_b128 a[164:167], v21 offset:0
  ds_read_b128 a[168:171], v20 offset:2048
  ds_read_b128 a[172:175], v21 offset:2048
  ds_read_b128 a[176:179], v20 offset:4096
  ds_read_b128 a[180:183], v21 offset:4096
  ds_read_b128 a[184:187], v20 offset:6144
  ds_read_b128 a[188:191], v21 offset:6144
  s_mov_b32 s50, 2
  s_waitcnt lgkmcnt(0)
  s_bitcmp1_b32 s28, 0
  s_cbranch_scc1 LKV_V0
LKV_K0:
  v_mfma_f32_16x16x32_bf16 v[32:35], a[32:35], a[160:163], 0
  s_add_u32 m0, s51, 0
  v_mfma_f32_16x16x32_bf16 v[32:35], a[36:39], a[164:167], v[32:35]
  buffer_load_dwordx4 v4, s[32:35], s48 offen offset:0 lds
  v_mfma_f32_16x16x32_bf16 v[36:39], a[40:43], a[160:163], 0
  s_add_u32 m0, s51, 0
  v_mfma_f32_16x16x32_bf16 v[36:39], a[44:47], a[164:167], v[36:39]
  buffer_load_dwordx4 v5, s[32:35], s48 offen offset:1024 lds
  v_mfma_f32_16x16x32_bf16 v[40:43], a[48:51], a[160:163], 0
  v_mfma_f32_16x16x32_bf16 v[40:43], a[52:55], a[164:167], v[40:43]
  v_mfma_f32_16x16x32_bf16 v[44:47], a[56:59], a[160:163], 0
  s_waitcnt lgkmcnt(0)
  s_barrier
  v_mfma_f32_16x16x32_bf16 v[44:47], a[60:63], a[164:167], v[44:47]
  v_mfma_f32_16x16x32_bf16 v[48:51], a[64:67], a[160:163], 0
  ds_read_b128 a[192:195], v20 offset:8192
  v_mfma_f32_16x16x32_bf16 v[48:51], a[68:71], a[164:167], v[48:51]
  s_add_u32 m0, s51, 32768
  v_mfma_f32_16x16x32_bf16 v[52:55], a[72:75], a[160:163], 0
  buffer_load_dwordx4 v12, s[36:39], s49 offen offset:0 nt lds
  v_mfma_f32_16x16x32_bf16 v[52:55], a[76:79], a[164:167], v[52:55]
  s_add_u32 m0, s51, 0
  v_mfma_f32_16x16x32_bf16 v[56:59], a[80:83], a[160:163], 0
  buffer_load_dwordx4 v6, s[32:35], s48 offen offset:2048 lds
  ds_read_b128 a[196:199], v21 offset:8192
  v_mfma_f32_16x16x32_bf16 v[56:59], a[84:87], a[164:167], v[56:59]
  s_add_u32 m0, s51, 32768
  v_mfma_f32_16x16x32_bf16 v[60:63], a[88:91], a[160:163], 0
  buffer_load_dwordx4 v13, s[36:39], s49 offen offset:1024 nt lds
  v_mfma_f32_16x16x32_bf16 v[60:63], a[92:95], a[164:167], v[60:63]
  v_mfma_f32_16x16x32_bf16 v[64:67], a[32:35], a[168:171], 0
  s_add_u32 m0, s51, 0
  v_mfma_f32_16x16x32_bf16 v[64:67], a[36:39], a[172:175], v[64:67]
  buffer_load_dwordx4 v7, s[32:35], s48 offen offset:3072 lds
  v_mfma_f32_16x16x32_bf16 v[68:71], a[40:43], a[168:171], 0
  s_add_u32 m0, s51, 4096
  ds_read_b128 a[200:203], v20 offset:10240
  v_mfma_f32_16x16x32_bf16 v[68:71], a[44:47], a[172:175], v[68:71]
  buffer_load_dwordx4 v8, s[32:35], s48 offen offset:0 lds
  v_mfma_f32_16x16x32_bf16 v[72:75], a[48:51], a[168:171], 0
  s_add_u32 m0, s51, 32768
  s_add_u32 s93, s93, 16384
  v_mfma_f32_16x16x32_bf16 v[72:75], a[52:55], a[172:175], v[72:75]
  buffer_load_dwordx4 v14, s[36:39], s49 offen offset:2048 nt lds
  v_mfma_f32_16x16x32_bf16 v[76:79], a[56:59], a[168:171], 0
  v_mfma_f32_16x16x32_bf16 v[76:79], a[60:63], a[172:175], v[76:79]
  s_add_u32 m0, s51, 4096
  v_mfma_f32_16x16x32_bf16 v[80:83], a[64:67], a[168:171], 0
  buffer_load_dwordx4 v9, s[32:35], s48 offen offset:1024 lds
  ds_read_b128 a[204:207], v21 offset:10240
  v_mfma_f32_16x16x32_bf16 v[80:83], a[68:71], a[172:175], v[80:83]
  v_mfma_f32_16x16x32_bf16 v[84:87], a[72:75], a[168:171], 0
  s_add_u32 m0, s51, 32768
  v_mfma_f32_16x16x32_bf16 v[84:87], a[76:79], a[172:175], v[84:87]
  buffer_load_dwordx4 v15, s[36:39], s49 offen offset:3072 nt lds
  v_mfma_f32_16x16x32_bf16 v[88:91], a[80:83], a[168:171], 0
  v_mfma_f32_16x16x32_bf16 v[88:91], a[84:87], a[172:175], v[88:91]
  s_add_u32 m0, s51, 4096
  v_mfma_f32_16x16x32_bf16 v[92:95], a[88:91], a[168:171], 0
  buffer_load_dwordx4 v10, s[32:35], s48 offen offset:2048 lds
  v_mfma_f32_16x16x32_bf16 v[92:95], a[92:95], a[172:175], v[92:95]
  v_mfma_f32_16x16x32_bf16 v[96:99], a[32:35], a[176:179], 0
  s_add_u32 m0, s51, 4096
  v_mfma_f32_16x16x32_bf16 v[96:99], a[36:39], a[180:183], v[96:99]
  buffer_load_dwordx4 v11, s[32:35], s48 offen offset:3072 lds
  v_xor_b32 v22, 0x10000, v22
  v_mfma_f32_16x16x32_bf16 v[100:103], a[40:43], a[176:179], 0
  s_add_u32 s48, s48, 128
  ds_read_b128 a[208:211], v20 offset:12288
  v_mfma_f32_16x16x32_bf16 v[100:103], a[44:47], a[180:183], v[100:103]
  v_xor_b32 v23, 0x10000, v23
  v_mfma_f32_16x16x32_bf16 v[104:107], a[48:51], a[176:179], 0
  s_add_u32 m0, s51, 36864
  v_mfma_f32_16x16x32_bf16 v[104:107], a[52:55], a[180:183], v[104:107]
  buffer_load_dwordx4 v16, s[36:39], s49 offen offset:0 nt lds
  v_mfma_f32_16x16x32_bf16 v[108:111], a[56:59], a[176:179], 0
  s_lshr_b32 s54, s2, 2
  v_mfma_f32_16x16x32_bf16 v[108:111], a[60:63], a[180:183], v[108:111]
  s_and_b32 s54, s54, 1
  v_xor_b32 v24, 0x10000, v24
  v_mfma_f32_16x16x32_bf16 v[112:115], a[64:67], a[176:179], 0
  s_lshl_b32 s55, s30, 2
  ds_read_b128 a[212:215], v21 offset:12288
  v_mfma_f32_16x16x32_bf16 v[112:115], a[68:71], a[180:183], v[112:115]
  s_sub_u32 s55, 30, s55
  v_xor_b32 v25, 0x10000, v25
  v_mfma_f32_16x16x32_bf16 v[116:119], a[72:75], a[176:179], 0
  s_mul_i32 s55, s55, s54
  v_mfma_f32_16x16x32_bf16 v[116:119], a[76:79], a[180:183], v[116:119]
  s_lshl_b32 s100, s30, 1
  buffer_load_dwordx4 v17, s[36:39], s49 offen offset:1024 nt lds
  v_mfma_f32_16x16x32_bf16 v[120:123], a[80:83], a[176:179], 0
  s_add_u32 s100, s100, s55
  v_mfma_f32_16x16x32_bf16 v[120:123], a[84:87], a[180:183], v[120:123]
  s_lshr_b32 s54, s2, 1
  v_xor_b32 v26, 0x10000, v26
  v_mfma_f32_16x16x32_bf16 v[124:127], a[88:91], a[176:179], 0
  s_and_b32 s54, s54, 1
  v_mfma_f32_16x16x32_bf16 v[124:127], a[92:95], a[180:183], v[124:127]
  s_add_u32 s100, s100, s54
  v_xor_b32 v27, 0x10000, v27
  v_mfma_f32_16x16x32_bf16 v[128:131], a[32:35], a[184:187], 0
  s_and_b32 s101, s2, 1
  v_mfma_f32_16x16x32_bf16 v[128:131], a[36:39], a[188:191], v[128:131]
  s_lshl_b32 s101, s101, 2
  v_mfma_f32_16x16x32_bf16 v[132:135], a[40:43], a[184:187], 0
  s_and_b32 s54, s31, 3
  ds_read_b128 a[216:219], v20 offset:14336
  v_mfma_f32_16x16x32_bf16 v[132:135], a[44:47], a[188:191], v[132:135]
  s_add_u32 s101, s101, s54
  v_xor_b32 v28, 0x10000, v28
  v_mfma_f32_16x16x32_bf16 v[136:139], a[48:51], a[184:187], 0
  s_mul_i32 s58, s29, 1048576
  v_mfma_f32_16x16x32_bf16 v[136:139], a[52:55], a[188:191], v[136:139]
  s_lshl_b32 s55, s30, 17
  buffer_load_dwordx4 v18, s[36:39], s49 offen offset:2048 nt lds
  v_mfma_f32_16x16x32_bf16 v[140:143], a[56:59], a[184:187], 0
  s_add_u32 s58, s58, s55
  v_mfma_f32_16x16x32_bf16 v[140:143], a[60:63], a[188:191], v[140:143]
  s_lshr_b32 s55, s28, 1
  v_xor_b32 v29, 0x10000, v29
  v_mfma_f32_16x16x32_bf16 v[144:147], a[64:67], a[184:187], 0
  s_lshl_b32 s55, s55, 16
  ds_read_b128 a[220:223], v21 offset:14336
  v_mfma_f32_16x16x32_bf16 v[144:147], a[68:71], a[188:191], v[144:147]
  s_add_u32 s58, s58, s55
  v_mfma_f32_16x16x32_bf16 v[148:151], a[72:75], a[184:187], 0
  s_and_b32 s55, s28, 1
  v_mfma_f32_16x16x32_bf16 v[148:151], a[76:79], a[188:191], v[148:151]
  s_mul_i32 s55, s55, 34816
  buffer_load_dwordx4 v19, s[36:39], s49 offen offset:3072 nt lds
  v_mfma_f32_16x16x32_bf16 v[152:155], a[80:83], a[184:187], 0
  s_add_u32 s58, s58, s55
  v_mfma_f32_16x16x32_bf16 v[152:155], a[84:87], a[188:191], v[152:155]
  s_add_u32 s49, s49, 524288
  v_mfma_f32_16x16x32_bf16 v[156:159], a[88:91], a[184:187], 0
  v_mfma_f32_16x16x32_bf16 v[156:159], a[92:95], a[188:191], v[156:159]
  s_waitcnt vmcnt(16) lgkmcnt(0)
  s_barrier
  v_mfma_f32_16x16x32_bf16 v[160:163], a[32:35], a[192:195], 0
  s_add_u32 s53, s52, s51
  s_add_u32 s52, s52, 0x10000
  v_mfma_f32_16x16x32_bf16 v[160:163], a[36:39], a[196:199], v[160:163]
  s_cmp_eq_u32 s52, 0x30000
  s_cselect_b32 s52, 0, s52
  v_mfma_f32_16x16x32_bf16 v[164:167], a[40:43], a[192:195], 0
  ds_read_b64_tr_b16 a[96:97], v22 offset:0
  v_mfma_f32_16x16x32_bf16 v[164:167], a[44:47], a[196:199], v[164:167]
  ds_read_b64_tr_b16 a[98:99], v22 offset:1024
  v_mfma_f32_16x16x32_bf16 v[168:171], a[48:51], a[192:195], 0
  ds_read_b64_tr_b16 a[100:101], v22 offset:8192
  v_mfma_f32_16x16x32_bf16 v[168:171], a[52:55], a[196:199], v[168:171]
  v_add_u32 v20, s52, v30
  v_add_u32 v21, s52, v31
  s_mov_b32 m0, s53
  v_mfma_f32_16x16x32_bf16 v[172:175], a[56:59], a[192:195], 0
  ds_read_b64_tr_b16 a[102:103], v22 offset:9216
  v_mfma_f32_16x16x32_bf16 v[172:175], a[60:63], a[196:199], v[172:175]
  ds_read_b128 a[160:163], v20 offset:0
  v_mfma_f32_16x16x32_bf16 v[176:179], a[64:67], a[192:195], 0
  ds_read_b64_tr_b16 a[104:105], v23 offset:0
  v_mfma_f32_16x16x32_bf16 v[176:179], a[68:71], a[196:199], v[176:179]
  buffer_load_dwordx4 v4, s[32:35], s48 offen offset:0 lds
  v_mfma_f32_16x16x32_bf16 v[180:183], a[72:75], a[192:195], 0
  ds_read_b64_tr_b16 a[106:107], v23 offset:1024
  v_mfma_f32_16x16x32_bf16 v[180:183], a[76:79], a[196:199], v[180:183]
  ds_read_b64_tr_b16 a[108:109], v23 offset:8192
  v_mfma_f32_16x16x32_bf16 v[184:187], a[80:83], a[192:195], 0
  ds_read_b64_tr_b16 a[110:111], v23 offset:9216
  v_mfma_f32_16x16x32_bf16 v[184:187], a[84:87], a[196:199], v[184:187]
  buffer_load_dwordx4 v5, s[32:35], s48 offen offset:1024 lds
  v_mfma_f32_16x16x32_bf16 v[188:191], a[88:91], a[192:195], 0
  ds_read_b128 a[164:167], v21 offset:0
  v_mfma_f32_16x16x32_bf16 v[188:191], a[92:95], a[196:199], v[188:191]
  v_mfma_f32_16x16x32_bf16 v[192:195], a[32:35], a[200:203], 0
  v_mfma_f32_16x16x32_bf16 v[192:195], a[36:39], a[204:207], v[192:195]
  v_mfma_f32_16x16x32_bf16 v[196:199], a[40:43], a[200:203], 0
  ds_read_b64_tr_b16 a[112:113], v24 offset:0
  v_mfma_f32_16x16x32_bf16 v[196:199], a[44:47], a[204:207], v[196:199]
  ds_read_b64_tr_b16 a[114:115], v24 offset:1024
  v_mfma_f32_16x16x32_bf16 v[200:203], a[48:51], a[200:203], 0
  ds_read_b64_tr_b16 a[116:117], v24 offset:8192
  v_mfma_f32_16x16x32_bf16 v[200:203], a[52:55], a[204:207], v[200:203]
  buffer_load_dwordx4 v6, s[32:35], s48 offen offset:2048 lds
  v_mfma_f32_16x16x32_bf16 v[204:207], a[56:59], a[200:203], 0
  ds_read_b64_tr_b16 a[118:119], v24 offset:9216
  v_mfma_f32_16x16x32_bf16 v[204:207], a[60:63], a[204:207], v[204:207]
  ds_read_b128 a[168:171], v20 offset:2048
  v_mfma_f32_16x16x32_bf16 v[208:211], a[64:67], a[200:203], 0
  ds_read_b64_tr_b16 a[120:121], v25 offset:0
  v_mfma_f32_16x16x32_bf16 v[208:211], a[68:71], a[204:207], v[208:211]
  v_mfma_f32_16x16x32_bf16 v[212:215], a[72:75], a[200:203], 0
  ds_read_b64_tr_b16 a[122:123], v25 offset:1024
  v_mfma_f32_16x16x32_bf16 v[212:215], a[76:79], a[204:207], v[212:215]
  ds_read_b64_tr_b16 a[124:125], v25 offset:8192
  v_mfma_f32_16x16x32_bf16 v[216:219], a[80:83], a[200:203], 0
  ds_read_b64_tr_b16 a[126:127], v25 offset:9216
  v_mfma_f32_16x16x32_bf16 v[216:219], a[84:87], a[204:207], v[216:219]
  buffer_load_dwordx4 v7, s[32:35], s48 offen offset:3072 lds
  v_mfma_f32_16x16x32_bf16 v[220:223], a[88:91], a[200:203], 0
  ds_read_b128 a[172:175], v21 offset:2048
  v_mfma_f32_16x16x32_bf16 v[220:223], a[92:95], a[204:207], v[220:223]
  v_mfma_f32_16x16x32_bf16 v[224:227], a[32:35], a[208:211], 0
  v_mfma_f32_16x16x32_bf16 v[224:227], a[36:39], a[212:215], v[224:227]
  v_mfma_f32_16x16x32_bf16 v[228:231], a[40:43], a[208:211], 0
  ds_read_b64_tr_b16 a[128:129], v26 offset:0
  v_mfma_f32_16x16x32_bf16 v[228:231], a[44:47], a[212:215], v[228:231]
  ds_read_b64_tr_b16 a[130:131], v26 offset:1024
  v_mfma_f32_16x16x32_bf16 v[232:235], a[48:51], a[208:211], 0
  ds_read_b64_tr_b16 a[132:133], v26 offset:8192
  s_add_u32 m0, s53, 4096
  v_mfma_f32_16x16x32_bf16 v[232:235], a[52:55], a[212:215], v[232:235]
  buffer_load_dwordx4 v8, s[32:35], s48 offen offset:0 lds
  v_mfma_f32_16x16x32_bf16 v[236:239], a[56:59], a[208:211], 0
  ds_read_b64_tr_b16 a[134:135], v26 offset:9216
  v_mfma_f32_16x16x32_bf16 v[236:239], a[60:63], a[212:215], v[236:239]
  ds_read_b128 a[176:179], v20 offset:4096
  v_mfma_f32_16x16x32_bf16 v[240:243], a[64:67], a[208:211], 0
  ds_read_b64_tr_b16 a[136:137], v27 offset:0
  v_mfma_f32_16x16x32_bf16 v[240:243], a[68:71], a[212:215], v[240:243]
  v_mfma_f32_16x16x32_bf16 v[244:247], a[72:75], a[208:211], 0
  ds_read_b64_tr_b16 a[138:139], v27 offset:1024
  v_mfma_f32_16x16x32_bf16 v[244:247], a[76:79], a[212:215], v[244:247]
  ds_read_b64_tr_b16 a[140:141], v27 offset:8192
  v_mfma_f32_16x16x32_bf16 v[248:251], a[80:83], a[208:211], 0
  ds_read_b64_tr_b16 a[142:143], v27 offset:9216
  v_mfma_f32_16x16x32_bf16 v[248:251], a[84:87], a[212:215], v[248:251]
  buffer_load_dwordx4 v9, s[32:35], s48 offen offset:1024 lds
  v_mfma_f32_16x16x32_bf16 v[252:255], a[88:91], a[208:211], 0
  ds_read_b128 a[180:183], v21 offset:4096
  v_mfma_f32_16x16x32_bf16 v[252:255], a[92:95], a[212:215], v[252:255]
  v_mfma_f32_16x16x32_bf16 a[0:3], a[32:35], a[216:219], 0
  v_mfma_f32_16x16x32_bf16 a[0:3], a[36:39], a[220:223], a[0:3]
  v_mfma_f32_16x16x32_bf16 a[4:7], a[40:43], a[216:219], 0
  ds_read_b64_tr_b16 a[144:145], v28 offset:0
  v_mfma_f32_16x16x32_bf16 a[4:7], a[44:47], a[220:223], a[4:7]
  ds_read_b64_tr_b16 a[146:147], v28 offset:1024
  v_mfma_f32_16x16x32_bf16 a[8:11], a[48:51], a[216:219], 0
  ds_read_b64_tr_b16 a[148:149], v28 offset:8192
  v_mfma_f32_16x16x32_bf16 a[8:11], a[52:55], a[220:223], a[8:11]
  buffer_load_dwordx4 v10, s[32:35], s48 offen offset:2048 lds
  v_mfma_f32_16x16x32_bf16 a[12:15], a[56:59], a[216:219], 0
  ds_read_b64_tr_b16 a[150:151], v28 offset:9216
  v_mfma_f32_16x16x32_bf16 a[12:15], a[60:63], a[220:223], a[12:15]
  ds_read_b128 a[184:187], v20 offset:6144
  v_mfma_f32_16x16x32_bf16 a[16:19], a[64:67], a[216:219], 0
  ds_read_b64_tr_b16 a[152:153], v29 offset:0
  v_mfma_f32_16x16x32_bf16 a[16:19], a[68:71], a[220:223], a[16:19]
  v_mfma_f32_16x16x32_bf16 a[20:23], a[72:75], a[216:219], 0
  ds_read_b64_tr_b16 a[154:155], v29 offset:1024
  v_mfma_f32_16x16x32_bf16 a[20:23], a[76:79], a[220:223], a[20:23]
  ds_read_b64_tr_b16 a[156:157], v29 offset:8192
  v_mfma_f32_16x16x32_bf16 a[24:27], a[80:83], a[216:219], 0
  ds_read_b64_tr_b16 a[158:159], v29 offset:9216
  v_mfma_f32_16x16x32_bf16 a[24:27], a[84:87], a[220:223], a[24:27]
  buffer_load_dwordx4 v11, s[32:35], s48 offen offset:3072 lds
  v_mfma_f32_16x16x32_bf16 a[28:31], a[88:91], a[216:219], 0
  ds_read_b128 a[188:191], v21 offset:6144
  v_mfma_f32_16x16x32_bf16 a[28:31], a[92:95], a[220:223], a[28:31]
  s_add_u32 s48, s48, 128
  buffer_load_dword a248, v0, s[44:47], s92 offen
  s_branch LKV_K
.p2align 6
LKV_K:
  s_waitcnt lgkmcnt(3)
  v_mfma_f32_16x16x32_bf16 v[32:35], a[96:99], a[160:163], v[32:35]
  v_mfma_f32_16x16x32_bf16 v[32:35], a[100:103], a[164:167], v[32:35]
  v_mfma_f32_16x16x32_bf16 v[36:39], a[104:107], a[160:163], v[36:39]
  v_mfma_f32_16x16x32_bf16 v[36:39], a[108:111], a[164:167], v[36:39]
  v_mfma_f32_16x16x32_bf16 v[40:43], a[112:115], a[160:163], v[40:43]
  v_mfma_f32_16x16x32_bf16 v[40:43], a[116:119], a[164:167], v[40:43]
  v_mfma_f32_16x16x32_bf16 v[44:47], a[120:123], a[160:163], v[44:47]
  s_waitcnt lgkmcnt(0)
  s_barrier
  v_mfma_f32_16x16x32_bf16 v[44:47], a[124:127], a[164:167], v[44:47]
  v_mfma_f32_16x16x32_bf16 v[48:51], a[128:131], a[160:163], v[48:51]
  ds_read_b128 a[192:195], v20 offset:8192
  v_mfma_f32_16x16x32_bf16 v[48:51], a[132:135], a[164:167], v[48:51]
  s_add_u32 m0, s51, 98304
  v_mfma_f32_16x16x32_bf16 v[52:55], a[136:139], a[160:163], v[52:55]
  buffer_load_dwordx4 v12, s[36:39], s49 offen offset:0 nt lds
  v_mfma_f32_16x16x32_bf16 v[52:55], a[140:143], a[164:167], v[52:55]
  v_mfma_f32_16x16x32_bf16 v[56:59], a[144:147], a[160:163], v[56:59]
  ds_read_b128 a[196:199], v21 offset:8192
  v_mfma_f32_16x16x32_bf16 v[56:59], a[148:151], a[164:167], v[56:59]
  v_mfma_f32_16x16x32_bf16 v[60:63], a[152:155], a[160:163], v[60:63]
  buffer_load_dwordx4 v13, s[36:39], s49 offen offset:1024 nt lds
  v_mfma_f32_16x16x32_bf16 v[60:63], a[156:159], a[164:167], v[60:63]
  v_mfma_f32_16x16x32_bf16 v[64:67], a[96:99], a[168:171], v[64:67]
  v_mfma_f32_16x16x32_bf16 v[64:67], a[100:103], a[172:175], v[64:67]
  v_mfma_f32_16x16x32_bf16 v[68:71], a[104:107], a[168:171], v[68:71]
  ds_read_b128 a[200:203], v20 offset:10240
  v_mfma_f32_16x16x32_bf16 v[68:71], a[108:111], a[172:175], v[68:71]
  v_mfma_f32_16x16x32_bf16 v[72:75], a[112:115], a[168:171], v[72:75]
  v_mfma_f32_16x16x32_bf16 v[72:75], a[116:119], a[172:175], v[72:75]
  buffer_load_dwordx4 v14, s[36:39], s49 offen offset:2048 nt lds
  v_mfma_f32_16x16x32_bf16 v[76:79], a[120:123], a[168:171], v[76:79]
  v_mfma_f32_16x16x32_bf16 v[76:79], a[124:127], a[172:175], v[76:79]
  v_mfma_f32_16x16x32_bf16 v[80:83], a[128:131], a[168:171], v[80:83]
  ds_read_b128 a[204:207], v21 offset:10240
  v_mfma_f32_16x16x32_bf16 v[80:83], a[132:135], a[172:175], v[80:83]
  v_mfma_f32_16x16x32_bf16 v[84:87], a[136:139], a[168:171], v[84:87]
  v_mfma_f32_16x16x32_bf16 v[84:87], a[140:143], a[172:175], v[84:87]
  buffer_load_dwordx4 v15, s[36:39], s49 offen offset:3072 nt lds
  v_mfma_f32_16x16x32_bf16 v[88:91], a[144:147], a[168:171], v[88:91]
  v_mfma_f32_16x16x32_bf16 v[88:91], a[148:151], a[172:175], v[88:91]
  v_mfma_f32_16x16x32_bf16 v[92:95], a[152:155], a[168:171], v[92:95]
  v_mfma_f32_16x16x32_bf16 v[92:95], a[156:159], a[172:175], v[92:95]
  v_mfma_f32_16x16x32_bf16 v[96:99], a[96:99], a[176:179], v[96:99]
  v_mfma_f32_16x16x32_bf16 v[96:99], a[100:103], a[180:183], v[96:99]
  v_xor_b32 v22, 0x10000, v22
  v_mfma_f32_16x16x32_bf16 v[100:103], a[104:107], a[176:179], v[100:103]
  ds_read_b128 a[208:211], v20 offset:12288
  v_mfma_f32_16x16x32_bf16 v[100:103], a[108:111], a[180:183], v[100:103]
  v_xor_b32 v23, 0x10000, v23
  v_mfma_f32_16x16x32_bf16 v[104:107], a[112:115], a[176:179], v[104:107]
  s_add_u32 m0, s51, 102400
  v_mfma_f32_16x16x32_bf16 v[104:107], a[116:119], a[180:183], v[104:107]
  buffer_load_dwordx4 v16, s[36:39], s49 offen offset:0 nt lds
  v_mfma_f32_16x16x32_bf16 v[108:111], a[120:123], a[176:179], v[108:111]
  v_mfma_f32_16x16x32_bf16 v[108:111], a[124:127], a[180:183], v[108:111]
  v_xor_b32 v24, 0x10000, v24
  v_mfma_f32_16x16x32_bf16 v[112:115], a[128:131], a[176:179], v[112:115]
  ds_read_b128 a[212:215], v21 offset:12288
  v_mfma_f32_16x16x32_bf16 v[112:115], a[132:135], a[180:183], v[112:115]
  v_xor_b32 v25, 0x10000, v25
  v_mfma_f32_16x16x32_bf16 v[116:119], a[136:139], a[176:179], v[116:119]
  v_mfma_f32_16x16x32_bf16 v[116:119], a[140:143], a[180:183], v[116:119]
  buffer_load_dwordx4 v17, s[36:39], s49 offen offset:1024 nt lds
  v_mfma_f32_16x16x32_bf16 v[120:123], a[144:147], a[176:179], v[120:123]
  v_mfma_f32_16x16x32_bf16 v[120:123], a[148:151], a[180:183], v[120:123]
  v_xor_b32 v26, 0x10000, v26
  v_mfma_f32_16x16x32_bf16 v[124:127], a[152:155], a[176:179], v[124:127]
  v_mfma_f32_16x16x32_bf16 v[124:127], a[156:159], a[180:183], v[124:127]
  v_xor_b32 v27, 0x10000, v27
  v_mfma_f32_16x16x32_bf16 v[128:131], a[96:99], a[184:187], v[128:131]
  v_mfma_f32_16x16x32_bf16 v[128:131], a[100:103], a[188:191], v[128:131]
  v_mfma_f32_16x16x32_bf16 v[132:135], a[104:107], a[184:187], v[132:135]
  ds_read_b128 a[216:219], v20 offset:14336
  v_mfma_f32_16x16x32_bf16 v[132:135], a[108:111], a[188:191], v[132:135]
  v_xor_b32 v28, 0x10000, v28
  v_mfma_f32_16x16x32_bf16 v[136:139], a[112:115], a[184:187], v[136:139]
  v_mfma_f32_16x16x32_bf16 v[136:139], a[116:119], a[188:191], v[136:139]
  buffer_load_dwordx4 v18, s[36:39], s49 offen offset:2048 nt lds
  v_mfma_f32_16x16x32_bf16 v[140:143], a[120:123], a[184:187], v[140:143]
  v_mfma_f32_16x16x32_bf16 v[140:143], a[124:127], a[188:191], v[140:143]
  v_xor_b32 v29, 0x10000, v29
  v_mfma_f32_16x16x32_bf16 v[144:147], a[128:131], a[184:187], v[144:147]
  ds_read_b128 a[220:223], v21 offset:14336
  v_mfma_f32_16x16x32_bf16 v[144:147], a[132:135], a[188:191], v[144:147]
  v_mfma_f32_16x16x32_bf16 v[148:151], a[136:139], a[184:187], v[148:151]
  v_mfma_f32_16x16x32_bf16 v[148:151], a[140:143], a[188:191], v[148:151]
  buffer_load_dwordx4 v19, s[36:39], s49 offen offset:3072 nt lds
  v_mfma_f32_16x16x32_bf16 v[152:155], a[144:147], a[184:187], v[152:155]
  v_mfma_f32_16x16x32_bf16 v[152:155], a[148:151], a[188:191], v[152:155]
  s_add_u32 s49, s49, 524288
  v_mfma_f32_16x16x32_bf16 v[156:159], a[152:155], a[184:187], v[156:159]
  v_mfma_f32_16x16x32_bf16 v[156:159], a[156:159], a[188:191], v[156:159]
  s_waitcnt vmcnt(17) lgkmcnt(0)
  s_barrier
  v_mfma_f32_16x16x32_bf16 v[160:163], a[96:99], a[192:195], v[160:163]
  s_add_u32 s53, s52, s51
  s_add_u32 s52, s52, 0x10000
  v_mfma_f32_16x16x32_bf16 v[160:163], a[100:103], a[196:199], v[160:163]
  s_cmp_eq_u32 s52, 0x30000
  s_cselect_b32 s52, 0, s52
  v_mfma_f32_16x16x32_bf16 v[164:167], a[104:107], a[192:195], v[164:167]
  ds_read_b64_tr_b16 a[32:33], v22 offset:0
  v_mfma_f32_16x16x32_bf16 v[164:167], a[108:111], a[196:199], v[164:167]
  ds_read_b64_tr_b16 a[34:35], v22 offset:1024
  v_mfma_f32_16x16x32_bf16 v[168:171], a[112:115], a[192:195], v[168:171]
  ds_read_b64_tr_b16 a[36:37], v22 offset:8192
  v_mfma_f32_16x16x32_bf16 v[168:171], a[116:119], a[196:199], v[168:171]
  v_add_u32 v20, s52, v30
  v_add_u32 v21, s52, v31
  s_mov_b32 m0, s53
  v_mfma_f32_16x16x32_bf16 v[172:175], a[120:123], a[192:195], v[172:175]
  ds_read_b64_tr_b16 a[38:39], v22 offset:9216
  v_mfma_f32_16x16x32_bf16 v[172:175], a[124:127], a[196:199], v[172:175]
  ds_read_b128 a[160:163], v20 offset:0
  v_mfma_f32_16x16x32_bf16 v[176:179], a[128:131], a[192:195], v[176:179]
  ds_read_b64_tr_b16 a[40:41], v23 offset:0
  v_mfma_f32_16x16x32_bf16 v[176:179], a[132:135], a[196:199], v[176:179]
  buffer_load_dwordx4 v4, s[32:35], s48 offen offset:0 lds
  v_mfma_f32_16x16x32_bf16 v[180:183], a[136:139], a[192:195], v[180:183]
  ds_read_b64_tr_b16 a[42:43], v23 offset:1024
  v_mfma_f32_16x16x32_bf16 v[180:183], a[140:143], a[196:199], v[180:183]
  ds_read_b64_tr_b16 a[44:45], v23 offset:8192
  v_mfma_f32_16x16x32_bf16 v[184:187], a[144:147], a[192:195], v[184:187]
  ds_read_b64_tr_b16 a[46:47], v23 offset:9216
  v_mfma_f32_16x16x32_bf16 v[184:187], a[148:151], a[196:199], v[184:187]
  buffer_load_dwordx4 v5, s[32:35], s48 offen offset:1024 lds
  v_mfma_f32_16x16x32_bf16 v[188:191], a[152:155], a[192:195], v[188:191]
  ds_read_b128 a[164:167], v21 offset:0
  v_mfma_f32_16x16x32_bf16 v[188:191], a[156:159], a[196:199], v[188:191]
  v_mfma_f32_16x16x32_bf16 v[192:195], a[96:99], a[200:203], v[192:195]
  v_mfma_f32_16x16x32_bf16 v[192:195], a[100:103], a[204:207], v[192:195]
  v_mfma_f32_16x16x32_bf16 v[196:199], a[104:107], a[200:203], v[196:199]
  ds_read_b64_tr_b16 a[48:49], v24 offset:0
  v_mfma_f32_16x16x32_bf16 v[196:199], a[108:111], a[204:207], v[196:199]
  ds_read_b64_tr_b16 a[50:51], v24 offset:1024
  v_mfma_f32_16x16x32_bf16 v[200:203], a[112:115], a[200:203], v[200:203]
  ds_read_b64_tr_b16 a[52:53], v24 offset:8192
  v_mfma_f32_16x16x32_bf16 v[200:203], a[116:119], a[204:207], v[200:203]
  buffer_load_dwordx4 v6, s[32:35], s48 offen offset:2048 lds
  v_mfma_f32_16x16x32_bf16 v[204:207], a[120:123], a[200:203], v[204:207]
  ds_read_b64_tr_b16 a[54:55], v24 offset:9216
  v_mfma_f32_16x16x32_bf16 v[204:207], a[124:127], a[204:207], v[204:207]
  ds_read_b128 a[168:171], v20 offset:2048
  v_mfma_f32_16x16x32_bf16 v[208:211], a[128:131], a[200:203], v[208:211]
  ds_read_b64_tr_b16 a[56:57], v25 offset:0
  v_mfma_f32_16x16x32_bf16 v[208:211], a[132:135], a[204:207], v[208:211]
  v_mfma_f32_16x16x32_bf16 v[212:215], a[136:139], a[200:203], v[212:215]
  ds_read_b64_tr_b16 a[58:59], v25 offset:1024
  v_mfma_f32_16x16x32_bf16 v[212:215], a[140:143], a[204:207], v[212:215]
  ds_read_b64_tr_b16 a[60:61], v25 offset:8192
  v_mfma_f32_16x16x32_bf16 v[216:219], a[144:147], a[200:203], v[216:219]
  ds_read_b64_tr_b16 a[62:63], v25 offset:9216
  v_mfma_f32_16x16x32_bf16 v[216:219], a[148:151], a[204:207], v[216:219]
  buffer_load_dwordx4 v7, s[32:35], s48 offen offset:3072 lds
  v_mfma_f32_16x16x32_bf16 v[220:223], a[152:155], a[200:203], v[220:223]
  ds_read_b128 a[172:175], v21 offset:2048
  v_mfma_f32_16x16x32_bf16 v[220:223], a[156:159], a[204:207], v[220:223]
  v_mfma_f32_16x16x32_bf16 v[224:227], a[96:99], a[208:211], v[224:227]
  v_mfma_f32_16x16x32_bf16 v[224:227], a[100:103], a[212:215], v[224:227]
  v_mfma_f32_16x16x32_bf16 v[228:231], a[104:107], a[208:211], v[228:231]
  ds_read_b64_tr_b16 a[64:65], v26 offset:0
  v_mfma_f32_16x16x32_bf16 v[228:231], a[108:111], a[212:215], v[228:231]
  ds_read_b64_tr_b16 a[66:67], v26 offset:1024
  v_mfma_f32_16x16x32_bf16 v[232:235], a[112:115], a[208:211], v[232:235]
  ds_read_b64_tr_b16 a[68:69], v26 offset:8192
  s_add_u32 m0, s53, 4096
  v_mfma_f32_16x16x32_bf16 v[232:235], a[116:119], a[212:215], v[232:235]
  buffer_load_dwordx4 v8, s[32:35], s48 offen offset:0 lds
  v_mfma_f32_16x16x32_bf16 v[236:239], a[120:123], a[208:211], v[236:239]
  ds_read_b64_tr_b16 a[70:71], v26 offset:9216
  v_mfma_f32_16x16x32_bf16 v[236:239], a[124:127], a[212:215], v[236:239]
  ds_read_b128 a[176:179], v20 offset:4096
  v_mfma_f32_16x16x32_bf16 v[240:243], a[128:131], a[208:211], v[240:243]
  ds_read_b64_tr_b16 a[72:73], v27 offset:0
  v_mfma_f32_16x16x32_bf16 v[240:243], a[132:135], a[212:215], v[240:243]
  v_mfma_f32_16x16x32_bf16 v[244:247], a[136:139], a[208:211], v[244:247]
  ds_read_b64_tr_b16 a[74:75], v27 offset:1024
  v_mfma_f32_16x16x32_bf16 v[244:247], a[140:143], a[212:215], v[244:247]
  ds_read_b64_tr_b16 a[76:77], v27 offset:8192
  v_mfma_f32_16x16x32_bf16 v[248:251], a[144:147], a[208:211], v[248:251]
  ds_read_b64_tr_b16 a[78:79], v27 offset:9216
  v_mfma_f32_16x16x32_bf16 v[248:251], a[148:151], a[212:215], v[248:251]
  buffer_load_dwordx4 v9, s[32:35], s48 offen offset:1024 lds
  v_mfma_f32_16x16x32_bf16 v[252:255], a[152:155], a[208:211], v[252:255]
  ds_read_b128 a[180:183], v21 offset:4096
  v_mfma_f32_16x16x32_bf16 v[252:255], a[156:159], a[212:215], v[252:255]
  v_mfma_f32_16x16x32_bf16 a[0:3], a[96:99], a[216:219], a[0:3]
  v_mfma_f32_16x16x32_bf16 a[0:3], a[100:103], a[220:223], a[0:3]
  v_mfma_f32_16x16x32_bf16 a[4:7], a[104:107], a[216:219], a[4:7]
  ds_read_b64_tr_b16 a[80:81], v28 offset:0
  v_mfma_f32_16x16x32_bf16 a[4:7], a[108:111], a[220:223], a[4:7]
  ds_read_b64_tr_b16 a[82:83], v28 offset:1024
  v_mfma_f32_16x16x32_bf16 a[8:11], a[112:115], a[216:219], a[8:11]
  ds_read_b64_tr_b16 a[84:85], v28 offset:8192
  v_mfma_f32_16x16x32_bf16 a[8:11], a[116:119], a[220:223], a[8:11]
  buffer_load_dwordx4 v10, s[32:35], s48 offen offset:2048 lds
  v_mfma_f32_16x16x32_bf16 a[12:15], a[120:123], a[216:219], a[12:15]
  ds_read_b64_tr_b16 a[86:87], v28 offset:9216
  v_mfma_f32_16x16x32_bf16 a[12:15], a[124:127], a[220:223], a[12:15]
  ds_read_b128 a[184:187], v20 offset:6144
  v_mfma_f32_16x16x32_bf16 a[16:19], a[128:131], a[216:219], a[16:19]
  ds_read_b64_tr_b16 a[88:89], v29 offset:0
  v_mfma_f32_16x16x32_bf16 a[16:19], a[132:135], a[220:223], a[16:19]
  v_mfma_f32_16x16x32_bf16 a[20:23], a[136:139], a[216:219], a[20:23]
  ds_read_b64_tr_b16 a[90:91], v29 offset:1024
  v_mfma_f32_16x16x32_bf16 a[20:23], a[140:143], a[220:223], a[20:23]
  ds_read_b64_tr_b16 a[92:93], v29 offset:8192
  v_mfma_f32_16x16x32_bf16 a[24:27], a[144:147], a[216:219], a[24:27]
  ds_read_b64_tr_b16 a[94:95], v29 offset:9216
  v_mfma_f32_16x16x32_bf16 a[24:27], a[148:151], a[220:223], a[24:27]
  buffer_load_dwordx4 v11, s[32:35], s48 offen offset:3072 lds
  v_mfma_f32_16x16x32_bf16 a[28:31], a[152:155], a[216:219], a[28:31]
  ds_read_b128 a[188:191], v21 offset:6144
  s_add_u32 s92, s92, 896
  v_mfma_f32_16x16x32_bf16 a[28:31], a[156:159], a[220:223], a[28:31]
  s_add_u32 s48, s48, 128
  buffer_load_dword a249, v2, s[96:99], s93 offen
  s_waitcnt lgkmcnt(4)
  v_mfma_f32_16x16x32_bf16 v[32:35], a[32:35], a[160:163], v[32:35]
  v_mfma_f32_16x16x32_bf16 v[32:35], a[36:39], a[164:167], v[32:35]
  v_mfma_f32_16x16x32_bf16 v[36:39], a[40:43], a[160:163], v[36:39]
  v_mfma_f32_16x16x32_bf16 v[36:39], a[44:47], a[164:167], v[36:39]
  v_mfma_f32_16x16x32_bf16 v[40:43], a[48:51], a[160:163], v[40:43]
  v_mfma_f32_16x16x32_bf16 v[40:43], a[52:55], a[164:167], v[40:43]
  v_mfma_f32_16x16x32_bf16 v[44:47], a[56:59], a[160:163], v[44:47]
  s_waitcnt lgkmcnt(0)
  s_barrier
  v_mfma_f32_16x16x32_bf16 v[44:47], a[60:63], a[164:167], v[44:47]
  v_mfma_f32_16x16x32_bf16 v[48:51], a[64:67], a[160:163], v[48:51]
  ds_read_b128 a[192:195], v20 offset:8192
  v_mfma_f32_16x16x32_bf16 v[48:51], a[68:71], a[164:167], v[48:51]
  s_add_u32 m0, s51, 32768
  v_mfma_f32_16x16x32_bf16 v[52:55], a[72:75], a[160:163], v[52:55]
  buffer_load_dwordx4 v12, s[36:39], s49 offen offset:0 nt lds
  v_mfma_f32_16x16x32_bf16 v[52:55], a[76:79], a[164:167], v[52:55]
  v_mfma_f32_16x16x32_bf16 v[56:59], a[80:83], a[160:163], v[56:59]
  ds_read_b128 a[196:199], v21 offset:8192
  v_mfma_f32_16x16x32_bf16 v[56:59], a[84:87], a[164:167], v[56:59]
  v_mfma_f32_16x16x32_bf16 v[60:63], a[88:91], a[160:163], v[60:63]
  buffer_load_dwordx4 v13, s[36:39], s49 offen offset:1024 nt lds
  v_mfma_f32_16x16x32_bf16 v[60:63], a[92:95], a[164:167], v[60:63]
  v_mfma_f32_16x16x32_bf16 v[64:67], a[32:35], a[168:171], v[64:67]
  v_mfma_f32_16x16x32_bf16 v[64:67], a[36:39], a[172:175], v[64:67]
  v_mfma_f32_16x16x32_bf16 v[68:71], a[40:43], a[168:171], v[68:71]
  ds_read_b128 a[200:203], v20 offset:10240
  v_mfma_f32_16x16x32_bf16 v[68:71], a[44:47], a[172:175], v[68:71]
  v_mfma_f32_16x16x32_bf16 v[72:75], a[48:51], a[168:171], v[72:75]
  s_add_u32 s93, s93, 16384
  v_mfma_f32_16x16x32_bf16 v[72:75], a[52:55], a[172:175], v[72:75]
  buffer_load_dwordx4 v14, s[36:39], s49 offen offset:2048 nt lds
  v_mfma_f32_16x16x32_bf16 v[76:79], a[56:59], a[168:171], v[76:79]
  v_mfma_f32_16x16x32_bf16 v[76:79], a[60:63], a[172:175], v[76:79]
  v_mfma_f32_16x16x32_bf16 v[80:83], a[64:67], a[168:171], v[80:83]
  ds_read_b128 a[204:207], v21 offset:10240
  v_mfma_f32_16x16x32_bf16 v[80:83], a[68:71], a[172:175], v[80:83]
  v_mfma_f32_16x16x32_bf16 v[84:87], a[72:75], a[168:171], v[84:87]
  v_mfma_f32_16x16x32_bf16 v[84:87], a[76:79], a[172:175], v[84:87]
  buffer_load_dwordx4 v15, s[36:39], s49 offen offset:3072 nt lds
  v_mfma_f32_16x16x32_bf16 v[88:91], a[80:83], a[168:171], v[88:91]
  v_mfma_f32_16x16x32_bf16 v[88:91], a[84:87], a[172:175], v[88:91]
  v_mfma_f32_16x16x32_bf16 v[92:95], a[88:91], a[168:171], v[92:95]
  v_mfma_f32_16x16x32_bf16 v[92:95], a[92:95], a[172:175], v[92:95]
  v_mfma_f32_16x16x32_bf16 v[96:99], a[32:35], a[176:179], v[96:99]
  v_mfma_f32_16x16x32_bf16 v[96:99], a[36:39], a[180:183], v[96:99]
  v_xor_b32 v22, 0x10000, v22
  v_mfma_f32_16x16x32_bf16 v[100:103], a[40:43], a[176:179], v[100:103]
  ds_read_b128 a[208:211], v20 offset:12288
  v_mfma_f32_16x16x32_bf16 v[100:103], a[44:47], a[180:183], v[100:103]
  v_xor_b32 v23, 0x10000, v23
  v_mfma_f32_16x16x32_bf16 v[104:107], a[48:51], a[176:179], v[104:107]
  s_add_u32 m0, s51, 36864
  v_mfma_f32_16x16x32_bf16 v[104:107], a[52:55], a[180:183], v[104:107]
  buffer_load_dwordx4 v16, s[36:39], s49 offen offset:0 nt lds
  v_mfma_f32_16x16x32_bf16 v[108:111], a[56:59], a[176:179], v[108:111]
  v_mfma_f32_16x16x32_bf16 v[108:111], a[60:63], a[180:183], v[108:111]
  v_xor_b32 v24, 0x10000, v24
  v_mfma_f32_16x16x32_bf16 v[112:115], a[64:67], a[176:179], v[112:115]
  ds_read_b128 a[212:215], v21 offset:12288
  v_mfma_f32_16x16x32_bf16 v[112:115], a[68:71], a[180:183], v[112:115]
  v_xor_b32 v25, 0x10000, v25
  v_mfma_f32_16x16x32_bf16 v[116:119], a[72:75], a[176:179], v[116:119]
  v_mfma_f32_16x16x32_bf16 v[116:119], a[76:79], a[180:183], v[116:119]
  buffer_load_dwordx4 v17, s[36:39], s49 offen offset:1024 nt lds
  v_mfma_f32_16x16x32_bf16 v[120:123], a[80:83], a[176:179], v[120:123]
  v_mfma_f32_16x16x32_bf16 v[120:123], a[84:87], a[180:183], v[120:123]
  v_xor_b32 v26, 0x10000, v26
  v_mfma_f32_16x16x32_bf16 v[124:127], a[88:91], a[176:179], v[124:127]
  v_mfma_f32_16x16x32_bf16 v[124:127], a[92:95], a[180:183], v[124:127]
  v_xor_b32 v27, 0x10000, v27
  v_mfma_f32_16x16x32_bf16 v[128:131], a[32:35], a[184:187], v[128:131]
  v_mfma_f32_16x16x32_bf16 v[128:131], a[36:39], a[188:191], v[128:131]
  v_mfma_f32_16x16x32_bf16 v[132:135], a[40:43], a[184:187], v[132:135]
  ds_read_b128 a[216:219], v20 offset:14336
  v_mfma_f32_16x16x32_bf16 v[132:135], a[44:47], a[188:191], v[132:135]
  v_xor_b32 v28, 0x10000, v28
  v_mfma_f32_16x16x32_bf16 v[136:139], a[48:51], a[184:187], v[136:139]
  v_mfma_f32_16x16x32_bf16 v[136:139], a[52:55], a[188:191], v[136:139]
  buffer_load_dwordx4 v18, s[36:39], s49 offen offset:2048 nt lds
  v_mfma_f32_16x16x32_bf16 v[140:143], a[56:59], a[184:187], v[140:143]
  v_mfma_f32_16x16x32_bf16 v[140:143], a[60:63], a[188:191], v[140:143]
  v_xor_b32 v29, 0x10000, v29
  v_mfma_f32_16x16x32_bf16 v[144:147], a[64:67], a[184:187], v[144:147]
  ds_read_b128 a[220:223], v21 offset:14336
  v_mfma_f32_16x16x32_bf16 v[144:147], a[68:71], a[188:191], v[144:147]
  v_mfma_f32_16x16x32_bf16 v[148:151], a[72:75], a[184:187], v[148:151]
  v_mfma_f32_16x16x32_bf16 v[148:151], a[76:79], a[188:191], v[148:151]
  buffer_load_dwordx4 v19, s[36:39], s49 offen offset:3072 nt lds
  v_mfma_f32_16x16x32_bf16 v[152:155], a[80:83], a[184:187], v[152:155]
  v_mfma_f32_16x16x32_bf16 v[152:155], a[84:87], a[188:191], v[152:155]
  s_add_u32 s49, s49, 524288
  v_mfma_f32_16x16x32_bf16 v[156:159], a[88:91], a[184:187], v[156:159]
  v_mfma_f32_16x16x32_bf16 v[156:159], a[92:95], a[188:191], v[156:159]
  s_waitcnt vmcnt(17) lgkmcnt(0)
  s_barrier
  v_mfma_f32_16x16x32_bf16 v[160:163], a[32:35], a[192:195], v[160:163]
  s_add_u32 s53, s52, s51
  s_add_u32 s52, s52, 0x10000
  v_mfma_f32_16x16x32_bf16 v[160:163], a[36:39], a[196:199], v[160:163]
  s_cmp_eq_u32 s52, 0x30000
  s_cselect_b32 s52, 0, s52
  v_mfma_f32_16x16x32_bf16 v[164:167], a[40:43], a[192:195], v[164:167]
  ds_read_b64_tr_b16 a[96:97], v22 offset:0
  v_mfma_f32_16x16x32_bf16 v[164:167], a[44:47], a[196:199], v[164:167]
  ds_read_b64_tr_b16 a[98:99], v22 offset:1024
  v_mfma_f32_16x16x32_bf16 v[168:171], a[48:51], a[192:195], v[168:171]
  ds_read_b64_tr_b16 a[100:101], v22 offset:8192
  v_mfma_f32_16x16x32_bf16 v[168:171], a[52:55], a[196:199], v[168:171]
  v_add_u32 v20, s52, v30
  v_add_u32 v21, s52, v31
  s_mov_b32 m0, s53
  v_mfma_f32_16x16x32_bf16 v[172:175], a[56:59], a[192:195], v[172:175]
  ds_read_b64_tr_b16 a[102:103], v22 offset:9216
  v_mfma_f32_16x16x32_bf16 v[172:175], a[60:63], a[196:199], v[172:175]
  ds_read_b128 a[160:163], v20 offset:0
  v_mfma_f32_16x16x32_bf16 v[176:179], a[64:67], a[192:195], v[176:179]
  ds_read_b64_tr_b16 a[104:105], v23 offset:0
  v_mfma_f32_16x16x32_bf16 v[176:179], a[68:71], a[196:199], v[176:179]
  buffer_load_dwordx4 v4, s[32:35], s48 offen offset:0 lds
  v_mfma_f32_16x16x32_bf16 v[180:183], a[72:75], a[192:195], v[180:183]
  ds_read_b64_tr_b16 a[106:107], v23 offset:1024
  v_mfma_f32_16x16x32_bf16 v[180:183], a[76:79], a[196:199], v[180:183]
  ds_read_b64_tr_b16 a[108:109], v23 offset:8192
  v_mfma_f32_16x16x32_bf16 v[184:187], a[80:83], a[192:195], v[184:187]
  ds_read_b64_tr_b16 a[110:111], v23 offset:9216
  v_mfma_f32_16x16x32_bf16 v[184:187], a[84:87], a[196:199], v[184:187]
  buffer_load_dwordx4 v5, s[32:35], s48 offen offset:1024 lds
  v_mfma_f32_16x16x32_bf16 v[188:191], a[88:91], a[192:195], v[188:191]
  ds_read_b128 a[164:167], v21 offset:0
  v_mfma_f32_16x16x32_bf16 v[188:191], a[92:95], a[196:199], v[188:191]
  v_mfma_f32_16x16x32_bf16 v[192:195], a[32:35], a[200:203], v[192:195]
  v_mfma_f32_16x16x32_bf16 v[192:195], a[36:39], a[204:207], v[192:195]
  v_mfma_f32_16x16x32_bf16 v[196:199], a[40:43], a[200:203], v[196:199]
  ds_read_b64_tr_b16 a[112:113], v24 offset:0
  v_mfma_f32_16x16x32_bf16 v[196:199], a[44:47], a[204:207], v[196:199]
  ds_read_b64_tr_b16 a[114:115], v24 offset:1024
  v_mfma_f32_16x16x32_bf16 v[200:203], a[48:51], a[200:203], v[200:203]
  ds_read_b64_tr_b16 a[116:117], v24 offset:8192
  v_mfma_f32_16x16x32_bf16 v[200:203], a[52:55], a[204:207], v[200:203]
  buffer_load_dwordx4 v6, s[32:35], s48 offen offset:2048 lds
  v_mfma_f32_16x16x32_bf16 v[204:207], a[56:59], a[200:203], v[204:207]
  ds_read_b64_tr_b16 a[118:119], v24 offset:9216
  v_mfma_f32_16x16x32_bf16 v[204:207], a[60:63], a[204:207], v[204:207]
  ds_read_b128 a[168:171], v20 offset:2048
  v_mfma_f32_16x16x32_bf16 v[208:211], a[64:67], a[200:203], v[208:211]
  ds_read_b64_tr_b16 a[120:121], v25 offset:0
  v_mfma_f32_16x16x32_bf16 v[208:211], a[68:71], a[204:207], v[208:211]
  v_mfma_f32_16x16x32_bf16 v[212:215], a[72:75], a[200:203], v[212:215]
  ds_read_b64_tr_b16 a[122:123], v25 offset:1024
  v_mfma_f32_16x16x32_bf16 v[212:215], a[76:79], a[204:207], v[212:215]
  ds_read_b64_tr_b16 a[124:125], v25 offset:8192
  v_mfma_f32_16x16x32_bf16 v[216:219], a[80:83], a[200:203], v[216:219]
  ds_read_b64_tr_b16 a[126:127], v25 offset:9216
  v_mfma_f32_16x16x32_bf16 v[216:219], a[84:87], a[204:207], v[216:219]
  buffer_load_dwordx4 v7, s[32:35], s48 offen offset:3072 lds
  v_mfma_f32_16x16x32_bf16 v[220:223], a[88:91], a[200:203], v[220:223]
  ds_read_b128 a[172:175], v21 offset:2048
  v_mfma_f32_16x16x32_bf16 v[220:223], a[92:95], a[204:207], v[220:223]
  v_mfma_f32_16x16x32_bf16 v[224:227], a[32:35], a[208:211], v[224:227]
  v_mfma_f32_16x16x32_bf16 v[224:227], a[36:39], a[212:215], v[224:227]
  v_mfma_f32_16x16x32_bf16 v[228:231], a[40:43], a[208:211], v[228:231]
  ds_read_b64_tr_b16 a[128:129], v26 offset:0
  v_mfma_f32_16x16x32_bf16 v[228:231], a[44:47], a[212:215], v[228:231]
  ds_read_b64_tr_b16 a[130:131], v26 offset:1024
  v_mfma_f32_16x16x32_bf16 v[232:235], a[48:51], a[208:211], v[232:235]
  ds_read_b64_tr_b16 a[132:133], v26 offset:8192
  s_add_u32 m0, s53, 4096
  v_mfma_f32_16x16x32_bf16 v[232:235], a[52:55], a[212:215], v[232:235]
  buffer_load_dwordx4 v8, s[32:35], s48 offen offset:0 lds
  v_mfma_f32_16x16x32_bf16 v[236:239], a[56:59], a[208:211], v[236:239]
  ds_read_b64_tr_b16 a[134:135], v26 offset:9216
  v_mfma_f32_16x16x32_bf16 v[236:239], a[60:63], a[212:215], v[236:239]
  ds_read_b128 a[176:179], v20 offset:4096
  v_mfma_f32_16x16x32_bf16 v[240:243], a[64:67], a[208:211], v[240:243]
  ds_read_b64_tr_b16 a[136:137], v27 offset:0
  v_mfma_f32_16x16x32_bf16 v[240:243], a[68:71], a[212:215], v[240:243]
  v_mfma_f32_16x16x32_bf16 v[244:247], a[72:75], a[208:211], v[244:247]
  ds_read_b64_tr_b16 a[138:139], v27 offset:1024
  v_mfma_f32_16x16x32_bf16 v[244:247], a[76:79], a[212:215], v[244:247]
  ds_read_b64_tr_b16 a[140:141], v27 offset:8192
  v_mfma_f32_16x16x32_bf16 v[248:251], a[80:83], a[208:211], v[248:251]
  ds_read_b64_tr_b16 a[142:143], v27 offset:9216
  v_mfma_f32_16x16x32_bf16 v[248:251], a[84:87], a[212:215], v[248:251]
  buffer_load_dwordx4 v9, s[32:35], s48 offen offset:1024 lds
  v_mfma_f32_16x16x32_bf16 v[252:255], a[88:91], a[208:211], v[252:255]
  ds_read_b128 a[180:183], v21 offset:4096
  v_mfma_f32_16x16x32_bf16 v[252:255], a[92:95], a[212:215], v[252:255]
  v_mfma_f32_16x16x32_bf16 a[0:3], a[32:35], a[216:219], a[0:3]
  v_mfma_f32_16x16x32_bf16 a[0:3], a[36:39], a[220:223], a[0:3]
  v_mfma_f32_16x16x32_bf16 a[4:7], a[40:43], a[216:219], a[4:7]
  ds_read_b64_tr_b16 a[144:145], v28 offset:0
  v_mfma_f32_16x16x32_bf16 a[4:7], a[44:47], a[220:223], a[4:7]
  ds_read_b64_tr_b16 a[146:147], v28 offset:1024
  v_mfma_f32_16x16x32_bf16 a[8:11], a[48:51], a[216:219], a[8:11]
  ds_read_b64_tr_b16 a[148:149], v28 offset:8192
  v_mfma_f32_16x16x32_bf16 a[8:11], a[52:55], a[220:223], a[8:11]
  buffer_load_dwordx4 v10, s[32:35], s48 offen offset:2048 lds
  v_mfma_f32_16x16x32_bf16 a[12:15], a[56:59], a[216:219], a[12:15]
  ds_read_b64_tr_b16 a[150:151], v28 offset:9216
  v_mfma_f32_16x16x32_bf16 a[12:15], a[60:63], a[220:223], a[12:15]
  ds_read_b128 a[184:187], v20 offset:6144
  v_mfma_f32_16x16x32_bf16 a[16:19], a[64:67], a[216:219], a[16:19]
  ds_read_b64_tr_b16 a[152:153], v29 offset:0
  v_mfma_f32_16x16x32_bf16 a[16:19], a[68:71], a[220:223], a[16:19]
  v_mfma_f32_16x16x32_bf16 a[20:23], a[72:75], a[216:219], a[20:23]
  ds_read_b64_tr_b16 a[154:155], v29 offset:1024
  v_mfma_f32_16x16x32_bf16 a[20:23], a[76:79], a[220:223], a[20:23]
  ds_read_b64_tr_b16 a[156:157], v29 offset:8192
  v_mfma_f32_16x16x32_bf16 a[24:27], a[80:83], a[216:219], a[24:27]
  ds_read_b64_tr_b16 a[158:159], v29 offset:9216
  v_mfma_f32_16x16x32_bf16 a[24:27], a[84:87], a[220:223], a[24:27]
  buffer_load_dwordx4 v11, s[32:35], s48 offen offset:3072 lds
  v_mfma_f32_16x16x32_bf16 a[28:31], a[88:91], a[216:219], a[28:31]
  ds_read_b128 a[188:191], v21 offset:6144
  v_mfma_f32_16x16x32_bf16 a[28:31], a[92:95], a[220:223], a[28:31]
  s_add_u32 s48, s48, 128
  buffer_load_dword a248, v0, s[44:47], s92 offen
  s_sub_u32 s50, s50, 1
  s_cmp_lg_u32 s50, 0
  s_cbranch_scc1 LKV_K
  s_waitcnt lgkmcnt(3)
  v_mfma_f32_16x16x32_bf16 v[32:35], a[96:99], a[160:163], v[32:35]
  v_mfma_f32_16x16x32_bf16 v[32:35], a[100:103], a[164:167], v[32:35]
  v_mfma_f32_16x16x32_bf16 v[36:39], a[104:107], a[160:163], v[36:39]
  v_mfma_f32_16x16x32_bf16 v[36:39], a[108:111], a[164:167], v[36:39]
  v_mfma_f32_16x16x32_bf16 v[40:43], a[112:115], a[160:163], v[40:43]
  v_mfma_f32_16x16x32_bf16 v[40:43], a[116:119], a[164:167], v[40:43]
  v_mfma_f32_16x16x32_bf16 v[44:47], a[120:123], a[160:163], v[44:47]
  s_waitcnt lgkmcnt(0)
  s_barrier
  v_mfma_f32_16x16x32_bf16 v[44:47], a[124:127], a[164:167], v[44:47]
  v_mfma_f32_16x16x32_bf16 v[48:51], a[128:131], a[160:163], v[48:51]
  ds_read_b128 a[192:195], v20 offset:8192
  s_mov_b32 s40, s14
  s_mov_b32 s41, s15
  v_mfma_f32_16x16x32_bf16 v[48:51], a[132:135], a[164:167], v[48:51]
  s_add_u32 m0, s51, 98304
  s_mov_b32 s42, 5242880
  v_mfma_f32_16x16x32_bf16 v[52:55], a[136:139], a[160:163], v[52:55]
  buffer_load_dwordx4 v12, s[36:39], s49 offen offset:0 nt lds
  s_mov_b32 s43, 0x20000
  v_mfma_f32_16x16x32_bf16 v[52:55], a[140:143], a[164:167], v[52:55]
  s_mul_i32 s54, s28, 320
  v_mfma_f32_16x16x32_bf16 v[56:59], a[144:147], a[160:163], v[56:59]
  ds_read_b128 a[196:199], v21 offset:8192
  v_add_u32 v3, s54, v1
  v_mfma_f32_16x16x32_bf16 v[56:59], a[148:151], a[164:167], v[56:59]
  v_add_u32 v3, 0, v3
  v_mul_u32_u24 v4, 1639, v3
  v_mfma_f32_16x16x32_bf16 v[60:63], a[152:155], a[160:163], v[60:63]
  buffer_load_dwordx4 v13, s[36:39], s49 offen offset:1024 nt lds
  v_lshrrev_b32 v4, 16, v4
  v_mfma_f32_16x16x32_bf16 v[60:63], a[156:159], a[164:167], v[60:63]
  v_mul_u32_u24 v4, 640, v4
  v_mfma_f32_16x16x32_bf16 v[64:67], a[96:99], a[168:171], v[64:67]
  v_lshl_add_u32 v4, v3, 4, v4
  v_mfma_f32_16x16x32_bf16 v[64:67], a[100:103], a[172:175], v[64:67]
  v_add_u32 v3, s54, v1
  v_mfma_f32_16x16x32_bf16 v[68:71], a[104:107], a[168:171], v[68:71]
  ds_read_b128 a[200:203], v20 offset:10240
  v_add_u32 v3, 64, v3
  v_mul_u32_u24 v5, 1639, v3
  v_mfma_f32_16x16x32_bf16 v[68:71], a[108:111], a[172:175], v[68:71]
  v_lshrrev_b32 v5, 16, v5
  v_mfma_f32_16x16x32_bf16 v[72:75], a[112:115], a[168:171], v[72:75]
  v_mul_u32_u24 v5, 640, v5
  v_mfma_f32_16x16x32_bf16 v[72:75], a[116:119], a[172:175], v[72:75]
  buffer_load_dwordx4 v14, s[36:39], s49 offen offset:2048 nt lds
  v_lshl_add_u32 v5, v3, 4, v5
  v_mfma_f32_16x16x32_bf16 v[76:79], a[120:123], a[168:171], v[76:79]
  v_add_u32 v3, s54, v1
  v_mfma_f32_16x16x32_bf16 v[76:79], a[124:127], a[172:175], v[76:79]
  v_add_u32 v3, 128, v3
  v_mfma_f32_16x16x32_bf16 v[80:83], a[128:131], a[168:171], v[80:83]
  ds_read_b128 a[204:207], v21 offset:10240
  v_mul_u32_u24 v6, 1639, v3
  v_lshrrev_b32 v6, 16, v6
  v_mfma_f32_16x16x32_bf16 v[80:83], a[132:135], a[172:175], v[80:83]
  v_mul_u32_u24 v6, 640, v6
  v_mfma_f32_16x16x32_bf16 v[84:87], a[136:139], a[168:171], v[84:87]
  v_lshl_add_u32 v6, v3, 4, v6
  v_mfma_f32_16x16x32_bf16 v[84:87], a[140:143], a[172:175], v[84:87]
  buffer_load_dwordx4 v15, s[36:39], s49 offen offset:3072 nt lds
  v_add_u32 v3, s54, v1
  v_mfma_f32_16x16x32_bf16 v[88:91], a[144:147], a[168:171], v[88:91]
  v_add_u32 v3, 192, v3
  v_mfma_f32_16x16x32_bf16 v[88:91], a[148:151], a[172:175], v[88:91]
  v_mul_u32_u24 v7, 1639, v3
  v_lshrrev_b32 v7, 16, v7
  v_mfma_f32_16x16x32_bf16 v[92:95], a[152:155], a[168:171], v[92:95]
  v_mul_u32_u24 v7, 640, v7
  v_mfma_f32_16x16x32_bf16 v[92:95], a[156:159], a[172:175], v[92:95]
  v_lshl_add_u32 v7, v3, 4, v7
  v_mfma_f32_16x16x32_bf16 v[96:99], a[96:99], a[176:179], v[96:99]
  v_add_u32 v3, s54, v1
  v_mfma_f32_16x16x32_bf16 v[96:99], a[100:103], a[180:183], v[96:99]
  v_xor_b32 v22, 0x10000, v22
  v_add_u32 v3, 256, v3
  v_mfma_f32_16x16x32_bf16 v[100:103], a[104:107], a[176:179], v[100:103]
  ds_read_b128 a[208:211], v20 offset:12288
  v_mul_u32_u24 v8, 1639, v3
  v_mfma_f32_16x16x32_bf16 v[100:103], a[108:111], a[180:183], v[100:103]
  v_xor_b32 v23, 0x10000, v23
  v_lshrrev_b32 v8, 16, v8
  v_mul_u32_u24 v8, 640, v8
  v_mfma_f32_16x16x32_bf16 v[104:107], a[112:115], a[176:179], v[104:107]
  s_add_u32 m0, s51, 102400
  v_lshl_add_u32 v8, v3, 4, v8
  v_mfma_f32_16x16x32_bf16 v[104:107], a[116:119], a[180:183], v[104:107]
  buffer_load_dwordx4 v16, s[36:39], s49 offen offset:0 nt lds
  s_mul_i32 s54, s28, 192
  v_mfma_f32_16x16x32_bf16 v[108:111], a[120:123], a[176:179], v[108:111]
  v_add_u32 v3, s54, v1
  v_mfma_f32_16x16x32_bf16 v[108:111], a[124:127], a[180:183], v[108:111]
  v_xor_b32 v24, 0x10000, v24
  v_add_u32 v3, 0, v3
  v_mfma_f32_16x16x32_bf16 v[112:115], a[128:131], a[176:179], v[112:115]
  ds_read_b128 a[212:215], v21 offset:12288
  v_mul_u32_u24 v9, 2731, v3
  v_lshrrev_b32 v9, 16, v9
  v_mfma_f32_16x16x32_bf16 v[112:115], a[132:135], a[180:183], v[112:115]
  v_xor_b32 v25, 0x10000, v25
  v_mul_u32_u24 v9, 3456, v9
  v_mfma_f32_16x16x32_bf16 v[116:119], a[136:139], a[176:179], v[116:119]
  v_lshl_add_u32 v9, v3, 4, v9
  v_mfma_f32_16x16x32_bf16 v[116:119], a[140:143], a[180:183], v[116:119]
  buffer_load_dwordx4 v17, s[36:39], s49 offen offset:1024 nt lds
  v_add_u32 v3, s54, v1
  v_mfma_f32_16x16x32_bf16 v[120:123], a[144:147], a[176:179], v[120:123]
  v_add_u32 v3, 64, v3
  v_mfma_f32_16x16x32_bf16 v[120:123], a[148:151], a[180:183], v[120:123]
  v_xor_b32 v26, 0x10000, v26
  v_mul_u32_u24 v10, 2731, v3
  v_lshrrev_b32 v10, 16, v10
  v_mfma_f32_16x16x32_bf16 v[124:127], a[152:155], a[176:179], v[124:127]
  v_mul_u32_u24 v10, 3456, v10
  v_mfma_f32_16x16x32_bf16 v[124:127], a[156:159], a[180:183], v[124:127]
  v_xor_b32 v27, 0x10000, v27
  v_lshl_add_u32 v10, v3, 4, v10
  v_mfma_f32_16x16x32_bf16 v[128:131], a[96:99], a[184:187], v[128:131]
  v_add_u32 v3, s54, v1
  v_mfma_f32_16x16x32_bf16 v[128:131], a[100:103], a[188:191], v[128:131]
  v_add_u32 v3, 128, v3
  v_mfma_f32_16x16x32_bf16 v[132:135], a[104:107], a[184:187], v[132:135]
  ds_read_b128 a[216:219], v20 offset:14336
  v_mul_u32_u24 v11, 2731, v3
  v_mfma_f32_16x16x32_bf16 v[132:135], a[108:111], a[188:191], v[132:135]
  v_xor_b32 v28, 0x10000, v28
  v_lshrrev_b32 v11, 16, v11
  v_mul_u32_u24 v11, 3456, v11
  v_mfma_f32_16x16x32_bf16 v[136:139], a[112:115], a[184:187], v[136:139]
  v_lshl_add_u32 v11, v3, 4, v11
  v_mfma_f32_16x16x32_bf16 v[136:139], a[116:119], a[188:191], v[136:139]
  buffer_load_dwordx4 v18, s[36:39], s49 offen offset:2048 nt lds
  s_and_b32 s54, s2, 1
  v_mfma_f32_16x16x32_bf16 v[140:143], a[120:123], a[184:187], v[140:143]
  s_lshr_b32 s55, s2, 1
  v_mfma_f32_16x16x32_bf16 v[140:143], a[124:127], a[188:191], v[140:143]
  v_xor_b32 v29, 0x10000, v29
  s_mul_i32 s95, s55, 40960
  v_mfma_f32_16x16x32_bf16 v[144:147], a[128:131], a[184:187], v[144:147]
  ds_read_b128 a[220:223], v21 offset:14336
  s_mul_i32 s54, s54, 640
  s_add_u32 s95, s95, s54
  v_mfma_f32_16x16x32_bf16 v[144:147], a[132:135], a[188:191], v[144:147]
  s_mul_i32 s55, s2, 205
  v_mfma_f32_16x16x32_bf16 v[148:151], a[136:139], a[184:187], v[148:151]
  s_lshr_b32 s55, s55, 11
  v_mfma_f32_16x16x32_bf16 v[148:151], a[140:143], a[188:191], v[148:151]
  buffer_load_dwordx4 v19, s[36:39], s49 offen offset:3072 nt lds
  s_mul_i32 s55, s55, 119040
  v_mfma_f32_16x16x32_bf16 v[152:155], a[144:147], a[184:187], v[152:155]
  s_mul_i32 s54, s2, 384
  v_mfma_f32_16x16x32_bf16 v[152:155], a[148:151], a[188:191], v[152:155]
  s_add_u32 s49, s49, 524288
  s_add_u32 s3, s55, s54
  v_mfma_f32_16x16x32_bf16 v[156:159], a[152:155], a[184:187], v[156:159]
  v_mfma_f32_16x16x32_bf16 v[156:159], a[156:159], a[188:191], v[156:159]
  s_waitcnt vmcnt(17) lgkmcnt(0)
  s_barrier
  v_mfma_f32_16x16x32_bf16 v[160:163], a[96:99], a[192:195], v[160:163]
  s_add_u32 s53, s52, s51
  s_add_u32 s52, s52, 0x10000
  v_mfma_f32_16x16x32_bf16 v[160:163], a[100:103], a[196:199], v[160:163]
  s_cmp_eq_u32 s52, 0x30000
  s_cselect_b32 s52, 0, s52
  buffer_load_dword v19, v2, s[96:99], s93 offen
  v_mfma_f32_16x16x32_bf16 v[164:167], a[104:107], a[192:195], v[164:167]
  ds_read_b64_tr_b16 a[32:33], v22 offset:0
  v_mfma_f32_16x16x32_bf16 v[164:167], a[108:111], a[196:199], v[164:167]
  ds_read_b64_tr_b16 a[34:35], v22 offset:1024
  v_mfma_f32_16x16x32_bf16 v[168:171], a[112:115], a[192:195], v[168:171]
  ds_read_b64_tr_b16 a[36:37], v22 offset:8192
  v_mfma_f32_16x16x32_bf16 v[168:171], a[116:119], a[196:199], v[168:171]
  v_add_u32 v20, s52, v30
  v_add_u32 v21, s52, v31
  buffer_load_dwordx4 a[224:227], v4, s[40:43], s95 offen nt
  v_mfma_f32_16x16x32_bf16 v[172:175], a[120:123], a[192:195], v[172:175]
  ds_read_b64_tr_b16 a[38:39], v22 offset:9216
  v_mfma_f32_16x16x32_bf16 v[172:175], a[124:127], a[196:199], v[172:175]
  ds_read_b128 a[160:163], v20 offset:0
  v_mfma_f32_16x16x32_bf16 v[176:179], a[128:131], a[192:195], v[176:179]
  ds_read_b64_tr_b16 a[40:41], v23 offset:0
  v_mfma_f32_16x16x32_bf16 v[176:179], a[132:135], a[196:199], v[176:179]
  buffer_load_dwordx4 a[228:231], v5, s[40:43], s95 offen nt
  v_mfma_f32_16x16x32_bf16 v[180:183], a[136:139], a[192:195], v[180:183]
  ds_read_b64_tr_b16 a[42:43], v23 offset:1024
  v_mfma_f32_16x16x32_bf16 v[180:183], a[140:143], a[196:199], v[180:183]
  ds_read_b64_tr_b16 a[44:45], v23 offset:8192
  v_mfma_f32_16x16x32_bf16 v[184:187], a[144:147], a[192:195], v[184:187]
  ds_read_b64_tr_b16 a[46:47], v23 offset:9216
  v_mfma_f32_16x16x32_bf16 v[184:187], a[148:151], a[196:199], v[184:187]
  buffer_load_dwordx4 a[232:235], v6, s[40:43], s95 offen nt
  v_mfma_f32_16x16x32_bf16 v[188:191], a[152:155], a[192:195], v[188:191]
  ds_read_b128 a[164:167], v21 offset:0
  v_mfma_f32_16x16x32_bf16 v[188:191], a[156:159], a[196:199], v[188:191]
  v_mfma_f32_16x16x32_bf16 v[192:195], a[96:99], a[200:203], v[192:195]
  v_mfma_f32_16x16x32_bf16 v[192:195], a[100:103], a[204:207], v[192:195]
  v_mfma_f32_16x16x32_bf16 v[196:199], a[104:107], a[200:203], v[196:199]
  ds_read_b64_tr_b16 a[48:49], v24 offset:0
  v_mfma_f32_16x16x32_bf16 v[196:199], a[108:111], a[204:207], v[196:199]
  ds_read_b64_tr_b16 a[50:51], v24 offset:1024
  v_mfma_f32_16x16x32_bf16 v[200:203], a[112:115], a[200:203], v[200:203]
  ds_read_b64_tr_b16 a[52:53], v24 offset:8192
  v_mfma_f32_16x16x32_bf16 v[200:203], a[116:119], a[204:207], v[200:203]
  buffer_load_dwordx4 a[236:239], v7, s[40:43], s95 offen nt
  v_mfma_f32_16x16x32_bf16 v[204:207], a[120:123], a[200:203], v[204:207]
  ds_read_b64_tr_b16 a[54:55], v24 offset:9216
  v_mfma_f32_16x16x32_bf16 v[204:207], a[124:127], a[204:207], v[204:207]
  ds_read_b128 a[168:171], v20 offset:2048
  v_mfma_f32_16x16x32_bf16 v[208:211], a[128:131], a[200:203], v[208:211]
  ds_read_b64_tr_b16 a[56:57], v25 offset:0
  v_mfma_f32_16x16x32_bf16 v[208:211], a[132:135], a[204:207], v[208:211]
  v_mfma_f32_16x16x32_bf16 v[212:215], a[136:139], a[200:203], v[212:215]
  ds_read_b64_tr_b16 a[58:59], v25 offset:1024
  v_mfma_f32_16x16x32_bf16 v[212:215], a[140:143], a[204:207], v[212:215]
  ds_read_b64_tr_b16 a[60:61], v25 offset:8192
  v_mfma_f32_16x16x32_bf16 v[216:219], a[144:147], a[200:203], v[216:219]
  ds_read_b64_tr_b16 a[62:63], v25 offset:9216
  v_mfma_f32_16x16x32_bf16 v[216:219], a[148:151], a[204:207], v[216:219]
  buffer_load_dwordx4 a[240:243], v8, s[40:43], s95 offen nt
  v_mfma_f32_16x16x32_bf16 v[220:223], a[152:155], a[200:203], v[220:223]
  ds_read_b128 a[172:175], v21 offset:2048
  v_mfma_f32_16x16x32_bf16 v[220:223], a[156:159], a[204:207], v[220:223]
  v_mfma_f32_16x16x32_bf16 v[224:227], a[96:99], a[208:211], v[224:227]
  v_mfma_f32_16x16x32_bf16 v[224:227], a[100:103], a[212:215], v[224:227]
  v_mfma_f32_16x16x32_bf16 v[228:231], a[104:107], a[208:211], v[228:231]
  ds_read_b64_tr_b16 a[64:65], v26 offset:0
  v_mfma_f32_16x16x32_bf16 v[228:231], a[108:111], a[212:215], v[228:231]
  ds_read_b64_tr_b16 a[66:67], v26 offset:1024
  v_mfma_f32_16x16x32_bf16 v[232:235], a[112:115], a[208:211], v[232:235]
  ds_read_b64_tr_b16 a[68:69], v26 offset:8192
  s_mov_b32 s40, s18
  s_mov_b32 s41, s19
  s_mov_b32 s42, 2457600
  v_mfma_f32_16x16x32_bf16 v[232:235], a[116:119], a[212:215], v[232:235]
  buffer_load_dwordx4 a[244:247], v9, s[40:43], s3 offen nt
  v_mfma_f32_16x16x32_bf16 v[236:239], a[120:123], a[208:211], v[236:239]
  ds_read_b64_tr_b16 a[70:71], v26 offset:9216
  v_mfma_f32_16x16x32_bf16 v[236:239], a[124:127], a[212:215], v[236:239]
  ds_read_b128 a[176:179], v20 offset:4096
  v_mfma_f32_16x16x32_bf16 v[240:243], a[128:131], a[208:211], v[240:243]
  ds_read_b64_tr_b16 a[72:73], v27 offset:0
  v_mfma_f32_16x16x32_bf16 v[240:243], a[132:135], a[212:215], v[240:243]
  v_mfma_f32_16x16x32_bf16 v[244:247], a[136:139], a[208:211], v[244:247]
  ds_read_b64_tr_b16 a[74:75], v27 offset:1024
  v_mfma_f32_16x16x32_bf16 v[244:247], a[140:143], a[212:215], v[244:247]
  ds_read_b64_tr_b16 a[76:77], v27 offset:8192
  v_mfma_f32_16x16x32_bf16 v[248:251], a[144:147], a[208:211], v[248:251]
  ds_read_b64_tr_b16 a[78:79], v27 offset:9216
  v_mfma_f32_16x16x32_bf16 v[248:251], a[148:151], a[212:215], v[248:251]
  buffer_load_dwordx4 a[248:251], v10, s[40:43], s3 offen nt
  v_mfma_f32_16x16x32_bf16 v[252:255], a[152:155], a[208:211], v[252:255]
  ds_read_b128 a[180:183], v21 offset:4096
  v_mfma_f32_16x16x32_bf16 v[252:255], a[156:159], a[212:215], v[252:255]
  v_mfma_f32_16x16x32_bf16 a[0:3], a[96:99], a[216:219], a[0:3]
  v_mfma_f32_16x16x32_bf16 a[0:3], a[100:103], a[220:223], a[0:3]
  v_mfma_f32_16x16x32_bf16 a[4:7], a[104:107], a[216:219], a[4:7]
  ds_read_b64_tr_b16 a[80:81], v28 offset:0
  v_mfma_f32_16x16x32_bf16 a[4:7], a[108:111], a[220:223], a[4:7]
  ds_read_b64_tr_b16 a[82:83], v28 offset:1024
  v_mfma_f32_16x16x32_bf16 a[8:11], a[112:115], a[216:219], a[8:11]
  ds_read_b64_tr_b16 a[84:85], v28 offset:8192
  v_mfma_f32_16x16x32_bf16 a[8:11], a[116:119], a[220:223], a[8:11]
  buffer_load_dwordx4 a[252:255], v11, s[40:43], s3 offen nt
  v_mfma_f32_16x16x32_bf16 a[12:15], a[120:123], a[216:219], a[12:15]
  ds_read_b64_tr_b16 a[86:87], v28 offset:9216
  v_mfma_f32_16x16x32_bf16 a[12:15], a[124:127], a[220:223], a[12:15]
  ds_read_b128 a[184:187], v20 offset:6144
  v_mfma_f32_16x16x32_bf16 a[16:19], a[128:131], a[216:219], a[16:19]
  ds_read_b64_tr_b16 a[88:89], v29 offset:0
  v_mfma_f32_16x16x32_bf16 a[16:19], a[132:135], a[220:223], a[16:19]
  v_mfma_f32_16x16x32_bf16 a[20:23], a[136:139], a[216:219], a[20:23]
  ds_read_b64_tr_b16 a[90:91], v29 offset:1024
  v_mfma_f32_16x16x32_bf16 a[20:23], a[140:143], a[220:223], a[20:23]
  ds_read_b64_tr_b16 a[92:93], v29 offset:8192
  v_mfma_f32_16x16x32_bf16 a[24:27], a[144:147], a[216:219], a[24:27]
  ds_read_b64_tr_b16 a[94:95], v29 offset:9216
  v_mfma_f32_16x16x32_bf16 a[24:27], a[148:151], a[220:223], a[24:27]
  v_mfma_f32_16x16x32_bf16 a[28:31], a[152:155], a[216:219], a[28:31]
  ds_read_b128 a[188:191], v21 offset:6144
  s_add_u32 s92, s92, 896
  v_mfma_f32_16x16x32_bf16 a[28:31], a[156:159], a[220:223], a[28:31]
  s_add_u32 s48, s48, 128
  s_waitcnt lgkmcnt(4)
  v_mfma_f32_16x16x32_bf16 v[32:35], a[32:35], a[160:163], v[32:35]
  s_mov_b32 s40, s26
  v_mfma_f32_16x16x32_bf16 v[32:35], a[36:39], a[164:167], v[32:35]
  s_mov_b32 s41, s27
  v_mfma_f32_16x16x32_bf16 v[36:39], a[40:43], a[160:163], v[36:39]
  s_mov_b32 s42, 82837504
  v_mfma_f32_16x16x32_bf16 v[36:39], a[44:47], a[164:167], v[36:39]
  s_mov_b32 s43, 0x20000
  v_mfma_f32_16x16x32_bf16 v[40:43], a[48:51], a[160:163], v[40:43]
  s_mov_b32 s32, s4
  v_mfma_f32_16x16x32_bf16 v[40:43], a[52:55], a[164:167], v[40:43]
  s_mov_b32 s33, s5
  v_mfma_f32_16x16x32_bf16 v[44:47], a[56:59], a[160:163], v[44:47]
  s_mov_b32 s34, 2621440
  v_mfma_f32_16x16x32_bf16 v[44:47], a[60:63], a[164:167], v[44:47]
  s_mov_b32 s35, 0x20000
  v_mfma_f32_16x16x32_bf16 v[48:51], a[64:67], a[160:163], v[48:51]
  ds_read_b128 a[192:195], v20 offset:8192
  s_mov_b32 s36, s8
  v_mfma_f32_16x16x32_bf16 v[48:51], a[68:71], a[164:167], v[48:51]
  s_mov_b32 s37, s9
  v_mfma_f32_16x16x32_bf16 v[52:55], a[72:75], a[160:163], v[52:55]
  s_mov_b32 s38, 5242880
  v_mfma_f32_16x16x32_bf16 v[52:55], a[76:79], a[164:167], v[52:55]
  s_mov_b32 s39, 0x20000
  v_mfma_f32_16x16x32_bf16 v[56:59], a[80:83], a[160:163], v[56:59]
  ds_read_b128 a[196:199], v21 offset:8192
  s_lshl_b32 s54, s28, 17
  v_mfma_f32_16x16x32_bf16 v[56:59], a[84:87], a[164:167], v[56:59]
  s_lshl_b32 s55, s29, 8
  s_waitcnt lgkmcnt(2)
  v_mfma_f32_16x16x32_bf16 v[60:63], a[88:91], a[160:163], v[60:63]
  s_add_u32 s54, s54, s55
  v_mfma_f32_16x16x32_bf16 v[60:63], a[92:95], a[164:167], v[60:63]
  v_lshlrev_b32 v16, 4, v1
  v_mfma_f32_16x16x32_bf16 v[64:67], a[32:35], a[168:171], v[64:67]
  v_lshrrev_b32 v2, 4, v1
  v_mfma_f32_16x16x32_bf16 v[64:67], a[36:39], a[172:175], v[64:67]
  v_lshlrev_b32 v3, 2, v2
  v_mfma_f32_16x16x32_bf16 v[68:71], a[40:43], a[168:171], v[68:71]
  ds_read_b128 a[200:203], v20 offset:10240
  v_lshlrev_b32 v2, 13, v2
  v_mfma_f32_16x16x32_bf16 v[68:71], a[44:47], a[172:175], v[68:71]
  v_add_u32 v2, s54, v2
  v_mfma_f32_16x16x32_bf16 v[72:75], a[48:51], a[168:171], v[72:75]
  v_and_b32 v0, 15, v1
  v_mfma_f32_16x16x32_bf16 v[72:75], a[52:55], a[172:175], v[72:75]
  v_xor_b32 v3, v3, v0
  v_mfma_f32_16x16x32_bf16 v[76:79], a[56:59], a[168:171], v[76:79]
  v_lshl_add_u32 v0, v3, 4, v2
  v_mfma_f32_16x16x32_bf16 v[76:79], a[60:63], a[172:175], v[76:79]
  v_xor_b32 v3, 2, v3
  v_mfma_f32_16x16x32_bf16 v[80:83], a[64:67], a[168:171], v[80:83]
  ds_read_b128 a[204:207], v21 offset:10240
  v_lshl_add_u32 v3, v3, 4, v2
  v_mfma_f32_16x16x32_bf16 v[80:83], a[68:71], a[172:175], v[80:83]
  v_add_u32 v12, 0, v0
  v_mfma_f32_16x16x32_bf16 v[84:87], a[72:75], a[168:171], v[84:87]
  v_add_u32 v13, 31744, v0
  v_mfma_f32_16x16x32_bf16 v[84:87], a[76:79], a[172:175], v[84:87]
  v_add_u32 v14, 63488, v3
  v_mfma_f32_16x16x32_bf16 v[88:91], a[80:83], a[168:171], v[88:91]
  v_add_u32 v15, 95232, v3
  v_mfma_f32_16x16x32_bf16 v[88:91], a[84:87], a[172:175], v[88:91]
  s_lshl_b32 s48, s28, 12
  v_mfma_f32_16x16x32_bf16 v[92:95], a[88:91], a[168:171], v[92:95]
  v_mfma_f32_16x16x32_bf16 v[92:95], a[92:95], a[172:175], v[92:95]
  s_add_u32 s48, s48, 98304
  v_mfma_f32_16x16x32_bf16 v[96:99], a[32:35], a[176:179], v[96:99]
  s_lshl_b32 s49, s28, 13
  v_mfma_f32_16x16x32_bf16 v[96:99], a[36:39], a[180:183], v[96:99]
  v_xor_b32 v22, 0x10000, v22
  s_lshl_b32 s54, s30, 2
  v_mfma_f32_16x16x32_bf16 v[100:103], a[40:43], a[176:179], v[100:103]
  ds_read_b128 a[208:211], v20 offset:12288
  s_add_u32 s54, s54, s28
  v_mfma_f32_16x16x32_bf16 v[100:103], a[44:47], a[180:183], v[100:103]
  v_xor_b32 v23, 0x10000, v23
  s_mul_i32 s54, s54, 40960
  v_mfma_f32_16x16x32_bf16 v[104:107], a[48:51], a[176:179], v[104:107]
  s_sub_u32 s55, 2580480, s54
  v_mfma_f32_16x16x32_bf16 v[104:107], a[52:55], a[180:183], v[104:107]
  v_lshrrev_b32 v2, 3, v1
  v_mfma_f32_16x16x32_bf16 v[108:111], a[56:59], a[176:179], v[108:111]
  v_mul_u32_u24 v2, 1280, v2
  v_mfma_f32_16x16x32_bf16 v[108:111], a[60:63], a[180:183], v[108:111]
  v_xor_b32 v24, 0x10000, v24
  v_lshrrev_b32 v3, 4, v1
  v_mfma_f32_16x16x32_bf16 v[112:115], a[64:67], a[176:179], v[112:115]
  ds_read_b128 a[212:215], v21 offset:12288
  v_and_b32 v0, 7, v1
  v_mfma_f32_16x16x32_bf16 v[112:115], a[68:71], a[180:183], v[112:115]
  v_xor_b32 v25, 0x10000, v25
  v_xor_b32 v3, v3, v0
  v_mfma_f32_16x16x32_bf16 v[116:119], a[72:75], a[176:179], v[116:119]
  v_lshl_add_u32 v0, v3, 4, v2
  v_mfma_f32_16x16x32_bf16 v[116:119], a[76:79], a[180:183], v[116:119]
  v_xor_b32 v3, 4, v3
  v_mfma_f32_16x16x32_bf16 v[120:123], a[80:83], a[176:179], v[120:123]
  v_lshl_add_u32 v3, v3, 4, v2
  v_mfma_f32_16x16x32_bf16 v[120:123], a[84:87], a[180:183], v[120:123]
  v_xor_b32 v26, 0x10000, v26
  v_add_u32 v4, 0, v0
  v_mfma_f32_16x16x32_bf16 v[124:127], a[88:91], a[176:179], v[124:127]
  v_add_u32 v4, s54, v4
  v_mfma_f32_16x16x32_bf16 v[124:127], a[92:95], a[180:183], v[124:127]
  v_xor_b32 v27, 0x10000, v27
  v_add_u32 v5, 9216, v3
  v_mfma_f32_16x16x32_bf16 v[128:131], a[32:35], a[184:187], v[128:131]
  v_add_u32 v5, s54, v5
  v_mfma_f32_16x16x32_bf16 v[128:131], a[36:39], a[188:191], v[128:131]
  v_add_u32 v6, 18432, v0
  v_mfma_f32_16x16x32_bf16 v[132:135], a[40:43], a[184:187], v[132:135]
  ds_read_b128 a[216:219], v20 offset:14336
  v_add_u32 v6, s54, v6
  v_mfma_f32_16x16x32_bf16 v[132:135], a[44:47], a[188:191], v[132:135]
  v_xor_b32 v28, 0x10000, v28
  v_add_u32 v7, 27648, v3
  v_mfma_f32_16x16x32_bf16 v[136:139], a[48:51], a[184:187], v[136:139]
  v_add_u32 v7, s54, v7
  v_mfma_f32_16x16x32_bf16 v[136:139], a[52:55], a[188:191], v[136:139]
  v_add_u32 v8, 0, v0
  v_mfma_f32_16x16x32_bf16 v[140:143], a[56:59], a[184:187], v[140:143]
  v_add_u32 v8, s55, v8
  v_mfma_f32_16x16x32_bf16 v[140:143], a[60:63], a[188:191], v[140:143]
  v_xor_b32 v29, 0x10000, v29
  v_add_u32 v9, 9216, v3
  v_mfma_f32_16x16x32_bf16 v[144:147], a[64:67], a[184:187], v[144:147]
  ds_read_b128 a[220:223], v21 offset:14336
  v_add_u32 v9, s55, v9
  v_mfma_f32_16x16x32_bf16 v[144:147], a[68:71], a[188:191], v[144:147]
  v_add_u32 v10, 18432, v0
  v_mfma_f32_16x16x32_bf16 v[148:151], a[72:75], a[184:187], v[148:151]
  v_add_u32 v10, s55, v10
  v_mfma_f32_16x16x32_bf16 v[148:151], a[76:79], a[188:191], v[148:151]
  v_add_u32 v11, 27648, v3
  v_mfma_f32_16x16x32_bf16 v[152:155], a[80:83], a[184:187], v[152:155]
  v_add_u32 v11, s55, v11
  v_mfma_f32_16x16x32_bf16 v[152:155], a[84:87], a[188:191], v[152:155]
  v_mfma_f32_16x16x32_bf16 v[156:159], a[88:91], a[184:187], v[156:159]
  s_getpc_b64 s[92:93]
L_ctqFalse:
  s_lshl_b32 s94, s28, 13
  s_add_u32 s94, s94, LKV_done - L_ctqFalse
  v_mfma_f32_16x16x32_bf16 v[156:159], a[92:95], a[188:191], v[156:159]
  s_waitcnt vmcnt(8) lgkmcnt(0)
  s_barrier
  v_lshlrev_b32 v2, 7, v1
  v_add_u32 v2, s94, v2
  s_mov_b32 s94, L_codeend - L_ctqFalse - 4
  v_mfma_f32_16x16x32_bf16 v[160:163], a[32:35], a[192:195], v[160:163]
  s_add_u32 s53, s52, s51
  s_add_u32 s52, s52, 0x10000
  v_min_u32 v3, s94, v2
  v_mfma_f32_16x16x32_bf16 v[160:163], a[36:39], a[196:199], v[160:163]
  s_cmp_eq_u32 s52, 0x30000
  s_cselect_b32 s52, 0, s52
  global_load_dword v0, v3, s[92:93]
  v_mfma_f32_16x16x32_bf16 v[164:167], a[40:43], a[192:195], v[164:167]
  ds_read_b64_tr_b16 a[96:97], v22 offset:0
  v_mfma_f32_16x16x32_bf16 v[164:167], a[44:47], a[196:199], v[164:167]
  ds_read_b64_tr_b16 a[98:99], v22 offset:1024
  v_mfma_f32_16x16x32_bf16 v[168:171], a[48:51], a[192:195], v[168:171]
  ds_read_b64_tr_b16 a[100:101], v22 offset:8192
  s_add_u32 m0, s49, 65536
  s_mov_b32 s51, 0
  v_mfma_f32_16x16x32_bf16 v[168:171], a[52:55], a[196:199], v[168:171]
  v_add_u32 v20, s52, v30
  v_add_u32 v21, s52, v31
  buffer_load_dwordx4 v4, s[32:35], s51 offen offset:0 lds
  v_mfma_f32_16x16x32_bf16 v[172:175], a[56:59], a[192:195], v[172:175]
  ds_read_b64_tr_b16 a[102:103], v22 offset:9216
  v_mfma_f32_16x16x32_bf16 v[172:175], a[60:63], a[196:199], v[172:175]
  ds_read_b128 a[160:163], v20 offset:0
  v_mfma_f32_16x16x32_bf16 v[176:179], a[64:67], a[192:195], v[176:179]
  ds_read_b64_tr_b16 a[104:105], v23 offset:0
  v_mfma_f32_16x16x32_bf16 v[176:179], a[68:71], a[196:199], v[176:179]
  buffer_load_dwordx4 v5, s[32:35], s51 offen offset:1024 lds
  v_mfma_f32_16x16x32_bf16 v[180:183], a[72:75], a[192:195], v[180:183]
  ds_read_b64_tr_b16 a[106:107], v23 offset:1024
  v_mfma_f32_16x16x32_bf16 v[180:183], a[76:79], a[196:199], v[180:183]
  ds_read_b64_tr_b16 a[108:109], v23 offset:8192
  v_mfma_f32_16x16x32_bf16 v[184:187], a[80:83], a[192:195], v[184:187]
  ds_read_b64_tr_b16 a[110:111], v23 offset:9216
  v_mfma_f32_16x16x32_bf16 v[184:187], a[84:87], a[196:199], v[184:187]
  buffer_load_dwordx4 v6, s[32:35], s51 offen offset:2048 lds
  v_mfma_f32_16x16x32_bf16 v[188:191], a[88:91], a[192:195], v[188:191]
  ds_read_b128 a[164:167], v21 offset:0
  v_mfma_f32_16x16x32_bf16 v[188:191], a[92:95], a[196:199], v[188:191]
  v_mfma_f32_16x16x32_bf16 v[192:195], a[32:35], a[200:203], v[192:195]
  v_mfma_f32_16x16x32_bf16 v[192:195], a[36:39], a[204:207], v[192:195]
  buffer_load_dwordx4 v7, s[32:35], s51 offen offset:3072 lds
  v_mfma_f32_16x16x32_bf16 v[196:199], a[40:43], a[200:203], v[196:199]
  ds_read_b64_tr_b16 a[112:113], v24 offset:0
  v_mfma_f32_16x16x32_bf16 v[196:199], a[44:47], a[204:207], v[196:199]
  ds_read_b64_tr_b16 a[114:115], v24 offset:1024
  v_mfma_f32_16x16x32_bf16 v[200:203], a[48:51], a[200:203], v[200:203]
  ds_read_b64_tr_b16 a[116:117], v24 offset:8192
  s_add_u32 m0, s49, 69632
  s_mov_b32 s51, 0
  v_mfma_f32_16x16x32_bf16 v[200:203], a[52:55], a[204:207], v[200:203]
  buffer_load_dwordx4 v8, s[32:35], s51 offen offset:0 lds
  v_mfma_f32_16x16x32_bf16 v[204:207], a[56:59], a[200:203], v[204:207]
  ds_read_b64_tr_b16 a[118:119], v24 offset:9216
  v_mfma_f32_16x16x32_bf16 v[204:207], a[60:63], a[204:207], v[204:207]
  ds_read_b128 a[168:171], v20 offset:2048
  v_mfma_f32_16x16x32_bf16 v[208:211], a[64:67], a[200:203], v[208:211]
  ds_read_b64_tr_b16 a[120:121], v25 offset:0
  v_mfma_f32_16x16x32_bf16 v[208:211], a[68:71], a[204:207], v[208:211]
  buffer_load_dwordx4 v9, s[32:35], s51 offen offset:1024 lds
  v_mfma_f32_16x16x32_bf16 v[212:215], a[72:75], a[200:203], v[212:215]
  ds_read_b64_tr_b16 a[122:123], v25 offset:1024
  v_mfma_f32_16x16x32_bf16 v[212:215], a[76:79], a[204:207], v[212:215]
  ds_read_b64_tr_b16 a[124:125], v25 offset:8192
  v_mfma_f32_16x16x32_bf16 v[216:219], a[80:83], a[200:203], v[216:219]
  ds_read_b64_tr_b16 a[126:127], v25 offset:9216
  v_mfma_f32_16x16x32_bf16 v[216:219], a[84:87], a[204:207], v[216:219]
  buffer_load_dwordx4 v10, s[32:35], s51 offen offset:2048 lds
  v_mfma_f32_16x16x32_bf16 v[220:223], a[88:91], a[200:203], v[220:223]
  ds_read_b128 a[172:175], v21 offset:2048
  v_mfma_f32_16x16x32_bf16 v[220:223], a[92:95], a[204:207], v[220:223]
  v_mfma_f32_16x16x32_bf16 v[224:227], a[32:35], a[208:211], v[224:227]
  v_mfma_f32_16x16x32_bf16 v[224:227], a[36:39], a[212:215], v[224:227]
  buffer_load_dwordx4 v11, s[32:35], s51 offen offset:3072 lds
  v_mfma_f32_16x16x32_bf16 v[228:231], a[40:43], a[208:211], v[228:231]
  ds_read_b64_tr_b16 a[128:129], v26 offset:0
  v_mfma_f32_16x16x32_bf16 v[228:231], a[44:47], a[212:215], v[228:231]
  ds_read_b64_tr_b16 a[130:131], v26 offset:1024
  v_mfma_f32_16x16x32_bf16 v[232:235], a[48:51], a[208:211], v[232:235]
  ds_read_b64_tr_b16 a[132:133], v26 offset:8192
  s_add_u32 m0, s49, 0
  s_mov_b32 s51, 128
  v_mfma_f32_16x16x32_bf16 v[232:235], a[52:55], a[212:215], v[232:235]
  buffer_load_dwordx4 v4, s[32:35], s51 offen offset:0 lds
  v_mfma_f32_16x16x32_bf16 v[236:239], a[56:59], a[208:211], v[236:239]
  ds_read_b64_tr_b16 a[134:135], v26 offset:9216
  v_mfma_f32_16x16x32_bf16 v[236:239], a[60:63], a[212:215], v[236:239]
  ds_read_b128 a[176:179], v20 offset:4096
  v_mfma_f32_16x16x32_bf16 v[240:243], a[64:67], a[208:211], v[240:243]
  ds_read_b64_tr_b16 a[136:137], v27 offset:0
  v_mfma_f32_16x16x32_bf16 v[240:243], a[68:71], a[212:215], v[240:243]
  buffer_load_dwordx4 v5, s[32:35], s51 offen offset:1024 lds
  v_mfma_f32_16x16x32_bf16 v[244:247], a[72:75], a[208:211], v[244:247]
  ds_read_b64_tr_b16 a[138:139], v27 offset:1024
  v_mfma_f32_16x16x32_bf16 v[244:247], a[76:79], a[212:215], v[244:247]
  ds_read_b64_tr_b16 a[140:141], v27 offset:8192
  v_mfma_f32_16x16x32_bf16 v[248:251], a[80:83], a[208:211], v[248:251]
  ds_read_b64_tr_b16 a[142:143], v27 offset:9216
  v_mfma_f32_16x16x32_bf16 v[248:251], a[84:87], a[212:215], v[248:251]
  buffer_load_dwordx4 v6, s[32:35], s51 offen offset:2048 lds
  v_mfma_f32_16x16x32_bf16 v[252:255], a[88:91], a[208:211], v[252:255]
  ds_read_b128 a[180:183], v21 offset:4096
  v_mfma_f32_16x16x32_bf16 v[252:255], a[92:95], a[212:215], v[252:255]
  buffer_load_dwordx4 v7, s[32:35], s51 offen offset:3072 lds
  v_mfma_f32_16x16x32_bf16 a[0:3], a[32:35], a[216:219], a[0:3]
  s_add_u32 m0, s49, 4096
  s_mov_b32 s51, 128
  v_mfma_f32_16x16x32_bf16 a[0:3], a[36:39], a[220:223], a[0:3]
  buffer_load_dwordx4 v8, s[32:35], s51 offen offset:0 lds
  v_mfma_f32_16x16x32_bf16 a[4:7], a[40:43], a[216:219], a[4:7]
  ds_read_b64_tr_b16 a[144:145], v28 offset:0
  v_mfma_f32_16x16x32_bf16 a[4:7], a[44:47], a[220:223], a[4:7]
  ds_read_b64_tr_b16 a[146:147], v28 offset:1024
  v_mfma_f32_16x16x32_bf16 a[8:11], a[48:51], a[216:219], a[8:11]
  ds_read_b64_tr_b16 a[148:149], v28 offset:8192
  v_mfma_f32_16x16x32_bf16 a[8:11], a[52:55], a[220:223], a[8:11]
  buffer_load_dwordx4 v9, s[32:35], s51 offen offset:1024 lds
  v_mfma_f32_16x16x32_bf16 a[12:15], a[56:59], a[216:219], a[12:15]
  ds_read_b64_tr_b16 a[150:151], v28 offset:9216
  v_mfma_f32_16x16x32_bf16 a[12:15], a[60:63], a[220:223], a[12:15]
  ds_read_b128 a[184:187], v20 offset:6144
  v_mfma_f32_16x16x32_bf16 a[16:19], a[64:67], a[216:219], a[16:19]
  ds_read_b64_tr_b16 a[152:153], v29 offset:0
  v_mfma_f32_16x16x32_bf16 a[16:19], a[68:71], a[220:223], a[16:19]
  buffer_load_dwordx4 v10, s[32:35], s51 offen offset:2048 lds
  v_mfma_f32_16x16x32_bf16 a[20:23], a[72:75], a[216:219], a[20:23]
  ds_read_b64_tr_b16 a[154:155], v29 offset:1024
  v_mfma_f32_16x16x32_bf16 a[20:23], a[76:79], a[220:223], a[20:23]
  ds_read_b64_tr_b16 a[156:157], v29 offset:8192
  v_mfma_f32_16x16x32_bf16 a[24:27], a[80:83], a[216:219], a[24:27]
  ds_read_b64_tr_b16 a[158:159], v29 offset:9216
  v_mfma_f32_16x16x32_bf16 a[24:27], a[84:87], a[220:223], a[24:27]
  buffer_load_dwordx4 v11, s[32:35], s51 offen offset:3072 lds
  v_mfma_f32_16x16x32_bf16 a[28:31], a[88:91], a[216:219], a[28:31]
  ds_read_b128 a[188:191], v21 offset:6144
  v_mfma_f32_16x16x32_bf16 a[28:31], a[92:95], a[220:223], a[28:31]
  s_waitcnt lgkmcnt(4)
  v_mfma_f32_16x16x32_bf16 v[32:35], a[96:99], a[160:163], v[32:35]
  v_mfma_f32_16x16x32_bf16 v[32:35], a[100:103], a[164:167], v[32:35]
  v_mfma_f32_16x16x32_bf16 v[36:39], a[104:107], a[160:163], v[36:39]
  v_mfma_f32_16x16x32_bf16 v[36:39], a[108:111], a[164:167], v[36:39]
  v_mfma_f32_16x16x32_bf16 v[40:43], a[112:115], a[160:163], v[40:43]
  s_waitcnt lgkmcnt(0)
  s_barrier
  v_mfma_f32_16x16x32_bf16 v[40:43], a[116:119], a[164:167], v[40:43]
  s_add_u32 m0, s48, 0
  s_mov_b32 s50, 0
  v_mfma_f32_16x16x32_bf16 v[44:47], a[120:123], a[160:163], v[44:47]
  buffer_load_dwordx4 v12, s[36:39], s50 offen offset:0 lds
  v_mfma_f32_16x16x32_bf16 v[44:47], a[124:127], a[164:167], v[44:47]
  v_mfma_f32_16x16x32_bf16 v[48:51], a[128:131], a[160:163], v[48:51]
  ds_read_b128 a[192:195], v20 offset:8192
  s_and_b32 s54, s28, 1
  v_mfma_f32_16x16x32_bf16 v[48:51], a[132:135], a[164:167], v[48:51]
  buffer_load_dwordx4 v13, s[36:39], s50 offen offset:1024 lds
  s_lshl_b32 s54, s54, 14
  v_mfma_f32_16x16x32_bf16 v[52:55], a[136:139], a[160:163], v[52:55]
  v_subrev_u32 v22, s54, v22
  v_mfma_f32_16x16x32_bf16 v[52:55], a[140:143], a[164:167], v[52:55]
  v_mfma_f32_16x16x32_bf16 v[56:59], a[144:147], a[160:163], v[56:59]
  ds_read_b128 a[196:199], v21 offset:8192
  s_add_u32 m0, s48, 0
  s_mov_b32 s50, 0
  v_subrev_u32 v23, s54, v23
  v_mfma_f32_16x16x32_bf16 v[56:59], a[148:151], a[164:167], v[56:59]
  buffer_load_dwordx4 v14, s[36:39], s50 offen offset:2048 lds
  v_subrev_u32 v24, s54, v24
  v_mfma_f32_16x16x32_bf16 v[60:63], a[152:155], a[160:163], v[60:63]
  v_mfma_f32_16x16x32_bf16 v[60:63], a[156:159], a[164:167], v[60:63]
  v_subrev_u32 v25, s54, v25
  v_mfma_f32_16x16x32_bf16 v[64:67], a[96:99], a[168:171], v[64:67]
  buffer_load_dwordx4 v15, s[36:39], s50 offen offset:3072 lds
  v_subrev_u32 v26, s54, v26
  v_mfma_f32_16x16x32_bf16 v[64:67], a[100:103], a[172:175], v[64:67]
  v_mfma_f32_16x16x32_bf16 v[68:71], a[104:107], a[168:171], v[68:71]
  ds_read_b128 a[200:203], v20 offset:10240
  v_subrev_u32 v27, s54, v27
  v_mfma_f32_16x16x32_bf16 v[68:71], a[108:111], a[172:175], v[68:71]
  s_add_u32 m0, s48, 16384
  s_mov_b32 s50, 524288
  v_subrev_u32 v28, s54, v28
  v_mfma_f32_16x16x32_bf16 v[72:75], a[112:115], a[168:171], v[72:75]
  buffer_load_dwordx4 v12, s[36:39], s50 offen offset:0 lds
  v_mfma_f32_16x16x32_bf16 v[72:75], a[116:119], a[172:175], v[72:75]
  v_subrev_u32 v29, s54, v29
  v_mfma_f32_16x16x32_bf16 v[76:79], a[120:123], a[168:171], v[76:79]
  v_cvt_pk_bf16_f32 v32, v32, v33
  s_lshr_b32 s54, s28, 1
  v_mfma_f32_16x16x32_bf16 v[76:79], a[124:127], a[172:175], v[76:79]
  buffer_load_dwordx4 v13, s[36:39], s50 offen offset:1024 lds
  v_cvt_pk_bf16_f32 v33, v34, v35
  v_mfma_f32_16x16x32_bf16 v[80:83], a[128:131], a[168:171], v[80:83]
  ds_read_b128 a[204:207], v21 offset:10240
  v_cvt_pk_bf16_f32 v34, v36, v37
  s_lshl_b32 s54, s54, 14
  v_mfma_f32_16x16x32_bf16 v[80:83], a[132:135], a[172:175], v[80:83]
  v_cvt_pk_bf16_f32 v35, v38, v39
  s_sub_u32 s54, s49, s54
  v_mfma_f32_16x16x32_bf16 v[84:87], a[136:139], a[168:171], v[84:87]
  s_add_u32 m0, s48, 16384
  s_mov_b32 s50, 524288
  v_cvt_pk_bf16_f32 v36, v40, v41
  v_add_u32 v18, s54, v30
  v_mfma_f32_16x16x32_bf16 v[84:87], a[140:143], a[172:175], v[84:87]
  buffer_load_dwordx4 v14, s[36:39], s50 offen offset:2048 lds
  v_cvt_pk_bf16_f32 v37, v42, v43
  v_mfma_f32_16x16x32_bf16 v[88:91], a[144:147], a[168:171], v[88:91]
  v_cvt_pk_bf16_f32 v38, v44, v45
  v_add_u32 v19, s54, v31
  v_mfma_f32_16x16x32_bf16 v[88:91], a[148:151], a[172:175], v[88:91]
  v_cvt_pk_bf16_f32 v39, v46, v47
  v_add_u32 v30, 0x10000, v18
  v_mfma_f32_16x16x32_bf16 v[92:95], a[152:155], a[168:171], v[92:95]
  buffer_load_dwordx4 v15, s[36:39], s50 offen offset:3072 lds
  v_cvt_pk_bf16_f32 v40, v48, v49
  v_mfma_f32_16x16x32_bf16 v[92:95], a[156:159], a[172:175], v[92:95]
  v_cvt_pk_bf16_f32 v41, v50, v51
  v_add_u32 v31, 0x10000, v19
  v_mfma_f32_16x16x32_bf16 v[96:99], a[96:99], a[176:179], v[96:99]
  v_cvt_pk_bf16_f32 v42, v52, v53
  v_mov_b32 v17, 0
  v_mfma_f32_16x16x32_bf16 v[96:99], a[100:103], a[180:183], v[96:99]
  v_cvt_pk_bf16_f32 v43, v54, v55
  v_mfma_f32_16x16x32_bf16 v[100:103], a[104:107], a[176:179], v[100:103]
  ds_read_b128 a[208:211], v20 offset:12288
  s_add_u32 m0, s49, 32768
  s_mov_b32 s51, 256
  v_cvt_pk_bf16_f32 v44, v56, v57
  s_mov_b32 s96, s26
  v_mfma_f32_16x16x32_bf16 v[100:103], a[108:111], a[180:183], v[100:103]
  buffer_load_dwordx4 v4, s[32:35], s51 offen offset:0 lds
  v_cvt_pk_bf16_f32 v45, v58, v59
  s_mov_b32 s97, s27
  v_mfma_f32_16x16x32_bf16 v[104:107], a[112:115], a[176:179], v[104:107]
  v_cvt_pk_bf16_f32 v46, v60, v61
  v_mfma_f32_16x16x32_bf16 v[104:107], a[116:119], a[180:183], v[104:107]
  v_cvt_pk_bf16_f32 v47, v62, v63
  s_mov_b32 s99, 0x20000
  v_mfma_f32_16x16x32_bf16 v[108:111], a[120:123], a[176:179], v[108:111]
  buffer_load_dwordx4 v5, s[32:35], s51 offen offset:1024 lds
  v_cvt_pk_bf16_f32 v48, v64, v65
  s_cmp_lt_u32 s30, 3
  s_cselect_b32 s98, 82837504, 0
  v_mfma_f32_16x16x32_bf16 v[108:111], a[124:127], a[180:183], v[108:111]
  v_cvt_pk_bf16_f32 v49, v66, v67
  v_mfma_f32_16x16x32_bf16 v[112:115], a[128:131], a[176:179], v[112:115]
  ds_read_b128 a[212:215], v21 offset:12288
  v_cvt_pk_bf16_f32 v50, v68, v69
  v_mfma_f32_16x16x32_bf16 v[112:115], a[132:135], a[180:183], v[112:115]
  v_cvt_pk_bf16_f32 v51, v70, v71
  v_mfma_f32_16x16x32_bf16 v[116:119], a[136:139], a[176:179], v[116:119]
  buffer_load_dwordx4 v6, s[32:35], s51 offen offset:2048 lds
  v_cvt_pk_bf16_f32 v52, v72, v73
  s_mov_b32 s44, s20
  v_mfma_f32_16x16x32_bf16 v[116:119], a[140:143], a[180:183], v[116:119]
  v_cvt_pk_bf16_f32 v53, v74, v75
  s_mov_b32 s45, s21
  v_mfma_f32_16x16x32_bf16 v[120:123], a[144:147], a[176:179], v[120:123]
  v_cvt_pk_bf16_f32 v54, v76, v77
  s_mov_b32 s46, 819200
  v_mfma_f32_16x16x32_bf16 v[120:123], a[148:151], a[180:183], v[120:123]
  buffer_load_dwordx4 v7, s[32:35], s51 offen offset:3072 lds
  v_cvt_pk_bf16_f32 v55, v78, v79
  s_mov_b32 s47, 0x20000
  v_mfma_f32_16x16x32_bf16 v[124:127], a[152:155], a[176:179], v[124:127]
  v_cvt_pk_bf16_f32 v56, v80, v81
  s_mul_i32 s55, s2, 205
  v_mfma_f32_16x16x32_bf16 v[124:127], a[156:159], a[180:183], v[124:127]
  v_cvt_pk_bf16_f32 v57, v82, v83
  s_lshr_b32 s55, s55, 11
  v_mfma_f32_16x16x32_bf16 v[128:131], a[96:99], a[184:187], v[128:131]
  s_add_u32 m0, s49, 36864
  s_mov_b32 s51, 256
  v_cvt_pk_bf16_f32 v58, v84, v85
  v_mfma_f32_16x16x32_bf16 v[128:131], a[100:103], a[188:191], v[128:131]
  buffer_load_dwordx4 v8, s[32:35], s51 offen offset:0 lds
  v_cvt_pk_bf16_f32 v59, v86, v87
  s_mul_i32 s56, s55, 39680
  v_mfma_f32_16x16x32_bf16 v[132:135], a[104:107], a[184:187], v[132:135]
  ds_read_b128 a[216:219], v20 offset:14336
  v_cvt_pk_bf16_f32 v60, v88, v89
  s_lshl_b32 s55, s2, 7
  v_mfma_f32_16x16x32_bf16 v[132:135], a[108:111], a[188:191], v[132:135]
  v_cvt_pk_bf16_f32 v61, v90, v91
  s_add_u32 s95, s56, s55
  v_mfma_f32_16x16x32_bf16 v[136:139], a[112:115], a[184:187], v[136:139]
  v_cvt_pk_bf16_f32 v62, v92, v93
  s_lshl_b32 s55, s28, 5
  v_mfma_f32_16x16x32_bf16 v[136:139], a[116:119], a[188:191], v[136:139]
  buffer_load_dwordx4 v9, s[32:35], s51 offen offset:1024 lds
  v_cvt_pk_bf16_f32 v63, v94, v95
  s_add_u32 s95, s95, s55
  v_mfma_f32_16x16x32_bf16 v[140:143], a[120:123], a[184:187], v[140:143]
  v_cvt_pk_bf16_f32 v64, v96, v97
  s_add_u32 s3, s95, 5120
  v_mfma_f32_16x16x32_bf16 v[140:143], a[124:127], a[188:191], v[140:143]
  v_cvt_pk_bf16_f32 v65, v98, v99
  v_mfma_f32_16x16x32_bf16 v[144:147], a[128:131], a[184:187], v[144:147]
  ds_read_b128 a[220:223], v21 offset:14336
  v_cvt_pk_bf16_f32 v66, v100, v101
  v_mfma_f32_16x16x32_bf16 v[144:147], a[132:135], a[188:191], v[144:147]
  v_cvt_pk_bf16_f32 v67, v102, v103
  v_lshrrev_b32 v20, 4, v1
  v_lshrrev_b32 v21, 2, v1
  v_mfma_f32_16x16x32_bf16 v[148:151], a[136:139], a[184:187], v[148:151]
  buffer_load_dwordx4 v10, s[32:35], s51 offen offset:2048 lds
  v_cvt_pk_bf16_f32 v68, v104, v105
  v_and_b32 v21, 3, v21
  v_mfma_f32_16x16x32_bf16 v[148:151], a[140:143], a[188:191], v[148:151]
  v_cvt_pk_bf16_f32 v69, v106, v107
  v_lshl_add_u32 v20, v20, 3, v21
  v_mfma_f32_16x16x32_bf16 v[152:155], a[144:147], a[184:187], v[152:155]
  v_cvt_pk_bf16_f32 v70, v108, v109
  v_mul_u32_u24 v20, 1280, v20
  v_mfma_f32_16x16x32_bf16 v[152:155], a[148:151], a[188:191], v[152:155]
  v_cvt_pk_bf16_f32 v71, v110, v111
  v_and_b32 v21, 3, v1
  v_mfma_f32_16x16x32_bf16 v[156:159], a[152:155], a[184:187], v[156:159]
  buffer_load_dwordx4 v11, s[32:35], s51 offen offset:3072 lds
  v_cvt_pk_bf16_f32 v72, v112, v113
  v_lshl_add_u32 v20, v21, 3, v20
  v_mfma_f32_16x16x32_bf16 v[156:159], a[156:159], a[188:191], v[156:159]
  v_cvt_pk_bf16_f32 v73, v114, v115
  s_waitcnt lgkmcnt(0)
  v_mfma_f32_16x16x32_bf16 v[160:163], a[96:99], a[192:195], v[160:163]
  v_cvt_pk_bf16_f32 v74, v116, v117
  v_mfma_f32_16x16x32_bf16 v[160:163], a[100:103], a[196:199], v[160:163]
  v_cvt_pk_bf16_f32 v75, v118, v119
  v_mfma_f32_16x16x32_bf16 v[164:167], a[104:107], a[192:195], v[164:167]
  v_cvt_pk_bf16_f32 v76, v120, v121
  s_waitcnt lgkmcnt(0)
  s_barrier
  v_mfma_f32_16x16x32_bf16 v[164:167], a[108:111], a[196:199], v[164:167]
  v_cvt_pk_bf16_f32 v77, v122, v123
  s_add_u32 m0, s48, 32768
  s_mov_b32 s50, 1048576
  v_mfma_f32_16x16x32_bf16 v[168:171], a[112:115], a[192:195], v[168:171]
  v_cvt_pk_bf16_f32 v78, v124, v125
  buffer_load_dwordx4 v12, s[36:39], s50 offen offset:0 lds
  v_mfma_f32_16x16x32_bf16 v[168:171], a[116:119], a[196:199], v[168:171]
  v_cvt_pk_bf16_f32 v79, v126, v127
  v_mfma_f32_16x16x32_bf16 v[172:175], a[120:123], a[192:195], v[172:175]
  v_cvt_pk_bf16_f32 v80, v128, v129
  v_mfma_f32_16x16x32_bf16 v[172:175], a[124:127], a[196:199], v[172:175]
  v_cvt_pk_bf16_f32 v81, v130, v131
  buffer_load_dwordx4 v13, s[36:39], s50 offen offset:1024 lds
  v_mfma_f32_16x16x32_bf16 v[176:179], a[128:131], a[192:195], v[176:179]
  v_cvt_pk_bf16_f32 v82, v132, v133
  v_mfma_f32_16x16x32_bf16 v[176:179], a[132:135], a[196:199], v[176:179]
  v_cvt_pk_bf16_f32 v83, v134, v135
  s_add_u32 m0, s48, 32768
  s_mov_b32 s50, 1048576
  v_mfma_f32_16x16x32_bf16 v[180:183], a[136:139], a[192:195], v[180:183]
  v_cvt_pk_bf16_f32 v84, v136, v137
  buffer_load_dwordx4 v14, s[36:39], s50 offen offset:2048 lds
  v_mfma_f32_16x16x32_bf16 v[180:183], a[140:143], a[196:199], v[180:183]
  v_cvt_pk_bf16_f32 v85, v138, v139
  v_mfma_f32_16x16x32_bf16 v[184:187], a[144:147], a[192:195], v[184:187]
  v_cvt_pk_bf16_f32 v86, v140, v141
  v_mfma_f32_16x16x32_bf16 v[184:187], a[148:151], a[196:199], v[184:187]
  v_cvt_pk_bf16_f32 v87, v142, v143
  buffer_load_dwordx4 v15, s[36:39], s50 offen offset:3072 lds
  v_mfma_f32_16x16x32_bf16 v[188:191], a[152:155], a[192:195], v[188:191]
  v_cvt_pk_bf16_f32 v88, v144, v145
  v_mfma_f32_16x16x32_bf16 v[188:191], a[156:159], a[196:199], v[188:191]
  v_cvt_pk_bf16_f32 v89, v146, v147
  v_mfma_f32_16x16x32_bf16 v[192:195], a[96:99], a[200:203], v[192:195]
  v_cvt_pk_bf16_f32 v90, v148, v149
  v_mfma_f32_16x16x32_bf16 v[192:195], a[100:103], a[204:207], v[192:195]
  v_cvt_pk_bf16_f32 v91, v150, v151
  s_add_u32 s57, s58, 0
  v_mfma_f32_16x16x32_bf16 v[196:199], a[104:107], a[200:203], v[196:199]
  v_cvt_pk_bf16_f32 v92, v152, v153
  buffer_store_dwordx4 v[32:35], v16, s[40:43], s57 offen offset:0 sc1
  v_mfma_f32_16x16x32_bf16 v[196:199], a[108:111], a[204:207], v[196:199]
  v_cvt_pk_bf16_f32 v93, v154, v155
  v_mfma_f32_16x16x32_bf16 v[200:203], a[112:115], a[200:203], v[200:203]
  v_cvt_pk_bf16_f32 v94, v156, v157
  v_mfma_f32_16x16x32_bf16 v[200:203], a[116:119], a[204:207], v[200:203]
  v_cvt_pk_bf16_f32 v95, v158, v159
  v_mfma_f32_16x16x32_bf16 v[204:207], a[120:123], a[200:203], v[204:207]
  v_cvt_pk_bf16_f32 v96, v160, v161
  v_mfma_f32_16x16x32_bf16 v[204:207], a[124:127], a[204:207], v[204:207]
  v_cvt_pk_bf16_f32 v97, v162, v163
  s_add_u32 s57, s58, 0
  v_mfma_f32_16x16x32_bf16 v[208:211], a[128:131], a[200:203], v[208:211]
  v_cvt_pk_bf16_f32 v98, v164, v165
  buffer_store_dwordx4 v[36:39], v16, s[40:43], s57 offen offset:1024 sc1
  v_mfma_f32_16x16x32_bf16 v[208:211], a[132:135], a[204:207], v[208:211]
  v_cvt_pk_bf16_f32 v99, v166, v167
  v_mfma_f32_16x16x32_bf16 v[212:215], a[136:139], a[200:203], v[212:215]
  v_cvt_pk_bf16_f32 v100, v168, v169
  v_mfma_f32_16x16x32_bf16 v[212:215], a[140:143], a[204:207], v[212:215]
  v_cvt_pk_bf16_f32 v101, v170, v171
  v_mfma_f32_16x16x32_bf16 v[216:219], a[144:147], a[200:203], v[216:219]
  v_cvt_pk_bf16_f32 v102, v172, v173
  v_mfma_f32_16x16x32_bf16 v[216:219], a[148:151], a[204:207], v[216:219]
  v_cvt_pk_bf16_f32 v103, v174, v175
  v_mfma_f32_16x16x32_bf16 v[220:223], a[152:155], a[200:203], v[220:223]
  v_cvt_pk_bf16_f32 v104, v176, v177
  s_add_u32 s57, s58, 4096
  v_mfma_f32_16x16x32_bf16 v[220:223], a[156:159], a[204:207], v[220:223]
  v_cvt_pk_bf16_f32 v105, v178, v179
  buffer_store_dwordx4 v[40:43], v16, s[40:43], s57 offen offset:0 sc1
  v_mfma_f32_16x16x32_bf16 v[224:227], a[96:99], a[208:211], v[224:227]
  v_cvt_pk_bf16_f32 v106, v180, v181
  v_mfma_f32_16x16x32_bf16 v[224:227], a[100:103], a[212:215], v[224:227]
  v_cvt_pk_bf16_f32 v107, v182, v183
  v_mfma_f32_16x16x32_bf16 v[228:231], a[104:107], a[208:211], v[228:231]
  v_cvt_pk_bf16_f32 v108, v184, v185
  v_mfma_f32_16x16x32_bf16 v[228:231], a[108:111], a[212:215], v[228:231]
  v_cvt_pk_bf16_f32 v109, v186, v187
  v_mfma_f32_16x16x32_bf16 v[232:235], a[112:115], a[208:211], v[232:235]
  v_cvt_pk_bf16_f32 v110, v188, v189
  v_mfma_f32_16x16x32_bf16 v[232:235], a[116:119], a[212:215], v[232:235]
  v_cvt_pk_bf16_f32 v111, v190, v191
  v_mfma_f32_16x16x32_bf16 v[236:239], a[120:123], a[208:211], v[236:239]
  v_cvt_pk_bf16_f32 v112, v192, v193
  s_waitcnt vmcnt(19) lgkmcnt(0)
  s_barrier
  v_mfma_f32_16x16x32_bf16 v[236:239], a[124:127], a[212:215], v[236:239]
  v_cvt_pk_bf16_f32 v113, v194, v195
  s_add_u32 s57, s58, 4096
  ds_read_b64_tr_b16 a[64:65], v22 offset:0
  v_mfma_f32_16x16x32_bf16 v[240:243], a[128:131], a[208:211], v[240:243]
  v_cvt_pk_bf16_f32 v114, v196, v197
  buffer_store_dwordx4 v[44:47], v16, s[40:43], s57 offen offset:1024 sc1
  ds_read_b64_tr_b16 a[66:67], v22 offset:1024
  v_mfma_f32_16x16x32_bf16 v[240:243], a[132:135], a[212:215], v[240:243]
  v_cvt_pk_bf16_f32 v115, v198, v199
  ds_read_b128 a[32:35], v30 offset:0
  v_mfma_f32_16x16x32_bf16 v[244:247], a[136:139], a[208:211], v[244:247]
  v_cvt_pk_bf16_f32 v116, v200, v201
  ds_read_b128 a[36:39], v30 offset:2048
  v_mfma_f32_16x16x32_bf16 v[244:247], a[140:143], a[212:215], v[244:247]
  v_cvt_pk_bf16_f32 v117, v202, v203
  ds_read_b128 a[40:43], v30 offset:4096
  v_mfma_f32_16x16x32_bf16 v[248:251], a[144:147], a[208:211], v[248:251]
  v_cvt_pk_bf16_f32 v118, v204, v205
  ds_read_b128 a[44:47], v30 offset:6144
  v_mfma_f32_16x16x32_bf16 v[248:251], a[148:151], a[212:215], v[248:251]
  v_cvt_pk_bf16_f32 v119, v206, v207
  s_add_u32 s57, s58, 8192
  ds_read_b64_tr_b16 a[68:69], v23 offset:0
  v_mfma_f32_16x16x32_bf16 v[252:255], a[152:155], a[208:211], v[252:255]
  v_cvt_pk_bf16_f32 v120, v208, v209
  buffer_store_dwordx4 v[48:51], v16, s[40:43], s57 offen offset:0 sc1
  ds_read_b64_tr_b16 a[70:71], v23 offset:1024
  v_mfma_f32_16x16x32_bf16 v[252:255], a[156:159], a[212:215], v[252:255]
  v_cvt_pk_bf16_f32 v121, v210, v211
  ds_read_b64_tr_b16 a[72:73], v24 offset:0
  v_mfma_f32_16x16x32_bf16 a[0:3], a[96:99], a[216:219], a[0:3]
  v_cvt_pk_bf16_f32 v122, v212, v213
  ds_read_b64_tr_b16 a[74:75], v24 offset:1024
  v_mfma_f32_16x16x32_bf16 a[0:3], a[100:103], a[220:223], a[0:3]
  v_cvt_pk_bf16_f32 v123, v214, v215
  ds_read_b64_tr_b16 a[76:77], v25 offset:0
  v_mfma_f32_16x16x32_bf16 a[4:7], a[104:107], a[216:219], a[4:7]
  v_cvt_pk_bf16_f32 v124, v216, v217
  s_add_u32 s57, s58, 8192
  ds_read_b64_tr_b16 a[78:79], v25 offset:1024
  v_mfma_f32_16x16x32_bf16 a[4:7], a[108:111], a[220:223], a[4:7]
  v_cvt_pk_bf16_f32 v125, v218, v219
  buffer_store_dwordx4 v[52:55], v16, s[40:43], s57 offen offset:1024 sc1
  ds_read_b64_tr_b16 a[80:81], v26 offset:0
  v_mfma_f32_16x16x32_bf16 a[8:11], a[112:115], a[216:219], a[8:11]
  v_cvt_pk_bf16_f32 v126, v220, v221
  ds_read_b64_tr_b16 a[82:83], v26 offset:1024
  v_mfma_f32_16x16x32_bf16 a[8:11], a[116:119], a[220:223], a[8:11]
  v_cvt_pk_bf16_f32 v127, v222, v223
  ds_read_b64_tr_b16 a[84:85], v27 offset:0
  v_mfma_f32_16x16x32_bf16 a[12:15], a[120:123], a[216:219], a[12:15]
  v_cvt_pk_bf16_f32 v32, v224, v225
  v_cvt_pk_bf16_f32 v33, v226, v227
  ds_read_b64_tr_b16 a[86:87], v27 offset:1024
  v_mfma_f32_16x16x32_bf16 a[12:15], a[124:127], a[220:223], a[12:15]
  v_cvt_pk_bf16_f32 v34, v228, v229
  v_cvt_pk_bf16_f32 v35, v230, v231
  s_add_u32 s57, s58, 12288
  ds_read_b64_tr_b16 a[88:89], v28 offset:0
  v_mfma_f32_16x16x32_bf16 a[16:19], a[128:131], a[216:219], a[16:19]
  v_cvt_pk_bf16_f32 v36, v232, v233
  buffer_store_dwordx4 v[56:59], v16, s[40:43], s57 offen offset:0 sc1
  ds_read_b64_tr_b16 a[90:91], v28 offset:1024
  v_mfma_f32_16x16x32_bf16 a[16:19], a[132:135], a[220:223], a[16:19]
  v_cvt_pk_bf16_f32 v37, v234, v235
  v_cvt_pk_bf16_f32 v38, v236, v237
  ds_read_b64_tr_b16 a[92:93], v29 offset:0
  v_mfma_f32_16x16x32_bf16 a[20:23], a[136:139], a[216:219], a[20:23]
  v_cvt_pk_bf16_f32 v39, v238, v239
  ds_read_b64_tr_b16 a[94:95], v29 offset:1024
  v_mfma_f32_16x16x32_bf16 a[20:23], a[140:143], a[220:223], a[20:23]
  v_cvt_pk_bf16_f32 v40, v240, v241
  v_cvt_pk_bf16_f32 v41, v242, v243
  ds_read_b128 a[48:51], v31 offset:0
  v_mfma_f32_16x16x32_bf16 a[24:27], a[144:147], a[216:219], a[24:27]
  v_cvt_pk_bf16_f32 v42, v244, v245
  v_cvt_pk_bf16_f32 v43, v246, v247
  ds_read_b128 a[52:55], v31 offset:2048
  v_mfma_f32_16x16x32_bf16 a[24:27], a[148:151], a[220:223], a[24:27]
  v_cvt_pk_bf16_f32 v44, v248, v249
  s_add_u32 s57, s58, 12288
  ds_read_b128 a[56:59], v31 offset:4096
  v_mfma_f32_16x16x32_bf16 a[28:31], a[152:155], a[216:219], a[28:31]
  v_cvt_pk_bf16_f32 v45, v250, v251
  v_cvt_pk_bf16_f32 v46, v252, v253
  buffer_store_dwordx4 v[60:63], v16, s[40:43], s57 offen offset:1024 sc1
  v_add_u32 v2, 0x8000, v2
  v_min_u32 v3, s94, v2
  ds_read_b128 a[60:63], v31 offset:6144
  v_mfma_f32_16x16x32_bf16 a[28:31], a[156:159], a[220:223], a[28:31]
  v_cvt_pk_bf16_f32 v47, v254, v255
  global_load_dword v0, v3, s[92:93]
  buffer_load_dwordx2 a[160:161], v20, s[44:47], s95 offen nt
  buffer_load_dwordx2 a[162:163], v20, s[44:47], s3 offen nt
  s_nop 5
  v_accvgpr_read_b32 v192, a0
  v_accvgpr_read_b32 v193, a1
  v_accvgpr_read_b32 v194, a2
  v_accvgpr_read_b32 v195, a3
  v_accvgpr_read_b32 v196, a4
  v_accvgpr_read_b32 v197, a5
  v_accvgpr_read_b32 v198, a6
  v_accvgpr_read_b32 v199, a7
  v_accvgpr_read_b32 v200, a8
  v_accvgpr_read_b32 v201, a9
  v_accvgpr_read_b32 v202, a10
  v_accvgpr_read_b32 v203, a11
  v_accvgpr_read_b32 v204, a12
  v_accvgpr_read_b32 v205, a13
  v_accvgpr_read_b32 v206, a14
  v_accvgpr_read_b32 v207, a15
  v_accvgpr_read_b32 v208, a16
  v_accvgpr_read_b32 v209, a17
  v_accvgpr_read_b32 v210, a18
  v_accvgpr_read_b32 v211, a19
  v_accvgpr_read_b32 v212, a20
  v_accvgpr_read_b32 v213, a21
  v_accvgpr_read_b32 v214, a22
  v_accvgpr_read_b32 v215, a23
  v_accvgpr_read_b32 v216, a24
  v_accvgpr_read_b32 v217, a25
  v_accvgpr_read_b32 v218, a26
  v_accvgpr_read_b32 v219, a27
  v_accvgpr_read_b32 v220, a28
  v_accvgpr_read_b32 v221, a29
  v_accvgpr_read_b32 v222, a30
  v_accvgpr_read_b32 v223, a31
  v_cvt_pk_bf16_f32 v48, v192, v193
  v_cvt_pk_bf16_f32 v49, v194, v195
  v_cvt_pk_bf16_f32 v50, v196, v197
  v_cvt_pk_bf16_f32 v51, v198, v199
  v_cvt_pk_bf16_f32 v52, v200, v201
  v_cvt_pk_bf16_f32 v53, v202, v203
  v_cvt_pk_bf16_f32 v54, v204, v205
  v_cvt_pk_bf16_f32 v55, v206, v207
  v_cvt_pk_bf16_f32 v56, v208, v209
  v_cvt_pk_bf16_f32 v57, v210, v211
  v_cvt_pk_bf16_f32 v58, v212, v213
  v_cvt_pk_bf16_f32 v59, v214, v215
  v_cvt_pk_bf16_f32 v60, v216, v217
  v_cvt_pk_bf16_f32 v61, v218, v219
  v_cvt_pk_bf16_f32 v62, v220, v221
  v_cvt_pk_bf16_f32 v63, v222, v223
  s_branch LKV_done
LKV_V0:
  v_mfma_f32_16x16x32_bf16 v[32:35], a[160:163], a[32:35], 0
  s_add_u32 m0, s51, 0
  v_mfma_f32_16x16x32_bf16 v[32:35], a[164:167], a[36:39], v[32:35]
  buffer_load_dwordx4 v4, s[32:35], s48 offen offset:0 lds
  v_mfma_f32_16x16x32_bf16 v[36:39], a[160:163], a[40:43], 0
  s_add_u32 m0, s51, 0
  v_mfma_f32_16x16x32_bf16 v[36:39], a[164:167], a[44:47], v[36:39]
  buffer_load_dwordx4 v5, s[32:35], s48 offen offset:1024 lds
  v_mfma_f32_16x16x32_bf16 v[40:43], a[160:163], a[48:51], 0
  v_mfma_f32_16x16x32_bf16 v[40:43], a[164:167], a[52:55], v[40:43]
  v_mfma_f32_16x16x32_bf16 v[44:47], a[160:163], a[56:59], 0
  s_waitcnt lgkmcnt(0)
  s_barrier
  v_mfma_f32_16x16x32_bf16 v[44:47], a[164:167], a[60:63], v[44:47]
  v_mfma_f32_16x16x32_bf16 v[48:51], a[160:163], a[64:67], 0
  ds_read_b128 a[192:195], v20 offset:8192
  v_mfma_f32_16x16x32_bf16 v[48:51], a[164:167], a[68:71], v[48:51]
  s_add_u32 m0, s51, 32768
  v_mfma_f32_16x16x32_bf16 v[52:55], a[160:163], a[72:75], 0
  buffer_load_dwordx4 v12, s[36:39], s49 offen offset:0 nt lds
  v_mfma_f32_16x16x32_bf16 v[52:55], a[164:167], a[76:79], v[52:55]
  s_add_u32 m0, s51, 0
  v_mfma_f32_16x16x32_bf16 v[56:59], a[160:163], a[80:83], 0
  buffer_load_dwordx4 v6, s[32:35], s48 offen offset:2048 lds
  ds_read_b128 a[196:199], v21 offset:8192
  v_mfma_f32_16x16x32_bf16 v[56:59], a[164:167], a[84:87], v[56:59]
  s_add_u32 m0, s51, 32768
  v_mfma_f32_16x16x32_bf16 v[60:63], a[160:163], a[88:91], 0
  buffer_load_dwordx4 v13, s[36:39], s49 offen offset:1024 nt lds
  v_mfma_f32_16x16x32_bf16 v[60:63], a[164:167], a[92:95], v[60:63]
  v_mfma_f32_16x16x32_bf16 v[64:67], a[168:171], a[32:35], 0
  s_add_u32 m0, s51, 0
  v_mfma_f32_16x16x32_bf16 v[64:67], a[172:175], a[36:39], v[64:67]
  buffer_load_dwordx4 v7, s[32:35], s48 offen offset:3072 lds
  v_mfma_f32_16x16x32_bf16 v[68:71], a[168:171], a[40:43], 0
  s_add_u32 m0, s51, 4096
  ds_read_b128 a[200:203], v20 offset:10240
  v_mfma_f32_16x16x32_bf16 v[68:71], a[172:175], a[44:47], v[68:71]
  buffer_load_dwordx4 v8, s[32:35], s48 offen offset:0 lds
  v_mfma_f32_16x16x32_bf16 v[72:75], a[168:171], a[48:51], 0
  s_add_u32 m0, s51, 32768
  s_add_u32 s93, s93, 16384
  v_mfma_f32_16x16x32_bf16 v[72:75], a[172:175], a[52:55], v[72:75]
  buffer_load_dwordx4 v14, s[36:39], s49 offen offset:2048 nt lds
  v_mfma_f32_16x16x32_bf16 v[76:79], a[168:171], a[56:59], 0
  v_mfma_f32_16x16x32_bf16 v[76:79], a[172:175], a[60:63], v[76:79]
  s_add_u32 m0, s51, 4096
  v_mfma_f32_16x16x32_bf16 v[80:83], a[168:171], a[64:67], 0
  buffer_load_dwordx4 v9, s[32:35], s48 offen offset:1024 lds
  ds_read_b128 a[204:207], v21 offset:10240
  v_mfma_f32_16x16x32_bf16 v[80:83], a[172:175], a[68:71], v[80:83]
  v_mfma_f32_16x16x32_bf16 v[84:87], a[168:171], a[72:75], 0
  s_add_u32 m0, s51, 32768
  v_mfma_f32_16x16x32_bf16 v[84:87], a[172:175], a[76:79], v[84:87]
  buffer_load_dwordx4 v15, s[36:39], s49 offen offset:3072 nt lds
  v_mfma_f32_16x16x32_bf16 v[88:91], a[168:171], a[80:83], 0
  v_mfma_f32_16x16x32_bf16 v[88:91], a[172:175], a[84:87], v[88:91]
  s_add_u32 m0, s51, 4096
  v_mfma_f32_16x16x32_bf16 v[92:95], a[168:171], a[88:91], 0
  buffer_load_dwordx4 v10, s[32:35], s48 offen offset:2048 lds
  v_mfma_f32_16x16x32_bf16 v[92:95], a[172:175], a[92:95], v[92:95]
  v_mfma_f32_16x16x32_bf16 v[96:99], a[176:179], a[32:35], 0
  s_add_u32 m0, s51, 4096
  v_mfma_f32_16x16x32_bf16 v[96:99], a[180:183], a[36:39], v[96:99]
  buffer_load_dwordx4 v11, s[32:35], s48 offen offset:3072 lds
  v_xor_b32 v22, 0x10000, v22
  v_mfma_f32_16x16x32_bf16 v[100:103], a[176:179], a[40:43], 0
  s_add_u32 s48, s48, 128
  ds_read_b128 a[208:211], v20 offset:12288
  v_mfma_f32_16x16x32_bf16 v[100:103], a[180:183], a[44:47], v[100:103]
  v_xor_b32 v23, 0x10000, v23
  v_mfma_f32_16x16x32_bf16 v[104:107], a[176:179], a[48:51], 0
  s_add_u32 m0, s51, 36864
  v_mfma_f32_16x16x32_bf16 v[104:107], a[180:183], a[52:55], v[104:107]
  buffer_load_dwordx4 v16, s[36:39], s49 offen offset:0 nt lds
  v_mfma_f32_16x16x32_bf16 v[108:111], a[176:179], a[56:59], 0
  s_lshr_b32 s54, s2, 2
  v_mfma_f32_16x16x32_bf16 v[108:111], a[180:183], a[60:63], v[108:111]
  s_and_b32 s54, s54, 1
  v_xor_b32 v24, 0x10000, v24
  v_mfma_f32_16x16x32_bf16 v[112:115], a[176:179], a[64:67], 0
  s_lshl_b32 s55, s30, 2
  ds_read_b128 a[212:215], v21 offset:12288
  v_mfma_f32_16x16x32_bf16 v[112:115], a[180:183], a[68:71], v[112:115]
  s_sub_u32 s55, 30, s55
  v_xor_b32 v25, 0x10000, v25
  v_mfma_f32_16x16x32_bf16 v[116:119], a[176:179], a[72:75], 0
  s_mul_i32 s55, s55, s54
  v_mfma_f32_16x16x32_bf16 v[116:119], a[180:183], a[76:79], v[116:119]
  s_lshl_b32 s100, s30, 1
  buffer_load_dwordx4 v17, s[36:39], s49 offen offset:1024 nt lds
  v_mfma_f32_16x16x32_bf16 v[120:123], a[176:179], a[80:83], 0
  s_add_u32 s100, s100, s55
  v_mfma_f32_16x16x32_bf16 v[120:123], a[180:183], a[84:87], v[120:123]
  s_lshr_b32 s54, s2, 1
  v_xor_b32 v26, 0x10000, v26
  v_mfma_f32_16x16x32_bf16 v[124:127], a[176:179], a[88:91], 0
  s_and_b32 s54, s54, 1
  v_mfma_f32_16x16x32_bf16 v[124:127], a[180:183], a[92:95], v[124:127]
  s_add_u32 s100, s100, s54
  v_xor_b32 v27, 0x10000, v27
  v_mfma_f32_16x16x32_bf16 v[128:131], a[184:187], a[32:35], 0
  s_and_b32 s101, s2, 1
  v_mfma_f32_16x16x32_bf16 v[128:131], a[188:191], a[36:39], v[128:131]
  s_lshl_b32 s101, s101, 2
  v_mfma_f32_16x16x32_bf16 v[132:135], a[184:187], a[40:43], 0
  s_and_b32 s54, s31, 3
  ds_read_b128 a[216:219], v20 offset:14336
  v_mfma_f32_16x16x32_bf16 v[132:135], a[188:191], a[44:47], v[132:135]
  s_add_u32 s101, s101, s54
  v_xor_b32 v28, 0x10000, v28
  v_mfma_f32_16x16x32_bf16 v[136:139], a[184:187], a[48:51], 0
  s_mul_i32 s58, s29, 1048576
  v_mfma_f32_16x16x32_bf16 v[136:139], a[188:191], a[52:55], v[136:139]
  s_lshl_b32 s55, s30, 17
  buffer_load_dwordx4 v18, s[36:39], s49 offen offset:2048 nt lds
  v_mfma_f32_16x16x32_bf16 v[140:143], a[184:187], a[56:59], 0
  s_add_u32 s58, s58, s55
  v_mfma_f32_16x16x32_bf16 v[140:143], a[188:191], a[60:63], v[140:143]
  s_lshr_b32 s55, s28, 1
  v_xor_b32 v29, 0x10000, v29
  v_mfma_f32_16x16x32_bf16 v[144:147], a[184:187], a[64:67], 0
  s_lshl_b32 s55, s55, 16
  ds_read_b128 a[220:223], v21 offset:14336
  v_mfma_f32_16x16x32_bf16 v[144:147], a[188:191], a[68:71], v[144:147]
  s_add_u32 s58, s58, s55
  v_mfma_f32_16x16x32_bf16 v[148:151], a[184:187], a[72:75], 0
  s_and_b32 s55, s28, 1
  v_mfma_f32_16x16x32_bf16 v[148:151], a[188:191], a[76:79], v[148:151]
  s_mul_i32 s55, s55, 34816
  buffer_load_dwordx4 v19, s[36:39], s49 offen offset:3072 nt lds
  v_mfma_f32_16x16x32_bf16 v[152:155], a[184:187], a[80:83], 0
  s_add_u32 s58, s58, s55
  v_mfma_f32_16x16x32_bf16 v[152:155], a[188:191], a[84:87], v[152:155]
  s_add_u32 s49, s49, 524288
  v_mfma_f32_16x16x32_bf16 v[156:159], a[184:187], a[88:91], 0
  v_mfma_f32_16x16x32_bf16 v[156:159], a[188:191], a[92:95], v[156:159]
  s_waitcnt vmcnt(16) lgkmcnt(0)
  s_barrier
  v_mfma_f32_16x16x32_bf16 v[160:163], a[192:195], a[32:35], 0
  s_add_u32 s53, s52, s51
  s_add_u32 s52, s52, 0x10000
  v_mfma_f32_16x16x32_bf16 v[160:163], a[196:199], a[36:39], v[160:163]
  s_cmp_eq_u32 s52, 0x30000
  s_cselect_b32 s52, 0, s52
  v_mfma_f32_16x16x32_bf16 v[164:167], a[192:195], a[40:43], 0
  ds_read_b64_tr_b16 a[96:97], v22 offset:0
  v_mfma_f32_16x16x32_bf16 v[164:167], a[196:199], a[44:47], v[164:167]
  ds_read_b64_tr_b16 a[98:99], v22 offset:1024
  v_mfma_f32_16x16x32_bf16 v[168:171], a[192:195], a[48:51], 0
  ds_read_b64_tr_b16 a[100:101], v22 offset:8192
  v_mfma_f32_16x16x32_bf16 v[168:171], a[196:199], a[52:55], v[168:171]
  v_add_u32 v20, s52, v30
  v_add_u32 v21, s52, v31
  s_mov_b32 m0, s53
  v_mfma_f32_16x16x32_bf16 v[172:175], a[192:195], a[56:59], 0
  ds_read_b64_tr_b16 a[102:103], v22 offset:9216
  v_mfma_f32_16x16x32_bf16 v[172:175], a[196:199], a[60:63], v[172:175]
  ds_read_b128 a[160:163], v20 offset:0
  v_mfma_f32_16x16x32_bf16 v[176:179], a[192:195], a[64:67], 0
  ds_read_b64_tr_b16 a[104:105], v23 offset:0
  v_mfma_f32_16x16x32_bf16 v[176:179], a[196:199], a[68:71], v[176:179]
  buffer_load_dwordx4 v4, s[32:35], s48 offen offset:0 lds
  v_mfma_f32_16x16x32_bf16 v[180:183], a[192:195], a[72:75], 0
  ds_read_b64_tr_b16 a[106:107], v23 offset:1024
  v_mfma_f32_16x16x32_bf16 v[180:183], a[196:199], a[76:79], v[180:183]
  ds_read_b64_tr_b16 a[108:109], v23 offset:8192
  v_mfma_f32_16x16x32_bf16 v[184:187], a[192:195], a[80:83], 0
  ds_read_b64_tr_b16 a[110:111], v23 offset:9216
  v_mfma_f32_16x16x32_bf16 v[184:187], a[196:199], a[84:87], v[184:187]
  buffer_load_dwordx4 v5, s[32:35], s48 offen offset:1024 lds
  v_mfma_f32_16x16x32_bf16 v[188:191], a[192:195], a[88:91], 0
  ds_read_b128 a[164:167], v21 offset:0
  v_mfma_f32_16x16x32_bf16 v[188:191], a[196:199], a[92:95], v[188:191]
  v_mfma_f32_16x16x32_bf16 v[192:195], a[200:203], a[32:35], 0
  v_mfma_f32_16x16x32_bf16 v[192:195], a[204:207], a[36:39], v[192:195]
  v_mfma_f32_16x16x32_bf16 v[196:199], a[200:203], a[40:43], 0
  ds_read_b64_tr_b16 a[112:113], v24 offset:0
  v_mfma_f32_16x16x32_bf16 v[196:199], a[204:207], a[44:47], v[196:199]
  ds_read_b64_tr_b16 a[114:115], v24 offset:1024
  v_mfma_f32_16x16x32_bf16 v[200:203], a[200:203], a[48:51], 0
  ds_read_b64_tr_b16 a[116:117], v24 offset:8192
  v_mfma_f32_16x16x32_bf16 v[200:203], a[204:207], a[52:55], v[200:203]
  buffer_load_dwordx4 v6, s[32:35], s48 offen offset:2048 lds
  v_mfma_f32_16x16x32_bf16 v[204:207], a[200:203], a[56:59], 0
  ds_read_b64_tr_b16 a[118:119], v24 offset:9216
  v_mfma_f32_16x16x32_bf16 v[204:207], a[204:207], a[60:63], v[204:207]
  ds_read_b128 a[168:171], v20 offset:2048
  v_mfma_f32_16x16x32_bf16 v[208:211], a[200:203], a[64:67], 0
  ds_read_b64_tr_b16 a[120:121], v25 offset:0
  v_mfma_f32_16x16x32_bf16 v[208:211], a[204:207], a[68:71], v[208:211]
  v_mfma_f32_16x16x32_bf16 v[212:215], a[200:203], a[72:75], 0
  ds_read_b64_tr_b16 a[122:123], v25 offset:1024
  v_mfma_f32_16x16x32_bf16 v[212:215], a[204:207], a[76:79], v[212:215]
  ds_read_b64_tr_b16 a[124:125], v25 offset:8192
  v_mfma_f32_16x16x32_bf16 v[216:219], a[200:203], a[80:83], 0
  ds_read_b64_tr_b16 a[126:127], v25 offset:9216
  v_mfma_f32_16x16x32_bf16 v[216:219], a[204:207], a[84:87], v[216:219]
  buffer_load_dwordx4 v7, s[32:35], s48 offen offset:3072 lds
  v_mfma_f32_16x16x32_bf16 v[220:223], a[200:203], a[88:91], 0
  ds_read_b128 a[172:175], v21 offset:2048
  v_mfma_f32_16x16x32_bf16 v[220:223], a[204:207], a[92:95], v[220:223]
  v_mfma_f32_16x16x32_bf16 v[224:227], a[208:211], a[32:35], 0
  v_mfma_f32_16x16x32_bf16 v[224:227], a[212:215], a[36:39], v[224:227]
  v_mfma_f32_16x16x32_bf16 v[228:231], a[208:211], a[40:43], 0
  ds_read_b64_tr_b16 a[128:129], v26 offset:0
  v_mfma_f32_16x16x32_bf16 v[228:231], a[212:215], a[44:47], v[228:231]
  ds_read_b64_tr_b16 a[130:131], v26 offset:1024
  v_mfma_f32_16x16x32_bf16 v[232:235], a[208:211], a[48:51], 0
  ds_read_b64_tr_b16 a[132:133], v26 offset:8192
  s_add_u32 m0, s53, 4096
  v_mfma_f32_16x16x32_bf16 v[232:235], a[212:215], a[52:55], v[232:235]
  buffer_load_dwordx4 v8, s[32:35], s48 offen offset:0 lds
  v_mfma_f32_16x16x32_bf16 v[236:239], a[208:211], a[56:59], 0
  ds_read_b64_tr_b16 a[134:135], v26 offset:9216
  v_mfma_f32_16x16x32_bf16 v[236:239], a[212:215], a[60:63], v[236:239]
  ds_read_b128 a[176:179], v20 offset:4096
  v_mfma_f32_16x16x32_bf16 v[240:243], a[208:211], a[64:67], 0
  ds_read_b64_tr_b16 a[136:137], v27 offset:0
  v_mfma_f32_16x16x32_bf16 v[240:243], a[212:215], a[68:71], v[240:243]
  v_mfma_f32_16x16x32_bf16 v[244:247], a[208:211], a[72:75], 0
  ds_read_b64_tr_b16 a[138:139], v27 offset:1024
  v_mfma_f32_16x16x32_bf16 v[244:247], a[212:215], a[76:79], v[244:247]
  ds_read_b64_tr_b16 a[140:141], v27 offset:8192
  v_mfma_f32_16x16x32_bf16 v[248:251], a[208:211], a[80:83], 0
  ds_read_b64_tr_b16 a[142:143], v27 offset:9216
  v_mfma_f32_16x16x32_bf16 v[248:251], a[212:215], a[84:87], v[248:251]
  buffer_load_dwordx4 v9, s[32:35], s48 offen offset:1024 lds
  v_mfma_f32_16x16x32_bf16 v[252:255], a[208:211], a[88:91], 0
  ds_read_b128 a[180:183], v21 offset:4096
  v_mfma_f32_16x16x32_bf16 v[252:255], a[212:215], a[92:95], v[252:255]
  v_mfma_f32_16x16x32_bf16 a[0:3], a[216:219], a[32:35], 0
  v_mfma_f32_16x16x32_bf16 a[0:3], a[220:223], a[36:39], a[0:3]
  v_mfma_f32_16x16x32_bf16 a[4:7], a[216:219], a[40:43], 0
  ds_read_b64_tr_b16 a[144:145], v28 offset:0
  v_mfma_f32_16x16x32_bf16 a[4:7], a[220:223], a[44:47], a[4:7]
  ds_read_b64_tr_b16 a[146:147], v28 offset:1024
  v_mfma_f32_16x16x32_bf16 a[8:11], a[216:219], a[48:51], 0
  ds_read_b64_tr_b16 a[148:149], v28 offset:8192
  v_mfma_f32_16x16x32_bf16 a[8:11], a[220:223], a[52:55], a[8:11]
  buffer_load_dwordx4 v10, s[32:35], s48 offen offset:2048 lds
  v_mfma_f32_16x16x32_bf16 a[12:15], a[216:219], a[56:59], 0
  ds_read_b64_tr_b16 a[150:151], v28 offset:9216
  v_mfma_f32_16x16x32_bf16 a[12:15], a[220:223], a[60:63], a[12:15]
  ds_read_b128 a[184:187], v20 offset:6144
  v_mfma_f32_16x16x32_bf16 a[16:19], a[216:219], a[64:67], 0
  ds_read_b64_tr_b16 a[152:153], v29 offset:0
  v_mfma_f32_16x16x32_bf16 a[16:19], a[220:223], a[68:71], a[16:19]
  v_mfma_f32_16x16x32_bf16 a[20:23], a[216:219], a[72:75], 0
  ds_read_b64_tr_b16 a[154:155], v29 offset:1024
  v_mfma_f32_16x16x32_bf16 a[20:23], a[220:223], a[76:79], a[20:23]
  ds_read_b64_tr_b16 a[156:157], v29 offset:8192
  v_mfma_f32_16x16x32_bf16 a[24:27], a[216:219], a[80:83], 0
  ds_read_b64_tr_b16 a[158:159], v29 offset:9216
  v_mfma_f32_16x16x32_bf16 a[24:27], a[220:223], a[84:87], a[24:27]
  buffer_load_dwordx4 v11, s[32:35], s48 offen offset:3072 lds
  v_mfma_f32_16x16x32_bf16 a[28:31], a[216:219], a[88:91], 0
  ds_read_b128 a[188:191], v21 offset:6144
  v_mfma_f32_16x16x32_bf16 a[28:31], a[220:223], a[92:95], a[28:31]
  s_add_u32 s48, s48, 128
  buffer_load_dword a248, v0, s[44:47], s92 offen
  s_branch LKV_V
.p2align 6
LKV_V:
  s_waitcnt lgkmcnt(3)
  v_mfma_f32_16x16x32_bf16 v[32:35], a[160:163], a[96:99], v[32:35]
  v_mfma_f32_16x16x32_bf16 v[32:35], a[164:167], a[100:103], v[32:35]
  v_mfma_f32_16x16x32_bf16 v[36:39], a[160:163], a[104:107], v[36:39]
  v_mfma_f32_16x16x32_bf16 v[36:39], a[164:167], a[108:111], v[36:39]
  v_mfma_f32_16x16x32_bf16 v[40:43], a[160:163], a[112:115], v[40:43]
  v_mfma_f32_16x16x32_bf16 v[40:43], a[164:167], a[116:119], v[40:43]
  v_mfma_f32_16x16x32_bf16 v[44:47], a[160:163], a[120:123], v[44:47]
  s_waitcnt lgkmcnt(0)
  s_barrier
  v_mfma_f32_16x16x32_bf16 v[44:47], a[164:167], a[124:127], v[44:47]
  v_mfma_f32_16x16x32_bf16 v[48:51], a[160:163], a[128:131], v[48:51]
  ds_read_b128 a[192:195], v20 offset:8192
  v_mfma_f32_16x16x32_bf16 v[48:51], a[164:167], a[132:135], v[48:51]
  s_add_u32 m0, s51, 98304
  v_mfma_f32_16x16x32_bf16 v[52:55], a[160:163], a[136:139], v[52:55]
  buffer_load_dwordx4 v12, s[36:39], s49 offen offset:0 nt lds
  v_mfma_f32_16x16x32_bf16 v[52:55], a[164:167], a[140:143], v[52:55]
  v_mfma_f32_16x16x32_bf16 v[56:59], a[160:163], a[144:147], v[56:59]
  ds_read_b128 a[196:199], v21 offset:8192
  v_mfma_f32_16x16x32_bf16 v[56:59], a[164:167], a[148:151], v[56:59]
  v_mfma_f32_16x16x32_bf16 v[60:63], a[160:163], a[152:155], v[60:63]
  buffer_load_dwordx4 v13, s[36:39], s49 offen offset:1024 nt lds
  v_mfma_f32_16x16x32_bf16 v[60:63], a[164:167], a[156:159], v[60:63]
  v_mfma_f32_16x16x32_bf16 v[64:67], a[168:171], a[96:99], v[64:67]
  v_mfma_f32_16x16x32_bf16 v[64:67], a[172:175], a[100:103], v[64:67]
  v_mfma_f32_16x16x32_bf16 v[68:71], a[168:171], a[104:107], v[68:71]
  ds_read_b128 a[200:203], v20 offset:10240
  v_mfma_f32_16x16x32_bf16 v[68:71], a[172:175], a[108:111], v[68:71]
  v_mfma_f32_16x16x32_bf16 v[72:75], a[168:171], a[112:115], v[72:75]
  v_mfma_f32_16x16x32_bf16 v[72:75], a[172:175], a[116:119], v[72:75]
  buffer_load_dwordx4 v14, s[36:39], s49 offen offset:2048 nt lds
  v_mfma_f32_16x16x32_bf16 v[76:79], a[168:171], a[120:123], v[76:79]
  v_mfma_f32_16x16x32_bf16 v[76:79], a[172:175], a[124:127], v[76:79]
  v_mfma_f32_16x16x32_bf16 v[80:83], a[168:171], a[128:131], v[80:83]
  ds_read_b128 a[204:207], v21 offset:10240
  v_mfma_f32_16x16x32_bf16 v[80:83], a[172:175], a[132:135], v[80:83]
  v_mfma_f32_16x16x32_bf16 v[84:87], a[168:171], a[136:139], v[84:87]
  v_mfma_f32_16x16x32_bf16 v[84:87], a[172:175], a[140:143], v[84:87]
  buffer_load_dwordx4 v15, s[36:39], s49 offen offset:3072 nt lds
  v_mfma_f32_16x16x32_bf16 v[88:91], a[168:171], a[144:147], v[88:91]
  v_mfma_f32_16x16x32_bf16 v[88:91], a[172:175], a[148:151], v[88:91]
  v_mfma_f32_16x16x32_bf16 v[92:95], a[168:171], a[152:155], v[92:95]
  v_mfma_f32_16x16x32_bf16 v[92:95], a[172:175], a[156:159], v[92:95]
  v_mfma_f32_16x16x32_bf16 v[96:99], a[176:179], a[96:99], v[96:99]
  v_mfma_f32_16x16x32_bf16 v[96:99], a[180:183], a[100:103], v[96:99]
  v_xor_b32 v22, 0x10000, v22
  v_mfma_f32_16x16x32_bf16 v[100:103], a[176:179], a[104:107], v[100:103]
  ds_read_b128 a[208:211], v20 offset:12288
  v_mfma_f32_16x16x32_bf16 v[100:103], a[180:183], a[108:111], v[100:103]
  v_xor_b32 v23, 0x10000, v23
  v_mfma_f32_16x16x32_bf16 v[104:107], a[176:179], a[112:115], v[104:107]
  s_add_u32 m0, s51, 102400
  v_mfma_f32_16x16x32_bf16 v[104:107], a[180:183], a[116:119], v[104:107]
  buffer_load_dwordx4 v16, s[36:39], s49 offen offset:0 nt lds
  v_mfma_f32_16x16x32_bf16 v[108:111], a[176:179], a[120:123], v[108:111]
  v_mfma_f32_16x16x32_bf16 v[108:111], a[180:183], a[124:127], v[108:111]
  v_xor_b32 v24, 0x10000, v24
  v_mfma_f32_16x16x32_bf16 v[112:115], a[176:179], a[128:131], v[112:115]
  ds_read_b128 a[212:215], v21 offset:12288
  v_mfma_f32_16x16x32_bf16 v[112:115], a[180:183], a[132:135], v[112:115]
  v_xor_b32 v25, 0x10000, v25
  v_mfma_f32_16x16x32_bf16 v[116:119], a[176:179], a[136:139], v[116:119]
  v_mfma_f32_16x16x32_bf16 v[116:119], a[180:183], a[140:143], v[116:119]
  buffer_load_dwordx4 v17, s[36:39], s49 offen offset:1024 nt lds
  v_mfma_f32_16x16x32_bf16 v[120:123], a[176:179], a[144:147], v[120:123]
  v_mfma_f32_16x16x32_bf16 v[120:123], a[180:183], a[148:151], v[120:123]
  v_xor_b32 v26, 0x10000, v26
  v_mfma_f32_16x16x32_bf16 v[124:127], a[176:179], a[152:155], v[124:127]
  v_mfma_f32_16x16x32_bf16 v[124:127], a[180:183], a[156:159], v[124:127]
  v_xor_b32 v27, 0x10000, v27
  v_mfma_f32_16x16x32_bf16 v[128:131], a[184:187], a[96:99], v[128:131]
  v_mfma_f32_16x16x32_bf16 v[128:131], a[188:191], a[100:103], v[128:131]
  v_mfma_f32_16x16x32_bf16 v[132:135], a[184:187], a[104:107], v[132:135]
  ds_read_b128 a[216:219], v20 offset:14336
  v_mfma_f32_16x16x32_bf16 v[132:135], a[188:191], a[108:111], v[132:135]
  v_xor_b32 v28, 0x10000, v28
  v_mfma_f32_16x16x32_bf16 v[136:139], a[184:187], a[112:115], v[136:139]
  v_mfma_f32_16x16x32_bf16 v[136:139], a[188:191], a[116:119], v[136:139]
  buffer_load_dwordx4 v18, s[36:39], s49 offen offset:2048 nt lds
  v_mfma_f32_16x16x32_bf16 v[140:143], a[184:187], a[120:123], v[140:143]
  v_mfma_f32_16x16x32_bf16 v[140:143], a[188:191], a[124:127], v[140:143]
  v_xor_b32 v29, 0x10000, v29
  v_mfma_f32_16x16x32_bf16 v[144:147], a[184:187], a[128:131], v[144:147]
  ds_read_b128 a[220:223], v21 offset:14336
  v_mfma_f32_16x16x32_bf16 v[144:147], a[188:191], a[132:135], v[144:147]
  v_mfma_f32_16x16x32_bf16 v[148:151], a[184:187], a[136:139], v[148:151]
  v_mfma_f32_16x16x32_bf16 v[148:151], a[188:191], a[140:143], v[148:151]
  buffer_load_dwordx4 v19, s[36:39], s49 offen offset:3072 nt lds
  v_mfma_f32_16x16x32_bf16 v[152:155], a[184:187], a[144:147], v[152:155]
  v_mfma_f32_16x16x32_bf16 v[152:155], a[188:191], a[148:151], v[152:155]
  s_add_u32 s49, s49, 524288
  v_mfma_f32_16x16x32_bf16 v[156:159], a[184:187], a[152:155], v[156:159]
  v_mfma_f32_16x16x32_bf16 v[156:159], a[188:191], a[156:159], v[156:159]
  s_waitcnt vmcnt(17) lgkmcnt(0)
  s_barrier
  v_mfma_f32_16x16x32_bf16 v[160:163], a[192:195], a[96:99], v[160:163]
  s_add_u32 s53, s52, s51
  s_add_u32 s52, s52, 0x10000
  v_mfma_f32_16x16x32_bf16 v[160:163], a[196:199], a[100:103], v[160:163]
  s_cmp_eq_u32 s52, 0x30000
  s_cselect_b32 s52, 0, s52
  v_mfma_f32_16x16x32_bf16 v[164:167], a[192:195], a[104:107], v[164:167]
  ds_read_b64_tr_b16 a[32:33], v22 offset:0
  v_mfma_f32_16x16x32_bf16 v[164:167], a[196:199], a[108:111], v[164:167]
  ds_read_b64_tr_b16 a[34:35], v22 offset:1024
  v_mfma_f32_16x16x32_bf16 v[168:171], a[192:195], a[112:115], v[168:171]
  ds_read_b64_tr_b16 a[36:37], v22 offset:8192
  v_mfma_f32_16x16x32_bf16 v[168:171], a[196:199], a[116:119], v[168:171]
  v_add_u32 v20, s52, v30
  v_add_u32 v21, s52, v31
  s_mov_b32 m0, s53
  v_mfma_f32_16x16x32_bf16 v[172:175], a[192:195], a[120:123], v[172:175]
  ds_read_b64_tr_b16 a[38:39], v22 offset:9216
  v_mfma_f32_16x16x32_bf16 v[172:175], a[196:199], a[124:127], v[172:175]
  ds_read_b128 a[160:163], v20 offset:0
  v_mfma_f32_16x16x32_bf16 v[176:179], a[192:195], a[128:131], v[176:179]
  ds_read_b64_tr_b16 a[40:41], v23 offset:0
  v_mfma_f32_16x16x32_bf16 v[176:179], a[196:199], a[132:135], v[176:179]
  buffer_load_dwordx4 v4, s[32:35], s48 offen offset:0 lds
  v_mfma_f32_16x16x32_bf16 v[180:183], a[192:195], a[136:139], v[180:183]
  ds_read_b64_tr_b16 a[42:43], v23 offset:1024
  v_mfma_f32_16x16x32_bf16 v[180:183], a[196:199], a[140:143], v[180:183]
  ds_read_b64_tr_b16 a[44:45], v23 offset:8192
  v_mfma_f32_16x16x32_bf16 v[184:187], a[192:195], a[144:147], v[184:187]
  ds_read_b64_tr_b16 a[46:47], v23 offset:9216
  v_mfma_f32_16x16x32_bf16 v[184:187], a[196:199], a[148:151], v[184:187]
  buffer_load_dwordx4 v5, s[32:35], s48 offen offset:1024 lds
  v_mfma_f32_16x16x32_bf16 v[188:191], a[192:195], a[152:155], v[188:191]
  ds_read_b128 a[164:167], v21 offset:0
  v_mfma_f32_16x16x32_bf16 v[188:191], a[196:199], a[156:159], v[188:191]
  v_mfma_f32_16x16x32_bf16 v[192:195], a[200:203], a[96:99], v[192:195]
  v_mfma_f32_16x16x32_bf16 v[192:195], a[204:207], a[100:103], v[192:195]
  v_mfma_f32_16x16x32_bf16 v[196:199], a[200:203], a[104:107], v[196:199]
  ds_read_b64_tr_b16 a[48:49], v24 offset:0
  v_mfma_f32_16x16x32_bf16 v[196:199], a[204:207], a[108:111], v[196:199]
  ds_read_b64_tr_b16 a[50:51], v24 offset:1024
  v_mfma_f32_16x16x32_bf16 v[200:203], a[200:203], a[112:115], v[200:203]
  ds_read_b64_tr_b16 a[52:53], v24 offset:8192
  v_mfma_f32_16x16x32_bf16 v[200:203], a[204:207], a[116:119], v[200:203]
  buffer_load_dwordx4 v6, s[32:35], s48 offen offset:2048 lds
  v_mfma_f32_16x16x32_bf16 v[204:207], a[200:203], a[120:123], v[204:207]
  ds_read_b64_tr_b16 a[54:55], v24 offset:9216
  v_mfma_f32_16x16x32_bf16 v[204:207], a[204:207], a[124:127], v[204:207]
  ds_read_b128 a[168:171], v20 offset:2048
  v_mfma_f32_16x16x32_bf16 v[208:211], a[200:203], a[128:131], v[208:211]
  ds_read_b64_tr_b16 a[56:57], v25 offset:0
  v_mfma_f32_16x16x32_bf16 v[208:211], a[204:207], a[132:135], v[208:211]
  v_mfma_f32_16x16x32_bf16 v[212:215], a[200:203], a[136:139], v[212:215]
  ds_read_b64_tr_b16 a[58:59], v25 offset:1024
  v_mfma_f32_16x16x32_bf16 v[212:215], a[204:207], a[140:143], v[212:215]
  ds_read_b64_tr_b16 a[60:61], v25 offset:8192
  v_mfma_f32_16x16x32_bf16 v[216:219], a[200:203], a[144:147], v[216:219]
  ds_read_b64_tr_b16 a[62:63], v25 offset:9216
  v_mfma_f32_16x16x32_bf16 v[216:219], a[204:207], a[148:151], v[216:219]
  buffer_load_dwordx4 v7, s[32:35], s48 offen offset:3072 lds
  v_mfma_f32_16x16x32_bf16 v[220:223], a[200:203], a[152:155], v[220:223]
  ds_read_b128 a[172:175], v21 offset:2048
  v_mfma_f32_16x16x32_bf16 v[220:223], a[204:207], a[156:159], v[220:223]
  v_mfma_f32_16x16x32_bf16 v[224:227], a[208:211], a[96:99], v[224:227]
  v_mfma_f32_16x16x32_bf16 v[224:227], a[212:215], a[100:103], v[224:227]
  v_mfma_f32_16x16x32_bf16 v[228:231], a[208:211], a[104:107], v[228:231]
  ds_read_b64_tr_b16 a[64:65], v26 offset:0
  v_mfma_f32_16x16x32_bf16 v[228:231], a[212:215], a[108:111], v[228:231]
  ds_read_b64_tr_b16 a[66:67], v26 offset:1024
  v_mfma_f32_16x16x32_bf16 v[232:235], a[208:211], a[112:115], v[232:235]
  ds_read_b64_tr_b16 a[68:69], v26 offset:8192
  s_add_u32 m0, s53, 4096
  v_mfma_f32_16x16x32_bf16 v[232:235], a[212:215], a[116:119], v[232:235]
  buffer_load_dwordx4 v8, s[32:35], s48 offen offset:0 lds
  v_mfma_f32_16x16x32_bf16 v[236:239], a[208:211], a[120:123], v[236:239]
  ds_read_b64_tr_b16 a[70:71], v26 offset:9216
  v_mfma_f32_16x16x32_bf16 v[236:239], a[212:215], a[124:127], v[236:239]
  ds_read_b128 a[176:179], v20 offset:4096
  v_mfma_f32_16x16x32_bf16 v[240:243], a[208:211], a[128:131], v[240:243]
  ds_read_b64_tr_b16 a[72:73], v27 offset:0
  v_mfma_f32_16x16x32_bf16 v[240:243], a[212:215], a[132:135], v[240:243]
  v_mfma_f32_16x16x32_bf16 v[244:247], a[208:211], a[136:139], v[244:247]
  ds_read_b64_tr_b16 a[74:75], v27 offset:1024
  v_mfma_f32_16x16x32_bf16 v[244:247], a[212:215], a[140:143], v[244:247]
  ds_read_b64_tr_b16 a[76:77], v27 offset:8192
  v_mfma_f32_16x16x32_bf16 v[248:251], a[208:211], a[144:147], v[248:251]
  ds_read_b64_tr_b16 a[78:79], v27 offset:9216
  v_mfma_f32_16x16x32_bf16 v[248:251], a[212:215], a[148:151], v[248:251]
  buffer_load_dwordx4 v9, s[32:35], s48 offen offset:1024 lds
  v_mfma_f32_16x16x32_bf16 v[252:255], a[208:211], a[152:155], v[252:255]
  ds_read_b128 a[180:183], v21 offset:4096
  v_mfma_f32_16x16x32_bf16 v[252:255], a[212:215], a[156:159], v[252:255]
  v_mfma_f32_16x16x32_bf16 a[0:3], a[216:219], a[96:99], a[0:3]
  v_mfma_f32_16x16x32_bf16 a[0:3], a[220:223], a[100:103], a[0:3]
  v_mfma_f32_16x16x32_bf16 a[4:7], a[216:219], a[104:107], a[4:7]
  ds_read_b64_tr_b16 a[80:81], v28 offset:0
  v_mfma_f32_16x16x32_bf16 a[4:7], a[220:223], a[108:111], a[4:7]
  ds_read_b64_tr_b16 a[82:83], v28 offset:1024
  v_mfma_f32_16x16x32_bf16 a[8:11], a[216:219], a[112:115], a[8:11]
  ds_read_b64_tr_b16 a[84:85], v28 offset:8192
  v_mfma_f32_16x16x32_bf16 a[8:11], a[220:223], a[116:119], a[8:11]
  buffer_load_dwordx4 v10, s[32:35], s48 offen offset:2048 lds
  v_mfma_f32_16x16x32_bf16 a[12:15], a[216:219], a[120:123], a[12:15]
  ds_read_b64_tr_b16 a[86:87], v28 offset:9216
  v_mfma_f32_16x16x32_bf16 a[12:15], a[220:223], a[124:127], a[12:15]
  ds_read_b128 a[184:187], v20 offset:6144
  v_mfma_f32_16x16x32_bf16 a[16:19], a[216:219], a[128:131], a[16:19]
  ds_read_b64_tr_b16 a[88:89], v29 offset:0
  v_mfma_f32_16x16x32_bf16 a[16:19], a[220:223], a[132:135], a[16:19]
  v_mfma_f32_16x16x32_bf16 a[20:23], a[216:219], a[136:139], a[20:23]
  ds_read_b64_tr_b16 a[90:91], v29 offset:1024
  v_mfma_f32_16x16x32_bf16 a[20:23], a[220:223], a[140:143], a[20:23]
  ds_read_b64_tr_b16 a[92:93], v29 offset:8192
  v_mfma_f32_16x16x32_bf16 a[24:27], a[216:219], a[144:147], a[24:27]
  ds_read_b64_tr_b16 a[94:95], v29 offset:9216
  v_mfma_f32_16x16x32_bf16 a[24:27], a[220:223], a[148:151], a[24:27]
  buffer_load_dwordx4 v11, s[32:35], s48 offen offset:3072 lds
  v_mfma_f32_16x16x32_bf16 a[28:31], a[216:219], a[152:155], a[28:31]
  ds_read_b128 a[188:191], v21 offset:6144
  s_add_u32 s92, s92, 896
  v_mfma_f32_16x16x32_bf16 a[28:31], a[220:223], a[156:159], a[28:31]
  s_add_u32 s48, s48, 128
  buffer_load_dword a249, v2, s[96:99], s93 offen
  s_waitcnt lgkmcnt(4)
  v_mfma_f32_16x16x32_bf16 v[32:35], a[160:163], a[32:35], v[32:35]
  v_mfma_f32_16x16x32_bf16 v[32:35], a[164:167], a[36:39], v[32:35]
  v_mfma_f32_16x16x32_bf16 v[36:39], a[160:163], a[40:43], v[36:39]
  v_mfma_f32_16x16x32_bf16 v[36:39], a[164:167], a[44:47], v[36:39]
  v_mfma_f32_16x16x32_bf16 v[40:43], a[160:163], a[48:51], v[40:43]
  v_mfma_f32_16x16x32_bf16 v[40:43], a[164:167], a[52:55], v[40:43]
  v_mfma_f32_16x16x32_bf16 v[44:47], a[160:163], a[56:59], v[44:47]
  s_waitcnt lgkmcnt(0)
  s_barrier
  v_mfma_f32_16x16x32_bf16 v[44:47], a[164:167], a[60:63], v[44:47]
  v_mfma_f32_16x16x32_bf16 v[48:51], a[160:163], a[64:67], v[48:51]
  ds_read_b128 a[192:195], v20 offset:8192
  v_mfma_f32_16x16x32_bf16 v[48:51], a[164:167], a[68:71], v[48:51]
  s_add_u32 m0, s51, 32768
  v_mfma_f32_16x16x32_bf16 v[52:55], a[160:163], a[72:75], v[52:55]
  buffer_load_dwordx4 v12, s[36:39], s49 offen offset:0 nt lds
  v_mfma_f32_16x16x32_bf16 v[52:55], a[164:167], a[76:79], v[52:55]
  v_mfma_f32_16x16x32_bf16 v[56:59], a[160:163], a[80:83], v[56:59]
  ds_read_b128 a[196:199], v21 offset:8192
  v_mfma_f32_16x16x32_bf16 v[56:59], a[164:167], a[84:87], v[56:59]
  v_mfma_f32_16x16x32_bf16 v[60:63], a[160:163], a[88:91], v[60:63]
  buffer_load_dwordx4 v13, s[36:39], s49 offen offset:1024 nt lds
  v_mfma_f32_16x16x32_bf16 v[60:63], a[164:167], a[92:95], v[60:63]
  v_mfma_f32_16x16x32_bf16 v[64:67], a[168:171], a[32:35], v[64:67]
  v_mfma_f32_16x16x32_bf16 v[64:67], a[172:175], a[36:39], v[64:67]
  v_mfma_f32_16x16x32_bf16 v[68:71], a[168:171], a[40:43], v[68:71]
  ds_read_b128 a[200:203], v20 offset:10240
  v_mfma_f32_16x16x32_bf16 v[68:71], a[172:175], a[44:47], v[68:71]
  v_mfma_f32_16x16x32_bf16 v[72:75], a[168:171], a[48:51], v[72:75]
  s_add_u32 s93, s93, 16384
  v_mfma_f32_16x16x32_bf16 v[72:75], a[172:175], a[52:55], v[72:75]
  buffer_load_dwordx4 v14, s[36:39], s49 offen offset:2048 nt lds
  v_mfma_f32_16x16x32_bf16 v[76:79], a[168:171], a[56:59], v[76:79]
  v_mfma_f32_16x16x32_bf16 v[76:79], a[172:175], a[60:63], v[76:79]
  v_mfma_f32_16x16x32_bf16 v[80:83], a[168:171], a[64:67], v[80:83]
  ds_read_b128 a[204:207], v21 offset:10240
  v_mfma_f32_16x16x32_bf16 v[80:83], a[172:175], a[68:71], v[80:83]
  v_mfma_f32_16x16x32_bf16 v[84:87], a[168:171], a[72:75], v[84:87]
  v_mfma_f32_16x16x32_bf16 v[84:87], a[172:175], a[76:79], v[84:87]
  buffer_load_dwordx4 v15, s[36:39], s49 offen offset:3072 nt lds
  v_mfma_f32_16x16x32_bf16 v[88:91], a[168:171], a[80:83], v[88:91]
  v_mfma_f32_16x16x32_bf16 v[88:91], a[172:175], a[84:87], v[88:91]
  v_mfma_f32_16x16x32_bf16 v[92:95], a[168:171], a[88:91], v[92:95]
  v_mfma_f32_16x16x32_bf16 v[92:95], a[172:175], a[92:95], v[92:95]
  v_mfma_f32_16x16x32_bf16 v[96:99], a[176:179], a[32:35], v[96:99]
  v_mfma_f32_16x16x32_bf16 v[96:99], a[180:183], a[36:39], v[96:99]
  v_xor_b32 v22, 0x10000, v22
  v_mfma_f32_16x16x32_bf16 v[100:103], a[176:179], a[40:43], v[100:103]
  ds_read_b128 a[208:211], v20 offset:12288
  v_mfma_f32_16x16x32_bf16 v[100:103], a[180:183], a[44:47], v[100:103]
  v_xor_b32 v23, 0x10000, v23
  v_mfma_f32_16x16x32_bf16 v[104:107], a[176:179], a[48:51], v[104:107]
  s_add_u32 m0, s51, 36864
  v_mfma_f32_16x16x32_bf16 v[104:107], a[180:183], a[52:55], v[104:107]
  buffer_load_dwordx4 v16, s[36:39], s49 offen offset:0 nt lds
  v_mfma_f32_16x16x32_bf16 v[108:111], a[176:179], a[56:59], v[108:111]
  v_mfma_f32_16x16x32_bf16 v[108:111], a[180:183], a[60:63], v[108:111]
  v_xor_b32 v24, 0x10000, v24
  v_mfma_f32_16x16x32_bf16 v[112:115], a[176:179], a[64:67], v[112:115]
  ds_read_b128 a[212:215], v21 offset:12288
  v_mfma_f32_16x16x32_bf16 v[112:115], a[180:183], a[68:71], v[112:115]
  v_xor_b32 v25, 0x10000, v25
  v_mfma_f32_16x16x32_bf16 v[116:119], a[176:179], a[72:75], v[116:119]
  v_mfma_f32_16x16x32_bf16 v[116:119], a[180:183], a[76:79], v[116:119]
  buffer_load_dwordx4 v17, s[36:39], s49 offen offset:1024 nt lds
  v_mfma_f32_16x16x32_bf16 v[120:123], a[176:179], a[80:83], v[120:123]
  v_mfma_f32_16x16x32_bf16 v[120:123], a[180:183], a[84:87], v[120:123]
  v_xor_b32 v26, 0x10000, v26
  v_mfma_f32_16x16x32_bf16 v[124:127], a[176:179], a[88:91], v[124:127]
  v_mfma_f32_16x16x32_bf16 v[124:127], a[180:183], a[92:95], v[124:127]
  v_xor_b32 v27, 0x10000, v27
  v_mfma_f32_16x16x32_bf16 v[128:131], a[184:187], a[32:35], v[128:131]
  v_mfma_f32_16x16x32_bf16 v[128:131], a[188:191], a[36:39], v[128:131]
  v_mfma_f32_16x16x32_bf16 v[132:135], a[184:187], a[40:43], v[132:135]
  ds_read_b128 a[216:219], v20 offset:14336
  v_mfma_f32_16x16x32_bf16 v[132:135], a[188:191], a[44:47], v[132:135]
  v_xor_b32 v28, 0x10000, v28
  v_mfma_f32_16x16x32_bf16 v[136:139], a[184:187], a[48:51], v[136:139]
  v_mfma_f32_16x16x32_bf16 v[136:139], a[188:191], a[52:55], v[136:139]
  buffer_load_dwordx4 v18, s[36:39], s49 offen offset:2048 nt lds
  v_mfma_f32_16x16x32_bf16 v[140:143], a[184:187], a[56:59], v[140:143]
  v_mfma_f32_16x16x32_bf16 v[140:143], a[188:191], a[60:63], v[140:143]
  v_xor_b32 v29, 0x10000, v29
  v_mfma_f32_16x16x32_bf16 v[144:147], a[184:187], a[64:67], v[144:147]
  ds_read_b128 a[220:223], v21 offset:14336
  v_mfma_f32_16x16x32_bf16 v[144:147], a[188:191], a[68:71], v[144:147]
  v_mfma_f32_16x16x32_bf16 v[148:151], a[184:187], a[72:75], v[148:151]
  v_mfma_f32_16x16x32_bf16 v[148:151], a[188:191], a[76:79], v[148:151]
  buffer_load_dwordx4 v19, s[36:39], s49 offen offset:3072 nt lds
  v_mfma_f32_16x16x32_bf16 v[152:155], a[184:187], a[80:83], v[152:155]
  v_mfma_f32_16x16x32_bf16 v[152:155], a[188:191], a[84:87], v[152:155]
  s_add_u32 s49, s49, 524288
  v_mfma_f32_16x16x32_bf16 v[156:159], a[184:187], a[88:91], v[156:159]
  v_mfma_f32_16x16x32_bf16 v[156:159], a[188:191], a[92:95], v[156:159]
  s_waitcnt vmcnt(17) lgkmcnt(0)
  s_barrier
  v_mfma_f32_16x16x32_bf16 v[160:163], a[192:195], a[32:35], v[160:163]
  s_add_u32 s53, s52, s51
  s_add_u32 s52, s52, 0x10000
  v_mfma_f32_16x16x32_bf16 v[160:163], a[196:199], a[36:39], v[160:163]
  s_cmp_eq_u32 s52, 0x30000
  s_cselect_b32 s52, 0, s52
  v_mfma_f32_16x16x32_bf16 v[164:167], a[192:195], a[40:43], v[164:167]
  ds_read_b64_tr_b16 a[96:97], v22 offset:0
  v_mfma_f32_16x16x32_bf16 v[164:167], a[196:199], a[44:47], v[164:167]
  ds_read_b64_tr_b16 a[98:99], v22 offset:1024
  v_mfma_f32_16x16x32_bf16 v[168:171], a[192:195], a[48:51], v[168:171]
  ds_read_b64_tr_b16 a[100:101], v22 offset:8192
  v_mfma_f32_16x16x32_bf16 v[168:171], a[196:199], a[52:55], v[168:171]
  v_add_u32 v20, s52, v30
  v_add_u32 v21, s52, v31
  s_mov_b32 m0, s53
  v_mfma_f32_16x16x32_bf16 v[172:175], a[192:195], a[56:59], v[172:175]
  ds_read_b64_tr_b16 a[102:103], v22 offset:9216
  v_mfma_f32_16x16x32_bf16 v[172:175], a[196:199], a[60:63], v[172:175]
  ds_read_b128 a[160:163], v20 offset:0
  v_mfma_f32_16x16x32_bf16 v[176:179], a[192:195], a[64:67], v[176:179]
  ds_read_b64_tr_b16 a[104:105], v23 offset:0
  v_mfma_f32_16x16x32_bf16 v[176:179], a[196:199], a[68:71], v[176:179]
  buffer_load_dwordx4 v4, s[32:35], s48 offen offset:0 lds
  v_mfma_f32_16x16x32_bf16 v[180:183], a[192:195], a[72:75], v[180:183]
  ds_read_b64_tr_b16 a[106:107], v23 offset:1024
  v_mfma_f32_16x16x32_bf16 v[180:183], a[196:199], a[76:79], v[180:183]
  ds_read_b64_tr_b16 a[108:109], v23 offset:8192
  v_mfma_f32_16x16x32_bf16 v[184:187], a[192:195], a[80:83], v[184:187]
  ds_read_b64_tr_b16 a[110:111], v23 offset:9216
  v_mfma_f32_16x16x32_bf16 v[184:187], a[196:199], a[84:87], v[184:187]
  buffer_load_dwordx4 v5, s[32:35], s48 offen offset:1024 lds
  v_mfma_f32_16x16x32_bf16 v[188:191], a[192:195], a[88:91], v[188:191]
  ds_read_b128 a[164:167], v21 offset:0
  v_mfma_f32_16x16x32_bf16 v[188:191], a[196:199], a[92:95], v[188:191]
  v_mfma_f32_16x16x32_bf16 v[192:195], a[200:203], a[32:35], v[192:195]
  v_mfma_f32_16x16x32_bf16 v[192:195], a[204:207], a[36:39], v[192:195]
  v_mfma_f32_16x16x32_bf16 v[196:199], a[200:203], a[40:43], v[196:199]
  ds_read_b64_tr_b16 a[112:113], v24 offset:0
  v_mfma_f32_16x16x32_bf16 v[196:199], a[204:207], a[44:47], v[196:199]
  ds_read_b64_tr_b16 a[114:115], v24 offset:1024
  v_mfma_f32_16x16x32_bf16 v[200:203], a[200:203], a[48:51], v[200:203]
  ds_read_b64_tr_b16 a[116:117], v24 offset:8192
  v_mfma_f32_16x16x32_bf16 v[200:203], a[204:207], a[52:55], v[200:203]
  buffer_load_dwordx4 v6, s[32:35], s48 offen offset:2048 lds
  v_mfma_f32_16x16x32_bf16 v[204:207], a[200:203], a[56:59], v[204:207]
  ds_read_b64_tr_b16 a[118:119], v24 offset:9216
  v_mfma_f32_16x16x32_bf16 v[204:207], a[204:207], a[60:63], v[204:207]
  ds_read_b128 a[168:171], v20 offset:2048
  v_mfma_f32_16x16x32_bf16 v[208:211], a[200:203], a[64:67], v[208:211]
  ds_read_b64_tr_b16 a[120:121], v25 offset:0
  v_mfma_f32_16x16x32_bf16 v[208:211], a[204:207], a[68:71], v[208:211]
  v_mfma_f32_16x16x32_bf16 v[212:215], a[200:203], a[72:75], v[212:215]
  ds_read_b64_tr_b16 a[122:123], v25 offset:1024
  v_mfma_f32_16x16x32_bf16 v[212:215], a[204:207], a[76:79], v[212:215]
  ds_read_b64_tr_b16 a[124:125], v25 offset:8192
  v_mfma_f32_16x16x32_bf16 v[216:219], a[200:203], a[80:83], v[216:219]
  ds_read_b64_tr_b16 a[126:127], v25 offset:9216
  v_mfma_f32_16x16x32_bf16 v[216:219], a[204:207], a[84:87], v[216:219]
  buffer_load_dwordx4 v7, s[32:35], s48 offen offset:3072 lds
  v_mfma_f32_16x16x32_bf16 v[220:223], a[200:203], a[88:91], v[220:223]
  ds_read_b128 a[172:175], v21 offset:2048
  v_mfma_f32_16x16x32_bf16 v[220:223], a[204:207], a[92:95], v[220:223]
  v_mfma_f32_16x16x32_bf16 v[224:227], a[208:211], a[32:35], v[224:227]
  v_mfma_f32_16x16x32_bf16 v[224:227], a[212:215], a[36:39], v[224:227]
  v_mfma_f32_16x16x32_bf16 v[228:231], a[208:211], a[40:43], v[228:231]
  ds_read_b64_tr_b16 a[128:129], v26 offset:0
  v_mfma_f32_16x16x32_bf16 v[228:231], a[212:215], a[44:47], v[228:231]
  ds_read_b64_tr_b16 a[130:131], v26 offset:1024
  v_mfma_f32_16x16x32_bf16 v[232:235], a[208:211], a[48:51], v[232:235]
  ds_read_b64_tr_b16 a[132:133], v26 offset:8192
  s_add_u32 m0, s53, 4096
  v_mfma_f32_16x16x32_bf16 v[232:235], a[212:215], a[52:55], v[232:235]
  buffer_load_dwordx4 v8, s[32:35], s48 offen offset:0 lds
  v_mfma_f32_16x16x32_bf16 v[236:239], a[208:211], a[56:59], v[236:239]
  ds_read_b64_tr_b16 a[134:135], v26 offset:9216
  v_mfma_f32_16x16x32_bf16 v[236:239], a[212:215], a[60:63], v[236:239]
  ds_read_b128 a[176:179], v20 offset:4096
  v_mfma_f32_16x16x32_bf16 v[240:243], a[208:211], a[64:67], v[240:243]
  ds_read_b64_tr_b16 a[136:137], v27 offset:0
  v_mfma_f32_16x16x32_bf16 v[240:243], a[212:215], a[68:71], v[240:243]
  v_mfma_f32_16x16x32_bf16 v[244:247], a[208:211], a[72:75], v[244:247]
  ds_read_b64_tr_b16 a[138:139], v27 offset:1024
  v_mfma_f32_16x16x32_bf16 v[244:247], a[212:215], a[76:79], v[244:247]
  ds_read_b64_tr_b16 a[140:141], v27 offset:8192
  v_mfma_f32_16x16x32_bf16 v[248:251], a[208:211], a[80:83], v[248:251]
  ds_read_b64_tr_b16 a[142:143], v27 offset:9216
  v_mfma_f32_16x16x32_bf16 v[248:251], a[212:215], a[84:87], v[248:251]
  buffer_load_dwordx4 v9, s[32:35], s48 offen offset:1024 lds
  v_mfma_f32_16x16x32_bf16 v[252:255], a[208:211], a[88:91], v[252:255]
  ds_read_b128 a[180:183], v21 offset:4096
  v_mfma_f32_16x16x32_bf16 v[252:255], a[212:215], a[92:95], v[252:255]
  v_mfma_f32_16x16x32_bf16 a[0:3], a[216:219], a[32:35], a[0:3]
  v_mfma_f32_16x16x32_bf16 a[0:3], a[220:223], a[36:39], a[0:3]
  v_mfma_f32_16x16x32_bf16 a[4:7], a[216:219], a[40:43], a[4:7]
  ds_read_b64_tr_b16 a[144:145], v28 offset:0
  v_mfma_f32_16x16x32_bf16 a[4:7], a[220:223], a[44:47], a[4:7]
  ds_read_b64_tr_b16 a[146:147], v28 offset:1024
  v_mfma_f32_16x16x32_bf16 a[8:11], a[216:219], a[48:51], a[8:11]
  ds_read_b64_tr_b16 a[148:149], v28 offset:8192
  v_mfma_f32_16x16x32_bf16 a[8:11], a[220:223], a[52:55], a[8:11]
  buffer_load_dwordx4 v10, s[32:35], s48 offen offset:2048 lds
  v_mfma_f32_16x16x32_bf16 a[12:15], a[216:219], a[56:59], a[12:15]
  ds_read_b64_tr_b16 a[150:151], v28 offset:9216
  v_mfma_f32_16x16x32_bf16 a[12:15], a[220:223], a[60:63], a[12:15]
  ds_read_b128 a[184:187], v20 offset:6144
  v_mfma_f32_16x16x32_bf16 a[16:19], a[216:219], a[64:67], a[16:19]
  ds_read_b64_tr_b16 a[152:153], v29 offset:0
  v_mfma_f32_16x16x32_bf16 a[16:19], a[220:223], a[68:71], a[16:19]
  v_mfma_f32_16x16x32_bf16 a[20:23], a[216:219], a[72:75], a[20:23]
  ds_read_b64_tr_b16 a[154:155], v29 offset:1024
  v_mfma_f32_16x16x32_bf16 a[20:23], a[220:223], a[76:79], a[20:23]
  ds_read_b64_tr_b16 a[156:157], v29 offset:8192
  v_mfma_f32_16x16x32_bf16 a[24:27], a[216:219], a[80:83], a[24:27]
  ds_read_b64_tr_b16 a[158:159], v29 offset:9216
  v_mfma_f32_16x16x32_bf16 a[24:27], a[220:223], a[84:87], a[24:27]
  buffer_load_dwordx4 v11, s[32:35], s48 offen offset:3072 lds
  v_mfma_f32_16x16x32_bf16 a[28:31], a[216:219], a[88:91], a[28:31]
  ds_read_b128 a[188:191], v21 offset:6144
  v_mfma_f32_16x16x32_bf16 a[28:31], a[220:223], a[92:95], a[28:31]
  s_add_u32 s48, s48, 128
  buffer_load_dword a248, v0, s[44:47], s92 offen
  s_sub_u32 s50, s50, 1
  s_cmp_lg_u32 s50, 0
  s_cbranch_scc1 LKV_V
  s_waitcnt lgkmcnt(3)
  v_mfma_f32_16x16x32_bf16 v[32:35], a[160:163], a[96:99], v[32:35]
  v_mfma_f32_16x16x32_bf16 v[32:35], a[164:167], a[100:103], v[32:35]
  v_mfma_f32_16x16x32_bf16 v[36:39], a[160:163], a[104:107], v[36:39]
  v_mfma_f32_16x16x32_bf16 v[36:39], a[164:167], a[108:111], v[36:39]
  v_mfma_f32_16x16x32_bf16 v[40:43], a[160:163], a[112:115], v[40:43]
  v_mfma_f32_16x16x32_bf16 v[40:43], a[164:167], a[116:119], v[40:43]
  v_mfma_f32_16x16x32_bf16 v[44:47], a[160:163], a[120:123], v[44:47]
  s_waitcnt lgkmcnt(0)
  s_barrier
  v_mfma_f32_16x16x32_bf16 v[44:47], a[164:167], a[124:127], v[44:47]
  v_mfma_f32_16x16x32_bf16 v[48:51], a[160:163], a[128:131], v[48:51]
  ds_read_b128 a[192:195], v20 offset:8192
  s_mov_b32 s40, s14
  s_mov_b32 s41, s15
  v_mfma_f32_16x16x32_bf16 v[48:51], a[164:167], a[132:135], v[48:51]
  s_add_u32 m0, s51, 98304
  s_mov_b32 s42, 5242880
  v_mfma_f32_16x16x32_bf16 v[52:55], a[160:163], a[136:139], v[52:55]
  buffer_load_dwordx4 v12, s[36:39], s49 offen offset:0 nt lds
  s_mov_b32 s43, 0x20000
  v_mfma_f32_16x16x32_bf16 v[52:55], a[164:167], a[140:143], v[52:55]
  s_mul_i32 s54, s28, 320
  v_mfma_f32_16x16x32_bf16 v[56:59], a[160:163], a[144:147], v[56:59]
  ds_read_b128 a[196:199], v21 offset:8192
  v_add_u32 v3, s54, v1
  v_mfma_f32_16x16x32_bf16 v[56:59], a[164:167], a[148:151], v[56:59]
  v_add_u32 v3, 0, v3
  v_mul_u32_u24 v4, 1639, v3
  v_mfma_f32_16x16x32_bf16 v[60:63], a[160:163], a[152:155], v[60:63]
  buffer_load_dwordx4 v13, s[36:39], s49 offen offset:1024 nt lds
  v_lshrrev_b32 v4, 16, v4
  v_mfma_f32_16x16x32_bf16 v[60:63], a[164:167], a[156:159], v[60:63]
  v_mul_u32_u24 v4, 640, v4
  v_mfma_f32_16x16x32_bf16 v[64:67], a[168:171], a[96:99], v[64:67]
  v_lshl_add_u32 v4, v3, 4, v4
  v_mfma_f32_16x16x32_bf16 v[64:67], a[172:175], a[100:103], v[64:67]
  v_add_u32 v3, s54, v1
  v_mfma_f32_16x16x32_bf16 v[68:71], a[168:171], a[104:107], v[68:71]
  ds_read_b128 a[200:203], v20 offset:10240
  v_add_u32 v3, 64, v3
  v_mul_u32_u24 v5, 1639, v3
  v_mfma_f32_16x16x32_bf16 v[68:71], a[172:175], a[108:111], v[68:71]
  v_lshrrev_b32 v5, 16, v5
  v_mfma_f32_16x16x32_bf16 v[72:75], a[168:171], a[112:115], v[72:75]
  v_mul_u32_u24 v5, 640, v5
  v_mfma_f32_16x16x32_bf16 v[72:75], a[172:175], a[116:119], v[72:75]
  buffer_load_dwordx4 v14, s[36:39], s49 offen offset:2048 nt lds
  v_lshl_add_u32 v5, v3, 4, v5
  v_mfma_f32_16x16x32_bf16 v[76:79], a[168:171], a[120:123], v[76:79]
  v_add_u32 v3, s54, v1
  v_mfma_f32_16x16x32_bf16 v[76:79], a[172:175], a[124:127], v[76:79]
  v_add_u32 v3, 128, v3
  v_mfma_f32_16x16x32_bf16 v[80:83], a[168:171], a[128:131], v[80:83]
  ds_read_b128 a[204:207], v21 offset:10240
  v_mul_u32_u24 v6, 1639, v3
  v_lshrrev_b32 v6, 16, v6
  v_mfma_f32_16x16x32_bf16 v[80:83], a[172:175], a[132:135], v[80:83]
  v_mul_u32_u24 v6, 640, v6
  v_mfma_f32_16x16x32_bf16 v[84:87], a[168:171], a[136:139], v[84:87]
  v_lshl_add_u32 v6, v3, 4, v6
  v_mfma_f32_16x16x32_bf16 v[84:87], a[172:175], a[140:143], v[84:87]
  buffer_load_dwordx4 v15, s[36:39], s49 offen offset:3072 nt lds
  v_add_u32 v3, s54, v1
  v_mfma_f32_16x16x32_bf16 v[88:91], a[168:171], a[144:147], v[88:91]
  v_add_u32 v3, 192, v3
  v_mfma_f32_16x16x32_bf16 v[88:91], a[172:175], a[148:151], v[88:91]
  v_mul_u32_u24 v7, 1639, v3
  v_lshrrev_b32 v7, 16, v7
  v_mfma_f32_16x16x32_bf16 v[92:95], a[168:171], a[152:155], v[92:95]
  v_mul_u32_u24 v7, 640, v7
  v_mfma_f32_16x16x32_bf16 v[92:95], a[172:175], a[156:159], v[92:95]
  v_lshl_add_u32 v7, v3, 4, v7
  v_mfma_f32_16x16x32_bf16 v[96:99], a[176:179], a[96:99], v[96:99]
  v_add_u32 v3, s54, v1
  v_mfma_f32_16x16x32_bf16 v[96:99], a[180:183], a[100:103], v[96:99]
  v_xor_b32 v22, 0x10000, v22
  v_add_u32 v3, 256, v3
  v_mfma_f32_16x16x32_bf16 v[100:103], a[176:179], a[104:107], v[100:103]
  ds_read_b128 a[208:211], v20 offset:12288
  v_mul_u32_u24 v8, 1639, v3
  v_mfma_f32_16x16x32_bf16 v[100:103], a[180:183], a[108:111], v[100:103]
  v_xor_b32 v23, 0x10000, v23
  v_lshrrev_b32 v8, 16, v8
  v_mul_u32_u24 v8, 640, v8
  v_mfma_f32_16x16x32_bf16 v[104:107], a[176:179], a[112:115], v[104:107]
  s_add_u32 m0, s51, 102400
  v_lshl_add_u32 v8, v3, 4, v8
  v_mfma_f32_16x16x32_bf16 v[104:107], a[180:183], a[116:119], v[104:107]
  buffer_load_dwordx4 v16, s[36:39], s49 offen offset:0 nt lds
  s_mul_i32 s54, s28, 192
  v_mfma_f32_16x16x32_bf16 v[108:111], a[176:179], a[120:123], v[108:111]
  v_add_u32 v3, s54, v1
  v_mfma_f32_16x16x32_bf16 v[108:111], a[180:183], a[124:127], v[108:111]
  v_xor_b32 v24, 0x10000, v24
  v_add_u32 v3, 0, v3
  v_mfma_f32_16x16x32_bf16 v[112:115], a[176:179], a[128:131], v[112:115]
  ds_read_b128 a[212:215], v21 offset:12288
  v_mul_u32_u24 v9, 2731, v3
  v_lshrrev_b32 v9, 16, v9
  v_mfma_f32_16x16x32_bf16 v[112:115], a[180:183], a[132:135], v[112:115]
  v_xor_b32 v25, 0x10000, v25
  v_mul_u32_u24 v9, 3456, v9
  v_mfma_f32_16x16x32_bf16 v[116:119], a[176:179], a[136:139], v[116:119]
  v_lshl_add_u32 v9, v3, 4, v9
  v_mfma_f32_16x16x32_bf16 v[116:119], a[180:183], a[140:143], v[116:119]
  buffer_load_dwordx4 v17, s[36:39], s49 offen offset:1024 nt lds
  v_add_u32 v3, s54, v1
  v_mfma_f32_16x16x32_bf16 v[120:123], a[176:179], a[144:147], v[120:123]
  v_add_u32 v3, 64, v3
  v_mfma_f32_16x16x32_bf16 v[120:123], a[180:183], a[148:151], v[120:123]
  v_xor_b32 v26, 0x10000, v26
  v_mul_u32_u24 v10, 2731, v3
  v_lshrrev_b32 v10, 16, v10
  v_mfma_f32_16x16x32_bf16 v[124:127], a[176:179], a[152:155], v[124:127]
  v_mul_u32_u24 v10, 3456, v10
  v_mfma_f32_16x16x32_bf16 v[124:127], a[180:183], a[156:159], v[124:127]
  v_xor_b32 v27, 0x10000, v27
  v_lshl_add_u32 v10, v3, 4, v10
  v_mfma_f32_16x16x32_bf16 v[128:131], a[184:187], a[96:99], v[128:131]
  v_add_u32 v3, s54, v1
  v_mfma_f32_16x16x32_bf16 v[128:131], a[188:191], a[100:103], v[128:131]
  v_add_u32 v3, 128, v3
  v_mfma_f32_16x16x32_bf16 v[132:135], a[184:187], a[104:107], v[132:135]
  ds_read_b128 a[216:219], v20 offset:14336
  v_mul_u32_u24 v11, 2731, v3
  v_mfma_f32_16x16x32_bf16 v[132:135], a[188:191], a[108:111], v[132:135]
  v_xor_b32 v28, 0x10000, v28
  v_lshrrev_b32 v11, 16, v11
  v_mul_u32_u24 v11, 3456, v11
  v_mfma_f32_16x16x32_bf16 v[136:139], a[184:187], a[112:115], v[136:139]
  v_lshl_add_u32 v11, v3, 4, v11
  v_mfma_f32_16x16x32_bf16 v[136:139], a[188:191], a[116:119], v[136:139]
  buffer_load_dwordx4 v18, s[36:39], s49 offen offset:2048 nt lds
  s_and_b32 s54, s2, 1
  v_mfma_f32_16x16x32_bf16 v[140:143], a[184:187], a[120:123], v[140:143]
  s_lshr_b32 s55, s2, 1
  v_mfma_f32_16x16x32_bf16 v[140:143], a[188:191], a[124:127], v[140:143]
  v_xor_b32 v29, 0x10000, v29
  s_mul_i32 s95, s55, 40960
  v_mfma_f32_16x16x32_bf16 v[144:147], a[184:187], a[128:131], v[144:147]
  ds_read_b128 a[220:223], v21 offset:14336
  s_mul_i32 s54, s54, 640
  s_add_u32 s95, s95, s54
  v_mfma_f32_16x16x32_bf16 v[144:147], a[188:191], a[132:135], v[144:147]
  s_mul_i32 s55, s2, 205
  v_mfma_f32_16x16x32_bf16 v[148:151], a[184:187], a[136:139], v[148:151]
  s_lshr_b32 s55, s55, 11
  v_mfma_f32_16x16x32_bf16 v[148:151], a[188:191], a[140:143], v[148:151]
  buffer_load_dwordx4 v19, s[36:39], s49 offen offset:3072 nt lds
  s_mul_i32 s55, s55, 119040
  v_mfma_f32_16x16x32_bf16 v[152:155], a[184:187], a[144:147], v[152:155]
  s_mul_i32 s54, s2, 384
  v_mfma_f32_16x16x32_bf16 v[152:155], a[188:191], a[148:151], v[152:155]
  s_add_u32 s49, s49, 524288
  s_add_u32 s3, s55, s54
  v_mfma_f32_16x16x32_bf16 v[156:159], a[184:187], a[152:155], v[156:159]
  v_mfma_f32_16x16x32_bf16 v[156:159], a[188:191], a[156:159], v[156:159]
  s_waitcnt vmcnt(17) lgkmcnt(0)
  s_barrier
  v_mfma_f32_16x16x32_bf16 v[160:163], a[192:195], a[96:99], v[160:163]
  s_add_u32 s53, s52, s51
  s_add_u32 s52, s52, 0x10000
  v_mfma_f32_16x16x32_bf16 v[160:163], a[196:199], a[100:103], v[160:163]
  s_cmp_eq_u32 s52, 0x30000
  s_cselect_b32 s52, 0, s52
  buffer_load_dword v19, v2, s[96:99], s93 offen
  v_mfma_f32_16x16x32_bf16 v[164:167], a[192:195], a[104:107], v[164:167]
  ds_read_b64_tr_b16 a[32:33], v22 offset:0
  v_mfma_f32_16x16x32_bf16 v[164:167], a[196:199], a[108:111], v[164:167]
  ds_read_b64_tr_b16 a[34:35], v22 offset:1024
  v_mfma_f32_16x16x32_bf16 v[168:171], a[192:195], a[112:115], v[168:171]
  ds_read_b64_tr_b16 a[36:37], v22 offset:8192
  v_mfma_f32_16x16x32_bf16 v[168:171], a[196:199], a[116:119], v[168:171]
  v_add_u32 v20, s52, v30
  v_add_u32 v21, s52, v31
  buffer_load_dwordx4 a[224:227], v4, s[40:43], s95 offen nt
  v_mfma_f32_16x16x32_bf16 v[172:175], a[192:195], a[120:123], v[172:175]
  ds_read_b64_tr_b16 a[38:39], v22 offset:9216
  v_mfma_f32_16x16x32_bf16 v[172:175], a[196:199], a[124:127], v[172:175]
  ds_read_b128 a[160:163], v20 offset:0
  v_mfma_f32_16x16x32_bf16 v[176:179], a[192:195], a[128:131], v[176:179]
  ds_read_b64_tr_b16 a[40:41], v23 offset:0
  v_mfma_f32_16x16x32_bf16 v[176:179], a[196:199], a[132:135], v[176:179]
  buffer_load_dwordx4 a[228:231], v5, s[40:43], s95 offen nt
  v_mfma_f32_16x16x32_bf16 v[180:183], a[192:195], a[136:139], v[180:183]
  ds_read_b64_tr_b16 a[42:43], v23 offset:1024
  v_mfma_f32_16x16x32_bf16 v[180:183], a[196:199], a[140:143], v[180:183]
  ds_read_b64_tr_b16 a[44:45], v23 offset:8192
  v_mfma_f32_16x16x32_bf16 v[184:187], a[192:195], a[144:147], v[184:187]
  ds_read_b64_tr_b16 a[46:47], v23 offset:9216
  v_mfma_f32_16x16x32_bf16 v[184:187], a[196:199], a[148:151], v[184:187]
  buffer_load_dwordx4 a[232:235], v6, s[40:43], s95 offen nt
  v_mfma_f32_16x16x32_bf16 v[188:191], a[192:195], a[152:155], v[188:191]
  ds_read_b128 a[164:167], v21 offset:0
  v_mfma_f32_16x16x32_bf16 v[188:191], a[196:199], a[156:159], v[188:191]
  v_mfma_f32_16x16x32_bf16 v[192:195], a[200:203], a[96:99], v[192:195]
  v_mfma_f32_16x16x32_bf16 v[192:195], a[204:207], a[100:103], v[192:195]
  v_mfma_f32_16x16x32_bf16 v[196:199], a[200:203], a[104:107], v[196:199]
  ds_read_b64_tr_b16 a[48:49], v24 offset:0
  v_mfma_f32_16x16x32_bf16 v[196:199], a[204:207], a[108:111], v[196:199]
  ds_read_b64_tr_b16 a[50:51], v24 offset:1024
  v_mfma_f32_16x16x32_bf16 v[200:203], a[200:203], a[112:115], v[200:203]
  ds_read_b64_tr_b16 a[52:53], v24 offset:8192
  v_mfma_f32_16x16x32_bf16 v[200:203], a[204:207], a[116:119], v[200:203]
  buffer_load_dwordx4 a[236:239], v7, s[40:43], s95 offen nt
  v_mfma_f32_16x16x32_bf16 v[204:207], a[200:203], a[120:123], v[204:207]
  ds_read_b64_tr_b16 a[54:55], v24 offset:9216
  v_mfma_f32_16x16x32_bf16 v[204:207], a[204:207], a[124:127], v[204:207]
  ds_read_b128 a[168:171], v20 offset:2048
  v_mfma_f32_16x16x32_bf16 v[208:211], a[200:203], a[128:131], v[208:211]
  ds_read_b64_tr_b16 a[56:57], v25 offset:0
  v_mfma_f32_16x16x32_bf16 v[208:211], a[204:207], a[132:135], v[208:211]
  v_mfma_f32_16x16x32_bf16 v[212:215], a[200:203], a[136:139], v[212:215]
  ds_read_b64_tr_b16 a[58:59], v25 offset:1024
  v_mfma_f32_16x16x32_bf16 v[212:215], a[204:207], a[140:143], v[212:215]
  ds_read_b64_tr_b16 a[60:61], v25 offset:8192
  v_mfma_f32_16x16x32_bf16 v[216:219], a[200:203], a[144:147], v[216:219]
  ds_read_b64_tr_b16 a[62:63], v25 offset:9216
  v_mfma_f32_16x16x32_bf16 v[216:219], a[204:207], a[148:151], v[216:219]
  buffer_load_dwordx4 a[240:243], v8, s[40:43], s95 offen nt
  v_mfma_f32_16x16x32_bf16 v[220:223], a[200:203], a[152:155], v[220:223]
  ds_read_b128 a[172:175], v21 offset:2048
  v_mfma_f32_16x16x32_bf16 v[220:223], a[204:207], a[156:159], v[220:223]
  v_mfma_f32_16x16x32_bf16 v[224:227], a[208:211], a[96:99], v[224:227]
  v_mfma_f32_16x16x32_bf16 v[224:227], a[212:215], a[100:103], v[224:227]
  v_mfma_f32_16x16x32_bf16 v[228:231], a[208:211], a[104:107], v[228:231]
  ds_read_b64_tr_b16 a[64:65], v26 offset:0
  v_mfma_f32_16x16x32_bf16 v[228:231], a[212:215], a[108:111], v[228:231]
  ds_read_b64_tr_b16 a[66:67], v26 offset:1024
  v_mfma_f32_16x16x32_bf16 v[232:235], a[208:211], a[112:115], v[232:235]
  ds_read_b64_tr_b16 a[68:69], v26 offset:8192
  s_mov_b32 s40, s18
  s_mov_b32 s41, s19
  s_mov_b32 s42, 2457600
  v_mfma_f32_16x16x32_bf16 v[232:235], a[212:215], a[116:119], v[232:235]
  buffer_load_dwordx4 a[244:247], v9, s[40:43], s3 offen nt
  v_mfma_f32_16x16x32_bf16 v[236:239], a[208:211], a[120:123], v[236:239]
  ds_read_b64_tr_b16 a[70:71], v26 offset:9216
  v_mfma_f32_16x16x32_bf16 v[236:239], a[212:215], a[124:127], v[236:239]
  ds_read_b128 a[176:179], v20 offset:4096
  v_mfma_f32_16x16x32_bf16 v[240:243], a[208:211], a[128:131], v[240:243]
  ds_read_b64_tr_b16 a[72:73], v27 offset:0
  v_mfma_f32_16x16x32_bf16 v[240:243], a[212:215], a[132:135], v[240:243]
  v_mfma_f32_16x16x32_bf16 v[244:247], a[208:211], a[136:139], v[244:247]
  ds_read_b64_tr_b16 a[74:75], v27 offset:1024
  v_mfma_f32_16x16x32_bf16 v[244:247], a[212:215], a[140:143], v[244:247]
  ds_read_b64_tr_b16 a[76:77], v27 offset:8192
  v_mfma_f32_16x16x32_bf16 v[248:251], a[208:211], a[144:147], v[248:251]
  ds_read_b64_tr_b16 a[78:79], v27 offset:9216
  v_mfma_f32_16x16x32_bf16 v[248:251], a[212:215], a[148:151], v[248:251]
  buffer_load_dwordx4 a[248:251], v10, s[40:43], s3 offen nt
  v_mfma_f32_16x16x32_bf16 v[252:255], a[208:211], a[152:155], v[252:255]
  ds_read_b128 a[180:183], v21 offset:4096
  v_mfma_f32_16x16x32_bf16 v[252:255], a[212:215], a[156:159], v[252:255]
  v_mfma_f32_16x16x32_bf16 a[0:3], a[216:219], a[96:99], a[0:3]
  v_mfma_f32_16x16x32_bf16 a[0:3], a[220:223], a[100:103], a[0:3]
  v_mfma_f32_16x16x32_bf16 a[4:7], a[216:219], a[104:107], a[4:7]
  ds_read_b64_tr_b16 a[80:81], v28 offset:0
  v_mfma_f32_16x16x32_bf16 a[4:7], a[220:223], a[108:111], a[4:7]
  ds_read_b64_tr_b16 a[82:83], v28 offset:1024
  v_mfma_f32_16x16x32_bf16 a[8:11], a[216:219], a[112:115], a[8:11]
  ds_read_b64_tr_b16 a[84:85], v28 offset:8192
  v_mfma_f32_16x16x32_bf16 a[8:11], a[220:223], a[116:119], a[8:11]
  buffer_load_dwordx4 a[252:255], v11, s[40:43], s3 offen nt
  v_mfma_f32_16x16x32_bf16 a[12:15], a[216:219], a[120:123], a[12:15]
  ds_read_b64_tr_b16 a[86:87], v28 offset:9216
  v_mfma_f32_16x16x32_bf16 a[12:15], a[220:223], a[124:127], a[12:15]
  ds_read_b128 a[184:187], v20 offset:6144
  v_mfma_f32_16x16x32_bf16 a[16:19], a[216:219], a[128:131], a[16:19]
  ds_read_b64_tr_b16 a[88:89], v29 offset:0
  v_mfma_f32_16x16x32_bf16 a[16:19], a[220:223], a[132:135], a[16:19]
  v_mfma_f32_16x16x32_bf16 a[20:23], a[216:219], a[136:139], a[20:23]
  ds_read_b64_tr_b16 a[90:91], v29 offset:1024
  v_mfma_f32_16x16x32_bf16 a[20:23], a[220:223], a[140:143], a[20:23]
  ds_read_b64_tr_b16 a[92:93], v29 offset:8192
  v_mfma_f32_16x16x32_bf16 a[24:27], a[216:219], a[144:147], a[24:27]
  ds_read_b64_tr_b16 a[94:95], v29 offset:9216
  v_mfma_f32_16x16x32_bf16 a[24:27], a[220:223], a[148:151], a[24:27]
  v_mfma_f32_16x16x32_bf16 a[28:31], a[216:219], a[152:155], a[28:31]
  ds_read_b128 a[188:191], v21 offset:6144
  s_add_u32 s92, s92, 896
  v_mfma_f32_16x16x32_bf16 a[28:31], a[220:223], a[156:159], a[28:31]
  s_add_u32 s48, s48, 128
  s_waitcnt lgkmcnt(4)
  v_mfma_f32_16x16x32_bf16 v[32:35], a[160:163], a[32:35], v[32:35]
  s_mov_b32 s40, s26
  v_mfma_f32_16x16x32_bf16 v[32:35], a[164:167], a[36:39], v[32:35]
  s_mov_b32 s41, s27
  v_mfma_f32_16x16x32_bf16 v[36:39], a[160:163], a[40:43], v[36:39]
  s_mov_b32 s42, 82837504
  v_mfma_f32_16x16x32_bf16 v[36:39], a[164:167], a[44:47], v[36:39]
  s_mov_b32 s43, 0x20000
  v_mfma_f32_16x16x32_bf16 v[40:43], a[160:163], a[48:51], v[40:43]
  s_mov_b32 s32, s4
  v_mfma_f32_16x16x32_bf16 v[40:43], a[164:167], a[52:55], v[40:43]
  s_mov_b32 s33, s5
  v_mfma_f32_16x16x32_bf16 v[44:47], a[160:163], a[56:59], v[44:47]
  s_mov_b32 s34, 2621440
  v_mfma_f32_16x16x32_bf16 v[44:47], a[164:167], a[60:63], v[44:47]
  s_mov_b32 s35, 0x20000
  v_mfma_f32_16x16x32_bf16 v[48:51], a[160:163], a[64:67], v[48:51]
  ds_read_b128 a[192:195], v20 offset:8192
  s_mov_b32 s36, s8
  v_mfma_f32_16x16x32_bf16 v[48:51], a[164:167], a[68:71], v[48:51]
  s_mov_b32 s37, s9
  v_mfma_f32_16x16x32_bf16 v[52:55], a[160:163], a[72:75], v[52:55]
  s_mov_b32 s38, 5242880
  v_mfma_f32_16x16x32_bf16 v[52:55], a[164:167], a[76:79], v[52:55]
  s_mov_b32 s39, 0x20000
  v_mfma_f32_16x16x32_bf16 v[56:59], a[160:163], a[80:83], v[56:59]
  ds_read_b128 a[196:199], v21 offset:8192
  s_lshl_b32 s54, s28, 17
  v_mfma_f32_16x16x32_bf16 v[56:59], a[164:167], a[84:87], v[56:59]
  s_lshl_b32 s55, s29, 8
  s_waitcnt lgkmcnt(2)
  v_mfma_f32_16x16x32_bf16 v[60:63], a[160:163], a[88:91], v[60:63]
  s_add_u32 s54, s54, s55
  v_mfma_f32_16x16x32_bf16 v[60:63], a[164:167], a[92:95], v[60:63]
  v_lshlrev_b32 v16, 4, v1
  v_mfma_f32_16x16x32_bf16 v[64:67], a[168:171], a[32:35], v[64:67]
  v_lshrrev_b32 v2, 4, v1
  v_mfma_f32_16x16x32_bf16 v[64:67], a[172:175], a[36:39], v[64:67]
  v_lshlrev_b32 v3, 2, v2
  v_mfma_f32_16x16x32_bf16 v[68:71], a[168:171], a[40:43], v[68:71]
  ds_read_b128 a[200:203], v20 offset:10240
  v_lshlrev_b32 v2, 13, v2
  v_mfma_f32_16x16x32_bf16 v[68:71], a[172:175], a[44:47], v[68:71]
  v_add_u32 v2, s54, v2
  v_mfma_f32_16x16x32_bf16 v[72:75], a[168:171], a[48:51], v[72:75]
  v_and_b32 v0, 15, v1
  v_mfma_f32_16x16x32_bf16 v[72:75], a[172:175], a[52:55], v[72:75]
  v_xor_b32 v3, v3, v0
  v_mfma_f32_16x16x32_bf16 v[76:79], a[168:171], a[56:59], v[76:79]
  v_lshl_add_u32 v0, v3, 4, v2
  v_mfma_f32_16x16x32_bf16 v[76:79], a[172:175], a[60:63], v[76:79]
  v_xor_b32 v3, 2, v3
  v_mfma_f32_16x16x32_bf16 v[80:83], a[168:171], a[64:67], v[80:83]
  ds_read_b128 a[204:207], v21 offset:10240
  v_lshl_add_u32 v3, v3, 4, v2
  v_mfma_f32_16x16x32_bf16 v[80:83], a[172:175], a[68:71], v[80:83]
  v_add_u32 v12, 0, v0
  v_mfma_f32_16x16x32_bf16 v[84:87], a[168:171], a[72:75], v[84:87]
  v_add_u32 v13, 31744, v0
  v_mfma_f32_16x16x32_bf16 v[84:87], a[172:175], a[76:79], v[84:87]
  v_add_u32 v14, 63488, v3
  v_mfma_f32_16x16x32_bf16 v[88:91], a[168:171], a[80:83], v[88:91]
  v_add_u32 v15, 95232, v3
  v_mfma_f32_16x16x32_bf16 v[88:91], a[172:175], a[84:87], v[88:91]
  s_lshl_b32 s48, s28, 12
  v_mfma_f32_16x16x32_bf16 v[92:95], a[168:171], a[88:91], v[92:95]
  v_mfma_f32_16x16x32_bf16 v[92:95], a[172:175], a[92:95], v[92:95]
  s_add_u32 s48, s48, 98304
  v_mfma_f32_16x16x32_bf16 v[96:99], a[176:179], a[32:35], v[96:99]
  s_lshl_b32 s49, s28, 13
  v_mfma_f32_16x16x32_bf16 v[96:99], a[180:183], a[36:39], v[96:99]
  v_xor_b32 v22, 0x10000, v22
  s_lshl_b32 s54, s30, 2
  v_mfma_f32_16x16x32_bf16 v[100:103], a[176:179], a[40:43], v[100:103]
  ds_read_b128 a[208:211], v20 offset:12288
  s_add_u32 s54, s54, s28
  v_mfma_f32_16x16x32_bf16 v[100:103], a[180:183], a[44:47], v[100:103]
  v_xor_b32 v23, 0x10000, v23
  s_mul_i32 s54, s54, 40960
  v_mfma_f32_16x16x32_bf16 v[104:107], a[176:179], a[48:51], v[104:107]
  s_sub_u32 s55, 2580480, s54
  v_mfma_f32_16x16x32_bf16 v[104:107], a[180:183], a[52:55], v[104:107]
  v_lshrrev_b32 v2, 3, v1
  v_mfma_f32_16x16x32_bf16 v[108:111], a[176:179], a[56:59], v[108:111]
  v_mul_u32_u24 v2, 1280, v2
  v_mfma_f32_16x16x32_bf16 v[108:111], a[180:183], a[60:63], v[108:111]
  v_xor_b32 v24, 0x10000, v24
  v_lshrrev_b32 v3, 4, v1
  v_mfma_f32_16x16x32_bf16 v[112:115], a[176:179], a[64:67], v[112:115]
  ds_read_b128 a[212:215], v21 offset:12288
  v_and_b32 v0, 7, v1
  v_mfma_f32_16x16x32_bf16 v[112:115], a[180:183], a[68:71], v[112:115]
  v_xor_b32 v25, 0x10000, v25
  v_xor_b32 v3, v3, v0
  v_mfma_f32_16x16x32_bf16 v[116:119], a[176:179], a[72:75], v[116:119]
  v_lshl_add_u32 v0, v3, 4, v2
  v_mfma_f32_16x16x32_bf16 v[116:119], a[180:183], a[76:79], v[116:119]
  v_xor_b32 v3, 4, v3
  v_mfma_f32_16x16x32_bf16 v[120:123], a[176:179], a[80:83], v[120:123]
  v_lshl_add_u32 v3, v3, 4, v2
  v_mfma_f32_16x16x32_bf16 v[120:123], a[180:183], a[84:87], v[120:123]
  v_xor_b32 v26, 0x10000, v26
  v_add_u32 v4, 0, v0
  v_mfma_f32_16x16x32_bf16 v[124:127], a[176:179], a[88:91], v[124:127]
  v_add_u32 v4, s54, v4
  v_mfma_f32_16x16x32_bf16 v[124:127], a[180:183], a[92:95], v[124:127]
  v_xor_b32 v27, 0x10000, v27
  v_add_u32 v5, 9216, v3
  v_mfma_f32_16x16x32_bf16 v[128:131], a[184:187], a[32:35], v[128:131]
  v_add_u32 v5, s54, v5
  v_mfma_f32_16x16x32_bf16 v[128:131], a[188:191], a[36:39], v[128:131]
  v_add_u32 v6, 18432, v0
  v_mfma_f32_16x16x32_bf16 v[132:135], a[184:187], a[40:43], v[132:135]
  ds_read_b128 a[216:219], v20 offset:14336
  v_add_u32 v6, s54, v6
  v_mfma_f32_16x16x32_bf16 v[132:135], a[188:191], a[44:47], v[132:135]
  v_xor_b32 v28, 0x10000, v28
  v_add_u32 v7, 27648, v3
  v_mfma_f32_16x16x32_bf16 v[136:139], a[184:187], a[48:51], v[136:139]
  v_add_u32 v7, s54, v7
  v_mfma_f32_16x16x32_bf16 v[136:139], a[188:191], a[52:55], v[136:139]
  v_add_u32 v8, 0, v0
  v_mfma_f32_16x16x32_bf16 v[140:143], a[184:187], a[56:59], v[140:143]
  v_add_u32 v8, s55, v8
  v_mfma_f32_16x16x32_bf16 v[140:143], a[188:191], a[60:63], v[140:143]
  v_xor_b32 v29, 0x10000, v29
  v_add_u32 v9, 9216, v3
  v_mfma_f32_16x16x32_bf16 v[144:147], a[184:187], a[64:67], v[144:147]
  ds_read_b128 a[220:223], v21 offset:14336
  v_add_u32 v9, s55, v9
  v_mfma_f32_16x16x32_bf16 v[144:147], a[188:191], a[68:71], v[144:147]
  v_add_u32 v10, 18432, v0
  v_mfma_f32_16x16x32_bf16 v[148:151], a[184:187], a[72:75], v[148:151]
  v_add_u32 v10, s55, v10
  v_mfma_f32_16x16x32_bf16 v[148:151], a[188:191], a[76:79], v[148:151]
  v_add_u32 v11, 27648, v3
  v_mfma_f32_16x16x32_bf16 v[152:155], a[184:187], a[80:83], v[152:155]
  v_add_u32 v11, s55, v11
  v_mfma_f32_16x16x32_bf16 v[152:155], a[188:191], a[84:87], v[152:155]
  v_mfma_f32_16x16x32_bf16 v[156:159], a[184:187], a[88:91], v[156:159]
  s_getpc_b64 s[92:93]
L_ctqTrue:
  s_lshl_b32 s94, s28, 13
  s_add_u32 s94, s94, LKV_done - L_ctqTrue
  v_mfma_f32_16x16x32_bf16 v[156:159], a[188:191], a[92:95], v[156:159]
  s_waitcnt vmcnt(8) lgkmcnt(0)
  s_barrier
  v_lshlrev_b32 v2, 7, v1
  v_add_u32 v2, s94, v2
  s_mov_b32 s94, L_codeend - L_ctqTrue - 4
  v_mfma_f32_16x16x32_bf16 v[160:163], a[192:195], a[32:35], v[160:163]
  s_add_u32 s53, s52, s51
  s_add_u32 s52, s52, 0x10000
  v_min_u32 v3, s94, v2
  v_mfma_f32_16x16x32_bf16 v[160:163], a[196:199], a[36:39], v[160:163]
  s_cmp_eq_u32 s52, 0x30000
  s_cselect_b32 s52, 0, s52
  global_load_dword v0, v3, s[92:93]
  v_mfma_f32_16x16x32_bf16 v[164:167], a[192:195], a[40:43], v[164:167]
  ds_read_b64_tr_b16 a[96:97], v22 offset:0
  v_mfma_f32_16x16x32_bf16 v[164:167], a[196:199], a[44:47], v[164:167]
  ds_read_b64_tr_b16 a[98:99], v22 offset:1024
  v_mfma_f32_16x16x32_bf16 v[168:171], a[192:195], a[48:51], v[168:171]
  ds_read_b64_tr_b16 a[100:101], v22 offset:8192
  s_add_u32 m0, s49, 65536
  s_mov_b32 s51, 0
  v_mfma_f32_16x16x32_bf16 v[168:171], a[196:199], a[52:55], v[168:171]
  v_add_u32 v20, s52, v30
  v_add_u32 v21, s52, v31
  buffer_load_dwordx4 v4, s[32:35], s51 offen offset:0 lds
  v_mfma_f32_16x16x32_bf16 v[172:175], a[192:195], a[56:59], v[172:175]
  ds_read_b64_tr_b16 a[102:103], v22 offset:9216
  v_mfma_f32_16x16x32_bf16 v[172:175], a[196:199], a[60:63], v[172:175]
  ds_read_b128 a[160:163], v20 offset:0
  v_mfma_f32_16x16x32_bf16 v[176:179], a[192:195], a[64:67], v[176:179]
  ds_read_b64_tr_b16 a[104:105], v23 offset:0
  v_mfma_f32_16x16x32_bf16 v[176:179], a[196:199], a[68:71], v[176:179]
  buffer_load_dwordx4 v5, s[32:35], s51 offen offset:1024 lds
  v_mfma_f32_16x16x32_bf16 v[180:183], a[192:195], a[72:75], v[180:183]
  ds_read_b64_tr_b16 a[106:107], v23 offset:1024
  v_mfma_f32_16x16x32_bf16 v[180:183], a[196:199], a[76:79], v[180:183]
  ds_read_b64_tr_b16 a[108:109], v23 offset:8192
  v_mfma_f32_16x16x32_bf16 v[184:187], a[192:195], a[80:83], v[184:187]
  ds_read_b64_tr_b16 a[110:111], v23 offset:9216
  v_mfma_f32_16x16x32_bf16 v[184:187], a[196:199], a[84:87], v[184:187]
  buffer_load_dwordx4 v6, s[32:35], s51 offen offset:2048 lds
  v_mfma_f32_16x16x32_bf16 v[188:191], a[192:195], a[88:91], v[188:191]
  ds_read_b128 a[164:167], v21 offset:0
  v_mfma_f32_16x16x32_bf16 v[188:191], a[196:199], a[92:95], v[188:191]
  v_mfma_f32_16x16x32_bf16 v[192:195], a[200:203], a[32:35], v[192:195]
  v_mfma_f32_16x16x32_bf16 v[192:195], a[204:207], a[36:39], v[192:195]
  buffer_load_dwordx4 v7, s[32:35], s51 offen offset:3072 lds
  v_mfma_f32_16x16x32_bf16 v[196:199], a[200:203], a[40:43], v[196:199]
  ds_read_b64_tr_b16 a[112:113], v24 offset:0
  v_mfma_f32_16x16x32_bf16 v[196:199], a[204:207], a[44:47], v[196:199]
  ds_read_b64_tr_b16 a[114:115], v24 offset:1024
  v_mfma_f32_16x16x32_bf16 v[200:203], a[200:203], a[48:51], v[200:203]
  ds_read_b64_tr_b16 a[116:117], v24 offset:8192
  s_add_u32 m0, s49, 69632
  s_mov_b32 s51, 0
  v_mfma_f32_16x16x32_bf16 v[200:203], a[204:207], a[52:55], v[200:203]
  buffer_load_dwordx4 v8, s[32:35], s51 offen offset:0 lds
  v_mfma_f32_16x16x32_bf16 v[204:207], a[200:203], a[56:59], v[204:207]
  ds_read_b64_tr_b16 a[118:119], v24 offset:9216
  v_mfma_f32_16x16x32_bf16 v[204:207], a[204:207], a[60:63], v[204:207]
  ds_read_b128 a[168:171], v20 offset:2048
  v_mfma_f32_16x16x32_bf16 v[208:211], a[200:203], a[64:67], v[208:211]
  ds_read_b64_tr_b16 a[120:121], v25 offset:0
  v_mfma_f32_16x16x32_bf16 v[208:211], a[204:207], a[68:71], v[208:211]
  buffer_load_dwordx4 v9, s[32:35], s51 offen offset:1024 lds
  v_mfma_f32_16x16x32_bf16 v[212:215], a[200:203], a[72:75], v[212:215]
  ds_read_b64_tr_b16 a[122:123], v25 offset:1024
  v_mfma_f32_16x16x32_bf16 v[212:215], a[204:207], a[76:79], v[212:215]
  ds_read_b64_tr_b16 a[124:125], v25 offset:8192
  v_mfma_f32_16x16x32_bf16 v[216:219], a[200:203], a[80:83], v[216:219]
  ds_read_b64_tr_b16 a[126:127], v25 offset:9216
  v_mfma_f32_16x16x32_bf16 v[216:219], a[204:207], a[84:87], v[216:219]
  buffer_load_dwordx4 v10, s[32:35], s51 offen offset:2048 lds
  v_mfma_f32_16x16x32_bf16 v[220:223], a[200:203], a[88:91], v[220:223]
  ds_read_b128 a[172:175], v21 offset:2048
  v_mfma_f32_16x16x32_bf16 v[220:223], a[204:207], a[92:95], v[220:223]
  v_mfma_f32_16x16x32_bf16 v[224:227], a[208:211], a[32:35], v[224:227]
  v_mfma_f32_16x16x32_bf16 v[224:227], a[212:215], a[36:39], v[224:227]
  buffer_load_dwordx4 v11, s[32:35], s51 offen offset:3072 lds
  v_mfma_f32_16x16x32_bf16 v[228:231], a[208:211], a[40:43], v[228:231]
  ds_read_b64_tr_b16 a[128:129], v26 offset:0
  v_mfma_f32_16x16x32_bf16 v[228:231], a[212:215], a[44:47], v[228:231]
  ds_read_b64_tr_b16 a[130:131], v26 offset:1024
  v_mfma_f32_16x16x32_bf16 v[232:235], a[208:211], a[48:51], v[232:235]
  ds_read_b64_tr_b16 a[132:133], v26 offset:8192
  s_add_u32 m0, s49, 0
  s_mov_b32 s51, 128
  v_mfma_f32_16x16x32_bf16 v[232:235], a[212:215], a[52:55], v[232:235]
  buffer_load_dwordx4 v4, s[32:35], s51 offen offset:0 lds
  v_mfma_f32_16x16x32_bf16 v[236:239], a[208:211], a[56:59], v[236:239]
  ds_read_b64_tr_b16 a[134:135], v26 offset:9216
  v_mfma_f32_16x16x32_bf16 v[236:239], a[212:215], a[60:63], v[236:239]
  ds_read_b128 a[176:179], v20 offset:4096
  v_mfma_f32_16x16x32_bf16 v[240:243], a[208:211], a[64:67], v[240:243]
  ds_read_b64_tr_b16 a[136:137], v27 offset:0
  v_mfma_f32_16x16x32_bf16 v[240:243], a[212:215], a[68:71], v[240:243]
  buffer_load_dwordx4 v5, s[32:35], s51 offen offset:1024 lds
  v_mfma_f32_16x16x32_bf16 v[244:247], a[208:211], a[72:75], v[244:247]
  ds_read_b64_tr_b16 a[138:139], v27 offset:1024
  v_mfma_f32_16x16x32_bf16 v[244:247], a[212:215], a[76:79], v[244:247]
  ds_read_b64_tr_b16 a[140:141], v27 offset:8192
  v_mfma_f32_16x16x32_bf16 v[248:251], a[208:211], a[80:83], v[248:251]
  ds_read_b64_tr_b16 a[142:143], v27 offset:9216
  v_mfma_f32_16x16x32_bf16 v[248:251], a[212:215], a[84:87], v[248:251]
  buffer_load_dwordx4 v6, s[32:35], s51 offen offset:2048 lds
  v_mfma_f32_16x16x32_bf16 v[252:255], a[208:211], a[88:91], v[252:255]
  ds_read_b128 a[180:183], v21 offset:4096
  v_mfma_f32_16x16x32_bf16 v[252:255], a[212:215], a[92:95], v[252:255]
  buffer_load_dwordx4 v7, s[32:35], s51 offen offset:3072 lds
  v_mfma_f32_16x16x32_bf16 a[0:3], a[216:219], a[32:35], a[0:3]
  s_add_u32 m0, s49, 4096
  s_mov_b32 s51, 128
  v_mfma_f32_16x16x32_bf16 a[0:3], a[220:223], a[36:39], a[0:3]
  buffer_load_dwordx4 v8, s[32:35], s51 offen offset:0 lds
  v_mfma_f32_16x16x32_bf16 a[4:7], a[216:219], a[40:43], a[4:7]
  ds_read_b64_tr_b16 a[144:145], v28 offset:0
  v_mfma_f32_16x16x32_bf16 a[4:7], a[220:223], a[44:47], a[4:7]
  ds_read_b64_tr_b16 a[146:147], v28 offset:1024
  v_mfma_f32_16x16x32_bf16 a[8:11], a[216:219], a[48:51], a[8:11]
  ds_read_b64_tr_b16 a[148:149], v28 offset:8192
  v_mfma_f32_16x16x32_bf16 a[8:11], a[220:223], a[52:55], a[8:11]
  buffer_load_dwordx4 v9, s[32:35], s51 offen offset:1024 lds
  v_mfma_f32_16x16x32_bf16 a[12:15], a[216:219], a[56:59], a[12:15]
  ds_read_b64_tr_b16 a[150:151], v28 offset:9216
  v_mfma_f32_16x16x32_bf16 a[12:15], a[220:223], a[60:63], a[12:15]
  ds_read_b128 a[184:187], v20 offset:6144
  v_mfma_f32_16x16x32_bf16 a[16:19], a[216:219], a[64:67], a[16:19]
  ds_read_b64_tr_b16 a[152:153], v29 offset:0
  v_mfma_f32_16x16x32_bf16 a[16:19], a[220:223], a[68:71], a[16:19]
  buffer_load_dwordx4 v10, s[32:35], s51 offen offset:2048 lds
  v_mfma_f32_16x16x32_bf16 a[20:23], a[216:219], a[72:75], a[20:23]
  ds_read_b64_tr_b16 a[154:155], v29 offset:1024
  v_mfma_f32_16x16x32_bf16 a[20:23], a[220:223], a[76:79], a[20:23]
  ds_read_b64_tr_b16 a[156:157], v29 offset:8192
  v_mfma_f32_16x16x32_bf16 a[24:27], a[216:219], a[80:83], a[24:27]
  ds_read_b64_tr_b16 a[158:159], v29 offset:9216
  v_mfma_f32_16x16x32_bf16 a[24:27], a[220:223], a[84:87], a[24:27]
  buffer_load_dwordx4 v11, s[32:35], s51 offen offset:3072 lds
  v_mfma_f32_16x16x32_bf16 a[28:31], a[216:219], a[88:91], a[28:31]
  ds_read_b128 a[188:191], v21 offset:6144
  v_mfma_f32_16x16x32_bf16 a[28:31], a[220:223], a[92:95], a[28:31]
  s_waitcnt lgkmcnt(4)
  v_mfma_f32_16x16x32_bf16 v[32:35], a[160:163], a[96:99], v[32:35]
  v_mfma_f32_16x16x32_bf16 v[32:35], a[164:167], a[100:103], v[32:35]
  v_mfma_f32_16x16x32_bf16 v[36:39], a[160:163], a[104:107], v[36:39]
  v_mfma_f32_16x16x32_bf16 v[36:39], a[164:167], a[108:111], v[36:39]
  v_mfma_f32_16x16x32_bf16 v[40:43], a[160:163], a[112:115], v[40:43]
  s_waitcnt lgkmcnt(0)
  s_barrier
  v_mfma_f32_16x16x32_bf16 v[40:43], a[164:167], a[116:119], v[40:43]
  s_add_u32 m0, s48, 0
  s_mov_b32 s50, 0
  v_mfma_f32_16x16x32_bf16 v[44:47], a[160:163], a[120:123], v[44:47]
  buffer_load_dwordx4 v12, s[36:39], s50 offen offset:0 lds
  v_mfma_f32_16x16x32_bf16 v[44:47], a[164:167], a[124:127], v[44:47]
  v_mfma_f32_16x16x32_bf16 v[48:51], a[160:163], a[128:131], v[48:51]
  ds_read_b128 a[192:195], v20 offset:8192
  s_and_b32 s54, s28, 1
  v_mfma_f32_16x16x32_bf16 v[48:51], a[164:167], a[132:135], v[48:51]
  buffer_load_dwordx4 v13, s[36:39], s50 offen offset:1024 lds
  s_lshl_b32 s54, s54, 14
  v_mfma_f32_16x16x32_bf16 v[52:55], a[160:163], a[136:139], v[52:55]
  v_subrev_u32 v22, s54, v22
  v_mfma_f32_16x16x32_bf16 v[52:55], a[164:167], a[140:143], v[52:55]
  v_mfma_f32_16x16x32_bf16 v[56:59], a[160:163], a[144:147], v[56:59]
  ds_read_b128 a[196:199], v21 offset:8192
  s_add_u32 m0, s48, 0
  s_mov_b32 s50, 0
  v_subrev_u32 v23, s54, v23
  v_mfma_f32_16x16x32_bf16 v[56:59], a[164:167], a[148:151], v[56:59]
  buffer_load_dwordx4 v14, s[36:39], s50 offen offset:2048 lds
  v_subrev_u32 v24, s54, v24
  v_mfma_f32_16x16x32_bf16 v[60:63], a[160:163], a[152:155], v[60:63]
  v_mfma_f32_16x16x32_bf16 v[60:63], a[164:167], a[156:159], v[60:63]
  v_subrev_u32 v25, s54, v25
  v_mfma_f32_16x16x32_bf16 v[64:67], a[168:171], a[96:99], v[64:67]
  buffer_load_dwordx4 v15, s[36:39], s50 offen offset:3072 lds
  v_subrev_u32 v26, s54, v26
  v_mfma_f32_16x16x32_bf16 v[64:67], a[172:175], a[100:103], v[64:67]
  v_mfma_f32_16x16x32_bf16 v[68:71], a[168:171], a[104:107], v[68:71]
  ds_read_b128 a[200:203], v20 offset:10240
  v_subrev_u32 v27, s54, v27
  v_mfma_f32_16x16x32_bf16 v[68:71], a[172:175], a[108:111], v[68:71]
  s_add_u32 m0, s48, 16384
  s_mov_b32 s50, 524288
  v_subrev_u32 v28, s54, v28
  v_mfma_f32_16x16x32_bf16 v[72:75], a[168:171], a[112:115], v[72:75]
  buffer_load_dwordx4 v12, s[36:39], s50 offen offset:0 lds
  v_mfma_f32_16x16x32_bf16 v[72:75], a[172:175], a[116:119], v[72:75]
  v_subrev_u32 v29, s54, v29
  v_mfma_f32_16x16x32_bf16 v[76:79], a[168:171], a[120:123], v[76:79]
  s_lshr_b32 s54, s28, 1
  v_mfma_f32_16x16x32_bf16 v[76:79], a[172:175], a[124:127], v[76:79]
  buffer_load_dwordx4 v13, s[36:39], s50 offen offset:1024 lds
  v_mfma_f32_16x16x32_bf16 v[80:83], a[168:171], a[128:131], v[80:83]
  ds_read_b128 a[204:207], v21 offset:10240
  s_lshl_b32 s54, s54, 14
  v_mfma_f32_16x16x32_bf16 v[80:83], a[172:175], a[132:135], v[80:83]
  s_sub_u32 s54, s49, s54
  v_mfma_f32_16x16x32_bf16 v[84:87], a[168:171], a[136:139], v[84:87]
  s_add_u32 m0, s48, 16384
  s_mov_b32 s50, 524288
  v_add_u32 v18, s54, v30
  v_mfma_f32_16x16x32_bf16 v[84:87], a[172:175], a[140:143], v[84:87]
  buffer_load_dwordx4 v14, s[36:39], s50 offen offset:2048 lds
  v_mfma_f32_16x16x32_bf16 v[88:91], a[168:171], a[144:147], v[88:91]
  v_add_u32 v19, s54, v31
  v_mfma_f32_16x16x32_bf16 v[88:91], a[172:175], a[148:151], v[88:91]
  v_add_u32 v30, 0x10000, v18
  v_mfma_f32_16x16x32_bf16 v[92:95], a[168:171], a[152:155], v[92:95]
  buffer_load_dwordx4 v15, s[36:39], s50 offen offset:3072 lds
  v_mfma_f32_16x16x32_bf16 v[92:95], a[172:175], a[156:159], v[92:95]
  v_add_u32 v31, 0x10000, v19
  v_mfma_f32_16x16x32_bf16 v[96:99], a[176:179], a[96:99], v[96:99]
  v_mov_b32 v17, 0
  v_mfma_f32_16x16x32_bf16 v[96:99], a[180:183], a[100:103], v[96:99]
  v_mfma_f32_16x16x32_bf16 v[100:103], a[176:179], a[104:107], v[100:103]
  ds_read_b128 a[208:211], v20 offset:12288
  s_add_u32 m0, s49, 32768
  s_mov_b32 s51, 256
  s_mov_b32 s96, s26
  v_mfma_f32_16x16x32_bf16 v[100:103], a[180:183], a[108:111], v[100:103]
  buffer_load_dwordx4 v4, s[32:35], s51 offen offset:0 lds
  s_mov_b32 s97, s27
  v_mfma_f32_16x16x32_bf16 v[104:107], a[176:179], a[112:115], v[104:107]
  v_mfma_f32_16x16x32_bf16 v[104:107], a[180:183], a[116:119], v[104:107]
  s_mov_b32 s99, 0x20000
  v_mfma_f32_16x16x32_bf16 v[108:111], a[176:179], a[120:123], v[108:111]
  buffer_load_dwordx4 v5, s[32:35], s51 offen offset:1024 lds
  v_cvt_pk_bf16_f32 v32, v32, v33
  v_cvt_pk_bf16_f32 v33, v34, v35
  s_cmp_lt_u32 s30, 3
  s_cselect_b32 s98, 82837504, 0
  v_mfma_f32_16x16x32_bf16 v[108:111], a[180:183], a[124:127], v[108:111]
  v_cvt_pk_bf16_f32 v34, v64, v65
  v_mfma_f32_16x16x32_bf16 v[112:115], a[176:179], a[128:131], v[112:115]
  ds_read_b128 a[212:215], v21 offset:12288
  v_cvt_pk_bf16_f32 v35, v66, v67
  v_mfma_f32_16x16x32_bf16 v[112:115], a[180:183], a[132:135], v[112:115]
  v_cvt_pk_bf16_f32 v36, v36, v37
  v_mfma_f32_16x16x32_bf16 v[116:119], a[176:179], a[136:139], v[116:119]
  buffer_load_dwordx4 v6, s[32:35], s51 offen offset:2048 lds
  v_cvt_pk_bf16_f32 v37, v38, v39
  s_mov_b32 s44, s20
  v_mfma_f32_16x16x32_bf16 v[116:119], a[180:183], a[140:143], v[116:119]
  v_cvt_pk_bf16_f32 v38, v68, v69
  s_mov_b32 s45, s21
  v_mfma_f32_16x16x32_bf16 v[120:123], a[176:179], a[144:147], v[120:123]
  v_cvt_pk_bf16_f32 v39, v70, v71
  s_mov_b32 s46, 819200
  v_mfma_f32_16x16x32_bf16 v[120:123], a[180:183], a[148:151], v[120:123]
  buffer_load_dwordx4 v7, s[32:35], s51 offen offset:3072 lds
  v_cvt_pk_bf16_f32 v40, v40, v41
  s_mov_b32 s47, 0x20000
  v_mfma_f32_16x16x32_bf16 v[124:127], a[176:179], a[152:155], v[124:127]
  v_cvt_pk_bf16_f32 v41, v42, v43
  s_mul_i32 s55, s2, 205
  v_mfma_f32_16x16x32_bf16 v[124:127], a[180:183], a[156:159], v[124:127]
  v_cvt_pk_bf16_f32 v42, v72, v73
  s_lshr_b32 s55, s55, 11
  v_mfma_f32_16x16x32_bf16 v[128:131], a[184:187], a[96:99], v[128:131]
  s_add_u32 m0, s49, 36864
  s_mov_b32 s51, 256
  v_cvt_pk_bf16_f32 v43, v74, v75
  v_mfma_f32_16x16x32_bf16 v[128:131], a[188:191], a[100:103], v[128:131]
  buffer_load_dwordx4 v8, s[32:35], s51 offen offset:0 lds
  v_cvt_pk_bf16_f32 v44, v44, v45
  s_mul_i32 s56, s55, 39680
  v_mfma_f32_16x16x32_bf16 v[132:135], a[184:187], a[104:107], v[132:135]
  ds_read_b128 a[216:219], v20 offset:14336
  v_cvt_pk_bf16_f32 v45, v46, v47
  s_lshl_b32 s55, s2, 7
  v_mfma_f32_16x16x32_bf16 v[132:135], a[188:191], a[108:111], v[132:135]
  v_cvt_pk_bf16_f32 v46, v76, v77
  s_add_u32 s95, s56, s55
  v_mfma_f32_16x16x32_bf16 v[136:139], a[184:187], a[112:115], v[136:139]
  v_cvt_pk_bf16_f32 v47, v78, v79
  s_lshl_b32 s55, s28, 5
  v_mfma_f32_16x16x32_bf16 v[136:139], a[188:191], a[116:119], v[136:139]
  buffer_load_dwordx4 v9, s[32:35], s51 offen offset:1024 lds
  v_cvt_pk_bf16_f32 v48, v48, v49
  v_cvt_pk_bf16_f32 v49, v50, v51
  s_add_u32 s95, s95, s55
  v_mfma_f32_16x16x32_bf16 v[140:143], a[184:187], a[120:123], v[140:143]
  v_cvt_pk_bf16_f32 v50, v80, v81
  s_add_u32 s3, s95, 5120
  v_mfma_f32_16x16x32_bf16 v[140:143], a[188:191], a[124:127], v[140:143]
  v_cvt_pk_bf16_f32 v51, v82, v83
  v_mfma_f32_16x16x32_bf16 v[144:147], a[184:187], a[128:131], v[144:147]
  ds_read_b128 a[220:223], v21 offset:14336
  v_cvt_pk_bf16_f32 v52, v52, v53
  v_mfma_f32_16x16x32_bf16 v[144:147], a[188:191], a[132:135], v[144:147]
  v_cvt_pk_bf16_f32 v53, v54, v55
  v_lshrrev_b32 v20, 4, v1
  v_lshrrev_b32 v21, 2, v1
  v_mfma_f32_16x16x32_bf16 v[148:151], a[184:187], a[136:139], v[148:151]
  buffer_load_dwordx4 v10, s[32:35], s51 offen offset:2048 lds
  v_cvt_pk_bf16_f32 v54, v84, v85
  v_and_b32 v21, 3, v21
  v_mfma_f32_16x16x32_bf16 v[148:151], a[188:191], a[140:143], v[148:151]
  v_cvt_pk_bf16_f32 v55, v86, v87
  v_lshl_add_u32 v20, v20, 3, v21
  v_mfma_f32_16x16x32_bf16 v[152:155], a[184:187], a[144:147], v[152:155]
  v_cvt_pk_bf16_f32 v56, v56, v57
  v_mul_u32_u24 v20, 1280, v20
  v_mfma_f32_16x16x32_bf16 v[152:155], a[188:191], a[148:151], v[152:155]
  v_cvt_pk_bf16_f32 v57, v58, v59
  v_and_b32 v21, 3, v1
  v_mfma_f32_16x16x32_bf16 v[156:159], a[184:187], a[152:155], v[156:159]
  buffer_load_dwordx4 v11, s[32:35], s51 offen offset:3072 lds
  v_cvt_pk_bf16_f32 v58, v88, v89
  v_lshl_add_u32 v20, v21, 3, v20
  v_mfma_f32_16x16x32_bf16 v[156:159], a[188:191], a[156:159], v[156:159]
  v_cvt_pk_bf16_f32 v59, v90, v91
  s_waitcnt lgkmcnt(0)
  v_mfma_f32_16x16x32_bf16 v[160:163], a[192:195], a[96:99], v[160:163]
  v_cvt_pk_bf16_f32 v60, v60, v61
  v_mfma_f32_16x16x32_bf16 v[160:163], a[196:199], a[100:103], v[160:163]
  v_cvt_pk_bf16_f32 v61, v62, v63
  v_mfma_f32_16x16x32_bf16 v[164:167], a[192:195], a[104:107], v[164:167]
  v_cvt_pk_bf16_f32 v62, v92, v93
  s_waitcnt lgkmcnt(0)
  s_barrier
  v_mfma_f32_16x16x32_bf16 v[164:167], a[196:199], a[108:111], v[164:167]
  v_cvt_pk_bf16_f32 v63, v94, v95
  s_add_u32 m0, s48, 32768
  s_mov_b32 s50, 1048576
  v_mfma_f32_16x16x32_bf16 v[168:171], a[192:195], a[112:115], v[168:171]
  buffer_load_dwordx4 v12, s[36:39], s50 offen offset:0 lds
  v_mfma_f32_16x16x32_bf16 v[168:171], a[196:199], a[116:119], v[168:171]
  v_mfma_f32_16x16x32_bf16 v[172:175], a[192:195], a[120:123], v[172:175]
  v_cvt_pk_bf16_f32 v64, v96, v97
  v_cvt_pk_bf16_f32 v65, v98, v99
  v_mfma_f32_16x16x32_bf16 v[172:175], a[196:199], a[124:127], v[172:175]
  v_cvt_pk_bf16_f32 v66, v128, v129
  buffer_load_dwordx4 v13, s[36:39], s50 offen offset:1024 lds
  v_mfma_f32_16x16x32_bf16 v[176:179], a[192:195], a[128:131], v[176:179]
  v_cvt_pk_bf16_f32 v67, v130, v131
  v_mfma_f32_16x16x32_bf16 v[176:179], a[196:199], a[132:135], v[176:179]
  v_cvt_pk_bf16_f32 v68, v100, v101
  s_add_u32 m0, s48, 32768
  s_mov_b32 s50, 1048576
  v_mfma_f32_16x16x32_bf16 v[180:183], a[192:195], a[136:139], v[180:183]
  v_cvt_pk_bf16_f32 v69, v102, v103
  buffer_load_dwordx4 v14, s[36:39], s50 offen offset:2048 lds
  v_mfma_f32_16x16x32_bf16 v[180:183], a[196:199], a[140:143], v[180:183]
  v_cvt_pk_bf16_f32 v70, v132, v133
  v_mfma_f32_16x16x32_bf16 v[184:187], a[192:195], a[144:147], v[184:187]
  v_cvt_pk_bf16_f32 v71, v134, v135
  v_mfma_f32_16x16x32_bf16 v[184:187], a[196:199], a[148:151], v[184:187]
  v_cvt_pk_bf16_f32 v72, v104, v105
  buffer_load_dwordx4 v15, s[36:39], s50 offen offset:3072 lds
  v_mfma_f32_16x16x32_bf16 v[188:191], a[192:195], a[152:155], v[188:191]
  v_cvt_pk_bf16_f32 v73, v106, v107
  v_mfma_f32_16x16x32_bf16 v[188:191], a[196:199], a[156:159], v[188:191]
  v_cvt_pk_bf16_f32 v74, v136, v137
  v_mfma_f32_16x16x32_bf16 v[192:195], a[200:203], a[96:99], v[192:195]
  v_cvt_pk_bf16_f32 v75, v138, v139
  v_mfma_f32_16x16x32_bf16 v[192:195], a[204:207], a[100:103], v[192:195]
  v_cvt_pk_bf16_f32 v76, v108, v109
  s_add_u32 s57, s58, 0
  v_mfma_f32_16x16x32_bf16 v[196:199], a[200:203], a[104:107], v[196:199]
  v_cvt_pk_bf16_f32 v77, v110, v111
  buffer_store_dwordx4 v[32:35], v16, s[40:43], s57 offen offset:0 sc1
  v_mfma_f32_16x16x32_bf16 v[196:199], a[204:207], a[108:111], v[196:199]
  v_cvt_pk_bf16_f32 v78, v140, v141
  v_mfma_f32_16x16x32_bf16 v[200:203], a[200:203], a[112:115], v[200:203]
  v_cvt_pk_bf16_f32 v79, v142, v143
  v_mfma_f32_16x16x32_bf16 v[200:203], a[204:207], a[116:119], v[200:203]
  v_cvt_pk_bf16_f32 v80, v112, v113
  v_cvt_pk_bf16_f32 v81, v114, v115
  v_mfma_f32_16x16x32_bf16 v[204:207], a[200:203], a[120:123], v[204:207]
  v_cvt_pk_bf16_f32 v82, v144, v145
  v_mfma_f32_16x16x32_bf16 v[204:207], a[204:207], a[124:127], v[204:207]
  v_cvt_pk_bf16_f32 v83, v146, v147
  s_add_u32 s57, s58, 0
  v_mfma_f32_16x16x32_bf16 v[208:211], a[200:203], a[128:131], v[208:211]
  v_cvt_pk_bf16_f32 v84, v116, v117
  buffer_store_dwordx4 v[36:39], v16, s[40:43], s57 offen offset:1024 sc1
  v_mfma_f32_16x16x32_bf16 v[208:211], a[204:207], a[132:135], v[208:211]
  v_cvt_pk_bf16_f32 v85, v118, v119
  v_mfma_f32_16x16x32_bf16 v[212:215], a[200:203], a[136:139], v[212:215]
  v_cvt_pk_bf16_f32 v86, v148, v149
  v_mfma_f32_16x16x32_bf16 v[212:215], a[204:207], a[140:143], v[212:215]
  v_cvt_pk_bf16_f32 v87, v150, v151
  v_mfma_f32_16x16x32_bf16 v[216:219], a[200:203], a[144:147], v[216:219]
  v_cvt_pk_bf16_f32 v88, v120, v121
  v_mfma_f32_16x16x32_bf16 v[216:219], a[204:207], a[148:151], v[216:219]
  v_cvt_pk_bf16_f32 v89, v122, v123
  v_mfma_f32_16x16x32_bf16 v[220:223], a[200:203], a[152:155], v[220:223]
  v_cvt_pk_bf16_f32 v90, v152, v153
  s_add_u32 s57, s58, 4096
  v_mfma_f32_16x16x32_bf16 v[220:223], a[204:207], a[156:159], v[220:223]
  v_cvt_pk_bf16_f32 v91, v154, v155
  buffer_store_dwordx4 v[40:43], v16, s[40:43], s57 offen offset:0 sc1
  v_mfma_f32_16x16x32_bf16 v[224:227], a[208:211], a[96:99], v[224:227]
  v_cvt_pk_bf16_f32 v92, v124, v125
  v_mfma_f32_16x16x32_bf16 v[224:227], a[212:215], a[100:103], v[224:227]
  v_cvt_pk_bf16_f32 v93, v126, v127
  v_mfma_f32_16x16x32_bf16 v[228:231], a[208:211], a[104:107], v[228:231]
  v_cvt_pk_bf16_f32 v94, v156, v157
  v_mfma_f32_16x16x32_bf16 v[228:231], a[212:215], a[108:111], v[228:231]
  v_cvt_pk_bf16_f32 v95, v158, v159
  v_mfma_f32_16x16x32_bf16 v[232:235], a[208:211], a[112:115], v[232:235]
  v_mfma_f32_16x16x32_bf16 v[232:235], a[212:215], a[116:119], v[232:235]
  v_mfma_f32_16x16x32_bf16 v[236:239], a[208:211], a[120:123], v[236:239]
  v_cvt_pk_bf16_f32 v96, v160, v161
  v_cvt_pk_bf16_f32 v97, v162, v163
  s_waitcnt vmcnt(19) lgkmcnt(0)
  s_barrier
  v_mfma_f32_16x16x32_bf16 v[236:239], a[212:215], a[124:127], v[236:239]
  v_cvt_pk_bf16_f32 v98, v192, v193
  s_add_u32 s57, s58, 4096
  ds_read_b64_tr_b16 a[64:65], v22 offset:0
  v_mfma_f32_16x16x32_bf16 v[240:243], a[208:211], a[128:131], v[240:243]
  v_cvt_pk_bf16_f32 v99, v194, v195
  buffer_store_dwordx4 v[44:47], v16, s[40:43], s57 offen offset:1024 sc1
  ds_read_b64_tr_b16 a[66:67], v22 offset:1024
  v_mfma_f32_16x16x32_bf16 v[240:243], a[212:215], a[132:135], v[240:243]
  v_cvt_pk_bf16_f32 v100, v164, v165
  ds_read_b128 a[32:35], v30 offset:0
  v_mfma_f32_16x16x32_bf16 v[244:247], a[208:211], a[136:139], v[244:247]
  v_cvt_pk_bf16_f32 v101, v166, v167
  v_cvt_pk_bf16_f32 v102, v196, v197
  ds_read_b128 a[36:39], v30 offset:2048
  v_mfma_f32_16x16x32_bf16 v[244:247], a[212:215], a[140:143], v[244:247]
  v_cvt_pk_bf16_f32 v103, v198, v199
  ds_read_b128 a[40:43], v30 offset:4096
  v_mfma_f32_16x16x32_bf16 v[248:251], a[208:211], a[144:147], v[248:251]
  v_cvt_pk_bf16_f32 v104, v168, v169
  ds_read_b128 a[44:47], v30 offset:6144
  v_mfma_f32_16x16x32_bf16 v[248:251], a[212:215], a[148:151], v[248:251]
  v_cvt_pk_bf16_f32 v105, v170, v171
  s_add_u32 s57, s58, 8192
  ds_read_b64_tr_b16 a[68:69], v23 offset:0
  v_mfma_f32_16x16x32_bf16 v[252:255], a[208:211], a[152:155], v[252:255]
  v_cvt_pk_bf16_f32 v106, v200, v201
  v_cvt_pk_bf16_f32 v107, v202, v203
  buffer_store_dwordx4 v[48:51], v16, s[40:43], s57 offen offset:0 sc1
  ds_read_b64_tr_b16 a[70:71], v23 offset:1024
  v_mfma_f32_16x16x32_bf16 v[252:255], a[212:215], a[156:159], v[252:255]
  v_cvt_pk_bf16_f32 v108, v172, v173
  ds_read_b64_tr_b16 a[72:73], v24 offset:0
  v_mfma_f32_16x16x32_bf16 a[0:3], a[216:219], a[96:99], a[0:3]
  v_cvt_pk_bf16_f32 v109, v174, v175
  ds_read_b64_tr_b16 a[74:75], v24 offset:1024
  v_mfma_f32_16x16x32_bf16 a[0:3], a[220:223], a[100:103], a[0:3]
  v_cvt_pk_bf16_f32 v110, v204, v205
  ds_read_b64_tr_b16 a[76:77], v25 offset:0
  v_mfma_f32_16x16x32_bf16 a[4:7], a[216:219], a[104:107], a[4:7]
  v_cvt_pk_bf16_f32 v111, v206, v207
  s_add_u32 s57, s58, 8192
  ds_read_b64_tr_b16 a[78:79], v25 offset:1024
  v_mfma_f32_16x16x32_bf16 a[4:7], a[220:223], a[108:111], a[4:7]
  v_cvt_pk_bf16_f32 v112, v176, v177
  v_cvt_pk_bf16_f32 v113, v178, v179
  buffer_store_dwordx4 v[52:55], v16, s[40:43], s57 offen offset:1024 sc1
  ds_read_b64_tr_b16 a[80:81], v26 offset:0
  v_mfma_f32_16x16x32_bf16 a[8:11], a[216:219], a[112:115], a[8:11]
  v_cvt_pk_bf16_f32 v114, v208, v209
  ds_read_b64_tr_b16 a[82:83], v26 offset:1024
  v_mfma_f32_16x16x32_bf16 a[8:11], a[220:223], a[116:119], a[8:11]
  v_cvt_pk_bf16_f32 v115, v210, v211
  ds_read_b64_tr_b16 a[84:85], v27 offset:0
  v_mfma_f32_16x16x32_bf16 a[12:15], a[216:219], a[120:123], a[12:15]
  v_cvt_pk_bf16_f32 v116, v180, v181
  ds_read_b64_tr_b16 a[86:87], v27 offset:1024
  v_mfma_f32_16x16x32_bf16 a[12:15], a[220:223], a[124:127], a[12:15]
  v_cvt_pk_bf16_f32 v117, v182, v183
  v_cvt_pk_bf16_f32 v118, v212, v213
  s_add_u32 s57, s58, 12288
  ds_read_b64_tr_b16 a[88:89], v28 offset:0
  v_mfma_f32_16x16x32_bf16 a[16:19], a[216:219], a[128:131], a[16:19]
  v_cvt_pk_bf16_f32 v119, v214, v215
  buffer_store_dwordx4 v[56:59], v16, s[40:43], s57 offen offset:0 sc1
  ds_read_b64_tr_b16 a[90:91], v28 offset:1024
  v_mfma_f32_16x16x32_bf16 a[16:19], a[220:223], a[132:135], a[16:19]
  v_cvt_pk_bf16_f32 v120, v184, v185
  ds_read_b64_tr_b16 a[92:93], v29 offset:0
  v_mfma_f32_16x16x32_bf16 a[20:23], a[216:219], a[136:139], a[20:23]
  v_cvt_pk_bf16_f32 v121, v186, v187
  ds_read_b64_tr_b16 a[94:95], v29 offset:1024
  v_mfma_f32_16x16x32_bf16 a[20:23], a[220:223], a[140:143], a[20:23]
  v_cvt_pk_bf16_f32 v122, v216, v217
  v_cvt_pk_bf16_f32 v123, v218, v219
  ds_read_b128 a[48:51], v31 offset:0
  v_mfma_f32_16x16x32_bf16 a[24:27], a[216:219], a[144:147], a[24:27]
  v_cvt_pk_bf16_f32 v124, v188, v189
  ds_read_b128 a[52:55], v31 offset:2048
  v_mfma_f32_16x16x32_bf16 a[24:27], a[220:223], a[148:151], a[24:27]
  v_cvt_pk_bf16_f32 v125, v190, v191
  s_add_u32 s57, s58, 12288
  ds_read_b128 a[56:59], v31 offset:4096
  v_mfma_f32_16x16x32_bf16 a[28:31], a[216:219], a[152:155], a[28:31]
  v_cvt_pk_bf16_f32 v126, v220, v221
  buffer_store_dwordx4 v[60:63], v16, s[40:43], s57 offen offset:1024 sc1
  v_add_u32 v2, 0x8000, v2
  v_min_u32 v3, s94, v2
  ds_read_b128 a[60:63], v31 offset:6144
  v_mfma_f32_16x16x32_bf16 a[28:31], a[220:223], a[156:159], a[28:31]
  v_cvt_pk_bf16_f32 v127, v222, v223
  global_load_dword v0, v3, s[92:93]
  buffer_load_dwordx2 a[160:161], v20, s[44:47], s95 offen nt
  buffer_load_dwordx2 a[162:163], v20, s[44:47], s3 offen nt
  s_nop 5
  v_accvgpr_read_b32 v192, a0
  v_accvgpr_read_b32 v193, a1
  v_accvgpr_read_b32 v194, a2
  v_accvgpr_read_b32 v195, a3
  v_accvgpr_read_b32 v196, a4
  v_accvgpr_read_b32 v197, a5
  v_accvgpr_read_b32 v198, a6
  v_accvgpr_read_b32 v199, a7
  v_accvgpr_read_b32 v200, a8
  v_accvgpr_read_b32 v201, a9
  v_accvgpr_read_b32 v202, a10
  v_accvgpr_read_b32 v203, a11
  v_accvgpr_read_b32 v204, a12
  v_accvgpr_read_b32 v205, a13
  v_accvgpr_read_b32 v206, a14
  v_accvgpr_read_b32 v207, a15
  v_accvgpr_read_b32 v208, a16
  v_accvgpr_read_b32 v209, a17
  v_accvgpr_read_b32 v210, a18
  v_accvgpr_read_b32 v211, a19
  v_accvgpr_read_b32 v212, a20
  v_accvgpr_read_b32 v213, a21
  v_accvgpr_read_b32 v214, a22
  v_accvgpr_read_b32 v215, a23
  v_accvgpr_read_b32 v216, a24
  v_accvgpr_read_b32 v217, a25
  v_accvgpr_read_b32 v218, a26
  v_accvgpr_read_b32 v219, a27
  v_accvgpr_read_b32 v220, a28
  v_accvgpr_read_b32 v221, a29
  v_accvgpr_read_b32 v222, a30
  v_accvgpr_read_b32 v223, a31
  v_cvt_pk_bf16_f32 v32, v224, v225
  v_cvt_pk_bf16_f32 v33, v226, v227
  v_cvt_pk_bf16_f32 v34, v192, v193
  v_cvt_pk_bf16_f32 v35, v194, v195
  v_cvt_pk_bf16_f32 v36, v228, v229
  v_cvt_pk_bf16_f32 v37, v230, v231
  v_cvt_pk_bf16_f32 v38, v196, v197
  v_cvt_pk_bf16_f32 v39, v198, v199
  v_cvt_pk_bf16_f32 v40, v232, v233
  v_cvt_pk_bf16_f32 v41, v234, v235
  v_cvt_pk_bf16_f32 v42, v200, v201
  v_cvt_pk_bf16_f32 v43, v202, v203
  v_cvt_pk_bf16_f32 v44, v236, v237
  v_cvt_pk_bf16_f32 v45, v238, v239
  v_cvt_pk_bf16_f32 v46, v204, v205
  v_cvt_pk_bf16_f32 v47, v206, v207
  v_cvt_pk_bf16_f32 v48, v240, v241
  v_cvt_pk_bf16_f32 v49, v242, v243
  v_cvt_pk_bf16_f32 v50, v208, v209
  v_cvt_pk_bf16_f32 v51, v210, v211
  v_cvt_pk_bf16_f32 v52, v244, v245
  v_cvt_pk_bf16_f32 v53, v246, v247
  v_cvt_pk_bf16_f32 v54, v212, v213
  v_cvt_pk_bf16_f32 v55, v214, v215
  v_cvt_pk_bf16_f32 v56, v248, v249
  v_cvt_pk_bf16_f32 v57, v250, v251
  v_cvt_pk_bf16_f32 v58, v216, v217
  v_cvt_pk_bf16_f32 v59, v218, v219
  v_cvt_pk_bf16_f32 v60, v252, v253
  v_cvt_pk_bf16_f32 v61, v254, v255
  v_cvt_pk_bf16_f32 v62, v220, v221
  v_cvt_pk_bf16_f32 v63, v222, v223
LKV_done:
  s_waitcnt lgkmcnt(13)
  v_mfma_f32_16x16x32_bf16 v[128:131], a[64:67], a[32:35], 0
  v_mfma_f32_16x16x32_bf16 v[132:135], a[64:67], a[36:39], 0
  s_waitcnt vmcnt(31) lgkmcnt(0)
  v_mfma_f32_16x16x32_bf16 v[136:139], a[64:67], a[40:43], 0
  ds_read_b64_tr_b16 a[96:97], v22 offset:8192
  v_mfma_f32_16x16x32_bf16 v[140:143], a[64:67], a[44:47], 0
  ds_read_b64_tr_b16 a[98:99], v22 offset:9216
  s_add_u32 m0, s49, 65536
  s_mov_b32 s51, 384
  v_mfma_f32_16x16x32_bf16 v[144:147], a[68:71], a[32:35], 0
  buffer_load_dwordx4 v4, s[32:35], s51 offen offset:0 lds
  v_mfma_f32_16x16x32_bf16 v[148:151], a[68:71], a[36:39], 0
  ds_read_b64_tr_b16 a[100:101], v23 offset:8192
  v_mfma_f32_16x16x32_bf16 v[152:155], a[68:71], a[40:43], 0
  ds_read_b64_tr_b16 a[102:103], v23 offset:9216
  v_mfma_f32_16x16x32_bf16 v[156:159], a[68:71], a[44:47], 0
  buffer_load_dwordx4 v5, s[32:35], s51 offen offset:1024 lds
  v_mfma_f32_16x16x32_bf16 v[160:163], a[72:75], a[32:35], 0
  ds_read_b64_tr_b16 a[104:105], v24 offset:8192
  v_mfma_f32_16x16x32_bf16 v[164:167], a[72:75], a[36:39], 0
  ds_read_b64_tr_b16 a[106:107], v24 offset:9216
  v_mfma_f32_16x16x32_bf16 v[168:171], a[72:75], a[40:43], 0
  buffer_load_dwordx4 v6, s[32:35], s51 offen offset:2048 lds
  v_mfma_f32_16x16x32_bf16 v[172:175], a[72:75], a[44:47], 0
  ds_read_b64_tr_b16 a[108:109], v25 offset:8192
  v_mfma_f32_16x16x32_bf16 v[176:179], a[76:79], a[32:35], 0
  ds_read_b64_tr_b16 a[110:111], v25 offset:9216
  v_mfma_f32_16x16x32_bf16 v[180:183], a[76:79], a[36:39], 0
  buffer_load_dwordx4 v7, s[32:35], s51 offen offset:3072 lds
  v_mfma_f32_16x16x32_bf16 v[184:187], a[76:79], a[40:43], 0
  ds_read_b64_tr_b16 a[112:113], v26 offset:8192
  v_mfma_f32_16x16x32_bf16 v[188:191], a[76:79], a[44:47], 0
  ds_read_b64_tr_b16 a[114:115], v26 offset:9216
  s_add_u32 m0, s48, 49152
  s_mov_b32 s50, 1572864
  v_mfma_f32_16x16x32_bf16 v[192:195], a[80:83], a[32:35], 0
  buffer_load_dwordx4 v12, s[36:39], s50 offen offset:0 lds
  v_mfma_f32_16x16x32_bf16 v[196:199], a[80:83], a[36:39], 0
  ds_read_b64_tr_b16 a[116:117], v27 offset:8192
  v_mfma_f32_16x16x32_bf16 v[200:203], a[80:83], a[40:43], 0
  ds_read_b64_tr_b16 a[118:119], v27 offset:9216
  v_mfma_f32_16x16x32_bf16 v[204:207], a[80:83], a[44:47], 0
  buffer_load_dwordx4 v13, s[36:39], s50 offen offset:1024 lds
  v_mfma_f32_16x16x32_bf16 v[208:211], a[84:87], a[32:35], 0
  ds_read_b64_tr_b16 a[120:121], v28 offset:8192
  v_mfma_f32_16x16x32_bf16 v[212:215], a[84:87], a[36:39], 0
  ds_read_b64_tr_b16 a[122:123], v28 offset:9216
  v_mfma_f32_16x16x32_bf16 v[216:219], a[84:87], a[40:43], 0
  ds_read_b128 a[128:131], v18 offset:0
  s_add_u32 s57, s58, 49152
  v_mfma_f32_16x16x32_bf16 v[220:223], a[84:87], a[44:47], 0
  ds_read_b64_tr_b16 a[124:125], v29 offset:8192
  buffer_store_dwordx4 v[32:35], v16, s[40:43], s57 offen offset:0 sc1
  v_mfma_f32_16x16x32_bf16 v[224:227], a[88:91], a[32:35], 0
  ds_read_b64_tr_b16 a[126:127], v29 offset:9216
  v_mfma_f32_16x16x32_bf16 v[228:231], a[88:91], a[36:39], 0
  ds_read_b128 a[132:135], v18 offset:2048
  v_mfma_f32_16x16x32_bf16 v[232:235], a[88:91], a[40:43], 0
  ds_read_b128 a[136:139], v18 offset:4096
  s_add_u32 s57, s58, 53248
  v_mfma_f32_16x16x32_bf16 v[236:239], a[88:91], a[44:47], 0
  ds_read_b128 a[140:143], v18 offset:6144
  buffer_store_dwordx4 v[40:43], v16, s[96:99], s57 offen offset:0 sc1
  v_mfma_f32_16x16x32_bf16 v[240:243], a[92:95], a[32:35], 0
  v_mfma_f32_16x16x32_bf16 v[244:247], a[92:95], a[36:39], 0
  s_add_u32 s57, s58, 49152
  v_mfma_f32_16x16x32_bf16 v[248:251], a[92:95], a[40:43], 0
  buffer_store_dwordx4 v[36:39], v16, s[40:43], s57 offen offset:1024 sc1
  v_mfma_f32_16x16x32_bf16 v[252:255], a[92:95], a[44:47], 0
  s_waitcnt lgkmcnt(3)
  v_mfma_f32_16x16x32_bf16 v[128:131], a[96:99], a[48:51], v[128:131]
  v_mfma_f32_16x16x32_bf16 v[132:135], a[96:99], a[52:55], v[132:135]
  s_waitcnt vmcnt(32) lgkmcnt(0)
  s_barrier
  v_mfma_f32_16x16x32_bf16 v[136:139], a[96:99], a[56:59], v[136:139]
  ds_read_b64_tr_b16 a[64:65], v22 offset:16384
  v_accvgpr_write_b32 a216, v40
  v_mfma_f32_16x16x32_bf16 v[140:143], a[96:99], a[60:63], v[140:143]
  ds_read_b64_tr_b16 a[66:67], v22 offset:17408
  s_add_u32 m0, s49, 69632
  s_mov_b32 s51, 384
  v_mfma_f32_16x16x32_bf16 v[144:147], a[100:103], a[48:51], v[144:147]
  buffer_load_dwordx4 v8, s[32:35], s51 offen offset:0 lds
  v_mfma_f32_16x16x32_bf16 v[148:151], a[100:103], a[52:55], v[148:151]
  ds_read_b64_tr_b16 a[68:69], v23 offset:16384
  v_accvgpr_write_b32 a217, v41
  v_mfma_f32_16x16x32_bf16 v[152:155], a[100:103], a[56:59], v[152:155]
  ds_read_b64_tr_b16 a[70:71], v23 offset:17408
  v_mfma_f32_16x16x32_bf16 v[156:159], a[100:103], a[60:63], v[156:159]
  buffer_load_dwordx4 v9, s[32:35], s51 offen offset:1024 lds
  v_mfma_f32_16x16x32_bf16 v[160:163], a[104:107], a[48:51], v[160:163]
  ds_read_b64_tr_b16 a[72:73], v24 offset:16384
  v_accvgpr_write_b32 a218, v42
  v_mfma_f32_16x16x32_bf16 v[164:167], a[104:107], a[52:55], v[164:167]
  ds_read_b64_tr_b16 a[74:75], v24 offset:17408
  v_mfma_f32_16x16x32_bf16 v[168:171], a[104:107], a[56:59], v[168:171]
  buffer_load_dwordx4 v10, s[32:35], s51 offen offset:2048 lds
  v_mfma_f32_16x16x32_bf16 v[172:175], a[104:107], a[60:63], v[172:175]
  ds_read_b64_tr_b16 a[76:77], v25 offset:16384
  v_accvgpr_write_b32 a219, v43
  v_mfma_f32_16x16x32_bf16 v[176:179], a[108:111], a[48:51], v[176:179]
  ds_read_b64_tr_b16 a[78:79], v25 offset:17408
  v_mfma_f32_16x16x32_bf16 v[180:183], a[108:111], a[52:55], v[180:183]
  buffer_load_dwordx4 v11, s[32:35], s51 offen offset:3072 lds
  v_mfma_f32_16x16x32_bf16 v[184:187], a[108:111], a[56:59], v[184:187]
  ds_read_b64_tr_b16 a[80:81], v26 offset:16384
  v_accvgpr_write_b32 a212, v44
  v_mfma_f32_16x16x32_bf16 v[188:191], a[108:111], a[60:63], v[188:191]
  ds_read_b64_tr_b16 a[82:83], v26 offset:17408
  s_add_u32 m0, s48, 49152
  s_mov_b32 s50, 1572864
  v_mfma_f32_16x16x32_bf16 v[192:195], a[112:115], a[48:51], v[192:195]
  buffer_load_dwordx4 v14, s[36:39], s50 offen offset:2048 lds
  v_mfma_f32_16x16x32_bf16 v[196:199], a[112:115], a[52:55], v[196:199]
  ds_read_b64_tr_b16 a[84:85], v27 offset:16384
  v_accvgpr_write_b32 a213, v45
  v_mfma_f32_16x16x32_bf16 v[200:203], a[112:115], a[56:59], v[200:203]
  ds_read_b64_tr_b16 a[86:87], v27 offset:17408
  v_mfma_f32_16x16x32_bf16 v[204:207], a[112:115], a[60:63], v[204:207]
  buffer_load_dwordx4 v15, s[36:39], s50 offen offset:3072 lds
  v_mfma_f32_16x16x32_bf16 v[208:211], a[116:119], a[48:51], v[208:211]
  ds_read_b64_tr_b16 a[88:89], v28 offset:16384
  v_accvgpr_write_b32 a214, v46
  v_mfma_f32_16x16x32_bf16 v[212:215], a[116:119], a[52:55], v[212:215]
  ds_read_b64_tr_b16 a[90:91], v28 offset:17408
  v_mfma_f32_16x16x32_bf16 v[216:219], a[116:119], a[56:59], v[216:219]
  ds_read_b128 a[144:147], v19 offset:0
  s_add_u32 s57, s58, 53248
  v_mfma_f32_16x16x32_bf16 v[220:223], a[116:119], a[60:63], v[220:223]
  ds_read_b64_tr_b16 a[92:93], v29 offset:16384
  v_accvgpr_write_b32 a215, v47
  buffer_store_dwordx4 v[44:47], v16, s[96:99], s57 offen offset:1024 sc1
  v_mfma_f32_16x16x32_bf16 v[224:227], a[120:123], a[48:51], v[224:227]
  ds_read_b64_tr_b16 a[94:95], v29 offset:17408
  v_mfma_f32_16x16x32_bf16 v[228:231], a[120:123], a[52:55], v[228:231]
  ds_read_b128 a[148:151], v19 offset:2048
  v_mfma_f32_16x16x32_bf16 v[232:235], a[120:123], a[56:59], v[232:235]
  ds_read_b128 a[152:155], v19 offset:4096
  v_accvgpr_write_b32 a208, v48
  v_mfma_f32_16x16x32_bf16 v[236:239], a[120:123], a[60:63], v[236:239]
  ds_read_b128 a[156:159], v19 offset:6144
  v_mfma_f32_16x16x32_bf16 v[240:243], a[124:127], a[48:51], v[240:243]
  v_mfma_f32_16x16x32_bf16 v[244:247], a[124:127], a[52:55], v[244:247]
  v_accvgpr_write_b32 a209, v49
  global_load_dwordx2 v[20:21], v17, s[24:25] sc1
  s_add_u32 s57, s58, 57344
  v_mfma_f32_16x16x32_bf16 v[248:251], a[124:127], a[56:59], v[248:251]
  buffer_store_dwordx4 v[48:51], v16, s[96:99], s57 offen offset:0 sc1
  v_mfma_f32_16x16x32_bf16 v[252:255], a[124:127], a[60:63], v[252:255]
  s_waitcnt lgkmcnt(2)
  v_mfma_f32_16x16x32_bf16 v[128:131], a[64:67], a[128:131], v[128:131]
  v_mfma_f32_16x16x32_bf16 v[132:135], a[64:67], a[132:135], v[132:135]
  s_waitcnt vmcnt(33) lgkmcnt(0)
  v_mfma_f32_16x16x32_bf16 v[136:139], a[64:67], a[136:139], v[136:139]
  ds_read_b64_tr_b16 a[96:97], v22 offset:24576
  v_accvgpr_write_b32 a210, v50
  v_mfma_f32_16x16x32_bf16 v[140:143], a[64:67], a[140:143], v[140:143]
  ds_read_b64_tr_b16 a[98:99], v22 offset:25600
  s_add_u32 m0, s49, 0
  s_mov_b32 s51, 512
  v_mfma_f32_16x16x32_bf16 v[144:147], a[68:71], a[128:131], v[144:147]
  buffer_load_dwordx4 v4, s[32:35], s51 offen offset:0 lds
  v_mfma_f32_16x16x32_bf16 v[148:151], a[68:71], a[132:135], v[148:151]
  ds_read_b64_tr_b16 a[100:101], v23 offset:24576
  v_accvgpr_write_b32 a211, v51
  v_mfma_f32_16x16x32_bf16 v[152:155], a[68:71], a[136:139], v[152:155]
  ds_read_b64_tr_b16 a[102:103], v23 offset:25600
  v_mfma_f32_16x16x32_bf16 v[156:159], a[68:71], a[140:143], v[156:159]
  buffer_load_dwordx4 v5, s[32:35], s51 offen offset:1024 lds
  v_mfma_f32_16x16x32_bf16 v[160:163], a[72:75], a[128:131], v[160:163]
  ds_read_b64_tr_b16 a[104:105], v24 offset:24576
  v_accvgpr_write_b32 a204, v52
  v_mfma_f32_16x16x32_bf16 v[164:167], a[72:75], a[132:135], v[164:167]
  ds_read_b64_tr_b16 a[106:107], v24 offset:25600
  v_mfma_f32_16x16x32_bf16 v[168:171], a[72:75], a[136:139], v[168:171]
  buffer_load_dwordx4 v6, s[32:35], s51 offen offset:2048 lds
  v_mfma_f32_16x16x32_bf16 v[172:175], a[72:75], a[140:143], v[172:175]
  ds_read_b64_tr_b16 a[108:109], v25 offset:24576
  v_accvgpr_write_b32 a205, v53
  v_mfma_f32_16x16x32_bf16 v[176:179], a[76:79], a[128:131], v[176:179]
  ds_read_b64_tr_b16 a[110:111], v25 offset:25600
  v_mfma_f32_16x16x32_bf16 v[180:183], a[76:79], a[132:135], v[180:183]
  buffer_load_dwordx4 v7, s[32:35], s51 offen offset:3072 lds
  v_mfma_f32_16x16x32_bf16 v[184:187], a[76:79], a[136:139], v[184:187]
  ds_read_b64_tr_b16 a[112:113], v26 offset:24576
  v_accvgpr_write_b32 a206, v54
  v_mfma_f32_16x16x32_bf16 v[188:191], a[76:79], a[140:143], v[188:191]
  ds_read_b64_tr_b16 a[114:115], v26 offset:25600
  s_add_u32 m0, s48, 0
  s_mov_b32 s50, 2097152
  v_mfma_f32_16x16x32_bf16 v[192:195], a[80:83], a[128:131], v[192:195]
  buffer_load_dwordx4 v12, s[36:39], s50 offen offset:0 lds
  v_mfma_f32_16x16x32_bf16 v[196:199], a[80:83], a[132:135], v[196:199]
  ds_read_b64_tr_b16 a[116:117], v27 offset:24576
  v_accvgpr_write_b32 a207, v55
  v_mfma_f32_16x16x32_bf16 v[200:203], a[80:83], a[136:139], v[200:203]
  ds_read_b64_tr_b16 a[118:119], v27 offset:25600
  v_mfma_f32_16x16x32_bf16 v[204:207], a[80:83], a[140:143], v[204:207]
  buffer_load_dwordx4 v13, s[36:39], s50 offen offset:1024 lds
  v_mfma_f32_16x16x32_bf16 v[208:211], a[84:87], a[128:131], v[208:211]
  ds_read_b64_tr_b16 a[120:121], v28 offset:24576
  v_accvgpr_write_b32 a200, v56
  v_mfma_f32_16x16x32_bf16 v[212:215], a[84:87], a[132:135], v[212:215]
  ds_read_b64_tr_b16 a[122:123], v28 offset:25600
  v_mfma_f32_16x16x32_bf16 v[216:219], a[84:87], a[136:139], v[216:219]
  ds_read_b128 a[32:35], v18 offset:32768
  s_add_u32 s57, s58, 57344
  v_mfma_f32_16x16x32_bf16 v[220:223], a[84:87], a[140:143], v[220:223]
  ds_read_b64_tr_b16 a[124:125], v29 offset:24576
  v_accvgpr_write_b32 a201, v57
  buffer_store_dwordx4 v[52:55], v16, s[96:99], s57 offen offset:1024 sc1
  v_mfma_f32_16x16x32_bf16 v[224:227], a[88:91], a[128:131], v[224:227]
  ds_read_b64_tr_b16 a[126:127], v29 offset:25600
  v_mfma_f32_16x16x32_bf16 v[228:231], a[88:91], a[132:135], v[228:231]
  ds_read_b128 a[36:39], v18 offset:34816
  v_mfma_f32_16x16x32_bf16 v[232:235], a[88:91], a[136:139], v[232:235]
  ds_read_b128 a[40:43], v18 offset:36864
  v_accvgpr_write_b32 a202, v58
  s_add_u32 s57, s58, 61440
  v_mfma_f32_16x16x32_bf16 v[236:239], a[88:91], a[140:143], v[236:239]
  ds_read_b128 a[44:47], v18 offset:38912
  buffer_store_dwordx4 v[60:63], v16, s[96:99], s57 offen offset:1024 sc1
  v_mfma_f32_16x16x32_bf16 v[240:243], a[92:95], a[128:131], v[240:243]
  v_mfma_f32_16x16x32_bf16 v[244:247], a[92:95], a[132:135], v[244:247]
  v_accvgpr_write_b32 a203, v59
  s_add_u32 s57, s58, 61440
  v_mfma_f32_16x16x32_bf16 v[248:251], a[92:95], a[136:139], v[248:251]
  buffer_store_dwordx4 v[56:59], v16, s[96:99], s57 offen offset:0 sc1
  v_mfma_f32_16x16x32_bf16 v[252:255], a[92:95], a[140:143], v[252:255]
  s_waitcnt lgkmcnt(2)
  v_mfma_f32_16x16x32_bf16 v[128:131], a[96:99], a[144:147], v[128:131]
  v_mfma_f32_16x16x32_bf16 v[132:135], a[96:99], a[148:151], v[132:135]
  s_waitcnt vmcnt(38) lgkmcnt(0)
  s_barrier
  v_mfma_f32_16x16x32_bf16 v[136:139], a[96:99], a[152:155], v[136:139]
  ds_read_b64_tr_b16 a[64:65], v22 offset:32768
  v_accvgpr_write_b32 a196, v60
  v_mfma_f32_16x16x32_bf16 v[140:143], a[96:99], a[156:159], v[140:143]
  ds_read_b64_tr_b16 a[66:67], v22 offset:33792
  s_add_u32 m0, s49, 4096
  s_mov_b32 s51, 512
  v_mfma_f32_16x16x32_bf16 v[144:147], a[100:103], a[144:147], v[144:147]
  buffer_load_dwordx4 v8, s[32:35], s51 offen offset:0 lds
  v_mfma_f32_16x16x32_bf16 v[148:151], a[100:103], a[148:151], v[148:151]
  ds_read_b64_tr_b16 a[68:69], v23 offset:32768
  v_accvgpr_write_b32 a197, v61
  v_mfma_f32_16x16x32_bf16 v[152:155], a[100:103], a[152:155], v[152:155]
  ds_read_b64_tr_b16 a[70:71], v23 offset:33792
  v_mfma_f32_16x16x32_bf16 v[156:159], a[100:103], a[156:159], v[156:159]
  buffer_load_dwordx4 v9, s[32:35], s51 offen offset:1024 lds
  v_mfma_f32_16x16x32_bf16 v[160:163], a[104:107], a[144:147], v[160:163]
  ds_read_b64_tr_b16 a[72:73], v24 offset:32768
  v_accvgpr_write_b32 a198, v62
  v_mfma_f32_16x16x32_bf16 v[164:167], a[104:107], a[148:151], v[164:167]
  ds_read_b64_tr_b16 a[74:75], v24 offset:33792
  v_mfma_f32_16x16x32_bf16 v[168:171], a[104:107], a[152:155], v[168:171]
  buffer_load_dwordx4 v10, s[32:35], s51 offen offset:2048 lds
  v_mfma_f32_16x16x32_bf16 v[172:175], a[104:107], a[156:159], v[172:175]
  ds_read_b64_tr_b16 a[76:77], v25 offset:32768
  v_accvgpr_write_b32 a199, v63
  v_mfma_f32_16x16x32_bf16 v[176:179], a[108:111], a[144:147], v[176:179]
  ds_read_b64_tr_b16 a[78:79], v25 offset:33792
  v_mfma_f32_16x16x32_bf16 v[180:183], a[108:111], a[148:151], v[180:183]
  buffer_load_dwordx4 v11, s[32:35], s51 offen offset:3072 lds
  v_mfma_f32_16x16x32_bf16 v[184:187], a[108:111], a[152:155], v[184:187]
  ds_read_b64_tr_b16 a[80:81], v26 offset:32768
  v_accvgpr_write_b32 a192, v64
  v_mfma_f32_16x16x32_bf16 v[188:191], a[108:111], a[156:159], v[188:191]
  ds_read_b64_tr_b16 a[82:83], v26 offset:33792
  s_add_u32 m0, s48, 0
  s_mov_b32 s50, 2097152
  v_mfma_f32_16x16x32_bf16 v[192:195], a[112:115], a[144:147], v[192:195]
  buffer_load_dwordx4 v14, s[36:39], s50 offen offset:2048 lds
  v_mfma_f32_16x16x32_bf16 v[196:199], a[112:115], a[148:151], v[196:199]
  ds_read_b64_tr_b16 a[84:85], v27 offset:32768
  v_accvgpr_write_b32 a193, v65
  v_mfma_f32_16x16x32_bf16 v[200:203], a[112:115], a[152:155], v[200:203]
  ds_read_b64_tr_b16 a[86:87], v27 offset:33792
  v_mfma_f32_16x16x32_bf16 v[204:207], a[112:115], a[156:159], v[204:207]
  buffer_load_dwordx4 v15, s[36:39], s50 offen offset:3072 lds
  v_mfma_f32_16x16x32_bf16 v[208:211], a[116:119], a[144:147], v[208:211]
  ds_read_b64_tr_b16 a[88:89], v28 offset:32768
  v_accvgpr_write_b32 a194, v66
  v_mfma_f32_16x16x32_bf16 v[212:215], a[116:119], a[148:151], v[212:215]
  ds_read_b64_tr_b16 a[90:91], v28 offset:33792
  v_mfma_f32_16x16x32_bf16 v[216:219], a[116:119], a[152:155], v[216:219]
  ds_read_b128 a[48:51], v19 offset:32768
  s_add_u32 s57, s58, 16384
  v_mfma_f32_16x16x32_bf16 v[220:223], a[116:119], a[156:159], v[220:223]
  ds_read_b64_tr_b16 a[92:93], v29 offset:32768
  v_accvgpr_write_b32 a195, v67
  buffer_store_dwordx4 v[64:67], v16, s[96:99], s57 offen offset:0 sc1
  v_mfma_f32_16x16x32_bf16 v[224:227], a[120:123], a[144:147], v[224:227]
  ds_read_b64_tr_b16 a[94:95], v29 offset:33792
  v_mfma_f32_16x16x32_bf16 v[228:231], a[120:123], a[148:151], v[228:231]
  ds_read_b128 a[52:55], v19 offset:34816
  v_mfma_f32_16x16x32_bf16 v[232:235], a[120:123], a[152:155], v[232:235]
  ds_read_b128 a[56:59], v19 offset:36864
  v_accvgpr_write_b32 a188, v68
  v_mfma_f32_16x16x32_bf16 v[236:239], a[120:123], a[156:159], v[236:239]
  ds_read_b128 a[60:63], v19 offset:38912
  v_mfma_f32_16x16x32_bf16 v[240:243], a[124:127], a[144:147], v[240:243]
  v_mfma_f32_16x16x32_bf16 v[244:247], a[124:127], a[148:151], v[244:247]
  v_accvgpr_write_b32 a189, v69
  s_add_u32 s57, s58, 16384
  v_mfma_f32_16x16x32_bf16 v[248:251], a[124:127], a[152:155], v[248:251]
  buffer_store_dwordx4 v[68:71], v16, s[96:99], s57 offen offset:1024 sc1
  v_mfma_f32_16x16x32_bf16 v[252:255], a[124:127], a[156:159], v[252:255]
  s_waitcnt lgkmcnt(3)
  v_mfma_f32_16x16x32_bf16 v[128:131], a[64:67], a[32:35], v[128:131]
  v_mfma_f32_16x16x32_bf16 v[132:135], a[64:67], a[36:39], v[132:135]
  s_waitcnt vmcnt(22) lgkmcnt(0)
  v_mfma_f32_16x16x32_bf16 v[136:139], a[64:67], a[40:43], v[136:139]
  ds_read_b64_tr_b16 a[96:97], v22 offset:40960
  v_accvgpr_write_b32 a190, v70
  v_mfma_f32_16x16x32_bf16 v[140:143], a[64:67], a[44:47], v[140:143]
  ds_read_b64_tr_b16 a[98:99], v22 offset:41984
  s_add_u32 m0, s49, 32768
  s_mov_b32 s51, 640
  v_mfma_f32_16x16x32_bf16 v[144:147], a[68:71], a[32:35], v[144:147]
  buffer_load_dwordx4 v4, s[32:35], s51 offen offset:0 lds
  v_mfma_f32_16x16x32_bf16 v[148:151], a[68:71], a[36:39], v[148:151]
  ds_read_b64_tr_b16 a[100:101], v23 offset:40960
  v_accvgpr_write_b32 a191, v71
  v_mfma_f32_16x16x32_bf16 v[152:155], a[68:71], a[40:43], v[152:155]
  ds_read_b64_tr_b16 a[102:103], v23 offset:41984
  v_mfma_f32_16x16x32_bf16 v[156:159], a[68:71], a[44:47], v[156:159]
  buffer_load_dwordx4 v5, s[32:35], s51 offen offset:1024 lds
  v_mfma_f32_16x16x32_bf16 v[160:163], a[72:75], a[32:35], v[160:163]
  ds_read_b64_tr_b16 a[104:105], v24 offset:40960
  v_accvgpr_write_b32 a184, v72
  v_mfma_f32_16x16x32_bf16 v[164:167], a[72:75], a[36:39], v[164:167]
  ds_read_b64_tr_b16 a[106:107], v24 offset:41984
  v_mfma_f32_16x16x32_bf16 v[168:171], a[72:75], a[40:43], v[168:171]
  buffer_load_dwordx4 v6, s[32:35], s51 offen offset:2048 lds
  v_mfma_f32_16x16x32_bf16 v[172:175], a[72:75], a[44:47], v[172:175]
  ds_read_b64_tr_b16 a[108:109], v25 offset:40960
  v_accvgpr_write_b32 a185, v73
  v_mfma_f32_16x16x32_bf16 v[176:179], a[76:79], a[32:35], v[176:179]
  ds_read_b64_tr_b16 a[110:111], v25 offset:41984
  v_mfma_f32_16x16x32_bf16 v[180:183], a[76:79], a[36:39], v[180:183]
  buffer_load_dwordx4 v7, s[32:35], s51 offen offset:3072 lds
  v_mfma_f32_16x16x32_bf16 v[184:187], a[76:79], a[40:43], v[184:187]
  ds_read_b64_tr_b16 a[112:113], v26 offset:40960
  v_accvgpr_write_b32 a186, v74
  v_mfma_f32_16x16x32_bf16 v[188:191], a[76:79], a[44:47], v[188:191]
  ds_read_b64_tr_b16 a[114:115], v26 offset:41984
  s_add_u32 m0, s48, 16384
  s_mov_b32 s50, 2621440
  v_mfma_f32_16x16x32_bf16 v[192:195], a[80:83], a[32:35], v[192:195]
  buffer_load_dwordx4 v12, s[36:39], s50 offen offset:0 lds
  v_mfma_f32_16x16x32_bf16 v[196:199], a[80:83], a[36:39], v[196:199]
  ds_read_b64_tr_b16 a[116:117], v27 offset:40960
  v_accvgpr_write_b32 a187, v75
  v_mfma_f32_16x16x32_bf16 v[200:203], a[80:83], a[40:43], v[200:203]
  ds_read_b64_tr_b16 a[118:119], v27 offset:41984
  v_mfma_f32_16x16x32_bf16 v[204:207], a[80:83], a[44:47], v[204:207]
  buffer_load_dwordx4 v13, s[36:39], s50 offen offset:1024 lds
  v_mfma_f32_16x16x32_bf16 v[208:211], a[84:87], a[32:35], v[208:211]
  ds_read_b64_tr_b16 a[120:121], v28 offset:40960
  v_accvgpr_write_b32 a180, v76
  v_mfma_f32_16x16x32_bf16 v[212:215], a[84:87], a[36:39], v[212:215]
  ds_read_b64_tr_b16 a[122:123], v28 offset:41984
  v_mfma_f32_16x16x32_bf16 v[216:219], a[84:87], a[40:43], v[216:219]
  ds_read_b128 a[128:131], v30 offset:0
  s_add_u32 s57, s58, 20480
  v_mfma_f32_16x16x32_bf16 v[220:223], a[84:87], a[44:47], v[220:223]
  ds_read_b64_tr_b16 a[124:125], v29 offset:40960
  v_accvgpr_write_b32 a181, v77
  buffer_store_dwordx4 v[72:75], v16, s[96:99], s57 offen offset:0 sc1
  v_mfma_f32_16x16x32_bf16 v[224:227], a[88:91], a[32:35], v[224:227]
  ds_read_b64_tr_b16 a[126:127], v29 offset:41984
  v_mfma_f32_16x16x32_bf16 v[228:231], a[88:91], a[36:39], v[228:231]
  ds_read_b128 a[132:135], v30 offset:2048
  v_mfma_f32_16x16x32_bf16 v[232:235], a[88:91], a[40:43], v[232:235]
  ds_read_b128 a[136:139], v30 offset:4096
  v_accvgpr_write_b32 a182, v78
  v_mfma_f32_16x16x32_bf16 v[236:239], a[88:91], a[44:47], v[236:239]
  ds_read_b128 a[140:143], v30 offset:6144
  v_mfma_f32_16x16x32_bf16 v[240:243], a[92:95], a[32:35], v[240:243]
  v_mfma_f32_16x16x32_bf16 v[244:247], a[92:95], a[36:39], v[244:247]
  v_accvgpr_write_b32 a183, v79
  s_add_u32 s57, s58, 20480
  v_mfma_f32_16x16x32_bf16 v[248:251], a[92:95], a[40:43], v[248:251]
  buffer_store_dwordx4 v[76:79], v16, s[96:99], s57 offen offset:1024 sc1
  v_mfma_f32_16x16x32_bf16 v[252:255], a[92:95], a[44:47], v[252:255]
  s_waitcnt lgkmcnt(3)
  v_mfma_f32_16x16x32_bf16 v[128:131], a[96:99], a[48:51], v[128:131]
  v_mfma_f32_16x16x32_bf16 v[132:135], a[96:99], a[52:55], v[132:135]
  s_waitcnt vmcnt(26) lgkmcnt(0)
  s_barrier
  v_mfma_f32_16x16x32_bf16 v[136:139], a[96:99], a[56:59], v[136:139]
  v_readfirstlane_b32 s0, v20
  v_readfirstlane_b32 s1, v21
  ds_read_b64_tr_b16 a[64:65], v22 offset:49152
  v_accvgpr_write_b32 a176, v80
  v_mfma_f32_16x16x32_bf16 v[140:143], a[96:99], a[60:63], v[140:143]
  s_cmp_eq_u32 s0, 0
  s_cbranch_scc1 LQ_nspin
LQ_nspin_ret:
  ds_read_b64_tr_b16 a[66:67], v22 offset:50176
  s_add_u32 m0, s49, 36864
  s_mov_b32 s51, 640
  v_mfma_f32_16x16x32_bf16 v[144:147], a[100:103], a[48:51], v[144:147]
  buffer_load_dwordx4 v8, s[32:35], s51 offen offset:0 lds
  v_mfma_f32_16x16x32_bf16 v[148:151], a[100:103], a[52:55], v[148:151]
  ds_read_b64_tr_b16 a[68:69], v23 offset:49152
  v_accvgpr_write_b32 a177, v81
  v_mfma_f32_16x16x32_bf16 v[152:155], a[100:103], a[56:59], v[152:155]
  ds_read_b64_tr_b16 a[70:71], v23 offset:50176
  v_mfma_f32_16x16x32_bf16 v[156:159], a[100:103], a[60:63], v[156:159]
  buffer_load_dwordx4 v9, s[32:35], s51 offen offset:1024 lds
  v_mfma_f32_16x16x32_bf16 v[160:163], a[104:107], a[48:51], v[160:163]
  ds_read_b64_tr_b16 a[72:73], v24 offset:49152
  v_accvgpr_write_b32 a178, v82
  v_mfma_f32_16x16x32_bf16 v[164:167], a[104:107], a[52:55], v[164:167]
  ds_read_b64_tr_b16 a[74:75], v24 offset:50176
  v_mfma_f32_16x16x32_bf16 v[168:171], a[104:107], a[56:59], v[168:171]
  buffer_load_dwordx4 v10, s[32:35], s51 offen offset:2048 lds
  v_mfma_f32_16x16x32_bf16 v[172:175], a[104:107], a[60:63], v[172:175]
  ds_read_b64_tr_b16 a[76:77], v25 offset:49152
  v_accvgpr_write_b32 a179, v83
  v_mfma_f32_16x16x32_bf16 v[176:179], a[108:111], a[48:51], v[176:179]
  ds_read_b64_tr_b16 a[78:79], v25 offset:50176
  v_mfma_f32_16x16x32_bf16 v[180:183], a[108:111], a[52:55], v[180:183]
  buffer_load_dwordx4 v11, s[32:35], s51 offen offset:3072 lds
  v_mfma_f32_16x16x32_bf16 v[184:187], a[108:111], a[56:59], v[184:187]
  ds_read_b64_tr_b16 a[80:81], v26 offset:49152
  v_accvgpr_write_b32 a172, v84
  v_mfma_f32_16x16x32_bf16 v[188:191], a[108:111], a[60:63], v[188:191]
  ds_read_b64_tr_b16 a[82:83], v26 offset:50176
  s_add_u32 m0, s48, 16384
  s_mov_b32 s50, 2621440
  v_mfma_f32_16x16x32_bf16 v[192:195], a[112:115], a[48:51], v[192:195]
  buffer_load_dwordx4 v14, s[36:39], s50 offen offset:2048 lds
  v_mfma_f32_16x16x32_bf16 v[196:199], a[112:115], a[52:55], v[196:199]
  ds_read_b64_tr_b16 a[84:85], v27 offset:49152
  v_accvgpr_write_b32 a173, v85
  v_mfma_f32_16x16x32_bf16 v[200:203], a[112:115], a[56:59], v[200:203]
  ds_read_b64_tr_b16 a[86:87], v27 offset:50176
  v_mfma_f32_16x16x32_bf16 v[204:207], a[112:115], a[60:63], v[204:207]
  buffer_load_dwordx4 v15, s[36:39], s50 offen offset:3072 lds
  v_mfma_f32_16x16x32_bf16 v[208:211], a[116:119], a[48:51], v[208:211]
  ds_read_b64_tr_b16 a[88:89], v28 offset:49152
  v_accvgpr_write_b32 a174, v86
  v_mfma_f32_16x16x32_bf16 v[212:215], a[116:119], a[52:55], v[212:215]
  ds_read_b64_tr_b16 a[90:91], v28 offset:50176
  v_mfma_f32_16x16x32_bf16 v[216:219], a[116:119], a[56:59], v[216:219]
  ds_read_b128 a[144:147], v31 offset:0
  s_add_u32 s57, s58, 24576
  v_mfma_f32_16x16x32_bf16 v[220:223], a[116:119], a[60:63], v[220:223]
  ds_read_b64_tr_b16 a[92:93], v29 offset:49152
  v_accvgpr_write_b32 a175, v87
  buffer_store_dwordx4 v[80:83], v16, s[96:99], s57 offen offset:0 sc1
  v_mfma_f32_16x16x32_bf16 v[224:227], a[120:123], a[48:51], v[224:227]
  ds_read_b64_tr_b16 a[94:95], v29 offset:50176
  v_mfma_f32_16x16x32_bf16 v[228:231], a[120:123], a[52:55], v[228:231]
  ds_read_b128 a[148:151], v31 offset:2048
  v_mfma_f32_16x16x32_bf16 v[232:235], a[120:123], a[56:59], v[232:235]
  ds_read_b128 a[152:155], v31 offset:4096
  v_accvgpr_write_b32 a168, v88
  s_add_u32 s57, s58, 28672
  v_mfma_f32_16x16x32_bf16 v[236:239], a[120:123], a[60:63], v[236:239]
  ds_read_b128 a[156:159], v31 offset:6144
  buffer_store_dwordx4 v[88:91], v16, s[96:99], s57 offen offset:0 sc1
  v_mfma_f32_16x16x32_bf16 v[240:243], a[124:127], a[48:51], v[240:243]
  v_accvgpr_read_b32 v60, a160
  v_mfma_f32_16x16x32_bf16 v[244:247], a[124:127], a[52:55], v[244:247]
  v_accvgpr_write_b32 a169, v89
  v_accvgpr_read_b32 v61, a161
  s_add_u32 s57, s58, 24576
  v_mfma_f32_16x16x32_bf16 v[248:251], a[124:127], a[56:59], v[248:251]
  v_accvgpr_read_b32 v62, a162
  buffer_store_dwordx4 v[84:87], v16, s[96:99], s57 offen offset:1024 sc1
  v_mfma_f32_16x16x32_bf16 v[252:255], a[124:127], a[60:63], v[252:255]
  v_accvgpr_read_b32 v63, a163
  s_waitcnt lgkmcnt(1)
  v_mfma_f32_16x16x32_bf16 v[128:131], a[64:67], a[128:131], v[128:131]
  v_mfma_f32_16x16x32_bf16 v[132:135], a[64:67], a[132:135], v[132:135]
  s_waitcnt vmcnt(21) lgkmcnt(0)
  v_mfma_f32_16x16x32_bf16 v[136:139], a[64:67], a[136:139], v[136:139]
  ds_read_b64_tr_b16 a[96:97], v22 offset:57344
  v_accvgpr_write_b32 a170, v90
  v_mfma_f32_16x16x32_bf16 v[140:143], a[64:67], a[140:143], v[140:143]
  ds_read_b64_tr_b16 a[98:99], v22 offset:58368
  s_add_u32 m0, s49, 65536
  s_mov_b32 s51, 768
  v_mfma_f32_16x16x32_bf16 v[144:147], a[68:71], a[128:131], v[144:147]
  buffer_load_dwordx4 v4, s[32:35], s51 offen offset:0 lds
  v_mfma_f32_16x16x32_bf16 v[148:151], a[68:71], a[132:135], v[148:151]
  ds_read_b64_tr_b16 a[100:101], v23 offset:57344
  v_accvgpr_write_b32 a171, v91
  v_mfma_f32_16x16x32_bf16 v[152:155], a[68:71], a[136:139], v[152:155]
  ds_read_b64_tr_b16 a[102:103], v23 offset:58368
  v_mfma_f32_16x16x32_bf16 v[156:159], a[68:71], a[140:143], v[156:159]
  buffer_load_dwordx4 v5, s[32:35], s51 offen offset:1024 lds
  v_mfma_f32_16x16x32_bf16 v[160:163], a[72:75], a[128:131], v[160:163]
  ds_read_b64_tr_b16 a[104:105], v24 offset:57344
  v_accvgpr_write_b32 a164, v92
  v_mfma_f32_16x16x32_bf16 v[164:167], a[72:75], a[132:135], v[164:167]
  ds_read_b64_tr_b16 a[106:107], v24 offset:58368
  v_mfma_f32_16x16x32_bf16 v[168:171], a[72:75], a[136:139], v[168:171]
  buffer_load_dwordx4 v6, s[32:35], s51 offen offset:2048 lds
  v_mfma_f32_16x16x32_bf16 v[172:175], a[72:75], a[140:143], v[172:175]
  ds_read_b64_tr_b16 a[108:109], v25 offset:57344
  v_accvgpr_write_b32 a165, v93
  v_mfma_f32_16x16x32_bf16 v[176:179], a[76:79], a[128:131], v[176:179]
  ds_read_b64_tr_b16 a[110:111], v25 offset:58368
  v_mfma_f32_16x16x32_bf16 v[180:183], a[76:79], a[132:135], v[180:183]
  buffer_load_dwordx4 v7, s[32:35], s51 offen offset:3072 lds
  v_mfma_f32_16x16x32_bf16 v[184:187], a[76:79], a[136:139], v[184:187]
  ds_read_b64_tr_b16 a[112:113], v26 offset:57344
  v_accvgpr_write_b32 a166, v94
  v_mfma_f32_16x16x32_bf16 v[188:191], a[76:79], a[140:143], v[188:191]
  ds_read_b64_tr_b16 a[114:115], v26 offset:58368
  s_add_u32 m0, s48, 32768
  s_mov_b32 s50, 3145728
  v_mfma_f32_16x16x32_bf16 v[192:195], a[80:83], a[128:131], v[192:195]
  buffer_load_dwordx4 v12, s[36:39], s50 offen offset:0 lds
  v_mfma_f32_16x16x32_bf16 v[196:199], a[80:83], a[132:135], v[196:199]
  ds_read_b64_tr_b16 a[116:117], v27 offset:57344
  v_accvgpr_write_b32 a167, v95
  v_mfma_f32_16x16x32_bf16 v[200:203], a[80:83], a[136:139], v[200:203]
  ds_read_b64_tr_b16 a[118:119], v27 offset:58368
  v_mfma_f32_16x16x32_bf16 v[204:207], a[80:83], a[140:143], v[204:207]
  buffer_load_dwordx4 v13, s[36:39], s50 offen offset:1024 lds
  v_mfma_f32_16x16x32_bf16 v[208:211], a[84:87], a[128:131], v[208:211]
  ds_read_b64_tr_b16 a[120:121], v28 offset:57344
  v_accvgpr_write_b32 a160, v96
  v_mfma_f32_16x16x32_bf16 v[212:215], a[84:87], a[132:135], v[212:215]
  ds_read_b64_tr_b16 a[122:123], v28 offset:58368
  v_mfma_f32_16x16x32_bf16 v[216:219], a[84:87], a[136:139], v[216:219]
  ds_read_b128 a[32:35], v18 offset:0
  s_add_u32 s57, s58, 28672
  v_mfma_f32_16x16x32_bf16 v[220:223], a[84:87], a[140:143], v[220:223]
  ds_read_b64_tr_b16 a[124:125], v29 offset:57344
  v_accvgpr_write_b32 a161, v97
  buffer_store_dwordx4 v[92:95], v16, s[96:99], s57 offen offset:1024 sc1
  v_mfma_f32_16x16x32_bf16 v[224:227], a[88:91], a[128:131], v[224:227]
  ds_read_b64_tr_b16 a[126:127], v29 offset:58368
  v_mfma_f32_16x16x32_bf16 v[228:231], a[88:91], a[132:135], v[228:231]
  ds_read_b128 a[36:39], v18 offset:2048
  v_mfma_f32_16x16x32_bf16 v[232:235], a[88:91], a[136:139], v[232:235]
  ds_read_b128 a[40:43], v18 offset:4096
  v_accvgpr_write_b32 a162, v98
  s_mul_i32 s53, s29, 1048576
  s_lshl_b32 s54, s28, 12
  s_add_u32 s53, s53, s54
  v_mfma_f32_16x16x32_bf16 v[236:239], a[88:91], a[140:143], v[236:239]
  ds_read_b128 a[44:47], v18 offset:6144
  s_lshl_b32 s52, s29, 7
  s_add_u32 s52, s52, 73404416
  v_mfma_f32_16x16x32_bf16 v[240:243], a[92:95], a[128:131], v[240:243]
  s_lshl_b32 s59, s30, 3
  s_add_u32 s59, s59, s52
  v_mfma_f32_16x16x32_bf16 v[244:247], a[92:95], a[132:135], v[244:247]
  v_accvgpr_write_b32 a163, v99
  s_lshr_b32 s54, s98, 26
  s_sub_u32 s54, 1, s54
  s_mul_i32 s54, s54, 82837504
  s_add_u32 s57, s58, 32768
  v_mfma_f32_16x16x32_bf16 v[248:251], a[92:95], a[136:139], v[248:251]
  s_max_u32 s59, s59, s54
  v_and_b32 v17, 7, v1
  buffer_store_dwordx4 v[96:99], v16, s[96:99], s57 offen offset:0 sc1
  v_mfma_f32_16x16x32_bf16 v[252:255], a[92:95], a[140:143], v[252:255]
  v_min_u32 v17, 2, v17
  v_lshlrev_b32 v17, 3, v17
  s_waitcnt lgkmcnt(0)
  v_mfma_f32_16x16x32_bf16 v[128:131], a[96:99], a[144:147], v[128:131]
  v_mfma_f32_16x16x32_bf16 v[132:135], a[96:99], a[148:151], v[132:135]
  s_waitcnt vmcnt(27) lgkmcnt(0)
  s_barrier
  v_mfma_f32_16x16x32_bf16 v[136:139], a[96:99], a[152:155], v[136:139]
  ds_read_b64_tr_b16 a[64:65], v22 offset:0
  v_accvgpr_write_b32 a0, v100
  v_accvgpr_read_b32 v64, a224
  v_mfma_f32_16x16x32_bf16 v[140:143], a[96:99], a[156:159], v[140:143]
  ds_read_b64_tr_b16 a[66:67], v22 offset:1024
  v_accvgpr_read_b32 v65, a225
  s_add_u32 m0, s49, 69632
  s_mov_b32 s51, 768
  v_mfma_f32_16x16x32_bf16 v[144:147], a[100:103], a[144:147], v[144:147]
  v_accvgpr_write_b32 a1, v101
  buffer_load_dwordx4 v8, s[32:35], s51 offen offset:0 lds
  v_mfma_f32_16x16x32_bf16 v[148:151], a[100:103], a[148:151], v[148:151]
  ds_read_b64_tr_b16 a[68:69], v23 offset:0
  v_accvgpr_read_b32 v66, a226
  v_mfma_f32_16x16x32_bf16 v[152:155], a[100:103], a[152:155], v[152:155]
  ds_read_b64_tr_b16 a[70:71], v23 offset:1024
  v_accvgpr_write_b32 a2, v102
  v_mfma_f32_16x16x32_bf16 v[156:159], a[100:103], a[156:159], v[156:159]
  v_accvgpr_read_b32 v67, a227
  buffer_load_dwordx4 v9, s[32:35], s51 offen offset:1024 lds
  v_mfma_f32_16x16x32_bf16 v[160:163], a[104:107], a[144:147], v[160:163]
  ds_read_b64_tr_b16 a[72:73], v24 offset:0
  v_accvgpr_write_b32 a3, v103
  v_mfma_f32_16x16x32_bf16 v[164:167], a[104:107], a[148:151], v[164:167]
  ds_read_b64_tr_b16 a[74:75], v24 offset:1024
  v_accvgpr_read_b32 v68, a228
  v_mfma_f32_16x16x32_bf16 v[168:171], a[104:107], a[152:155], v[168:171]
  v_accvgpr_write_b32 a4, v104
  buffer_load_dwordx4 v10, s[32:35], s51 offen offset:2048 lds
  v_mfma_f32_16x16x32_bf16 v[172:175], a[104:107], a[156:159], v[172:175]
  ds_read_b64_tr_b16 a[76:77], v25 offset:0
  v_accvgpr_read_b32 v69, a229
  v_mfma_f32_16x16x32_bf16 v[176:179], a[108:111], a[144:147], v[176:179]
  ds_read_b64_tr_b16 a[78:79], v25 offset:1024
  v_accvgpr_write_b32 a5, v105
  v_mfma_f32_16x16x32_bf16 v[180:183], a[108:111], a[148:151], v[180:183]
  v_accvgpr_read_b32 v70, a230
  buffer_load_dwordx4 v11, s[32:35], s51 offen offset:3072 lds
  v_mfma_f32_16x16x32_bf16 v[184:187], a[108:111], a[152:155], v[184:187]
  ds_read_b64_tr_b16 a[80:81], v26 offset:0
  v_accvgpr_write_b32 a6, v106
  v_mfma_f32_16x16x32_bf16 v[188:191], a[108:111], a[156:159], v[188:191]
  ds_read_b64_tr_b16 a[82:83], v26 offset:1024
  v_accvgpr_read_b32 v71, a231
  s_add_u32 m0, s48, 32768
  s_mov_b32 s50, 3145728
  v_mfma_f32_16x16x32_bf16 v[192:195], a[112:115], a[144:147], v[192:195]
  buffer_load_dwordx4 v14, s[36:39], s50 offen offset:2048 lds
  v_mfma_f32_16x16x32_bf16 v[196:199], a[112:115], a[148:151], v[196:199]
  ds_read_b64_tr_b16 a[84:85], v27 offset:0
  v_accvgpr_write_b32 a7, v107
  v_accvgpr_read_b32 v72, a232
  v_mfma_f32_16x16x32_bf16 v[200:203], a[112:115], a[152:155], v[200:203]
  ds_read_b64_tr_b16 a[86:87], v27 offset:1024
  v_accvgpr_read_b32 v73, a233
  v_mfma_f32_16x16x32_bf16 v[204:207], a[112:115], a[156:159], v[204:207]
  v_accvgpr_write_b32 a8, v108
  buffer_load_dwordx4 v15, s[36:39], s50 offen offset:3072 lds
  v_mfma_f32_16x16x32_bf16 v[208:211], a[116:119], a[144:147], v[208:211]
  ds_read_b64_tr_b16 a[88:89], v28 offset:0
  v_accvgpr_read_b32 v74, a234
  v_mfma_f32_16x16x32_bf16 v[212:215], a[116:119], a[148:151], v[212:215]
  ds_read_b64_tr_b16 a[90:91], v28 offset:1024
  v_accvgpr_write_b32 a9, v109
  v_mfma_f32_16x16x32_bf16 v[216:219], a[116:119], a[152:155], v[216:219]
  ds_read_b128 a[48:51], v19 offset:0
  v_accvgpr_read_b32 v75, a235
  s_add_u32 s57, s58, 32768
  v_mfma_f32_16x16x32_bf16 v[220:223], a[116:119], a[156:159], v[220:223]
  ds_read_b64_tr_b16 a[92:93], v29 offset:0
  v_accvgpr_write_b32 a10, v110
  buffer_store_dwordx4 v[100:103], v16, s[96:99], s57 offen offset:1024 sc1
  v_mfma_f32_16x16x32_bf16 v[224:227], a[120:123], a[144:147], v[224:227]
  ds_read_b64_tr_b16 a[94:95], v29 offset:1024
  v_accvgpr_read_b32 v76, a236
  v_mfma_f32_16x16x32_bf16 v[228:231], a[120:123], a[148:151], v[228:231]
  ds_read_b128 a[52:55], v19 offset:2048
  v_accvgpr_write_b32 a11, v111
  v_mfma_f32_16x16x32_bf16 v[232:235], a[120:123], a[152:155], v[232:235]
  ds_read_b128 a[56:59], v19 offset:4096
  v_accvgpr_read_b32 v77, a237
  s_add_u32 s57, s58, 36864
  v_mfma_f32_16x16x32_bf16 v[236:239], a[120:123], a[156:159], v[236:239]
  ds_read_b128 a[60:63], v19 offset:6144
  v_accvgpr_write_b32 a12, v112
  buffer_store_dwordx4 v[108:111], v16, s[96:99], s57 offen offset:1024 sc1
  v_mfma_f32_16x16x32_bf16 v[240:243], a[124:127], a[144:147], v[240:243]
  v_accvgpr_read_b32 v78, a238
  v_mfma_f32_16x16x32_bf16 v[244:247], a[124:127], a[148:151], v[244:247]
  v_accvgpr_write_b32 a13, v113
  s_add_u32 s57, s58, 36864
  v_mfma_f32_16x16x32_bf16 v[248:251], a[124:127], a[152:155], v[248:251]
  v_accvgpr_read_b32 v79, a239
  buffer_store_dwordx4 v[104:107], v16, s[96:99], s57 offen offset:0 sc1
  v_mfma_f32_16x16x32_bf16 v[252:255], a[124:127], a[156:159], v[252:255]
  s_waitcnt lgkmcnt(1)
  v_mfma_f32_16x16x32_bf16 v[128:131], a[64:67], a[32:35], v[128:131]
  v_mfma_f32_16x16x32_bf16 v[132:135], a[64:67], a[36:39], v[132:135]
  s_waitcnt vmcnt(22) lgkmcnt(0)
  v_mfma_f32_16x16x32_bf16 v[136:139], a[64:67], a[40:43], v[136:139]
  ds_read_b64_tr_b16 a[96:97], v22 offset:8192
  v_accvgpr_write_b32 a14, v114
  v_accvgpr_read_b32 v80, a240
  v_mfma_f32_16x16x32_bf16 v[140:143], a[64:67], a[44:47], v[140:143]
  ds_read_b64_tr_b16 a[98:99], v22 offset:9216
  v_accvgpr_read_b32 v81, a241
  s_add_u32 m0, s49, 0
  s_mov_b32 s51, 896
  v_mfma_f32_16x16x32_bf16 v[144:147], a[68:71], a[32:35], v[144:147]
  v_accvgpr_write_b32 a15, v115
  buffer_load_dwordx4 v4, s[32:35], s51 offen offset:0 lds
  v_mfma_f32_16x16x32_bf16 v[148:151], a[68:71], a[36:39], v[148:151]
  ds_read_b64_tr_b16 a[100:101], v23 offset:8192
  v_accvgpr_read_b32 v82, a242
  v_mfma_f32_16x16x32_bf16 v[152:155], a[68:71], a[40:43], v[152:155]
  ds_read_b64_tr_b16 a[102:103], v23 offset:9216
  v_accvgpr_write_b32 a16, v116
  v_mfma_f32_16x16x32_bf16 v[156:159], a[68:71], a[44:47], v[156:159]
  v_accvgpr_read_b32 v83, a243
  buffer_load_dwordx4 v5, s[32:35], s51 offen offset:1024 lds
  v_mfma_f32_16x16x32_bf16 v[160:163], a[72:75], a[32:35], v[160:163]
  ds_read_b64_tr_b16 a[104:105], v24 offset:8192
  v_accvgpr_write_b32 a17, v117
  v_mfma_f32_16x16x32_bf16 v[164:167], a[72:75], a[36:39], v[164:167]
  ds_read_b64_tr_b16 a[106:107], v24 offset:9216
  v_accvgpr_read_b32 v84, a244
  v_mfma_f32_16x16x32_bf16 v[168:171], a[72:75], a[40:43], v[168:171]
  v_accvgpr_write_b32 a18, v118
  buffer_load_dwordx4 v6, s[32:35], s51 offen offset:2048 lds
  v_mfma_f32_16x16x32_bf16 v[172:175], a[72:75], a[44:47], v[172:175]
  ds_read_b64_tr_b16 a[108:109], v25 offset:8192
  v_accvgpr_read_b32 v85, a245
  v_mfma_f32_16x16x32_bf16 v[176:179], a[76:79], a[32:35], v[176:179]
  ds_read_b64_tr_b16 a[110:111], v25 offset:9216
  v_accvgpr_write_b32 a19, v119
  v_mfma_f32_16x16x32_bf16 v[180:183], a[76:79], a[36:39], v[180:183]
  v_accvgpr_read_b32 v86, a246
  buffer_load_dwordx4 v7, s[32:35], s51 offen offset:3072 lds
  v_mfma_f32_16x16x32_bf16 v[184:187], a[76:79], a[40:43], v[184:187]
  ds_read_b64_tr_b16 a[112:113], v26 offset:8192
  v_accvgpr_write_b32 a20, v120
  v_mfma_f32_16x16x32_bf16 v[188:191], a[76:79], a[44:47], v[188:191]
  ds_read_b64_tr_b16 a[114:115], v26 offset:9216
  v_accvgpr_read_b32 v87, a247
  s_add_u32 m0, s48, 49152
  s_mov_b32 s50, 3670016
  v_mfma_f32_16x16x32_bf16 v[192:195], a[80:83], a[32:35], v[192:195]
  buffer_load_dwordx4 v12, s[36:39], s50 offen offset:0 lds
  v_mfma_f32_16x16x32_bf16 v[196:199], a[80:83], a[36:39], v[196:199]
  ds_read_b64_tr_b16 a[116:117], v27 offset:8192
  v_accvgpr_write_b32 a21, v121
  v_accvgpr_read_b32 v88, a248
  v_mfma_f32_16x16x32_bf16 v[200:203], a[80:83], a[40:43], v[200:203]
  ds_read_b64_tr_b16 a[118:119], v27 offset:9216
  v_accvgpr_read_b32 v89, a249
  v_mfma_f32_16x16x32_bf16 v[204:207], a[80:83], a[44:47], v[204:207]
  v_accvgpr_write_b32 a22, v122
  buffer_load_dwordx4 v13, s[36:39], s50 offen offset:1024 lds
  v_mfma_f32_16x16x32_bf16 v[208:211], a[84:87], a[32:35], v[208:211]
  ds_read_b64_tr_b16 a[120:121], v28 offset:8192
  v_accvgpr_read_b32 v90, a250
  v_mfma_f32_16x16x32_bf16 v[212:215], a[84:87], a[36:39], v[212:215]
  ds_read_b64_tr_b16 a[122:123], v28 offset:9216
  v_accvgpr_write_b32 a23, v123
  v_mfma_f32_16x16x32_bf16 v[216:219], a[84:87], a[40:43], v[216:219]
  ds_read_b128 a[128:131], v18 offset:32768
  v_accvgpr_read_b32 v91, a251
  s_add_u32 s57, s58, 40960
  v_mfma_f32_16x16x32_bf16 v[220:223], a[84:87], a[44:47], v[220:223]
  ds_read_b64_tr_b16 a[124:125], v29 offset:8192
  v_accvgpr_write_b32 a24, v124
  buffer_store_dwordx4 v[112:115], v16, s[96:99], s57 offen offset:0 sc1
  v_mfma_f32_16x16x32_bf16 v[224:227], a[88:91], a[32:35], v[224:227]
  ds_read_b64_tr_b16 a[126:127], v29 offset:9216
  v_accvgpr_read_b32 v92, a252
  v_mfma_f32_16x16x32_bf16 v[228:231], a[88:91], a[36:39], v[228:231]
  ds_read_b128 a[132:135], v18 offset:34816
  v_accvgpr_write_b32 a25, v125
  v_mfma_f32_16x16x32_bf16 v[232:235], a[88:91], a[40:43], v[232:235]
  ds_read_b128 a[136:139], v18 offset:36864
  v_accvgpr_read_b32 v93, a253
  v_mfma_f32_16x16x32_bf16 v[236:239], a[88:91], a[44:47], v[236:239]
  ds_read_b128 a[140:143], v18 offset:38912
  v_accvgpr_write_b32 a26, v126
  v_mfma_f32_16x16x32_bf16 v[240:243], a[92:95], a[32:35], v[240:243]
  v_accvgpr_read_b32 v94, a254
  v_mfma_f32_16x16x32_bf16 v[244:247], a[92:95], a[36:39], v[244:247]
  v_accvgpr_write_b32 a27, v127
  s_add_u32 s57, s58, 40960
  v_mfma_f32_16x16x32_bf16 v[248:251], a[92:95], a[40:43], v[248:251]
  v_accvgpr_read_b32 v95, a255
  buffer_store_dwordx4 v[116:119], v16, s[96:99], s57 offen offset:1024 sc1
  v_mfma_f32_16x16x32_bf16 v[252:255], a[92:95], a[44:47], v[252:255]
  s_waitcnt lgkmcnt(1)
  v_mfma_f32_16x16x32_bf16 v[128:131], a[96:99], a[48:51], v[128:131]
  v_mfma_f32_16x16x32_bf16 v[132:135], a[96:99], a[52:55], v[132:135]
  s_waitcnt vmcnt(28) lgkmcnt(0)
  s_barrier
  v_mfma_f32_16x16x32_bf16 v[136:139], a[96:99], a[56:59], v[136:139]
  ds_read_b64_tr_b16 a[64:65], v22 offset:16384
  v_lshrrev_b32 v2, 4, v1
  v_mfma_f32_16x16x32_bf16 v[140:143], a[96:99], a[60:63], v[140:143]
  ds_read_b64_tr_b16 a[66:67], v22 offset:17408
  v_lshrrev_b32 v3, 2, v1
  s_add_u32 m0, s49, 4096
  s_mov_b32 s51, 896
  v_mfma_f32_16x16x32_bf16 v[144:147], a[100:103], a[48:51], v[144:147]
  v_and_b32 v3, 3, v3
  buffer_load_dwordx4 v8, s[32:35], s51 offen offset:0 lds
  v_mfma_f32_16x16x32_bf16 v[148:151], a[100:103], a[52:55], v[148:151]
  ds_read_b64_tr_b16 a[68:69], v23 offset:16384
  v_mfma_f32_16x16x32_bf16 v[152:155], a[100:103], a[56:59], v[152:155]
  ds_read_b64_tr_b16 a[70:71], v23 offset:17408
  v_and_b32 v0, 3, v1
  v_mfma_f32_16x16x32_bf16 v[156:159], a[100:103], a[60:63], v[156:159]
  v_lshlrev_b32 v0, 3, v0
  buffer_load_dwordx4 v9, s[32:35], s51 offen offset:1024 lds
  v_mfma_f32_16x16x32_bf16 v[160:163], a[104:107], a[48:51], v[160:163]
  ds_read_b64_tr_b16 a[72:73], v24 offset:16384
  v_lshl_add_u32 v56, v2, 2, v3
  v_mfma_f32_16x16x32_bf16 v[164:167], a[104:107], a[52:55], v[164:167]
  ds_read_b64_tr_b16 a[74:75], v24 offset:17408
  v_mfma_f32_16x16x32_bf16 v[168:171], a[104:107], a[56:59], v[168:171]
  v_mul_u32_u24 v56, 640, v56
  buffer_load_dwordx4 v10, s[32:35], s51 offen offset:2048 lds
  v_mfma_f32_16x16x32_bf16 v[172:175], a[104:107], a[60:63], v[172:175]
  ds_read_b64_tr_b16 a[76:77], v25 offset:16384
  s_mul_i32 s95, s28, 160
  v_mfma_f32_16x16x32_bf16 v[176:179], a[108:111], a[48:51], v[176:179]
  ds_read_b64_tr_b16 a[78:79], v25 offset:17408
  s_add_u32 s95, s95, 131072
  v_mfma_f32_16x16x32_bf16 v[180:183], a[108:111], a[52:55], v[180:183]
  buffer_load_dwordx4 v11, s[32:35], s51 offen offset:3072 lds
  v_mfma_f32_16x16x32_bf16 v[184:187], a[108:111], a[56:59], v[184:187]
  ds_read_b64_tr_b16 a[80:81], v26 offset:16384
  v_add3_u32 v56, v56, v0, s95
  v_mfma_f32_16x16x32_bf16 v[188:191], a[108:111], a[60:63], v[188:191]
  ds_read_b64_tr_b16 a[82:83], v26 offset:17408
  v_accvgpr_write_b32 a226, v56
  s_add_u32 m0, s48, 49152
  s_mov_b32 s50, 3670016
  v_mfma_f32_16x16x32_bf16 v[192:195], a[112:115], a[48:51], v[192:195]
  buffer_load_dwordx4 v14, s[36:39], s50 offen offset:2048 lds
  v_mfma_f32_16x16x32_bf16 v[196:199], a[112:115], a[52:55], v[196:199]
  ds_read_b64_tr_b16 a[84:85], v27 offset:16384
  s_lshl_b32 s95, s28, 10
  v_mfma_f32_16x16x32_bf16 v[200:203], a[112:115], a[56:59], v[200:203]
  ds_read_b64_tr_b16 a[86:87], v27 offset:17408
  s_add_u32 s95, s95, 131072
  v_mfma_f32_16x16x32_bf16 v[204:207], a[112:115], a[60:63], v[204:207]
  v_lshlrev_b32 v56, 3, v1
  buffer_load_dwordx4 v15, s[36:39], s50 offen offset:3072 lds
  v_mfma_f32_16x16x32_bf16 v[208:211], a[116:119], a[48:51], v[208:211]
  ds_read_b64_tr_b16 a[88:89], v28 offset:16384
  v_mfma_f32_16x16x32_bf16 v[212:215], a[116:119], a[52:55], v[212:215]
  ds_read_b64_tr_b16 a[90:91], v28 offset:17408
  v_add_u32 v56, s95, v56
  v_mfma_f32_16x16x32_bf16 v[216:219], a[116:119], a[56:59], v[216:219]
  ds_read_b128 a[144:147], v19 offset:32768
  v_accvgpr_write_b32 a227, v56
  s_add_u32 s57, s58, 45056
  v_mfma_f32_16x16x32_bf16 v[220:223], a[116:119], a[60:63], v[220:223]
  ds_read_b64_tr_b16 a[92:93], v29 offset:16384
  v_lshlrev_b32 v56, 7, v1
  buffer_store_dwordx4 v[120:123], v16, s[96:99], s57 offen offset:0 sc1
  v_mfma_f32_16x16x32_bf16 v[224:227], a[120:123], a[48:51], v[224:227]
  ds_read_b64_tr_b16 a[94:95], v29 offset:17408
  v_mfma_f32_16x16x32_bf16 v[228:231], a[120:123], a[52:55], v[228:231]
  ds_read_b128 a[148:151], v19 offset:34816
  v_cmp_gt_u32 vcc, 50, v1
  v_mfma_f32_16x16x32_bf16 v[232:235], a[120:123], a[56:59], v[232:235]
  ds_read_b128 a[152:155], v19 offset:36864
  v_mov_b32 v2, 0x40000000
  v_mfma_f32_16x16x32_bf16 v[236:239], a[120:123], a[60:63], v[236:239]
  ds_read_b128 a[156:159], v19 offset:38912
  s_nop 0
  v_mfma_f32_16x16x32_bf16 v[240:243], a[124:127], a[48:51], v[240:243]
  v_mfma_f32_16x16x32_bf16 v[244:247], a[124:127], a[52:55], v[244:247]
  v_cndmask_b32 v56, v2, v56, vcc
  s_add_u32 s57, s58, 45056
  v_mfma_f32_16x16x32_bf16 v[248:251], a[124:127], a[56:59], v[248:251]
  v_accvgpr_write_b32 a228, v56
  buffer_store_dwordx4 v[124:127], v16, s[96:99], s57 offen offset:1024 sc1
  v_mfma_f32_16x16x32_bf16 v[252:255], a[124:127], a[60:63], v[252:255]
  s_waitcnt lgkmcnt(2)
  v_mfma_f32_16x16x32_bf16 v[128:131], a[64:67], a[128:131], v[128:131]
  v_mfma_f32_16x16x32_bf16 v[132:135], a[64:67], a[132:135], v[132:135]
  s_waitcnt vmcnt(21) lgkmcnt(0)
  v_mfma_f32_16x16x32_bf16 v[136:139], a[64:67], a[136:139], v[136:139]
  ds_read_b64_tr_b16 a[96:97], v22 offset:24576
  v_lshrrev_b32 v2, 4, v1
  v_mfma_f32_16x16x32_bf16 v[140:143], a[64:67], a[140:143], v[140:143]
  ds_read_b64_tr_b16 a[98:99], v22 offset:25600
  v_lshrrev_b32 v3, 2, v1
  s_add_u32 m0, s49, 32768
  s_mov_b32 s51, 1024
  v_mfma_f32_16x16x32_bf16 v[144:147], a[68:71], a[128:131], v[144:147]
  v_and_b32 v3, 3, v3
  buffer_load_dwordx4 v4, s[32:35], s51 offen offset:0 lds
  v_mfma_f32_16x16x32_bf16 v[148:151], a[68:71], a[132:135], v[148:151]
  ds_read_b64_tr_b16 a[100:101], v23 offset:24576
  v_mfma_f32_16x16x32_bf16 v[152:155], a[68:71], a[136:139], v[152:155]
  ds_read_b64_tr_b16 a[102:103], v23 offset:25600
  v_lshl_add_u32 v56, v2, 3, v3
  v_mfma_f32_16x16x32_bf16 v[156:159], a[68:71], a[140:143], v[156:159]
  v_mul_u32_u24 v56, 384, v56
  buffer_load_dwordx4 v5, s[32:35], s51 offen offset:1024 lds
  v_mfma_f32_16x16x32_bf16 v[160:163], a[72:75], a[128:131], v[160:163]
  ds_read_b64_tr_b16 a[104:105], v24 offset:24576
  s_mul_i32 s95, s28, 96
  v_mfma_f32_16x16x32_bf16 v[164:167], a[72:75], a[132:135], v[164:167]
  ds_read_b64_tr_b16 a[106:107], v24 offset:25600
  v_mfma_f32_16x16x32_bf16 v[168:171], a[72:75], a[136:139], v[168:171]
  s_add_u32 s95, s95, 151552
  buffer_load_dwordx4 v6, s[32:35], s51 offen offset:2048 lds
  v_mfma_f32_16x16x32_bf16 v[172:175], a[72:75], a[140:143], v[172:175]
  ds_read_b64_tr_b16 a[108:109], v25 offset:24576
  v_add3_u32 v56, v56, v0, s95
  v_mfma_f32_16x16x32_bf16 v[176:179], a[76:79], a[128:131], v[176:179]
  ds_read_b64_tr_b16 a[110:111], v25 offset:25600
  v_accvgpr_write_b32 a232, v56
  v_mfma_f32_16x16x32_bf16 v[180:183], a[76:79], a[132:135], v[180:183]
  buffer_load_dwordx4 v7, s[32:35], s51 offen offset:3072 lds
  v_mfma_f32_16x16x32_bf16 v[184:187], a[76:79], a[136:139], v[184:187]
  ds_read_b64_tr_b16 a[112:113], v26 offset:24576
  s_lshl_b32 s55, s100, 6
  v_mfma_f32_16x16x32_bf16 v[188:191], a[76:79], a[140:143], v[188:191]
  ds_read_b64_tr_b16 a[114:115], v26 offset:25600
  s_mul_i32 s54, s28, 24
  s_add_u32 m0, s48, 0
  s_mov_b32 s50, 4194304
  v_mfma_f32_16x16x32_bf16 v[192:195], a[80:83], a[128:131], v[192:195]
  buffer_load_dwordx4 v12, s[36:39], s50 offen offset:0 lds
  v_mfma_f32_16x16x32_bf16 v[196:199], a[80:83], a[132:135], v[196:199]
  ds_read_b64_tr_b16 a[116:117], v27 offset:24576
  s_add_u32 s54, s54, s55
  v_mfma_f32_16x16x32_bf16 v[200:203], a[80:83], a[136:139], v[200:203]
  ds_read_b64_tr_b16 a[118:119], v27 offset:25600
  s_sub_u32 s54, s54, 16
  v_mfma_f32_16x16x32_bf16 v[204:207], a[80:83], a[140:143], v[204:207]
  s_and_b32 s55, s28, 1
  buffer_load_dwordx4 v13, s[36:39], s50 offen offset:1024 lds
  v_mfma_f32_16x16x32_bf16 v[208:211], a[84:87], a[128:131], v[208:211]
  ds_read_b64_tr_b16 a[120:121], v28 offset:24576
  v_mfma_f32_16x16x32_bf16 v[212:215], a[84:87], a[132:135], v[212:215]
  ds_read_b64_tr_b16 a[122:123], v28 offset:25600
  s_lshl_b32 s55, s55, 2
  v_mfma_f32_16x16x32_bf16 v[216:219], a[84:87], a[136:139], v[216:219]
  ds_read_b128 a[32:35], v30 offset:0
  v_lshrrev_b32 v51, 3, v1
  v_mfma_f32_16x16x32_bf16 v[220:223], a[84:87], a[140:143], v[220:223]
  ds_read_b64_tr_b16 a[124:125], v29 offset:24576
  v_add_u32 v51, s54, v51
  v_mfma_f32_16x16x32_bf16 v[224:227], a[88:91], a[128:131], v[224:227]
  ds_read_b64_tr_b16 a[126:127], v29 offset:25600
  v_mfma_f32_16x16x32_bf16 v[228:231], a[88:91], a[132:135], v[228:231]
  ds_read_b128 a[36:39], v30 offset:2048
  v_lshrrev_b32 v52, 4, v1
  v_mfma_f32_16x16x32_bf16 v[232:235], a[88:91], a[136:139], v[232:235]
  ds_read_b128 a[40:43], v30 offset:4096
  v_and_b32 v50, 7, v1
  v_mfma_f32_16x16x32_bf16 v[236:239], a[88:91], a[140:143], v[236:239]
  ds_read_b128 a[44:47], v30 offset:6144
  v_xor_b32 v52, v52, v50
  v_mfma_f32_16x16x32_bf16 v[240:243], a[92:95], a[128:131], v[240:243]
  v_mfma_f32_16x16x32_bf16 v[244:247], a[92:95], a[132:135], v[244:247]
  v_xor_b32 v52, s55, v52
  v_mfma_f32_16x16x32_bf16 v[248:251], a[92:95], a[136:139], v[248:251]
  v_add_u32 v50, 0, v51
  v_mfma_f32_16x16x32_bf16 v[252:255], a[92:95], a[140:143], v[252:255]
  s_waitcnt lgkmcnt(2)
  v_mfma_f32_16x16x32_bf16 v[128:131], a[96:99], a[144:147], v[128:131]
  v_mfma_f32_16x16x32_bf16 v[132:135], a[96:99], a[148:151], v[132:135]
  s_waitcnt vmcnt(6) lgkmcnt(0)
  s_barrier
  s_cmp_lg_u32 s28, 0
  s_cbranch_scc1 LQ_sig
  v_mov_b32 v46, s0
  v_mov_b32 v47, s1
  v_mov_b32 v44, 0
  s_mov_b64 exec, 1
  buffer_store_dwordx2 v[46:47], v44, s[40:43], s59 offen sc1
  s_mov_b64 exec, -1
LQ_sig:
  v_mfma_f32_16x16x32_bf16 v[136:139], a[96:99], a[152:155], v[136:139]
  ds_read_b64_tr_b16 a[64:65], v22 offset:32768
  v_max_i32 v50, 0, v50
  v_mfma_f32_16x16x32_bf16 v[140:143], a[96:99], a[156:159], v[140:143]
  ds_read_b64_tr_b16 a[66:67], v22 offset:33792
  v_mul_u32_u24 v50, 1280, v50
  s_add_u32 m0, s49, 36864
  s_mov_b32 s51, 1024
  v_mfma_f32_16x16x32_bf16 v[144:147], a[100:103], a[144:147], v[144:147]
  v_xor_b32 v53, 0, v52
  buffer_load_dwordx4 v8, s[32:35], s51 offen offset:0 lds
  v_mfma_f32_16x16x32_bf16 v[148:151], a[100:103], a[148:151], v[148:151]
  ds_read_b64_tr_b16 a[68:69], v23 offset:32768
  v_mfma_f32_16x16x32_bf16 v[152:155], a[100:103], a[152:155], v[152:155]
  ds_read_b64_tr_b16 a[70:71], v23 offset:33792
  v_lshl_add_u32 v32, v53, 4, v50
  v_mfma_f32_16x16x32_bf16 v[156:159], a[100:103], a[156:159], v[156:159]
  v_add_u32 v50, 8, v51
  buffer_load_dwordx4 v9, s[32:35], s51 offen offset:1024 lds
  v_mfma_f32_16x16x32_bf16 v[160:163], a[104:107], a[144:147], v[160:163]
  ds_read_b64_tr_b16 a[72:73], v24 offset:32768
  v_max_i32 v50, 0, v50
  v_mfma_f32_16x16x32_bf16 v[164:167], a[104:107], a[148:151], v[164:167]
  ds_read_b64_tr_b16 a[74:75], v24 offset:33792
  v_mfma_f32_16x16x32_bf16 v[168:171], a[104:107], a[152:155], v[168:171]
  v_mul_u32_u24 v50, 1280, v50
  buffer_load_dwordx4 v10, s[32:35], s51 offen offset:2048 lds
  v_mfma_f32_16x16x32_bf16 v[172:175], a[104:107], a[156:159], v[172:175]
  ds_read_b64_tr_b16 a[76:77], v25 offset:32768
  v_xor_b32 v53, 4, v52
  v_mfma_f32_16x16x32_bf16 v[176:179], a[108:111], a[144:147], v[176:179]
  ds_read_b64_tr_b16 a[78:79], v25 offset:33792
  v_lshl_add_u32 v33, v53, 4, v50
  v_mfma_f32_16x16x32_bf16 v[180:183], a[108:111], a[148:151], v[180:183]
  buffer_load_dwordx4 v11, s[32:35], s51 offen offset:3072 lds
  v_mfma_f32_16x16x32_bf16 v[184:187], a[108:111], a[152:155], v[184:187]
  ds_read_b64_tr_b16 a[80:81], v26 offset:32768
  s_lshr_b32 s56, s28, 1
  v_mfma_f32_16x16x32_bf16 v[188:191], a[108:111], a[156:159], v[188:191]
  ds_read_b64_tr_b16 a[82:83], v26 offset:33792
  s_and_b32 s56, s56, s28
  s_add_u32 m0, s48, 0
  s_mov_b32 s50, 4194304
  v_mfma_f32_16x16x32_bf16 v[192:195], a[112:115], a[144:147], v[192:195]
  buffer_load_dwordx4 v14, s[36:39], s50 offen offset:2048 lds
  v_mfma_f32_16x16x32_bf16 v[196:199], a[112:115], a[148:151], v[196:199]
  ds_read_b64_tr_b16 a[84:85], v27 offset:32768
  s_lshl_b32 s56, s56, 30
  v_mfma_f32_16x16x32_bf16 v[200:203], a[112:115], a[152:155], v[200:203]
  ds_read_b64_tr_b16 a[86:87], v27 offset:33792
  v_add_u32 v33, s56, v33
  v_mfma_f32_16x16x32_bf16 v[204:207], a[112:115], a[156:159], v[204:207]
  v_add_u32 v50, 16, v51
  buffer_load_dwordx4 v15, s[36:39], s50 offen offset:3072 lds
  v_mfma_f32_16x16x32_bf16 v[208:211], a[116:119], a[144:147], v[208:211]
  ds_read_b64_tr_b16 a[88:89], v28 offset:32768
  v_mfma_f32_16x16x32_bf16 v[212:215], a[116:119], a[148:151], v[212:215]
  ds_read_b64_tr_b16 a[90:91], v28 offset:33792
  v_max_i32 v50, 0, v50
  v_mfma_f32_16x16x32_bf16 v[216:219], a[116:119], a[152:155], v[216:219]
  ds_read_b128 a[48:51], v31 offset:0
  v_mul_u32_u24 v50, 1280, v50
  v_mfma_f32_16x16x32_bf16 v[220:223], a[116:119], a[156:159], v[220:223]
  ds_read_b64_tr_b16 a[92:93], v29 offset:32768
  v_xor_b32 v53, 0, v52
  v_mfma_f32_16x16x32_bf16 v[224:227], a[120:123], a[144:147], v[224:227]
  ds_read_b64_tr_b16 a[94:95], v29 offset:33792
  v_mfma_f32_16x16x32_bf16 v[228:231], a[120:123], a[148:151], v[228:231]
  ds_read_b128 a[52:55], v31 offset:2048
  v_lshl_add_u32 v34, v53, 4, v50
  v_mfma_f32_16x16x32_bf16 v[232:235], a[120:123], a[152:155], v[232:235]
  ds_read_b128 a[56:59], v31 offset:4096
  s_lshr_b32 s56, s28, 1
  v_mfma_f32_16x16x32_bf16 v[236:239], a[120:123], a[156:159], v[236:239]
  ds_read_b128 a[60:63], v31 offset:6144
  s_and_b32 s56, s56, s28
  v_mfma_f32_16x16x32_bf16 v[240:243], a[124:127], a[144:147], v[240:243]
  v_mfma_f32_16x16x32_bf16 v[244:247], a[124:127], a[148:151], v[244:247]
  s_lshl_b32 s56, s56, 30
  v_mfma_f32_16x16x32_bf16 v[248:251], a[124:127], a[152:155], v[248:251]
  v_add_u32 v34, s56, v34
  v_mfma_f32_16x16x32_bf16 v[252:255], a[124:127], a[156:159], v[252:255]
  s_waitcnt lgkmcnt(2)
  v_mfma_f32_16x16x32_bf16 v[128:131], a[64:67], a[32:35], v[128:131]
  v_mfma_f32_16x16x32_bf16 v[132:135], a[64:67], a[36:39], v[132:135]
  s_waitcnt vmcnt(16) lgkmcnt(0)
  v_mfma_f32_16x16x32_bf16 v[136:139], a[64:67], a[40:43], v[136:139]
  ds_read_b64_tr_b16 a[96:97], v22 offset:40960
  v_lshlrev_b32 v50, 4, v1
  v_mfma_f32_16x16x32_bf16 v[140:143], a[64:67], a[44:47], v[140:143]
  ds_read_b64_tr_b16 a[98:99], v22 offset:41984
  s_mul_i32 s56, s101, 5
  s_add_u32 m0, s49, 65536
  s_mov_b32 s51, 1152
  v_mfma_f32_16x16x32_bf16 v[144:147], a[68:71], a[32:35], v[144:147]
  s_lshl_b32 s54, s28, 2
  buffer_load_dwordx4 v4, s[32:35], s51 offen offset:0 lds
  v_mfma_f32_16x16x32_bf16 v[148:151], a[68:71], a[36:39], v[148:151]
  ds_read_b64_tr_b16 a[100:101], v23 offset:40960
  v_mfma_f32_16x16x32_bf16 v[152:155], a[68:71], a[40:43], v[152:155]
  ds_read_b64_tr_b16 a[102:103], v23 offset:41984
  s_add_u32 s54, s54, 0
  v_mfma_f32_16x16x32_bf16 v[156:159], a[68:71], a[44:47], v[156:159]
  s_min_u32 s54, s54, 14
  buffer_load_dwordx4 v5, s[32:35], s51 offen offset:1024 lds
  v_mfma_f32_16x16x32_bf16 v[160:163], a[72:75], a[32:35], v[160:163]
  ds_read_b64_tr_b16 a[104:105], v24 offset:40960
  s_mul_i32 s55, s54, 52
  v_mfma_f32_16x16x32_bf16 v[164:167], a[72:75], a[36:39], v[164:167]
  ds_read_b64_tr_b16 a[106:107], v24 offset:41984
  v_mfma_f32_16x16x32_bf16 v[168:171], a[72:75], a[40:43], v[168:171]
  s_lshr_b32 s55, s55, 8
  buffer_load_dwordx4 v6, s[32:35], s51 offen offset:2048 lds
  v_mfma_f32_16x16x32_bf16 v[172:175], a[72:75], a[44:47], v[172:175]
  ds_read_b64_tr_b16 a[108:109], v25 offset:40960
  s_mul_i32 s55, s55, 35
  v_mfma_f32_16x16x32_bf16 v[176:179], a[76:79], a[32:35], v[176:179]
  ds_read_b64_tr_b16 a[110:111], v25 offset:41984
  s_add_u32 s54, s54, s55
  v_mfma_f32_16x16x32_bf16 v[180:183], a[76:79], a[36:39], v[180:183]
  buffer_load_dwordx4 v7, s[32:35], s51 offen offset:3072 lds
  v_mfma_f32_16x16x32_bf16 v[184:187], a[76:79], a[40:43], v[184:187]
  ds_read_b64_tr_b16 a[112:113], v26 offset:40960
  s_add_u32 s54, s54, s56
  v_mfma_f32_16x16x32_bf16 v[188:191], a[76:79], a[44:47], v[188:191]
  ds_read_b64_tr_b16 a[114:115], v26 offset:41984
  s_mul_i32 s54, s54, 21504
  s_add_u32 m0, s48, 16384
  s_mov_b32 s50, 4718592
  v_mfma_f32_16x16x32_bf16 v[192:195], a[80:83], a[32:35], v[192:195]
  buffer_load_dwordx4 v12, s[36:39], s50 offen offset:0 lds
  v_mfma_f32_16x16x32_bf16 v[196:199], a[80:83], a[36:39], v[196:199]
  ds_read_b64_tr_b16 a[116:117], v27 offset:40960
  s_add_u32 s54, s54, 70070272
  v_mfma_f32_16x16x32_bf16 v[200:203], a[80:83], a[40:43], v[200:203]
  ds_read_b64_tr_b16 a[118:119], v27 offset:41984
  v_add_u32 v35, s54, v50
  v_mfma_f32_16x16x32_bf16 v[204:207], a[80:83], a[44:47], v[204:207]
  s_lshl_b32 s54, s28, 2
  buffer_load_dwordx4 v13, s[36:39], s50 offen offset:1024 lds
  v_mfma_f32_16x16x32_bf16 v[208:211], a[84:87], a[32:35], v[208:211]
  ds_read_b64_tr_b16 a[120:121], v28 offset:40960
  v_mfma_f32_16x16x32_bf16 v[212:215], a[84:87], a[36:39], v[212:215]
  ds_read_b64_tr_b16 a[122:123], v28 offset:41984
  s_add_u32 s54, s54, 1
  v_mfma_f32_16x16x32_bf16 v[216:219], a[84:87], a[40:43], v[216:219]
  ds_read_b128 a[128:131], v18 offset:0
  s_min_u32 s54, s54, 14
  v_mfma_f32_16x16x32_bf16 v[220:223], a[84:87], a[44:47], v[220:223]
  ds_read_b64_tr_b16 a[124:125], v29 offset:40960
  s_mul_i32 s55, s54, 52
  v_mfma_f32_16x16x32_bf16 v[224:227], a[88:91], a[32:35], v[224:227]
  ds_read_b64_tr_b16 a[126:127], v29 offset:41984
  v_mfma_f32_16x16x32_bf16 v[228:231], a[88:91], a[36:39], v[228:231]
  ds_read_b128 a[132:135], v18 offset:2048
  s_lshr_b32 s55, s55, 8
  v_mfma_f32_16x16x32_bf16 v[232:235], a[88:91], a[40:43], v[232:235]
  ds_read_b128 a[136:139], v18 offset:4096
  s_mul_i32 s55, s55, 35
  v_mfma_f32_16x16x32_bf16 v[236:239], a[88:91], a[44:47], v[236:239]
  ds_read_b128 a[140:143], v18 offset:6144
  s_add_u32 s54, s54, s55
  v_mfma_f32_16x16x32_bf16 v[240:243], a[92:95], a[32:35], v[240:243]
  v_mfma_f32_16x16x32_bf16 v[244:247], a[92:95], a[36:39], v[244:247]
  s_add_u32 s54, s54, s56
  v_mfma_f32_16x16x32_bf16 v[248:251], a[92:95], a[40:43], v[248:251]
  s_mul_i32 s54, s54, 21504
  v_mfma_f32_16x16x32_bf16 v[252:255], a[92:95], a[44:47], v[252:255]
  s_waitcnt lgkmcnt(2)
  v_mfma_f32_16x16x32_bf16 v[128:131], a[96:99], a[48:51], v[128:131]
  v_mfma_f32_16x16x32_bf16 v[132:135], a[96:99], a[52:55], v[132:135]
  s_waitcnt vmcnt(20) lgkmcnt(0)
  s_barrier
  v_mfma_f32_16x16x32_bf16 v[136:139], a[96:99], a[56:59], v[136:139]
  ds_read_b64_tr_b16 a[64:65], v22 offset:49152
  s_add_u32 s54, s54, 70070272
  v_mfma_f32_16x16x32_bf16 v[140:143], a[96:99], a[60:63], v[140:143]
  ds_read_b64_tr_b16 a[66:67], v22 offset:50176
  v_add_u32 v36, s54, v50
  s_add_u32 m0, s49, 69632
  s_mov_b32 s51, 1152
  v_mfma_f32_16x16x32_bf16 v[144:147], a[100:103], a[48:51], v[144:147]
  s_lshl_b32 s54, s28, 2
  buffer_load_dwordx4 v8, s[32:35], s51 offen offset:0 lds
  v_mfma_f32_16x16x32_bf16 v[148:151], a[100:103], a[52:55], v[148:151]
  ds_read_b64_tr_b16 a[68:69], v23 offset:49152
  v_mfma_f32_16x16x32_bf16 v[152:155], a[100:103], a[56:59], v[152:155]
  ds_read_b64_tr_b16 a[70:71], v23 offset:50176
  s_add_u32 s54, s54, 2
  v_mfma_f32_16x16x32_bf16 v[156:159], a[100:103], a[60:63], v[156:159]
  s_min_u32 s54, s54, 14
  buffer_load_dwordx4 v9, s[32:35], s51 offen offset:1024 lds
  v_mfma_f32_16x16x32_bf16 v[160:163], a[104:107], a[48:51], v[160:163]
  ds_read_b64_tr_b16 a[72:73], v24 offset:49152
  s_mul_i32 s55, s54, 52
  v_mfma_f32_16x16x32_bf16 v[164:167], a[104:107], a[52:55], v[164:167]
  ds_read_b64_tr_b16 a[74:75], v24 offset:50176
  v_mfma_f32_16x16x32_bf16 v[168:171], a[104:107], a[56:59], v[168:171]
  s_lshr_b32 s55, s55, 8
  buffer_load_dwordx4 v10, s[32:35], s51 offen offset:2048 lds
  v_mfma_f32_16x16x32_bf16 v[172:175], a[104:107], a[60:63], v[172:175]
  ds_read_b64_tr_b16 a[76:77], v25 offset:49152
  s_mul_i32 s55, s55, 35
  v_mfma_f32_16x16x32_bf16 v[176:179], a[108:111], a[48:51], v[176:179]
  ds_read_b64_tr_b16 a[78:79], v25 offset:50176
  s_add_u32 s54, s54, s55
  v_mfma_f32_16x16x32_bf16 v[180:183], a[108:111], a[52:55], v[180:183]
  buffer_load_dwordx4 v11, s[32:35], s51 offen offset:3072 lds
  v_mfma_f32_16x16x32_bf16 v[184:187], a[108:111], a[56:59], v[184:187]
  ds_read_b64_tr_b16 a[80:81], v26 offset:49152
  s_add_u32 s54, s54, s56
  v_mfma_f32_16x16x32_bf16 v[188:191], a[108:111], a[60:63], v[188:191]
  ds_read_b64_tr_b16 a[82:83], v26 offset:50176
  s_mul_i32 s54, s54, 21504
  s_add_u32 m0, s48, 16384
  s_mov_b32 s50, 4718592
  v_mfma_f32_16x16x32_bf16 v[192:195], a[112:115], a[48:51], v[192:195]
  buffer_load_dwordx4 v14, s[36:39], s50 offen offset:2048 lds
  v_mfma_f32_16x16x32_bf16 v[196:199], a[112:115], a[52:55], v[196:199]
  ds_read_b64_tr_b16 a[84:85], v27 offset:49152
  s_add_u32 s54, s54, 70070272
  v_mfma_f32_16x16x32_bf16 v[200:203], a[112:115], a[56:59], v[200:203]
  ds_read_b64_tr_b16 a[86:87], v27 offset:50176
  v_add_u32 v37, s54, v50
  v_mfma_f32_16x16x32_bf16 v[204:207], a[112:115], a[60:63], v[204:207]
  s_lshl_b32 s54, s28, 2
  buffer_load_dwordx4 v15, s[36:39], s50 offen offset:3072 lds
  v_mfma_f32_16x16x32_bf16 v[208:211], a[116:119], a[48:51], v[208:211]
  ds_read_b64_tr_b16 a[88:89], v28 offset:49152
  v_mfma_f32_16x16x32_bf16 v[212:215], a[116:119], a[52:55], v[212:215]
  ds_read_b64_tr_b16 a[90:91], v28 offset:50176
  s_add_u32 s54, s54, 3
  v_mfma_f32_16x16x32_bf16 v[216:219], a[116:119], a[56:59], v[216:219]
  ds_read_b128 a[144:147], v19 offset:0
  s_min_u32 s54, s54, 14
  v_mfma_f32_16x16x32_bf16 v[220:223], a[116:119], a[60:63], v[220:223]
  ds_read_b64_tr_b16 a[92:93], v29 offset:49152
  s_mul_i32 s55, s54, 52
  v_mfma_f32_16x16x32_bf16 v[224:227], a[120:123], a[48:51], v[224:227]
  ds_read_b64_tr_b16 a[94:95], v29 offset:50176
  v_mfma_f32_16x16x32_bf16 v[228:231], a[120:123], a[52:55], v[228:231]
  ds_read_b128 a[148:151], v19 offset:2048
  s_lshr_b32 s55, s55, 8
  v_mfma_f32_16x16x32_bf16 v[232:235], a[120:123], a[56:59], v[232:235]
  ds_read_b128 a[152:155], v19 offset:4096
  s_mul_i32 s55, s55, 35
  v_mfma_f32_16x16x32_bf16 v[236:239], a[120:123], a[60:63], v[236:239]
  ds_read_b128 a[156:159], v19 offset:6144
  s_add_u32 s54, s54, s55
  v_mfma_f32_16x16x32_bf16 v[240:243], a[124:127], a[48:51], v[240:243]
  v_mfma_f32_16x16x32_bf16 v[244:247], a[124:127], a[52:55], v[244:247]
  s_add_u32 s54, s54, s56
  v_mfma_f32_16x16x32_bf16 v[248:251], a[124:127], a[56:59], v[248:251]
  s_mul_i32 s54, s54, 21504
  v_mfma_f32_16x16x32_bf16 v[252:255], a[124:127], a[60:63], v[252:255]
  s_waitcnt lgkmcnt(2)
  v_mfma_f32_16x16x32_bf16 v[128:131], a[64:67], a[128:131], v[128:131]
  v_mfma_f32_16x16x32_bf16 v[132:135], a[64:67], a[132:135], v[132:135]
  s_waitcnt vmcnt(14) lgkmcnt(0)
  v_mfma_f32_16x16x32_bf16 v[136:139], a[64:67], a[136:139], v[136:139]
  ds_read_b64_tr_b16 a[96:97], v22 offset:57344
  s_add_u32 s54, s54, 70070272
  v_mfma_f32_16x16x32_bf16 v[140:143], a[64:67], a[140:143], v[140:143]
  ds_read_b64_tr_b16 a[98:99], v22 offset:58368
  v_add_u32 v38, s54, v50
  v_mfma_f32_16x16x32_bf16 v[144:147], a[68:71], a[128:131], v[144:147]
  s_lshr_b32 s56, s28, 1
  v_mfma_f32_16x16x32_bf16 v[148:151], a[68:71], a[132:135], v[148:151]
  ds_read_b64_tr_b16 a[100:101], v23 offset:57344
  v_mfma_f32_16x16x32_bf16 v[152:155], a[68:71], a[136:139], v[152:155]
  ds_read_b64_tr_b16 a[102:103], v23 offset:58368
  s_and_b32 s56, s56, s28
  v_mfma_f32_16x16x32_bf16 v[156:159], a[68:71], a[140:143], v[156:159]
  s_lshl_b32 s56, s56, 30
  v_mfma_f32_16x16x32_bf16 v[160:163], a[72:75], a[128:131], v[160:163]
  ds_read_b64_tr_b16 a[104:105], v24 offset:57344
  v_add_u32 v38, s56, v38
  v_mfma_f32_16x16x32_bf16 v[164:167], a[72:75], a[132:135], v[164:167]
  ds_read_b64_tr_b16 a[106:107], v24 offset:58368
  v_mfma_f32_16x16x32_bf16 v[168:171], a[72:75], a[136:139], v[168:171]
  v_and_b32 v50, 15, v1
  v_mfma_f32_16x16x32_bf16 v[172:175], a[72:75], a[140:143], v[172:175]
  ds_read_b64_tr_b16 a[108:109], v25 offset:57344
  v_lshrrev_b32 v51, 1, v50
  v_mfma_f32_16x16x32_bf16 v[176:179], a[76:79], a[128:131], v[176:179]
  ds_read_b64_tr_b16 a[110:111], v25 offset:58368
  v_lshlrev_b32 v50, 7, v50
  v_mfma_f32_16x16x32_bf16 v[180:183], a[76:79], a[132:135], v[180:183]
  v_mfma_f32_16x16x32_bf16 v[184:187], a[76:79], a[136:139], v[184:187]
  ds_read_b64_tr_b16 a[112:113], v26 offset:57344
  v_lshrrev_b32 v52, 4, v1
  v_mfma_f32_16x16x32_bf16 v[188:191], a[76:79], a[140:143], v[188:191]
  ds_read_b64_tr_b16 a[114:115], v26 offset:58368
  v_xor_b32 v51, v51, v52
  v_mfma_f32_16x16x32_bf16 v[192:195], a[80:83], a[128:131], v[192:195]
  v_mfma_f32_16x16x32_bf16 v[196:199], a[80:83], a[132:135], v[196:199]
  ds_read_b64_tr_b16 a[116:117], v27 offset:57344
  v_lshl_add_u32 v39, v51, 4, v50
  v_mfma_f32_16x16x32_bf16 v[200:203], a[80:83], a[136:139], v[200:203]
  ds_read_b64_tr_b16 a[118:119], v27 offset:58368
  v_xor_b32 v51, 4, v51
  v_mfma_f32_16x16x32_bf16 v[204:207], a[80:83], a[140:143], v[204:207]
  v_lshl_add_u32 v40, v51, 4, v50
  v_mfma_f32_16x16x32_bf16 v[208:211], a[84:87], a[128:131], v[208:211]
  ds_read_b64_tr_b16 a[120:121], v28 offset:57344
  v_mfma_f32_16x16x32_bf16 v[212:215], a[84:87], a[132:135], v[212:215]
  ds_read_b64_tr_b16 a[122:123], v28 offset:58368
  v_accvgpr_write_b32 a234, v32
  v_mfma_f32_16x16x32_bf16 v[216:219], a[84:87], a[136:139], v[216:219]
  ds_read_b128 a[32:35], v18 offset:32768
  v_accvgpr_write_b32 a235, v33
  v_mfma_f32_16x16x32_bf16 v[220:223], a[84:87], a[140:143], v[220:223]
  ds_read_b64_tr_b16 a[124:125], v29 offset:57344
  v_accvgpr_write_b32 a236, v34
  v_mfma_f32_16x16x32_bf16 v[224:227], a[88:91], a[128:131], v[224:227]
  ds_read_b64_tr_b16 a[126:127], v29 offset:58368
  v_mfma_f32_16x16x32_bf16 v[228:231], a[88:91], a[132:135], v[228:231]
  ds_read_b128 a[36:39], v18 offset:34816
  v_accvgpr_write_b32 a237, v35
  v_mfma_f32_16x16x32_bf16 v[232:235], a[88:91], a[136:139], v[232:235]
  ds_read_b128 a[40:43], v18 offset:36864
  v_accvgpr_write_b32 a238, v36
  v_mfma_f32_16x16x32_bf16 v[236:239], a[88:91], a[140:143], v[236:239]
  ds_read_b128 a[44:47], v18 offset:38912
  v_accvgpr_write_b32 a239, v37
  v_mfma_f32_16x16x32_bf16 v[240:243], a[92:95], a[128:131], v[240:243]
  v_mfma_f32_16x16x32_bf16 v[244:247], a[92:95], a[132:135], v[244:247]
  v_accvgpr_write_b32 a240, v38
  v_mfma_f32_16x16x32_bf16 v[248:251], a[92:95], a[136:139], v[248:251]
  v_accvgpr_write_b32 a241, v39
  v_mfma_f32_16x16x32_bf16 v[252:255], a[92:95], a[140:143], v[252:255]
  s_mov_b32 s3, s58
  s_waitcnt lgkmcnt(2)
  v_mfma_f32_16x16x32_bf16 v[128:131], a[96:99], a[144:147], v[128:131]
  v_mfma_f32_16x16x32_bf16 v[132:135], a[96:99], a[148:151], v[132:135]
  s_waitcnt vmcnt(12) lgkmcnt(0)
  s_barrier
  v_mfma_f32_16x16x32_bf16 v[136:139], a[96:99], a[152:155], v[136:139]
  ds_read_b64_tr_b16 a[64:65], v22 offset:0
  s_mul_i32 s54, s28, 5120
  v_mfma_f32_16x16x32_bf16 v[140:143], a[96:99], a[156:159], v[140:143]
  ds_read_b64_tr_b16 a[66:67], v22 offset:1024
  v_mfma_f32_16x16x32_bf16 v[144:147], a[100:103], a[144:147], v[144:147]
  s_add_u32 s54, s54, 131072
  v_mfma_f32_16x16x32_bf16 v[148:151], a[100:103], a[148:151], v[148:151]
  ds_read_b64_tr_b16 a[68:69], v23 offset:0
  v_mfma_f32_16x16x32_bf16 v[152:155], a[100:103], a[152:155], v[152:155]
  ds_read_b64_tr_b16 a[70:71], v23 offset:1024
  v_add_u32 v57, s54, v16
  v_mfma_f32_16x16x32_bf16 v[156:159], a[100:103], a[156:159], v[156:159]
  v_mfma_f32_16x16x32_bf16 v[160:163], a[104:107], a[144:147], v[160:163]
  ds_read_b64_tr_b16 a[72:73], v24 offset:0
  s_mul_i32 s54, s28, 3072
  v_mfma_f32_16x16x32_bf16 v[164:167], a[104:107], a[148:151], v[164:167]
  ds_read_b64_tr_b16 a[74:75], v24 offset:1024
  v_mfma_f32_16x16x32_bf16 v[168:171], a[104:107], a[152:155], v[168:171]
  s_add_u32 s54, s54, 151552
  v_mfma_f32_16x16x32_bf16 v[172:175], a[104:107], a[156:159], v[172:175]
  ds_read_b64_tr_b16 a[76:77], v25 offset:0
  v_mfma_f32_16x16x32_bf16 v[176:179], a[108:111], a[144:147], v[176:179]
  ds_read_b64_tr_b16 a[78:79], v25 offset:1024
  v_add_u32 v58, s54, v16
  v_mfma_f32_16x16x32_bf16 v[180:183], a[108:111], a[148:151], v[180:183]
  v_mfma_f32_16x16x32_bf16 v[184:187], a[108:111], a[152:155], v[184:187]
  ds_read_b64_tr_b16 a[80:81], v26 offset:0
  ds_write_b128 v57, v[64:67] offset:0
  v_mfma_f32_16x16x32_bf16 v[188:191], a[108:111], a[156:159], v[188:191]
  ds_read_b64_tr_b16 a[82:83], v26 offset:1024
  v_mfma_f32_16x16x32_bf16 v[192:195], a[112:115], a[144:147], v[192:195]
  ds_write_b128 v57, v[68:71] offset:1024
  v_mfma_f32_16x16x32_bf16 v[196:199], a[112:115], a[148:151], v[196:199]
  ds_read_b64_tr_b16 a[84:85], v27 offset:0
  v_mfma_f32_16x16x32_bf16 v[200:203], a[112:115], a[152:155], v[200:203]
  ds_read_b64_tr_b16 a[86:87], v27 offset:1024
  ds_write_b128 v57, v[72:75] offset:2048
  v_mfma_f32_16x16x32_bf16 v[204:207], a[112:115], a[156:159], v[204:207]
  v_mfma_f32_16x16x32_bf16 v[208:211], a[116:119], a[144:147], v[208:211]
  ds_read_b64_tr_b16 a[88:89], v28 offset:0
  ds_write_b128 v57, v[76:79] offset:3072
  v_mfma_f32_16x16x32_bf16 v[212:215], a[116:119], a[148:151], v[212:215]
  ds_read_b64_tr_b16 a[90:91], v28 offset:1024
  v_mfma_f32_16x16x32_bf16 v[216:219], a[116:119], a[152:155], v[216:219]
  ds_read_b128 a[48:51], v19 offset:32768
  ds_write_b128 v57, v[80:83] offset:4096
  v_mfma_f32_16x16x32_bf16 v[220:223], a[116:119], a[156:159], v[220:223]
  ds_read_b64_tr_b16 a[92:93], v29 offset:0
  v_mfma_f32_16x16x32_bf16 v[224:227], a[120:123], a[144:147], v[224:227]
  ds_read_b64_tr_b16 a[94:95], v29 offset:1024
  ds_write_b128 v58, v[84:87] offset:0
  v_mfma_f32_16x16x32_bf16 v[228:231], a[120:123], a[148:151], v[228:231]
  ds_read_b128 a[52:55], v19 offset:34816
  v_mfma_f32_16x16x32_bf16 v[232:235], a[120:123], a[152:155], v[232:235]
  ds_read_b128 a[56:59], v19 offset:36864
  ds_write_b128 v58, v[88:91] offset:1024
  v_mfma_f32_16x16x32_bf16 v[236:239], a[120:123], a[156:159], v[236:239]
  ds_read_b128 a[60:63], v19 offset:38912
  v_mfma_f32_16x16x32_bf16 v[240:243], a[124:127], a[144:147], v[240:243]
  ds_write_b128 v58, v[92:95] offset:2048
  v_mfma_f32_16x16x32_bf16 v[244:247], a[124:127], a[148:151], v[244:247]
  v_mfma_f32_16x16x32_bf16 v[248:251], a[124:127], a[152:155], v[248:251]
  v_mfma_f32_16x16x32_bf16 v[252:255], a[124:127], a[156:159], v[252:255]
  s_waitcnt lgkmcnt(6)
  v_mfma_f32_16x16x32_bf16 v[128:131], a[64:67], a[32:35], v[128:131]
  v_mfma_f32_16x16x32_bf16 v[132:135], a[64:67], a[36:39], v[132:135]
  s_waitcnt vmcnt(2) lgkmcnt(0)
  v_mfma_f32_16x16x32_bf16 v[136:139], a[64:67], a[40:43], v[136:139]
  ds_read_b64_tr_b16 a[96:97], v22 offset:8192
  v_mov_b32 v64, 0
  v_mfma_f32_16x16x32_bf16 v[140:143], a[64:67], a[44:47], v[140:143]
  ds_read_b64_tr_b16 a[98:99], v22 offset:9216
  v_mfma_f32_16x16x32_bf16 v[144:147], a[68:71], a[32:35], v[144:147]
  v_mov_b32 v65, 0
  v_mfma_f32_16x16x32_bf16 v[148:151], a[68:71], a[36:39], v[148:151]
  ds_read_b64_tr_b16 a[100:101], v23 offset:8192
  v_mfma_f32_16x16x32_bf16 v[152:155], a[68:71], a[40:43], v[152:155]
  ds_read_b64_tr_b16 a[102:103], v23 offset:9216
  v_mfma_f32_16x16x32_bf16 v[156:159], a[68:71], a[44:47], v[156:159]
  v_mov_b32 v66, 0
  v_mfma_f32_16x16x32_bf16 v[160:163], a[72:75], a[32:35], v[160:163]
  ds_read_b64_tr_b16 a[104:105], v24 offset:8192
  v_mfma_f32_16x16x32_bf16 v[164:167], a[72:75], a[36:39], v[164:167]
  ds_read_b64_tr_b16 a[106:107], v24 offset:9216
  v_mfma_f32_16x16x32_bf16 v[168:171], a[72:75], a[40:43], v[168:171]
  v_mov_b32 v67, 0
  v_mfma_f32_16x16x32_bf16 v[172:175], a[72:75], a[44:47], v[172:175]
  ds_read_b64_tr_b16 a[108:109], v25 offset:8192
  v_mfma_f32_16x16x32_bf16 v[176:179], a[76:79], a[32:35], v[176:179]
  ds_read_b64_tr_b16 a[110:111], v25 offset:9216
  v_mov_b32 v68, 0
  v_mfma_f32_16x16x32_bf16 v[180:183], a[76:79], a[36:39], v[180:183]
  v_mfma_f32_16x16x32_bf16 v[184:187], a[76:79], a[40:43], v[184:187]
  ds_read_b64_tr_b16 a[112:113], v26 offset:8192
  v_mfma_f32_16x16x32_bf16 v[188:191], a[76:79], a[44:47], v[188:191]
  ds_read_b64_tr_b16 a[114:115], v26 offset:9216
  v_mov_b32 v69, 0
  v_mfma_f32_16x16x32_bf16 v[192:195], a[80:83], a[32:35], v[192:195]
  v_mfma_f32_16x16x32_bf16 v[196:199], a[80:83], a[36:39], v[196:199]
  ds_read_b64_tr_b16 a[116:117], v27 offset:8192
  v_mfma_f32_16x16x32_bf16 v[200:203], a[80:83], a[40:43], v[200:203]
  ds_read_b64_tr_b16 a[118:119], v27 offset:9216
  v_mov_b32 v70, 0
  v_mfma_f32_16x16x32_bf16 v[204:207], a[80:83], a[44:47], v[204:207]
  v_mfma_f32_16x16x32_bf16 v[208:211], a[84:87], a[32:35], v[208:211]
  ds_read_b64_tr_b16 a[120:121], v28 offset:8192
  v_mfma_f32_16x16x32_bf16 v[212:215], a[84:87], a[36:39], v[212:215]
  ds_read_b64_tr_b16 a[122:123], v28 offset:9216
  v_mov_b32 v71, 0
  v_mfma_f32_16x16x32_bf16 v[216:219], a[84:87], a[40:43], v[216:219]
  ds_read_b128 a[128:131], v30 offset:0
  v_mfma_f32_16x16x32_bf16 v[220:223], a[84:87], a[44:47], v[220:223]
  ds_read_b64_tr_b16 a[124:125], v29 offset:8192
  v_mov_b32 v72, 0
  v_mfma_f32_16x16x32_bf16 v[224:227], a[88:91], a[32:35], v[224:227]
  ds_read_b64_tr_b16 a[126:127], v29 offset:9216
  v_mfma_f32_16x16x32_bf16 v[228:231], a[88:91], a[36:39], v[228:231]
  ds_read_b128 a[132:135], v30 offset:2048
  v_mfma_f32_16x16x32_bf16 v[232:235], a[88:91], a[40:43], v[232:235]
  ds_read_b128 a[136:139], v30 offset:4096
  v_mov_b32 v73, 0
  v_mfma_f32_16x16x32_bf16 v[236:239], a[88:91], a[44:47], v[236:239]
  ds_read_b128 a[140:143], v30 offset:6144
  v_mfma_f32_16x16x32_bf16 v[240:243], a[92:95], a[32:35], v[240:243]
  v_mfma_f32_16x16x32_bf16 v[244:247], a[92:95], a[36:39], v[244:247]
  v_mov_b32 v74, 0
  v_mfma_f32_16x16x32_bf16 v[248:251], a[92:95], a[40:43], v[248:251]
  v_mfma_f32_16x16x32_bf16 v[252:255], a[92:95], a[44:47], v[252:255]
  s_waitcnt lgkmcnt(4)
  v_mfma_f32_16x16x32_bf16 v[128:131], a[96:99], a[48:51], v[128:131]
  v_mfma_f32_16x16x32_bf16 v[132:135], a[96:99], a[52:55], v[132:135]
  s_waitcnt vmcnt(0) lgkmcnt(0)
  s_barrier
  v_mfma_f32_16x16x32_bf16 v[136:139], a[96:99], a[56:59], v[136:139]
  ds_read_b64_tr_b16 a[64:65], v22 offset:16384
  v_mov_b32 v75, 0
  v_accvgpr_read_b32 v58, a226
  v_accvgpr_read_b32 v57, a232
  buffer_load_dwordx2 v[20:21], v17, s[40:43], s52 offen sc1
  v_mfma_f32_16x16x32_bf16 v[140:143], a[96:99], a[60:63], v[140:143]
  ds_read_b64_tr_b16 a[66:67], v22 offset:17408
  s_and_b32 s54, s2, 1
  v_mfma_f32_16x16x32_bf16 v[144:147], a[100:103], a[48:51], v[144:147]
  v_mov_b32 v76, 0
  s_mul_i32 s54, s54, 20
  v_mfma_f32_16x16x32_bf16 v[148:151], a[100:103], a[52:55], v[148:151]
  ds_read_b64_tr_b16 a[68:69], v23 offset:16384
  s_mul_i32 s56, s28, 5
  s_add_u32 s54, s54, s56
  v_mfma_f32_16x16x32_bf16 v[152:155], a[100:103], a[56:59], v[152:155]
  ds_read_b64_tr_b16 a[70:71], v23 offset:17408
  ds_read_b64_tr_b16 v[108:109], v58 offset:0
  v_mfma_f32_16x16x32_bf16 v[156:159], a[100:103], a[60:63], v[156:159]
  v_mov_b32 v77, 0
  ds_read_b64_tr_b16 v[110:111], v58 offset:10240
  v_mfma_f32_16x16x32_bf16 v[160:163], a[104:107], a[48:51], v[160:163]
  ds_read_b64_tr_b16 a[72:73], v24 offset:16384
  ds_read_b64_tr_b16 v[112:113], v58 offset:32
  v_mfma_f32_16x16x32_bf16 v[164:167], a[104:107], a[52:55], v[164:167]
  ds_read_b64_tr_b16 a[74:75], v24 offset:17408
  ds_read_b64_tr_b16 v[114:115], v58 offset:10272
  ds_read_b64_tr_b16 v[116:117], v58 offset:64
  v_mfma_f32_16x16x32_bf16 v[168:171], a[104:107], a[56:59], v[168:171]
  v_mov_b32 v78, 0
  ds_read_b64_tr_b16 v[118:119], v58 offset:10304
  v_mfma_f32_16x16x32_bf16 v[172:175], a[104:107], a[60:63], v[172:175]
  ds_read_b64_tr_b16 a[76:77], v25 offset:16384
  ds_read_b64_tr_b16 v[120:121], v58 offset:96
  v_mfma_f32_16x16x32_bf16 v[176:179], a[108:111], a[48:51], v[176:179]
  ds_read_b64_tr_b16 a[78:79], v25 offset:17408
  v_mov_b32 v79, 0
  ds_read_b64_tr_b16 v[122:123], v58 offset:10336
  v_mfma_f32_16x16x32_bf16 v[180:183], a[108:111], a[52:55], v[180:183]
  ds_read_b64_tr_b16 v[124:125], v58 offset:128
  ds_read_b64_tr_b16 v[126:127], v58 offset:10368
  v_mfma_f32_16x16x32_bf16 v[184:187], a[108:111], a[56:59], v[184:187]
  ds_read_b64_tr_b16 a[80:81], v26 offset:16384
  ds_read_b64_tr_b16 v[96:97], v57 offset:0
  v_mfma_f32_16x16x32_bf16 v[188:191], a[108:111], a[60:63], v[188:191]
  ds_read_b64_tr_b16 a[82:83], v26 offset:17408
  v_mov_b32 v80, 0
  ds_read_b64_tr_b16 v[98:99], v57 offset:1536
  v_mfma_f32_16x16x32_bf16 v[192:195], a[112:115], a[48:51], v[192:195]
  ds_read_b64_tr_b16 v[100:101], v57 offset:32
  v_mfma_f32_16x16x32_bf16 v[196:199], a[112:115], a[52:55], v[196:199]
  ds_read_b64_tr_b16 a[84:85], v27 offset:16384
  ds_read_b64_tr_b16 v[102:103], v57 offset:1568
  ds_read_b64_tr_b16 v[104:105], v57 offset:64
  v_mfma_f32_16x16x32_bf16 v[200:203], a[112:115], a[56:59], v[200:203]
  ds_read_b64_tr_b16 a[86:87], v27 offset:17408
  v_mov_b32 v81, 0
  ds_read_b64_tr_b16 v[106:107], v57 offset:1600
  v_mfma_f32_16x16x32_bf16 v[204:207], a[112:115], a[60:63], v[204:207]
  s_mul_i32 s59, s54, 132096
  v_mfma_f32_16x16x32_bf16 v[208:211], a[116:119], a[48:51], v[208:211]
  ds_read_b64_tr_b16 a[88:89], v28 offset:16384
  s_lshr_b32 s55, s2, 1
  s_lshl_b32 s55, s55, 10
  v_mfma_f32_16x16x32_bf16 v[212:215], a[116:119], a[52:55], v[212:215]
  ds_read_b64_tr_b16 a[90:91], v28 offset:17408
  v_mov_b32 v82, 0
  s_add_u32 s59, s59, s55
  v_mfma_f32_16x16x32_bf16 v[216:219], a[116:119], a[56:59], v[216:219]
  ds_read_b128 a[144:147], v31 offset:0
  s_add_u32 s59, s59, 59379712
  v_mfma_f32_16x16x32_bf16 v[220:223], a[116:119], a[60:63], v[220:223]
  ds_read_b64_tr_b16 a[92:93], v29 offset:16384
  v_mov_b32 v83, 0
  s_mul_i32 s55, s2, 205
  v_mfma_f32_16x16x32_bf16 v[224:227], a[120:123], a[48:51], v[224:227]
  ds_read_b64_tr_b16 a[94:95], v29 offset:17408
  s_lshr_b32 s55, s55, 11
  s_mul_i32 s56, s55, 10
  v_mfma_f32_16x16x32_bf16 v[228:231], a[120:123], a[52:55], v[228:231]
  ds_read_b128 a[148:151], v31 offset:2048
  s_sub_u32 s56, s2, s56
  v_mfma_f32_16x16x32_bf16 v[232:235], a[120:123], a[56:59], v[232:235]
  ds_read_b128 a[152:155], v31 offset:4096
  v_mov_b32 v84, 0
  s_lshl_b32 s56, s56, 2
  v_mfma_f32_16x16x32_bf16 v[236:239], a[120:123], a[60:63], v[236:239]
  ds_read_b128 a[156:159], v31 offset:6144
  s_add_u32 s56, s56, s28
  v_mfma_f32_16x16x32_bf16 v[240:243], a[124:127], a[48:51], v[240:243]
  s_mul_i32 s58, s56, 64512
  s_lshl_b32 s55, s55, 10
  v_mfma_f32_16x16x32_bf16 v[244:247], a[124:127], a[52:55], v[244:247]
  v_mov_b32 v85, 0
  s_add_u32 s58, s58, s55
  v_mfma_f32_16x16x32_bf16 v[248:251], a[124:127], a[56:59], v[248:251]
  s_add_u32 s58, s58, 70070272
  v_mfma_f32_16x16x32_bf16 v[252:255], a[124:127], a[60:63], v[252:255]
  s_cmp_lt_u32 s2, 200
  s_cselect_b32 s58, s58, 82837504
  s_waitcnt lgkmcnt(1)
  v_mfma_f32_16x16x32_bf16 v[128:131], a[64:67], a[128:131], v[128:131]
  s_waitcnt vmcnt(0)
  v_cmp_ne_u64 vcc, s[0:1], v[20:21]
  s_nop 1
  s_cbranch_vccnz LQ_spin
LQ_spin_ret:
  v_mfma_f32_16x16x32_bf16 v[132:135], a[64:67], a[132:135], v[132:135]
  v_mfma_f32_16x16x32_bf16 v[136:139], a[64:67], a[136:139], v[136:139]
  ds_read_b64_tr_b16 a[96:97], v22 offset:24576
  v_mov_b32 v86, 0
  v_mfma_f32_16x16x32_bf16 v[140:143], a[64:67], a[140:143], v[140:143]
  ds_read_b64_tr_b16 a[98:99], v22 offset:25600
  s_and_b32 m0, s53, 0x1ffff
  v_mfma_f32_16x16x32_bf16 v[144:147], a[68:71], a[128:131], v[144:147]
  buffer_load_dwordx4 v16, s[40:43], s53 offen offset:0 sc1 lds
  v_mfma_f32_16x16x32_bf16 v[148:151], a[68:71], a[132:135], v[148:151]
  ds_read_b64_tr_b16 a[100:101], v23 offset:24576
  v_mov_b32 v87, 0
  v_mfma_f32_16x16x32_bf16 v[152:155], a[68:71], a[136:139], v[152:155]
  ds_read_b64_tr_b16 a[102:103], v23 offset:25600
  v_mfma_f32_16x16x32_bf16 v[156:159], a[68:71], a[140:143], v[156:159]
  buffer_load_dwordx4 v16, s[40:43], s53 offen offset:1024 sc1 lds
  v_mfma_f32_16x16x32_bf16 v[160:163], a[72:75], a[128:131], v[160:163]
  ds_read_b64_tr_b16 a[104:105], v24 offset:24576
  v_mov_b32 v88, 0
  v_mfma_f32_16x16x32_bf16 v[164:167], a[72:75], a[132:135], v[164:167]
  ds_read_b64_tr_b16 a[106:107], v24 offset:25600
  v_mfma_f32_16x16x32_bf16 v[168:171], a[72:75], a[136:139], v[168:171]
  v_mfma_f32_16x16x32_bf16 v[172:175], a[72:75], a[140:143], v[172:175]
  ds_read_b64_tr_b16 a[108:109], v25 offset:24576
  v_mov_b32 v89, 0
  v_mfma_f32_16x16x32_bf16 v[176:179], a[76:79], a[128:131], v[176:179]
  ds_read_b64_tr_b16 a[110:111], v25 offset:25600
  v_mfma_f32_16x16x32_bf16 v[180:183], a[76:79], a[132:135], v[180:183]
  v_mfma_f32_16x16x32_bf16 v[184:187], a[76:79], a[136:139], v[184:187]
  ds_read_b64_tr_b16 a[112:113], v26 offset:24576
  v_mov_b32 v90, 0
  v_mfma_f32_16x16x32_bf16 v[188:191], a[76:79], a[140:143], v[188:191]
  ds_read_b64_tr_b16 a[114:115], v26 offset:25600
  s_add_u32 s53, s53, 16384
  buffer_store_dwordx4 v[108:111], v16, s[40:43], s59 offen sc1
  v_mfma_f32_16x16x32_bf16 v[192:195], a[80:83], a[128:131], v[192:195]
  s_and_b32 m0, s53, 0x1ffff
  v_mfma_f32_16x16x32_bf16 v[196:199], a[80:83], a[132:135], v[196:199]
  ds_read_b64_tr_b16 a[116:117], v27 offset:24576
  v_mov_b32 v91, 0
  buffer_load_dwordx4 v16, s[40:43], s53 offen offset:0 sc1 lds
  v_mfma_f32_16x16x32_bf16 v[200:203], a[80:83], a[136:139], v[200:203]
  ds_read_b64_tr_b16 a[118:119], v27 offset:25600
  v_mfma_f32_16x16x32_bf16 v[204:207], a[80:83], a[140:143], v[204:207]
  v_mfma_f32_16x16x32_bf16 v[208:211], a[84:87], a[128:131], v[208:211]
  ds_read_b64_tr_b16 a[120:121], v28 offset:24576
  v_mov_b32 v92, 0
  buffer_load_dwordx4 v16, s[40:43], s53 offen offset:1024 sc1 lds
  v_mfma_f32_16x16x32_bf16 v[212:215], a[84:87], a[132:135], v[212:215]
  ds_read_b64_tr_b16 a[122:123], v28 offset:25600
  v_mfma_f32_16x16x32_bf16 v[216:219], a[84:87], a[136:139], v[216:219]
  v_mfma_f32_16x16x32_bf16 v[220:223], a[84:87], a[140:143], v[220:223]
  ds_read_b64_tr_b16 a[124:125], v29 offset:24576
  v_mov_b32 v93, 0
  v_mfma_f32_16x16x32_bf16 v[224:227], a[88:91], a[128:131], v[224:227]
  ds_read_b64_tr_b16 a[126:127], v29 offset:25600
  v_mfma_f32_16x16x32_bf16 v[228:231], a[88:91], a[132:135], v[228:231]
  v_mfma_f32_16x16x32_bf16 v[232:235], a[88:91], a[136:139], v[232:235]
  v_mov_b32 v94, 0
  v_mfma_f32_16x16x32_bf16 v[236:239], a[88:91], a[140:143], v[236:239]
  s_add_u32 s59, s59, 132096
  v_mfma_f32_16x16x32_bf16 v[240:243], a[92:95], a[128:131], v[240:243]
  s_add_u32 s53, s53, 16384
  buffer_store_dwordx4 v[112:115], v16, s[40:43], s59 offen sc1
  v_mfma_f32_16x16x32_bf16 v[244:247], a[92:95], a[132:135], v[244:247]
  v_mov_b32 v95, 0
  s_add_u32 s59, s59, 132096
  v_mfma_f32_16x16x32_bf16 v[248:251], a[92:95], a[136:139], v[248:251]
  buffer_store_dwordx4 v[116:119], v16, s[40:43], s59 offen sc1
  s_add_u32 s59, s59, 132096
  v_mfma_f32_16x16x32_bf16 v[252:255], a[92:95], a[140:143], v[252:255]
  buffer_store_dwordx4 v[120:123], v16, s[40:43], s59 offen sc1
  s_waitcnt lgkmcnt(0)
  v_mfma_f32_16x16x32_bf16 v[128:131], a[96:99], a[144:147], v[128:131]
  v_mfma_f32_16x16x32_bf16 v[132:135], a[96:99], a[148:151], v[132:135]
  s_waitcnt lgkmcnt(0)
  s_barrier
  v_mfma_f32_16x16x32_bf16 v[136:139], a[96:99], a[152:155], v[136:139]
  v_mfma_f32_16x16x32_bf16 v[140:143], a[96:99], a[156:159], v[140:143]
  s_and_b32 m0, s53, 0x1ffff
  v_mfma_f32_16x16x32_bf16 v[144:147], a[100:103], a[144:147], v[144:147]
  buffer_load_dwordx4 v16, s[40:43], s53 offen offset:0 sc1 lds
  v_mfma_f32_16x16x32_bf16 v[148:151], a[100:103], a[148:151], v[148:151]
  v_mfma_f32_16x16x32_bf16 v[152:155], a[100:103], a[152:155], v[152:155]
  v_mfma_f32_16x16x32_bf16 v[156:159], a[100:103], a[156:159], v[156:159]
  buffer_load_dwordx4 v16, s[40:43], s53 offen offset:1024 sc1 lds
  v_mfma_f32_16x16x32_bf16 v[160:163], a[104:107], a[144:147], v[160:163]
  v_mfma_f32_16x16x32_bf16 v[164:167], a[104:107], a[148:151], v[164:167]
  v_mfma_f32_16x16x32_bf16 v[168:171], a[104:107], a[152:155], v[168:171]
  buffer_load_dwordx4 v16, s[40:43], s53 offen offset:2048 sc1 lds
  v_mfma_f32_16x16x32_bf16 v[172:175], a[104:107], a[156:159], v[172:175]
  v_mfma_f32_16x16x32_bf16 v[176:179], a[108:111], a[144:147], v[176:179]
  v_mfma_f32_16x16x32_bf16 v[180:183], a[108:111], a[148:151], v[180:183]
  buffer_load_dwordx4 v16, s[40:43], s53 offen offset:3072 sc1 lds
  v_mfma_f32_16x16x32_bf16 v[184:187], a[108:111], a[152:155], v[184:187]
  v_mfma_f32_16x16x32_bf16 v[188:191], a[108:111], a[156:159], v[188:191]
  s_add_u32 s53, s53, 16384
  s_add_u32 s59, s59, 132096
  v_mfma_f32_16x16x32_bf16 v[192:195], a[112:115], a[144:147], v[192:195]
  buffer_store_dwordx4 v[124:127], v16, s[40:43], s59 offen sc1
  s_and_b32 m0, s53, 0x1ffff
  v_mfma_f32_16x16x32_bf16 v[196:199], a[112:115], a[148:151], v[196:199]
  buffer_load_dwordx4 v16, s[40:43], s53 offen offset:0 sc1 lds
  v_mfma_f32_16x16x32_bf16 v[200:203], a[112:115], a[152:155], v[200:203]
  v_mfma_f32_16x16x32_bf16 v[204:207], a[112:115], a[156:159], v[204:207]
  v_mfma_f32_16x16x32_bf16 v[208:211], a[116:119], a[144:147], v[208:211]
  buffer_store_dwordx4 v[96:99], v16, s[40:43], s58 offen sc1
  buffer_load_dwordx4 v16, s[40:43], s53 offen offset:1024 sc1 lds
  v_mfma_f32_16x16x32_bf16 v[212:215], a[116:119], a[148:151], v[212:215]
  v_mfma_f32_16x16x32_bf16 v[216:219], a[116:119], a[152:155], v[216:219]
  v_mfma_f32_16x16x32_bf16 v[220:223], a[116:119], a[156:159], v[220:223]
  buffer_load_dwordx4 v16, s[40:43], s53 offen offset:2048 sc1 lds
  s_add_u32 s58, s58, 21504
  v_mfma_f32_16x16x32_bf16 v[224:227], a[120:123], a[144:147], v[224:227]
  buffer_store_dwordx4 v[100:103], v16, s[40:43], s58 offen sc1
  v_mfma_f32_16x16x32_bf16 v[228:231], a[120:123], a[148:151], v[228:231]
  v_mfma_f32_16x16x32_bf16 v[232:235], a[120:123], a[152:155], v[232:235]
  buffer_load_dwordx4 v16, s[40:43], s53 offen offset:3072 sc1 lds
  v_mfma_f32_16x16x32_bf16 v[236:239], a[120:123], a[156:159], v[236:239]
  s_add_u32 s58, s58, 21504
  v_mfma_f32_16x16x32_bf16 v[240:243], a[124:127], a[144:147], v[240:243]
  s_add_u32 s53, s53, 16384
  buffer_store_dwordx4 v[104:107], v16, s[40:43], s58 offen sc1
  v_mfma_f32_16x16x32_bf16 v[244:247], a[124:127], a[148:151], v[244:247]
  v_mfma_f32_16x16x32_bf16 v[248:251], a[124:127], a[152:155], v[248:251]
  v_mfma_f32_16x16x32_bf16 v[252:255], a[124:127], a[156:159], v[252:255]
L_qe:
  v_accvgpr_mov_b32 a132, a0
  v_accvgpr_mov_b32 a133, a1
  v_accvgpr_mov_b32 a134, a2
  v_accvgpr_mov_b32 a135, a3
  v_accvgpr_mov_b32 a136, a4
  v_accvgpr_mov_b32 a137, a5
  v_accvgpr_mov_b32 a138, a6
  v_accvgpr_mov_b32 a139, a7
  v_accvgpr_mov_b32 a140, a8
  v_accvgpr_mov_b32 a141, a9
  v_accvgpr_mov_b32 a142, a10
  v_accvgpr_mov_b32 a143, a11
  v_accvgpr_mov_b32 a144, a12
  v_accvgpr_mov_b32 a145, a13
  v_accvgpr_mov_b32 a146, a14
  v_accvgpr_mov_b32 a147, a15
  v_accvgpr_mov_b32 a148, a16
  v_accvgpr_mov_b32 a149, a17
  v_accvgpr_mov_b32 a150, a18
  v_accvgpr_mov_b32 a151, a19
  v_accvgpr_mov_b32 a152, a20
  v_accvgpr_mov_b32 a153, a21
  v_accvgpr_mov_b32 a154, a22
  v_accvgpr_mov_b32 a155, a23
  v_accvgpr_mov_b32 a156, a24
  v_accvgpr_mov_b32 a157, a25
  v_accvgpr_mov_b32 a158, a26
  v_accvgpr_mov_b32 a159, a27
  s_mov_b32 s58, 1040356334
  s_mov_b32 s59, 1040356334
  s_and_b32 m0, s53, 0x1ffff
  s_nop 0
  buffer_load_dwordx4 v16, s[40:43], s53 offen offset:0 sc1 lds
  buffer_load_dwordx4 v16, s[40:43], s53 offen offset:1024 sc1 lds
  buffer_load_dwordx4 v16, s[40:43], s53 offen offset:2048 sc1 lds
  buffer_load_dwordx4 v16, s[40:43], s53 offen offset:3072 sc1 lds
  s_add_u32 s53, s53, 16384
  v_pk_mul_f32 v[128:129], v[128:129], s[58:59]
  v_pk_mul_f32 v[130:131], v[130:131], s[58:59]
  v_pk_mul_f32 v[144:145], v[144:145], s[58:59]
  v_pk_mul_f32 v[146:147], v[146:147], s[58:59]
  v_cvt_pk_bf16_f32 v128, v128, v129
  v_cvt_pk_bf16_f32 v129, v130, v131
  v_cvt_pk_bf16_f32 v130, v144, v145
  v_cvt_pk_bf16_f32 v131, v146, v147
  v_accvgpr_write_b32 a0, v128
  v_accvgpr_write_b32 a1, v129
  v_accvgpr_write_b32 a2, v130
  v_accvgpr_write_b32 a3, v131
  v_pk_mul_f32 v[160:161], v[160:161], s[58:59]
  v_pk_mul_f32 v[162:163], v[162:163], s[58:59]
  v_pk_mul_f32 v[176:177], v[176:177], s[58:59]
  v_pk_mul_f32 v[178:179], v[178:179], s[58:59]
  v_cvt_pk_bf16_f32 v160, v160, v161
  v_cvt_pk_bf16_f32 v161, v162, v163
  v_cvt_pk_bf16_f32 v162, v176, v177
  v_cvt_pk_bf16_f32 v163, v178, v179
  v_accvgpr_write_b32 a4, v160
  v_accvgpr_write_b32 a5, v161
  v_accvgpr_write_b32 a6, v162
  v_accvgpr_write_b32 a7, v163
  v_pk_mul_f32 v[192:193], v[192:193], s[58:59]
  v_pk_mul_f32 v[194:195], v[194:195], s[58:59]
  v_pk_mul_f32 v[208:209], v[208:209], s[58:59]
  v_pk_mul_f32 v[210:211], v[210:211], s[58:59]
  v_cvt_pk_bf16_f32 v192, v192, v193
  v_cvt_pk_bf16_f32 v193, v194, v195
  v_cvt_pk_bf16_f32 v194, v208, v209
  v_cvt_pk_bf16_f32 v195, v210, v211
  v_accvgpr_write_b32 a8, v192
  v_accvgpr_write_b32 a9, v193
  v_accvgpr_write_b32 a10, v194
  v_accvgpr_write_b32 a11, v195
  v_pk_mul_f32 v[224:225], v[224:225], s[58:59]
  v_pk_mul_f32 v[226:227], v[226:227], s[58:59]
  v_pk_mul_f32 v[240:241], v[240:241], s[58:59]
  v_pk_mul_f32 v[242:243], v[242:243], s[58:59]
  v_cvt_pk_bf16_f32 v224, v224, v225
  v_cvt_pk_bf16_f32 v225, v226, v227
  v_cvt_pk_bf16_f32 v226, v240, v241
  v_cvt_pk_bf16_f32 v227, v242, v243
  v_accvgpr_write_b32 a12, v224
  v_accvgpr_write_b32 a13, v225
  v_accvgpr_write_b32 a14, v226
  v_accvgpr_write_b32 a15, v227
  v_pk_mul_f32 v[132:133], v[132:133], s[58:59]
  v_pk_mul_f32 v[134:135], v[134:135], s[58:59]
  v_pk_mul_f32 v[148:149], v[148:149], s[58:59]
  v_pk_mul_f32 v[150:151], v[150:151], s[58:59]
  v_cvt_pk_bf16_f32 v132, v132, v133
  v_cvt_pk_bf16_f32 v133, v134, v135
  v_cvt_pk_bf16_f32 v134, v148, v149
  v_cvt_pk_bf16_f32 v135, v150, v151
  v_accvgpr_write_b32 a16, v132
  v_accvgpr_write_b32 a17, v133
  v_accvgpr_write_b32 a18, v134
  v_accvgpr_write_b32 a19, v135
  v_pk_mul_f32 v[164:165], v[164:165], s[58:59]
  v_pk_mul_f32 v[166:167], v[166:167], s[58:59]
  v_pk_mul_f32 v[180:181], v[180:181], s[58:59]
  v_pk_mul_f32 v[182:183], v[182:183], s[58:59]
  v_cvt_pk_bf16_f32 v164, v164, v165
  v_cvt_pk_bf16_f32 v165, v166, v167
  v_cvt_pk_bf16_f32 v166, v180, v181
  v_cvt_pk_bf16_f32 v167, v182, v183
  v_accvgpr_write_b32 a20, v164
  v_accvgpr_write_b32 a21, v165
  v_accvgpr_write_b32 a22, v166
  v_accvgpr_write_b32 a23, v167
  v_pk_mul_f32 v[196:197], v[196:197], s[58:59]
  v_pk_mul_f32 v[198:199], v[198:199], s[58:59]
  v_pk_mul_f32 v[212:213], v[212:213], s[58:59]
  v_pk_mul_f32 v[214:215], v[214:215], s[58:59]
  v_cvt_pk_bf16_f32 v196, v196, v197
  v_cvt_pk_bf16_f32 v197, v198, v199
  v_cvt_pk_bf16_f32 v198, v212, v213
  v_cvt_pk_bf16_f32 v199, v214, v215
  v_accvgpr_write_b32 a24, v196
  v_accvgpr_write_b32 a25, v197
  v_accvgpr_write_b32 a26, v198
  v_accvgpr_write_b32 a27, v199
  v_pk_mul_f32 v[228:229], v[228:229], s[58:59]
  v_pk_mul_f32 v[230:231], v[230:231], s[58:59]
  v_pk_mul_f32 v[244:245], v[244:245], s[58:59]
  v_pk_mul_f32 v[246:247], v[246:247], s[58:59]
  v_cvt_pk_bf16_f32 v228, v228, v229
  v_cvt_pk_bf16_f32 v229, v230, v231
  v_cvt_pk_bf16_f32 v230, v244, v245
  v_cvt_pk_bf16_f32 v231, v246, v247
  v_accvgpr_write_b32 a28, v228
  v_accvgpr_write_b32 a29, v229
  v_accvgpr_write_b32 a30, v230
  v_accvgpr_write_b32 a31, v231
  v_pk_mul_f32 v[136:137], v[136:137], s[58:59]
  v_pk_mul_f32 v[138:139], v[138:139], s[58:59]
  v_pk_mul_f32 v[152:153], v[152:153], s[58:59]
  v_pk_mul_f32 v[154:155], v[154:155], s[58:59]
  v_cvt_pk_bf16_f32 v136, v136, v137
  v_cvt_pk_bf16_f32 v137, v138, v139
  v_cvt_pk_bf16_f32 v138, v152, v153
  v_cvt_pk_bf16_f32 v139, v154, v155
  v_accvgpr_write_b32 a32, v136
  v_accvgpr_write_b32 a33, v137
  v_accvgpr_write_b32 a34, v138
  v_accvgpr_write_b32 a35, v139
  v_pk_mul_f32 v[168:169], v[168:169], s[58:59]
  v_pk_mul_f32 v[170:171], v[170:171], s[58:59]
  v_pk_mul_f32 v[184:185], v[184:185], s[58:59]
  v_pk_mul_f32 v[186:187], v[186:187], s[58:59]
  v_cvt_pk_bf16_f32 v168, v168, v169
  v_cvt_pk_bf16_f32 v169, v170, v171
  v_cvt_pk_bf16_f32 v170, v184, v185
  v_cvt_pk_bf16_f32 v171, v186, v187
  v_accvgpr_write_b32 a36, v168
  v_accvgpr_write_b32 a37, v169
  v_accvgpr_write_b32 a38, v170
  v_accvgpr_write_b32 a39, v171
  v_pk_mul_f32 v[200:201], v[200:201], s[58:59]
  v_pk_mul_f32 v[202:203], v[202:203], s[58:59]
  v_pk_mul_f32 v[216:217], v[216:217], s[58:59]
  v_pk_mul_f32 v[218:219], v[218:219], s[58:59]
  v_cvt_pk_bf16_f32 v200, v200, v201
  v_cvt_pk_bf16_f32 v201, v202, v203
  v_cvt_pk_bf16_f32 v202, v216, v217
  v_cvt_pk_bf16_f32 v203, v218, v219
  v_accvgpr_write_b32 a40, v200
  v_accvgpr_write_b32 a41, v201
  v_accvgpr_write_b32 a42, v202
  v_accvgpr_write_b32 a43, v203
  v_pk_mul_f32 v[232:233], v[232:233], s[58:59]
  v_pk_mul_f32 v[234:235], v[234:235], s[58:59]
  v_pk_mul_f32 v[248:249], v[248:249], s[58:59]
  v_pk_mul_f32 v[250:251], v[250:251], s[58:59]
  v_cvt_pk_bf16_f32 v232, v232, v233
  v_cvt_pk_bf16_f32 v233, v234, v235
  v_cvt_pk_bf16_f32 v234, v248, v249
  v_cvt_pk_bf16_f32 v235, v250, v251
  v_accvgpr_write_b32 a44, v232
  v_accvgpr_write_b32 a45, v233
  v_accvgpr_write_b32 a46, v234
  v_accvgpr_write_b32 a47, v235
  v_pk_mul_f32 v[140:141], v[140:141], s[58:59]
  v_pk_mul_f32 v[142:143], v[142:143], s[58:59]
  v_pk_mul_f32 v[156:157], v[156:157], s[58:59]
  v_pk_mul_f32 v[158:159], v[158:159], s[58:59]
  v_cvt_pk_bf16_f32 v140, v140, v141
  v_cvt_pk_bf16_f32 v141, v142, v143
  v_cvt_pk_bf16_f32 v142, v156, v157
  v_cvt_pk_bf16_f32 v143, v158, v159
  v_accvgpr_write_b32 a48, v140
  v_accvgpr_write_b32 a49, v141
  v_accvgpr_write_b32 a50, v142
  v_accvgpr_write_b32 a51, v143
  v_pk_mul_f32 v[172:173], v[172:173], s[58:59]
  v_pk_mul_f32 v[174:175], v[174:175], s[58:59]
  v_pk_mul_f32 v[188:189], v[188:189], s[58:59]
  v_pk_mul_f32 v[190:191], v[190:191], s[58:59]
  v_cvt_pk_bf16_f32 v172, v172, v173
  v_cvt_pk_bf16_f32 v173, v174, v175
  v_cvt_pk_bf16_f32 v174, v188, v189
  v_cvt_pk_bf16_f32 v175, v190, v191
  v_accvgpr_write_b32 a52, v172
  v_accvgpr_write_b32 a53, v173
  v_accvgpr_write_b32 a54, v174
  v_accvgpr_write_b32 a55, v175
  v_pk_mul_f32 v[204:205], v[204:205], s[58:59]
  v_pk_mul_f32 v[206:207], v[206:207], s[58:59]
  v_pk_mul_f32 v[220:221], v[220:221], s[58:59]
  v_pk_mul_f32 v[222:223], v[222:223], s[58:59]
  v_cvt_pk_bf16_f32 v204, v204, v205
  v_cvt_pk_bf16_f32 v205, v206, v207
  v_cvt_pk_bf16_f32 v206, v220, v221
  v_cvt_pk_bf16_f32 v207, v222, v223
  v_accvgpr_write_b32 a56, v204
  v_accvgpr_write_b32 a57, v205
  v_accvgpr_write_b32 a58, v206
  v_accvgpr_write_b32 a59, v207
  v_pk_mul_f32 v[236:237], v[236:237], s[58:59]
  v_pk_mul_f32 v[238:239], v[238:239], s[58:59]
  v_pk_mul_f32 v[252:253], v[252:253], s[58:59]
  v_pk_mul_f32 v[254:255], v[254:255], s[58:59]
  v_cvt_pk_bf16_f32 v236, v236, v237
  v_cvt_pk_bf16_f32 v237, v238, v239
  v_cvt_pk_bf16_f32 v238, v252, v253
  v_cvt_pk_bf16_f32 v239, v254, v255
  v_accvgpr_write_b32 a60, v236
  v_accvgpr_write_b32 a61, v237
  v_accvgpr_write_b32 a62, v238
  v_accvgpr_write_b32 a63, v239
  s_cmp_lg_u32 s30, 0
  s_cbranch_scc1 LA_nob5
  s_and_b32 m0, s53, 0x1ffff
  s_nop 0
  buffer_load_dwordx4 v16, s[40:43], s53 offen offset:0 sc1 lds
  buffer_load_dwordx4 v16, s[40:43], s53 offen offset:1024 sc1 lds
  buffer_load_dwordx4 v16, s[40:43], s53 offen offset:2048 sc1 lds
  buffer_load_dwordx4 v16, s[40:43], s53 offen offset:3072 sc1 lds
  s_add_u32 s53, s53, 16384
LA_nob5:
  s_lshl_b32 s51, s30, 2
  s_add_u32 s50, s51, s28
  v_lshlrev_b32 v4, 4, v1
  v_lshrrev_b32 v2, 4, v1
  v_lshlrev_b32 v2, 2, v2
  v_and_b32 v3, 15, v1
  v_mov_b32 v255, 0xf149f2ca
  v_mov_b32 v5, v4
  v_mov_b32 v6, 0x3f803f80
  v_add_u32 v7, 0, v2
  v_cmp_gt_u32 s[92:93], v7, v3
  v_accvgpr_write_b32 a128, v6
  v_add_u32 v7, 1, v2
  v_cmp_gt_u32 s[94:95], v7, v3
  v_accvgpr_write_b32 a129, v6
  v_add_u32 v7, 2, v2
  v_cmp_gt_u32 s[96:97], v7, v3
  v_accvgpr_write_b32 a130, v6
  v_add_u32 v7, 3, v2
  v_cmp_gt_u32 s[98:99], v7, v3
  v_accvgpr_write_b32 a131, v6
  v_mov_b32 v208, 0
  v_mov_b32 v209, 0
  v_mov_b32 v210, 0
  v_mov_b32 v211, 0
  v_mov_b32 v212, 0
  v_mov_b32 v213, 0
  v_mov_b32 v214, 0
  v_mov_b32 v215, 0
  v_mov_b32 v216, 0
  v_mov_b32 v217, 0
  v_mov_b32 v218, 0
  v_mov_b32 v219, 0
  v_mov_b32 v220, 0
  v_mov_b32 v221, 0
  v_mov_b32 v222, 0
  v_mov_b32 v223, 0
  v_mov_b32 v6, 0
  s_cmp_lg_u32 s50, 0
  s_cbranch_scc1 LA_nomask0
  v_cndmask_b32 v208, v6, v255, s[92:93]
  v_cndmask_b32 v220, v6, v255, s[92:93]
  v_mov_b32 v212, v255
  v_cndmask_b32 v209, v6, v255, s[94:95]
  v_cndmask_b32 v221, v6, v255, s[94:95]
  v_mov_b32 v213, v255
  v_cndmask_b32 v210, v6, v255, s[96:97]
  v_cndmask_b32 v222, v6, v255, s[96:97]
  v_mov_b32 v214, v255
  v_cndmask_b32 v211, v6, v255, s[98:99]
  v_cndmask_b32 v223, v6, v255, s[98:99]
  v_mov_b32 v215, v255
LA_nomask0:
  v_accvgpr_read_b32 v12, a228
  s_mov_b32 s44, s16
  s_mov_b32 s45, s17
  s_mov_b32 s46, 2621440
  s_mov_b32 s47, 0x20000
  s_lshl_b32 s55, s100, 6
  s_and_b32 s54, s31, 3
  s_lshl_b32 s54, s54, 2
  s_add_u32 s54, s54, s28
  s_mul_i32 s54, s54, 5
  s_add_u32 s55, s55, s54
  s_max_u32 s55, s55, 16
  s_sub_u32 s55, s55, 16
  s_mul_i32 s57, s55, 1280
  s_mov_b32 s38, 896
  s_lshl_b64 s[36:37], 7, s50
  s_lshl_b64 s[54:55], 1, s51
  s_or_b64 s[36:37], s[36:37], s[54:55]
  s_lshr_b64 s[36:37], s[36:37], 1
  s_lshl_b64 s[54:55], 32, s51
  s_or_b32 s36, s36, s54
  s_or_b32 s36, s36, 3221225472
  s_mov_b32 s54, 49280
  s_cmp_lt_u32 s30, 3
  s_cselect_b32 s54, 768, s54
  s_or_b32 s36, s36, s54
  s_or_b32 s37, s37, 1
  s_waitcnt vmcnt(18)
  s_barrier
  ds_read_b128 a[64:67], v5 offset:0
  ds_read_b128 a[68:71], v5 offset:1024
  ds_read_b128 a[72:75], v5 offset:4096
  ds_read_b128 a[76:79], v5 offset:5120
  ds_read_b128 a[80:83], v5 offset:8192
  ds_read_b128 a[84:87], v5 offset:9216
  ds_read_b128 a[88:91], v5 offset:12288
  ds_read_b128 a[92:95], v5 offset:13312
  v_accvgpr_read_b32 v11, a227
  s_nop 0
  ds_write_b64 v11, v[60:61]
  ds_write_b64 v11, v[62:63] offset:512
  s_mul_i32 s55, s2, 205
  s_lshr_b32 s55, s55, 11
  s_mul_i32 s56, s55, 10
  s_sub_u32 s56, s2, s56
  s_lshl_b32 s56, s56, 2
  s_add_u32 s56, s56, s28
  s_waitcnt lgkmcnt(0)
  ds_read_b64_tr_b16 v[60:61], v11
  ds_read_b64_tr_b16 v[62:63], v11 offset:512
  s_mul_i32 s58, s56, 21504
  s_lshl_b32 s55, s55, 10
  s_add_u32 s58, s58, s55
  s_add_u32 s58, s58, 69206016
  s_cmp_lt_u32 s2, 200
  s_cselect_b32 s58, s58, 82837504
  s_waitcnt lgkmcnt(0)
  buffer_store_dwordx4 v[60:63], v4, s[40:43], s58 offen sc1
  s_waitcnt vmcnt(9)
  s_barrier
  s_waitcnt lgkmcnt(0)
  v_mfma_f32_16x16x32_bf16 v[160:163], a[64:67], a[0:3], v[208:211]
  v_mov_b32 v16, 0
  v_mov_b32 v17, 0
  v_mfma_f32_16x16x32_bf16 v[160:163], a[68:71], a[4:7], v[160:163]
  v_mov_b32 v18, 0
  v_mov_b32 v19, 0
  v_mfma_f32_16x16x32_bf16 v[160:163], a[72:75], a[8:11], v[160:163]
  v_mov_b32 v20, 0
  v_mov_b32 v21, 0
  v_mfma_f32_16x16x32_bf16 v[160:163], a[76:79], a[12:15], v[160:163]
  v_mov_b32 v22, 0
  v_mov_b32 v23, 0
  v_mfma_f32_16x16x32_bf16 v[168:171], a[64:67], a[16:19], v[216:219]
  v_mov_b32 v24, 0
  v_mov_b32 v25, 0
  v_mfma_f32_16x16x32_bf16 v[168:171], a[68:71], a[20:23], v[168:171]
  v_mov_b32 v26, 0
  v_mov_b32 v27, 0
  v_mfma_f32_16x16x32_bf16 v[168:171], a[72:75], a[24:27], v[168:171]
  v_mov_b32 v28, 0
  v_mov_b32 v29, 0
  v_mfma_f32_16x16x32_bf16 v[168:171], a[76:79], a[28:31], v[168:171]
  v_mov_b32 v30, 0
  v_mov_b32 v31, 0
  v_mfma_f32_16x16x32_bf16 v[164:167], a[80:83], a[0:3], v[212:215]
  v_mov_b32 v128, 0
  v_mov_b32 v129, 0
  v_mfma_f32_16x16x32_bf16 v[164:167], a[84:87], a[4:7], v[164:167]
  v_mov_b32 v130, 0
  v_mov_b32 v131, 0
  v_mfma_f32_16x16x32_bf16 v[164:167], a[88:91], a[8:11], v[164:167]
  v_mov_b32 v132, 0
  v_mov_b32 v133, 0
  v_mfma_f32_16x16x32_bf16 v[164:167], a[92:95], a[12:15], v[164:167]
  v_mov_b32 v134, 0
  v_mov_b32 v135, 0
  v_mfma_f32_16x16x32_bf16 v[172:175], a[80:83], a[16:19], v[220:223]
  v_mov_b32 v136, 0
  v_mov_b32 v137, 0
  v_mfma_f32_16x16x32_bf16 v[172:175], a[84:87], a[20:23], v[172:175]
  v_mov_b32 v138, 0
  v_mov_b32 v139, 0
  v_mfma_f32_16x16x32_bf16 v[172:175], a[88:91], a[24:27], v[172:175]
  v_mov_b32 v140, 0
  v_mov_b32 v141, 0
  v_mfma_f32_16x16x32_bf16 v[172:175], a[92:95], a[28:31], v[172:175]
  v_mov_b32 v142, 0
  v_mov_b32 v143, 0
  v_mfma_f32_16x16x32_bf16 v[176:179], a[64:67], a[32:35], 0
  v_mov_b32 v144, 0
  v_mov_b32 v145, 0
  v_mfma_f32_16x16x32_bf16 v[176:179], a[68:71], a[36:39], v[176:179]
  v_mov_b32 v146, 0
  v_mov_b32 v147, 0
  v_mfma_f32_16x16x32_bf16 v[176:179], a[72:75], a[40:43], v[176:179]
  v_mov_b32 v148, 0
  v_mov_b32 v149, 0
  v_mfma_f32_16x16x32_bf16 v[176:179], a[76:79], a[44:47], v[176:179]
  v_mov_b32 v150, 0
  v_mov_b32 v151, 0
  v_mfma_f32_16x16x32_bf16 v[184:187], a[64:67], a[48:51], 0
  v_mov_b32 v152, 0
  v_mov_b32 v153, 0
  v_mfma_f32_16x16x32_bf16 v[184:187], a[68:71], a[52:55], v[184:187]
  v_mov_b32 v154, 0
  v_mov_b32 v155, 0
  v_mfma_f32_16x16x32_bf16 v[184:187], a[72:75], a[56:59], v[184:187]
  v_max3_f32 v240, v160, v161, v162
  v_max3_f32 v241, v163, v164, v165
  v_max3_f32 v240, v240, v166, v167
  v_mfma_f32_16x16x32_bf16 v[184:187], a[76:79], a[60:63], v[184:187]
  v_max_f32 v240, v240, v241
  v_mov_b32 v241, v240
  v_mfma_f32_16x16x32_bf16 v[180:183], a[80:83], a[32:35], 0
  v_max3_f32 v242, v168, v169, v170
  v_max3_f32 v243, v171, v172, v173
  v_max3_f32 v242, v242, v174, v175
  v_mfma_f32_16x16x32_bf16 v[180:183], a[84:87], a[36:39], v[180:183]
  v_max_f32 v242, v242, v243
  v_mov_b32 v243, v242
  v_mfma_f32_16x16x32_bf16 v[180:183], a[88:91], a[40:43], v[180:183]
  s_nop 0
  v_permlane32_swap_b32 v240, v241
  v_mfma_f32_16x16x32_bf16 v[180:183], a[92:95], a[44:47], v[180:183]
  v_permlane32_swap_b32 v242, v243
  v_max_f32 v240, v240, v241
  v_mov_b32 v241, v240
  v_mfma_f32_16x16x32_bf16 v[188:191], a[80:83], a[48:51], 0
  v_max_f32 v242, v242, v243
  v_mov_b32 v243, v242
  v_mfma_f32_16x16x32_bf16 v[188:191], a[84:87], a[52:55], v[188:191]
  s_nop 0
  v_permlane16_swap_b32 v240, v241
  v_permlane16_swap_b32 v242, v243
  v_mfma_f32_16x16x32_bf16 v[188:191], a[88:91], a[56:59], v[188:191]
  v_max_f32 v240, v240, v241
  v_sub_f32 v240, 0, v240
  v_mfma_f32_16x16x32_bf16 v[188:191], a[92:95], a[60:63], v[188:191]
  v_max_f32 v242, v242, v243
  v_sub_f32 v242, 0, v242
  v_add_u32 v5, 0x4000, v5
  v_and_b32 v5, 0x1ffff, v5
  ds_read_b128 a[64:67], v5 offset:0
  ds_read_b128 a[68:71], v5 offset:1024
  ds_read_b128 a[72:75], v5 offset:4096
  ds_read_b128 a[76:79], v5 offset:5120
  ds_read_b128 a[80:83], v5 offset:8192
  ds_read_b128 a[84:87], v5 offset:9216
  ds_read_b128 a[88:91], v5 offset:12288
  ds_read_b128 a[92:95], v5 offset:13312
  v_add_u32 v5, 0x4000, v5
  v_and_b32 v5, 0x1ffff, v5
  ds_read_b128 a[96:99], v5 offset:2048
  ds_read_b128 a[100:103], v5 offset:3072
  ds_read_b128 a[104:107], v5 offset:6144
  ds_read_b128 a[108:111], v5 offset:7168
  ds_read_b128 a[112:115], v5 offset:10240
  ds_read_b128 a[116:119], v5 offset:11264
  ds_read_b128 a[120:123], v5 offset:14336
  ds_read_b128 a[124:127], v5 offset:15360
  v_add_f32 v160, v160, v240
  v_add_f32 v161, v161, v240
  v_add_f32 v162, v162, v240
  v_add_f32 v163, v163, v240
  v_add_f32 v164, v164, v240
  v_add_f32 v165, v165, v240
  v_add_f32 v166, v166, v240
  v_add_f32 v167, v167, v240
  v_add_f32 v168, v168, v242
  v_add_f32 v169, v169, v242
  v_add_f32 v170, v170, v242
  v_add_f32 v171, v171, v242
  v_add_f32 v172, v172, v242
  v_add_f32 v173, v173, v242
  v_add_f32 v174, v174, v242
  v_add_f32 v175, v175, v242
  v_exp_f32 v160, v160
  v_max3_f32 v244, v176, v177, v178
  v_max3_f32 v245, v179, v180, v181
  v_exp_f32 v161, v161
  v_max3_f32 v244, v244, v182, v183
  v_max_f32 v244, v244, v245
  v_exp_f32 v162, v162
  v_mov_b32 v245, v244
  v_max3_f32 v246, v184, v185, v186
  v_exp_f32 v163, v163
  v_max3_f32 v247, v187, v188, v189
  v_max3_f32 v246, v246, v190, v191
  v_exp_f32 v168, v168
  v_max_f32 v246, v246, v247
  v_mov_b32 v247, v246
  v_exp_f32 v169, v169
  s_nop 0
  v_permlane32_swap_b32 v244, v245
  v_exp_f32 v170, v170
  v_permlane32_swap_b32 v246, v247
  v_max_f32 v244, v244, v245
  v_exp_f32 v171, v171
  v_mov_b32 v245, v244
  v_max_f32 v246, v246, v247
  v_exp_f32 v164, v164
  v_mov_b32 v247, v246
  s_nop 0
  v_exp_f32 v165, v165
  v_permlane16_swap_b32 v244, v245
  v_permlane16_swap_b32 v246, v247
  v_exp_f32 v166, v166
  v_max_f32 v244, v244, v245
  v_sub_f32 v244, 0, v244
  v_exp_f32 v167, v167
  v_max_f32 v246, v246, v247
  v_sub_f32 v246, 0, v246
  v_exp_f32 v172, v172
  v_exp_f32 v173, v173
  v_exp_f32 v174, v174
  v_exp_f32 v175, v175
  v_cvt_pk_bf16_f32 v192, v160, v161
  v_cvt_pk_bf16_f32 v193, v162, v163
  v_cvt_pk_bf16_f32 v196, v168, v169
  v_cvt_pk_bf16_f32 v197, v170, v171
  v_cvt_pk_bf16_f32 v194, v164, v165
  v_cvt_pk_bf16_f32 v195, v166, v167
  v_cvt_pk_bf16_f32 v198, v172, v173
  v_cvt_pk_bf16_f32 v199, v174, v175
  v_mov_b32 v156, 0
  v_mov_b32 v157, 0
  v_mov_b32 v158, 0
  v_mov_b32 v159, 0
  v_mov_b32 v32, 0
  v_mov_b32 v33, 0
  v_mov_b32 v34, 0
  v_mov_b32 v35, 0
  v_mov_b32 v36, 0
  v_mov_b32 v37, 0
  v_mov_b32 v38, 0
  v_mov_b32 v39, 0
  v_mov_b32 v40, 0
  v_mov_b32 v41, 0
  v_mov_b32 v42, 0
  v_mov_b32 v43, 0
  v_mov_b32 v44, 0
  v_mov_b32 v45, 0
  v_mov_b32 v46, 0
  v_mov_b32 v47, 0
  v_mov_b32 v48, 0
  v_mov_b32 v49, 0
  v_mov_b32 v50, 0
  v_mov_b32 v51, 0
  v_mov_b32 v52, 0
  v_mov_b32 v53, 0
  v_mov_b32 v54, 0
  v_mov_b32 v55, 0
  v_mov_b32 v56, 0
  v_mov_b32 v57, 0
  v_mov_b32 v58, 0
  v_mov_b32 v59, 0
  v_mov_b32 v60, 0
  v_mov_b32 v61, 0
  v_mov_b32 v62, 0
  v_mov_b32 v63, 0
  v_mov_b32 v96, 0
  v_mov_b32 v97, 0
  v_mov_b32 v98, 0
  v_mov_b32 v99, 0
  v_mov_b32 v100, 0
  v_mov_b32 v101, 0
  v_mov_b32 v102, 0
  v_mov_b32 v103, 0
  v_mov_b32 v104, 0
  v_mov_b32 v105, 0
  v_mov_b32 v106, 0
  v_mov_b32 v107, 0
  v_mov_b32 v108, 0
  v_mov_b32 v109, 0
  v_mov_b32 v110, 0
  v_mov_b32 v111, 0
  v_mov_b32 v112, 0
  v_mov_b32 v113, 0
  v_mov_b32 v114, 0
  v_mov_b32 v115, 0
  v_mov_b32 v116, 0
  v_mov_b32 v117, 0
  v_mov_b32 v118, 0
  v_mov_b32 v119, 0
  v_mov_b32 v120, 0
  v_mov_b32 v121, 0
  v_mov_b32 v122, 0
  v_mov_b32 v123, 0
  v_mov_b32 v124, 0
  v_mov_b32 v125, 0
  v_mov_b32 v126, 0
  v_mov_b32 v127, 0
  v_add_f32 v176, v176, v244
  v_mov_b32 v224, v244
  v_mov_b32 v208, v240
  v_add_f32 v177, v177, v244
  v_mov_b32 v225, v244
  v_mov_b32 v209, v240
  v_add_f32 v178, v178, v244
  v_mov_b32 v226, v244
  v_mov_b32 v210, v240
  v_add_f32 v179, v179, v244
  v_mov_b32 v227, v244
  v_mov_b32 v211, v240
  v_add_f32 v180, v180, v244
  v_mov_b32 v228, v244
  v_mov_b32 v212, v240
  v_add_f32 v181, v181, v244
  v_mov_b32 v229, v244
  v_mov_b32 v213, v240
  v_add_f32 v182, v182, v244
  v_mov_b32 v230, v244
  v_mov_b32 v214, v240
  v_add_f32 v183, v183, v244
  v_mov_b32 v231, v244
  v_mov_b32 v215, v240
  v_add_f32 v184, v184, v246
  v_mov_b32 v232, v246
  v_mov_b32 v216, v242
  v_add_f32 v185, v185, v246
  v_mov_b32 v233, v246
  v_mov_b32 v217, v242
  v_add_f32 v186, v186, v246
  v_mov_b32 v234, v246
  v_mov_b32 v218, v242
  v_add_f32 v187, v187, v246
  v_mov_b32 v235, v246
  v_mov_b32 v219, v242
  v_add_f32 v188, v188, v246
  v_mov_b32 v236, v246
  v_mov_b32 v220, v242
  v_add_f32 v189, v189, v246
  v_mov_b32 v237, v246
  v_mov_b32 v221, v242
  v_add_f32 v190, v190, v246
  v_mov_b32 v238, v246
  v_mov_b32 v222, v242
  v_add_f32 v191, v191, v246
  v_mov_b32 v239, v246
  v_mov_b32 v223, v242
  s_mov_b32 s48, 0
  s_mov_b32 s89, 0
  s_waitcnt vmcnt(2) lgkmcnt(0)
  s_barrier
LA_H:
  s_cmp_eq_u32 s48, 32
  s_cbranch_scc1 LA_fin
  s_add_u32 s54, s48, 1
  s_lshr_b64 s[58:59], s[36:37], s54
  s_ff1_i32_b64 s49, s[58:59]
  s_add_u32 s49, s49, s54
  s_cmp_eq_u32 s54, s50
  s_cbranch_scc1 LA_e1
LA_e1r:
  s_sub_u32 s54, s48, 5
  s_cmp_eq_u32 s54, s51
  s_cbranch_scc1 LA_fa
LA_far:
  s_mov_b32 s54, 3221275520
  s_bitcmp1_b32 s54, s48
  s_cbranch_scc1 LA_act
LA_sel:
  s_cmp_eq_u32 s48, 0
  s_cbranch_scc1 LA_sel00
LA_selr:
  s_cmp_ge_u32 s48, 30
  s_cbranch_scc1 LA_sel0
  s_cmp_gt_u32 s48, s50
  s_cbranch_scc1 LA_O2
  s_cmp_eq_u32 s48, s50
  s_cbranch_scc1 LA_T2
  s_add_u32 s54, s48, 2
  s_cmp_gt_u32 s54, s51
  s_cbranch_scc1 LA_S2
  s_branch LA_S1
LA_sel00:
  s_cmp_lt_u32 s30, 3
  s_cbranch_scc1 LA_selr
  s_branch LA_SK
LA_sel0:
  s_cmp_gt_u32 s48, s50
  s_cbranch_scc1 LA_O0
  s_cmp_eq_u32 s48, s50
  s_cbranch_scc1 LA_T0
  s_branch LA_S0
.p2align 6
LA_S1:
  v_mfma_f32_16x16x32_bf16 v[160:163], a[64:67], a[0:3], v[208:211]
  v_exp_f32 v176, v176
  v_mfma_f32_16x16x32_bf16 v[160:163], a[68:71], a[4:7], v[160:163]
  v_mfma_f32_16x16x32_bf16 v[160:163], a[72:75], a[8:11], v[160:163]
  v_exp_f32 v177, v177
  v_mfma_f32_16x16x32_bf16 v[160:163], a[76:79], a[12:15], v[160:163]
  v_mfma_f32_16x16x32_bf16 v[168:171], a[64:67], a[16:19], v[216:219]
  v_exp_f32 v178, v178
  v_mfma_f32_16x16x32_bf16 v[168:171], a[68:71], a[20:23], v[168:171]
  v_cvt_pk_bf16_f32 v200, v176, v177
  v_mfma_f32_16x16x32_bf16 v[168:171], a[72:75], a[24:27], v[168:171]
  v_exp_f32 v179, v179
  v_mfma_f32_16x16x32_bf16 v[168:171], a[76:79], a[28:31], v[168:171]
  v_mfma_f32_16x16x32_bf16 v[164:167], a[80:83], a[0:3], v[212:215]
  v_exp_f32 v184, v184
  v_mfma_f32_16x16x32_bf16 v[164:167], a[84:87], a[4:7], v[164:167]
  v_cvt_pk_bf16_f32 v201, v178, v179
  v_mfma_f32_16x16x32_bf16 v[164:167], a[88:91], a[8:11], v[164:167]
  v_exp_f32 v185, v185
  v_mfma_f32_16x16x32_bf16 v[164:167], a[92:95], a[12:15], v[164:167]
  v_mfma_f32_16x16x32_bf16 v[172:175], a[80:83], a[16:19], v[220:223]
  v_exp_f32 v186, v186
  s_and_b32 m0, s53, 0x1ffff
  v_mfma_f32_16x16x32_bf16 v[172:175], a[84:87], a[20:23], v[172:175]
  v_cvt_pk_bf16_f32 v204, v184, v185
  v_mfma_f32_16x16x32_bf16 v[172:175], a[88:91], a[24:27], v[172:175]
  v_exp_f32 v187, v187
  v_mfma_f32_16x16x32_bf16 v[172:175], a[92:95], a[28:31], v[172:175]
  buffer_load_dwordx4 v4, s[40:43], s53 offen offset:0 sc1 lds
  s_waitcnt lgkmcnt(0)
  v_mfma_f32_16x16x32_bf16 v[16:19], a[96:99], v[192:195], v[16:19]
  v_exp_f32 v180, v180
  v_mfma_f32_16x16x32_bf16 v[48:51], a[96:99], v[196:199], v[48:51]
  v_cvt_pk_bf16_f32 v205, v186, v187
  v_mfma_f32_16x16x32_bf16 v[20:23], a[100:103], v[192:195], v[20:23]
  v_exp_f32 v181, v181
  v_mfma_f32_16x16x32_bf16 v[52:55], a[100:103], v[196:199], v[52:55]
  buffer_load_dwordx4 v4, s[40:43], s53 offen offset:1024 sc1 lds
  v_mfma_f32_16x16x32_bf16 v[24:27], a[104:107], v[192:195], v[24:27]
  v_exp_f32 v182, v182
  v_mfma_f32_16x16x32_bf16 v[56:59], a[104:107], v[196:199], v[56:59]
  v_cvt_pk_bf16_f32 v202, v180, v181
  v_mfma_f32_16x16x32_bf16 v[28:31], a[108:111], v[192:195], v[28:31]
  v_exp_f32 v183, v183
  v_mfma_f32_16x16x32_bf16 v[60:63], a[108:111], v[196:199], v[60:63]
  buffer_load_dwordx4 v4, s[40:43], s53 offen offset:2048 sc1 lds
  v_mfma_f32_16x16x32_bf16 v[32:35], a[112:115], v[192:195], v[32:35]
  v_exp_f32 v188, v188
  v_mfma_f32_16x16x32_bf16 v[64:67], a[112:115], v[196:199], v[64:67]
  v_cvt_pk_bf16_f32 v203, v182, v183
  v_mfma_f32_16x16x32_bf16 v[36:39], a[116:119], v[192:195], v[36:39]
  v_exp_f32 v189, v189
  v_mfma_f32_16x16x32_bf16 v[68:71], a[116:119], v[196:199], v[68:71]
  buffer_load_dwordx4 v4, s[40:43], s53 offen offset:3072 sc1 lds
  v_mfma_f32_16x16x32_bf16 v[40:43], a[120:123], v[192:195], v[40:43]
  v_exp_f32 v190, v190
  v_mfma_f32_16x16x32_bf16 v[72:75], a[120:123], v[196:199], v[72:75]
  v_cvt_pk_bf16_f32 v206, v188, v189
  v_mfma_f32_16x16x32_bf16 v[44:47], a[124:127], v[192:195], v[44:47]
  v_exp_f32 v191, v191
  v_mfma_f32_16x16x32_bf16 v[76:79], a[124:127], v[196:199], v[76:79]
  v_mfma_f32_16x16x32_bf16 v[144:147], a[128:131], v[192:195], v[144:147]
  s_add_u32 s53, s53, 16384
  v_mfma_f32_16x16x32_bf16 v[148:151], a[128:131], v[196:199], v[148:151]
  v_cvt_pk_bf16_f32 v207, v190, v191
  s_add_u32 s48, s48, 1
  v_mfma_f32_16x16x32_bf16 v[176:179], a[64:67], a[32:35], v[224:227]
  v_exp_f32 v160, v160
  v_mfma_f32_16x16x32_bf16 v[176:179], a[68:71], a[36:39], v[176:179]
  v_mfma_f32_16x16x32_bf16 v[176:179], a[72:75], a[40:43], v[176:179]
  v_exp_f32 v161, v161
  v_mfma_f32_16x16x32_bf16 v[176:179], a[76:79], a[44:47], v[176:179]
  v_mfma_f32_16x16x32_bf16 v[184:187], a[64:67], a[48:51], v[232:235]
  v_exp_f32 v162, v162
  v_mfma_f32_16x16x32_bf16 v[184:187], a[68:71], a[52:55], v[184:187]
  ds_read_b128 a[64:67], v5 offset:0
  v_cvt_pk_bf16_f32 v192, v160, v161
  v_mfma_f32_16x16x32_bf16 v[184:187], a[72:75], a[56:59], v[184:187]
  v_exp_f32 v163, v163
  v_mfma_f32_16x16x32_bf16 v[184:187], a[76:79], a[60:63], v[184:187]
  ds_read_b128 a[68:71], v5 offset:1024
  ds_read_b128 a[72:75], v5 offset:4096
  v_mfma_f32_16x16x32_bf16 v[180:183], a[80:83], a[32:35], v[228:231]
  v_exp_f32 v168, v168
  v_mfma_f32_16x16x32_bf16 v[180:183], a[84:87], a[36:39], v[180:183]
  ds_read_b128 a[76:79], v5 offset:5120
  v_cvt_pk_bf16_f32 v193, v162, v163
  v_mfma_f32_16x16x32_bf16 v[180:183], a[88:91], a[40:43], v[180:183]
  v_exp_f32 v169, v169
  v_mfma_f32_16x16x32_bf16 v[180:183], a[92:95], a[44:47], v[180:183]
  s_waitcnt vmcnt(4) lgkmcnt(4)
  s_barrier
  v_mfma_f32_16x16x32_bf16 v[188:191], a[80:83], a[48:51], v[236:239]
  v_exp_f32 v170, v170
  v_mfma_f32_16x16x32_bf16 v[188:191], a[84:87], a[52:55], v[188:191]
  ds_read_b128 a[80:83], v5 offset:8192
  v_cvt_pk_bf16_f32 v196, v168, v169
  v_mfma_f32_16x16x32_bf16 v[188:191], a[88:91], a[56:59], v[188:191]
  v_exp_f32 v171, v171
  v_mfma_f32_16x16x32_bf16 v[188:191], a[92:95], a[60:63], v[188:191]
  ds_read_b128 a[84:87], v5 offset:9216
  ds_read_b128 a[88:91], v5 offset:12288
  v_mfma_f32_16x16x32_bf16 v[80:83], a[96:99], v[200:203], v[80:83]
  v_exp_f32 v164, v164
  v_mfma_f32_16x16x32_bf16 v[112:115], a[96:99], v[204:207], v[112:115]
  ds_read_b128 a[92:95], v5 offset:13312
  v_add_u32 v5, 0x4000, v5
  v_cvt_pk_bf16_f32 v197, v170, v171
  v_mfma_f32_16x16x32_bf16 v[84:87], a[100:103], v[200:203], v[84:87]
  v_exp_f32 v165, v165
  v_mfma_f32_16x16x32_bf16 v[116:119], a[100:103], v[204:207], v[116:119]
  v_and_b32 v5, 0x1ffff, v5
  ds_read_b128 a[96:99], v5 offset:2048
  v_mfma_f32_16x16x32_bf16 v[88:91], a[104:107], v[200:203], v[88:91]
  v_exp_f32 v166, v166
  v_mfma_f32_16x16x32_bf16 v[120:123], a[104:107], v[204:207], v[120:123]
  ds_read_b128 a[100:103], v5 offset:3072
  v_cvt_pk_bf16_f32 v194, v164, v165
  v_mfma_f32_16x16x32_bf16 v[92:95], a[108:111], v[200:203], v[92:95]
  v_exp_f32 v167, v167
  v_mfma_f32_16x16x32_bf16 v[124:127], a[108:111], v[204:207], v[124:127]
  ds_read_b128 a[104:107], v5 offset:6144
  v_mfma_f32_16x16x32_bf16 v[96:99], a[112:115], v[200:203], v[96:99]
  v_exp_f32 v172, v172
  v_mfma_f32_16x16x32_bf16 v[128:131], a[112:115], v[204:207], v[128:131]
  ds_read_b128 a[108:111], v5 offset:7168
  v_cvt_pk_bf16_f32 v195, v166, v167
  v_mfma_f32_16x16x32_bf16 v[100:103], a[116:119], v[200:203], v[100:103]
  v_exp_f32 v173, v173
  v_mfma_f32_16x16x32_bf16 v[132:135], a[116:119], v[204:207], v[132:135]
  ds_read_b128 a[112:115], v5 offset:10240
  v_mfma_f32_16x16x32_bf16 v[104:107], a[120:123], v[200:203], v[104:107]
  v_exp_f32 v174, v174
  v_mfma_f32_16x16x32_bf16 v[136:139], a[120:123], v[204:207], v[136:139]
  ds_read_b128 a[116:119], v5 offset:11264
  v_cvt_pk_bf16_f32 v198, v172, v173
  v_mfma_f32_16x16x32_bf16 v[108:111], a[124:127], v[200:203], v[108:111]
  v_exp_f32 v175, v175
  v_mfma_f32_16x16x32_bf16 v[140:143], a[124:127], v[204:207], v[140:143]
  ds_read_b128 a[120:123], v5 offset:14336
  v_mfma_f32_16x16x32_bf16 v[152:155], a[128:131], v[200:203], v[152:155]
  ds_read_b128 a[124:127], v5 offset:15360
  s_cmp_lg_u32 s48, s49
  v_mfma_f32_16x16x32_bf16 v[156:159], a[128:131], v[204:207], v[156:159]
  v_cvt_pk_bf16_f32 v199, v174, v175
  s_waitcnt lgkmcnt(8)
  s_cbranch_scc1 LA_S1
  s_branch LA_H
.p2align 6
LA_S2:
  v_mfma_f32_16x16x32_bf16 v[160:163], a[64:67], a[0:3], v[208:211]
  v_exp_f32 v176, v176
  v_mfma_f32_16x16x32_bf16 v[160:163], a[68:71], a[4:7], v[160:163]
  v_mfma_f32_16x16x32_bf16 v[160:163], a[72:75], a[8:11], v[160:163]
  v_exp_f32 v177, v177
  v_mfma_f32_16x16x32_bf16 v[160:163], a[76:79], a[12:15], v[160:163]
  v_mfma_f32_16x16x32_bf16 v[168:171], a[64:67], a[16:19], v[216:219]
  v_exp_f32 v178, v178
  v_mfma_f32_16x16x32_bf16 v[168:171], a[68:71], a[20:23], v[168:171]
  v_cvt_pk_bf16_f32 v200, v176, v177
  v_mfma_f32_16x16x32_bf16 v[168:171], a[72:75], a[24:27], v[168:171]
  v_exp_f32 v179, v179
  v_mfma_f32_16x16x32_bf16 v[168:171], a[76:79], a[28:31], v[168:171]
  v_mfma_f32_16x16x32_bf16 v[164:167], a[80:83], a[0:3], v[212:215]
  v_exp_f32 v184, v184
  v_mfma_f32_16x16x32_bf16 v[164:167], a[84:87], a[4:7], v[164:167]
  v_cvt_pk_bf16_f32 v201, v178, v179
  v_mfma_f32_16x16x32_bf16 v[164:167], a[88:91], a[8:11], v[164:167]
  v_exp_f32 v185, v185
  v_mfma_f32_16x16x32_bf16 v[164:167], a[92:95], a[12:15], v[164:167]
  s_waitcnt vmcnt(4) lgkmcnt(0)
  s_barrier
  v_mfma_f32_16x16x32_bf16 v[172:175], a[80:83], a[16:19], v[220:223]
  v_exp_f32 v186, v186
  s_and_b32 m0, s53, 0x1ffff
  v_mfma_f32_16x16x32_bf16 v[172:175], a[84:87], a[20:23], v[172:175]
  v_cvt_pk_bf16_f32 v204, v184, v185
  v_mfma_f32_16x16x32_bf16 v[172:175], a[88:91], a[24:27], v[172:175]
  v_exp_f32 v187, v187
  v_mfma_f32_16x16x32_bf16 v[172:175], a[92:95], a[28:31], v[172:175]
  buffer_load_dwordx4 v4, s[40:43], s53 offen offset:0 sc1 lds
  v_mfma_f32_16x16x32_bf16 v[16:19], a[96:99], v[192:195], v[16:19]
  v_exp_f32 v180, v180
  v_mfma_f32_16x16x32_bf16 v[48:51], a[96:99], v[196:199], v[48:51]
  v_cvt_pk_bf16_f32 v205, v186, v187
  v_mfma_f32_16x16x32_bf16 v[20:23], a[100:103], v[192:195], v[20:23]
  v_exp_f32 v181, v181
  v_mfma_f32_16x16x32_bf16 v[52:55], a[100:103], v[196:199], v[52:55]
  buffer_load_dwordx4 v4, s[40:43], s53 offen offset:1024 sc1 lds
  v_mfma_f32_16x16x32_bf16 v[24:27], a[104:107], v[192:195], v[24:27]
  v_exp_f32 v182, v182
  v_mfma_f32_16x16x32_bf16 v[56:59], a[104:107], v[196:199], v[56:59]
  v_cvt_pk_bf16_f32 v202, v180, v181
  v_mfma_f32_16x16x32_bf16 v[28:31], a[108:111], v[192:195], v[28:31]
  v_exp_f32 v183, v183
  v_mfma_f32_16x16x32_bf16 v[60:63], a[108:111], v[196:199], v[60:63]
  buffer_load_dwordx4 v4, s[40:43], s53 offen offset:2048 sc1 lds
  v_mfma_f32_16x16x32_bf16 v[32:35], a[112:115], v[192:195], v[32:35]
  v_exp_f32 v188, v188
  v_mfma_f32_16x16x32_bf16 v[64:67], a[112:115], v[196:199], v[64:67]
  v_cvt_pk_bf16_f32 v203, v182, v183
  v_mfma_f32_16x16x32_bf16 v[36:39], a[116:119], v[192:195], v[36:39]
  v_exp_f32 v189, v189
  v_mfma_f32_16x16x32_bf16 v[68:71], a[116:119], v[196:199], v[68:71]
  buffer_load_dwordx4 v4, s[40:43], s53 offen offset:3072 sc1 lds
  v_mfma_f32_16x16x32_bf16 v[40:43], a[120:123], v[192:195], v[40:43]
  v_exp_f32 v190, v190
  v_mfma_f32_16x16x32_bf16 v[72:75], a[120:123], v[196:199], v[72:75]
  v_cvt_pk_bf16_f32 v206, v188, v189
  v_mfma_f32_16x16x32_bf16 v[44:47], a[124:127], v[192:195], v[44:47]
  v_exp_f32 v191, v191
  v_mfma_f32_16x16x32_bf16 v[76:79], a[124:127], v[196:199], v[76:79]
  v_mfma_f32_16x16x32_bf16 v[144:147], a[128:131], v[192:195], v[144:147]
  s_add_u32 s53, s53, 16384
  v_mfma_f32_16x16x32_bf16 v[148:151], a[128:131], v[196:199], v[148:151]
  v_cvt_pk_bf16_f32 v207, v190, v191
  s_add_u32 s48, s48, 1
  v_mfma_f32_16x16x32_bf16 v[176:179], a[64:67], a[32:35], v[224:227]
  v_exp_f32 v160, v160
  v_mfma_f32_16x16x32_bf16 v[176:179], a[68:71], a[36:39], v[176:179]
  v_mfma_f32_16x16x32_bf16 v[176:179], a[72:75], a[40:43], v[176:179]
  v_exp_f32 v161, v161
  v_mfma_f32_16x16x32_bf16 v[176:179], a[76:79], a[44:47], v[176:179]
  v_mfma_f32_16x16x32_bf16 v[184:187], a[64:67], a[48:51], v[232:235]
  v_exp_f32 v162, v162
  v_mfma_f32_16x16x32_bf16 v[184:187], a[68:71], a[52:55], v[184:187]
  ds_read_b128 a[64:67], v5 offset:0
  v_cvt_pk_bf16_f32 v192, v160, v161
  v_mfma_f32_16x16x32_bf16 v[184:187], a[72:75], a[56:59], v[184:187]
  v_exp_f32 v163, v163
  v_mfma_f32_16x16x32_bf16 v[184:187], a[76:79], a[60:63], v[184:187]
  ds_read_b128 a[68:71], v5 offset:1024
  ds_read_b128 a[72:75], v5 offset:4096
  v_mfma_f32_16x16x32_bf16 v[180:183], a[80:83], a[32:35], v[228:231]
  v_exp_f32 v168, v168
  v_mfma_f32_16x16x32_bf16 v[180:183], a[84:87], a[36:39], v[180:183]
  ds_read_b128 a[76:79], v5 offset:5120
  v_cvt_pk_bf16_f32 v193, v162, v163
  v_mfma_f32_16x16x32_bf16 v[180:183], a[88:91], a[40:43], v[180:183]
  v_exp_f32 v169, v169
  v_mfma_f32_16x16x32_bf16 v[180:183], a[92:95], a[44:47], v[180:183]
  s_waitcnt vmcnt(8) lgkmcnt(4)
  s_barrier
  v_mfma_f32_16x16x32_bf16 v[188:191], a[80:83], a[48:51], v[236:239]
  v_exp_f32 v170, v170
  v_mfma_f32_16x16x32_bf16 v[188:191], a[84:87], a[52:55], v[188:191]
  ds_read_b128 a[80:83], v5 offset:8192
  v_cvt_pk_bf16_f32 v196, v168, v169
  v_mfma_f32_16x16x32_bf16 v[188:191], a[88:91], a[56:59], v[188:191]
  v_exp_f32 v171, v171
  v_mfma_f32_16x16x32_bf16 v[188:191], a[92:95], a[60:63], v[188:191]
  ds_read_b128 a[84:87], v5 offset:9216
  ds_read_b128 a[88:91], v5 offset:12288
  v_mfma_f32_16x16x32_bf16 v[80:83], a[96:99], v[200:203], v[80:83]
  v_exp_f32 v164, v164
  s_and_b32 m0, s53, 0x1ffff
  v_mfma_f32_16x16x32_bf16 v[112:115], a[96:99], v[204:207], v[112:115]
  ds_read_b128 a[92:95], v5 offset:13312
  v_add_u32 v5, 0x4000, v5
  v_cvt_pk_bf16_f32 v197, v170, v171
  v_mfma_f32_16x16x32_bf16 v[84:87], a[100:103], v[200:203], v[84:87]
  v_exp_f32 v165, v165
  v_mfma_f32_16x16x32_bf16 v[116:119], a[100:103], v[204:207], v[116:119]
  v_and_b32 v5, 0x1ffff, v5
  ds_read_b128 a[96:99], v5 offset:2048
  buffer_load_dwordx4 v4, s[40:43], s53 offen offset:0 sc1 lds
  v_mfma_f32_16x16x32_bf16 v[88:91], a[104:107], v[200:203], v[88:91]
  v_exp_f32 v166, v166
  v_mfma_f32_16x16x32_bf16 v[120:123], a[104:107], v[204:207], v[120:123]
  ds_read_b128 a[100:103], v5 offset:3072
  v_cvt_pk_bf16_f32 v194, v164, v165
  v_mfma_f32_16x16x32_bf16 v[92:95], a[108:111], v[200:203], v[92:95]
  v_exp_f32 v167, v167
  v_mfma_f32_16x16x32_bf16 v[124:127], a[108:111], v[204:207], v[124:127]
  ds_read_b128 a[104:107], v5 offset:6144
  buffer_load_dwordx4 v4, s[40:43], s53 offen offset:1024 sc1 lds
  v_mfma_f32_16x16x32_bf16 v[96:99], a[112:115], v[200:203], v[96:99]
  v_exp_f32 v172, v172
  v_mfma_f32_16x16x32_bf16 v[128:131], a[112:115], v[204:207], v[128:131]
  ds_read_b128 a[108:111], v5 offset:7168
  v_cvt_pk_bf16_f32 v195, v166, v167
  v_mfma_f32_16x16x32_bf16 v[100:103], a[116:119], v[200:203], v[100:103]
  v_exp_f32 v173, v173
  v_mfma_f32_16x16x32_bf16 v[132:135], a[116:119], v[204:207], v[132:135]
  ds_read_b128 a[112:115], v5 offset:10240
  buffer_load_dwordx4 v4, s[40:43], s53 offen offset:2048 sc1 lds
  v_mfma_f32_16x16x32_bf16 v[104:107], a[120:123], v[200:203], v[104:107]
  v_exp_f32 v174, v174
  v_mfma_f32_16x16x32_bf16 v[136:139], a[120:123], v[204:207], v[136:139]
  ds_read_b128 a[116:119], v5 offset:11264
  v_cvt_pk_bf16_f32 v198, v172, v173
  v_mfma_f32_16x16x32_bf16 v[108:111], a[124:127], v[200:203], v[108:111]
  v_exp_f32 v175, v175
  v_mfma_f32_16x16x32_bf16 v[140:143], a[124:127], v[204:207], v[140:143]
  ds_read_b128 a[120:123], v5 offset:14336
  buffer_load_dwordx4 v4, s[40:43], s53 offen offset:3072 sc1 lds
  v_mfma_f32_16x16x32_bf16 v[152:155], a[128:131], v[200:203], v[152:155]
  ds_read_b128 a[124:127], v5 offset:15360
  s_add_u32 s53, s53, 16384
  s_cmp_lg_u32 s48, s49
  v_mfma_f32_16x16x32_bf16 v[156:159], a[128:131], v[204:207], v[156:159]
  v_cvt_pk_bf16_f32 v199, v174, v175
  s_waitcnt lgkmcnt(8)
  s_cbranch_scc1 LA_S2
  s_branch LA_H
.p2align 6
LA_T2:
  v_mfma_f32_16x16x32_bf16 v[160:163], a[64:67], a[32:35], v[224:227]
  v_exp_f32 v176, v176
  v_mfma_f32_16x16x32_bf16 v[160:163], a[68:71], a[36:39], v[160:163]
  v_mfma_f32_16x16x32_bf16 v[160:163], a[72:75], a[40:43], v[160:163]
  v_exp_f32 v177, v177
  v_mfma_f32_16x16x32_bf16 v[160:163], a[76:79], a[44:47], v[160:163]
  v_mfma_f32_16x16x32_bf16 v[168:171], a[64:67], a[48:51], v[232:235]
  v_exp_f32 v178, v178
  v_mfma_f32_16x16x32_bf16 v[168:171], a[68:71], a[52:55], v[168:171]
  ds_read_b128 a[64:67], v5 offset:0
  v_cvt_pk_bf16_f32 v200, v176, v177
  v_mfma_f32_16x16x32_bf16 v[168:171], a[72:75], a[56:59], v[168:171]
  v_exp_f32 v179, v179
  v_mfma_f32_16x16x32_bf16 v[168:171], a[76:79], a[60:63], v[168:171]
  ds_read_b128 a[68:71], v5 offset:1024
  ds_read_b128 a[72:75], v5 offset:4096
  v_mfma_f32_16x16x32_bf16 v[164:167], a[80:83], a[32:35], v[228:231]
  v_exp_f32 v184, v184
  v_mfma_f32_16x16x32_bf16 v[164:167], a[84:87], a[36:39], v[164:167]
  ds_read_b128 a[76:79], v5 offset:5120
  v_cvt_pk_bf16_f32 v201, v178, v179
  v_mfma_f32_16x16x32_bf16 v[164:167], a[88:91], a[40:43], v[164:167]
  v_exp_f32 v185, v185
  v_mfma_f32_16x16x32_bf16 v[164:167], a[92:95], a[44:47], v[164:167]
  s_waitcnt vmcnt(8) lgkmcnt(4)
  s_barrier
  v_mfma_f32_16x16x32_bf16 v[172:175], a[80:83], a[48:51], v[236:239]
  v_exp_f32 v186, v186
  v_mfma_f32_16x16x32_bf16 v[172:175], a[84:87], a[52:55], v[172:175]
  ds_read_b128 a[80:83], v5 offset:8192
  v_cvt_pk_bf16_f32 v204, v184, v185
  v_mfma_f32_16x16x32_bf16 v[172:175], a[88:91], a[56:59], v[172:175]
  v_exp_f32 v187, v187
  v_mfma_f32_16x16x32_bf16 v[172:175], a[92:95], a[60:63], v[172:175]
  ds_read_b128 a[84:87], v5 offset:9216
  ds_read_b128 a[88:91], v5 offset:12288
  v_mfma_f32_16x16x32_bf16 v[16:19], a[96:99], v[192:195], v[16:19]
  v_exp_f32 v180, v180
  s_and_b32 m0, s53, 0x1ffff
  v_mfma_f32_16x16x32_bf16 v[48:51], a[96:99], v[196:199], v[48:51]
  ds_read_b128 a[92:95], v5 offset:13312
  v_cvt_pk_bf16_f32 v205, v186, v187
  v_mfma_f32_16x16x32_bf16 v[20:23], a[100:103], v[192:195], v[20:23]
  v_exp_f32 v181, v181
  v_mfma_f32_16x16x32_bf16 v[52:55], a[100:103], v[196:199], v[52:55]
  ds_read_b128 a[96:99], v5 offset:2048
  buffer_load_dwordx4 v4, s[40:43], s53 offen offset:0 sc1 lds
  v_mfma_f32_16x16x32_bf16 v[24:27], a[104:107], v[192:195], v[24:27]
  v_exp_f32 v182, v182
  v_mfma_f32_16x16x32_bf16 v[56:59], a[104:107], v[196:199], v[56:59]
  ds_read_b128 a[100:103], v5 offset:3072
  v_cvt_pk_bf16_f32 v202, v180, v181
  v_mfma_f32_16x16x32_bf16 v[28:31], a[108:111], v[192:195], v[28:31]
  v_exp_f32 v183, v183
  v_mfma_f32_16x16x32_bf16 v[60:63], a[108:111], v[196:199], v[60:63]
  ds_read_b128 a[104:107], v5 offset:6144
  buffer_load_dwordx4 v4, s[40:43], s53 offen offset:1024 sc1 lds
  v_mfma_f32_16x16x32_bf16 v[32:35], a[112:115], v[192:195], v[32:35]
  v_exp_f32 v188, v188
  v_mfma_f32_16x16x32_bf16 v[64:67], a[112:115], v[196:199], v[64:67]
  ds_read_b128 a[108:111], v5 offset:7168
  v_cvt_pk_bf16_f32 v203, v182, v183
  v_mfma_f32_16x16x32_bf16 v[36:39], a[116:119], v[192:195], v[36:39]
  v_exp_f32 v189, v189
  v_mfma_f32_16x16x32_bf16 v[68:71], a[116:119], v[196:199], v[68:71]
  ds_read_b128 a[112:115], v5 offset:10240
  buffer_load_dwordx4 v4, s[40:43], s53 offen offset:2048 sc1 lds
  v_mfma_f32_16x16x32_bf16 v[40:43], a[120:123], v[192:195], v[40:43]
  v_exp_f32 v190, v190
  v_mfma_f32_16x16x32_bf16 v[72:75], a[120:123], v[196:199], v[72:75]
  ds_read_b128 a[116:119], v5 offset:11264
  v_cvt_pk_bf16_f32 v206, v188, v189
  v_mfma_f32_16x16x32_bf16 v[44:47], a[124:127], v[192:195], v[44:47]
  v_exp_f32 v191, v191
  v_mfma_f32_16x16x32_bf16 v[76:79], a[124:127], v[196:199], v[76:79]
  ds_read_b128 a[120:123], v5 offset:14336
  buffer_load_dwordx4 v4, s[40:43], s53 offen offset:3072 sc1 lds
  v_mfma_f32_16x16x32_bf16 v[144:147], a[128:131], v[192:195], v[144:147]
  ds_read_b128 a[124:127], v5 offset:15360
  s_add_u32 s53, s53, 16384
  v_mfma_f32_16x16x32_bf16 v[148:151], a[128:131], v[196:199], v[148:151]
  v_cvt_pk_bf16_f32 v207, v190, v191
  s_add_u32 s48, s48, 1
  s_waitcnt lgkmcnt(8)
  v_mfma_f32_16x16x32_bf16 v[176:179], a[64:67], a[32:35], v[224:227]
  v_exp_f32 v160, v160
  v_mfma_f32_16x16x32_bf16 v[176:179], a[68:71], a[36:39], v[176:179]
  v_add_u32 v5, 0x4000, v5
  v_mfma_f32_16x16x32_bf16 v[176:179], a[72:75], a[40:43], v[176:179]
  v_exp_f32 v161, v161
  v_mfma_f32_16x16x32_bf16 v[176:179], a[76:79], a[44:47], v[176:179]
  v_and_b32 v5, 0x1ffff, v5
  v_mfma_f32_16x16x32_bf16 v[184:187], a[64:67], a[48:51], v[232:235]
  v_exp_f32 v162, v162
  v_mfma_f32_16x16x32_bf16 v[184:187], a[68:71], a[52:55], v[184:187]
  ds_read_b128 a[64:67], v5 offset:0
  v_cvt_pk_bf16_f32 v192, v160, v161
  v_mfma_f32_16x16x32_bf16 v[184:187], a[72:75], a[56:59], v[184:187]
  v_exp_f32 v163, v163
  v_mfma_f32_16x16x32_bf16 v[184:187], a[76:79], a[60:63], v[184:187]
  ds_read_b128 a[68:71], v5 offset:1024
  ds_read_b128 a[72:75], v5 offset:4096
  v_mfma_f32_16x16x32_bf16 v[180:183], a[80:83], a[32:35], v[228:231]
  v_exp_f32 v168, v168
  v_mfma_f32_16x16x32_bf16 v[180:183], a[84:87], a[36:39], v[180:183]
  ds_read_b128 a[76:79], v5 offset:5120
  v_cvt_pk_bf16_f32 v193, v162, v163
  v_mfma_f32_16x16x32_bf16 v[180:183], a[88:91], a[40:43], v[180:183]
  v_exp_f32 v169, v169
  v_mfma_f32_16x16x32_bf16 v[180:183], a[92:95], a[44:47], v[180:183]
  s_waitcnt vmcnt(8) lgkmcnt(4)
  s_barrier
  v_mfma_f32_16x16x32_bf16 v[188:191], a[80:83], a[48:51], v[236:239]
  v_exp_f32 v170, v170
  v_mfma_f32_16x16x32_bf16 v[188:191], a[84:87], a[52:55], v[188:191]
  ds_read_b128 a[80:83], v5 offset:8192
  v_cvt_pk_bf16_f32 v196, v168, v169
  v_mfma_f32_16x16x32_bf16 v[188:191], a[88:91], a[56:59], v[188:191]
  v_exp_f32 v171, v171
  v_mfma_f32_16x16x32_bf16 v[188:191], a[92:95], a[60:63], v[188:191]
  ds_read_b128 a[84:87], v5 offset:9216
  ds_read_b128 a[88:91], v5 offset:12288
  v_mfma_f32_16x16x32_bf16 v[80:83], a[96:99], v[200:203], v[80:83]
  v_exp_f32 v164, v164
  s_and_b32 m0, s53, 0x1ffff
  v_mfma_f32_16x16x32_bf16 v[112:115], a[96:99], v[204:207], v[112:115]
  ds_read_b128 a[92:95], v5 offset:13312
  v_cvt_pk_bf16_f32 v197, v170, v171
  v_mfma_f32_16x16x32_bf16 v[84:87], a[100:103], v[200:203], v[84:87]
  v_exp_f32 v165, v165
  v_mfma_f32_16x16x32_bf16 v[116:119], a[100:103], v[204:207], v[116:119]
  ds_read_b128 a[96:99], v5 offset:2048
  buffer_load_dwordx4 v4, s[40:43], s53 offen offset:0 sc1 lds
  v_mfma_f32_16x16x32_bf16 v[88:91], a[104:107], v[200:203], v[88:91]
  v_exp_f32 v166, v166
  v_mfma_f32_16x16x32_bf16 v[120:123], a[104:107], v[204:207], v[120:123]
  ds_read_b128 a[100:103], v5 offset:3072
  v_cvt_pk_bf16_f32 v194, v164, v165
  v_mfma_f32_16x16x32_bf16 v[92:95], a[108:111], v[200:203], v[92:95]
  v_exp_f32 v167, v167
  v_mfma_f32_16x16x32_bf16 v[124:127], a[108:111], v[204:207], v[124:127]
  ds_read_b128 a[104:107], v5 offset:6144
  buffer_load_dwordx4 v4, s[40:43], s53 offen offset:1024 sc1 lds
  v_mfma_f32_16x16x32_bf16 v[96:99], a[112:115], v[200:203], v[96:99]
  v_exp_f32 v172, v172
  v_mfma_f32_16x16x32_bf16 v[128:131], a[112:115], v[204:207], v[128:131]
  ds_read_b128 a[108:111], v5 offset:7168
  v_cvt_pk_bf16_f32 v195, v166, v167
  v_mfma_f32_16x16x32_bf16 v[100:103], a[116:119], v[200:203], v[100:103]
  v_exp_f32 v173, v173
  v_mfma_f32_16x16x32_bf16 v[132:135], a[116:119], v[204:207], v[132:135]
  ds_read_b128 a[112:115], v5 offset:10240
  buffer_load_dwordx4 v4, s[40:43], s53 offen offset:2048 sc1 lds
  v_mfma_f32_16x16x32_bf16 v[104:107], a[120:123], v[200:203], v[104:107]
  v_exp_f32 v174, v174
  v_mfma_f32_16x16x32_bf16 v[136:139], a[120:123], v[204:207], v[136:139]
  ds_read_b128 a[116:119], v5 offset:11264
  v_cvt_pk_bf16_f32 v198, v172, v173
  v_mfma_f32_16x16x32_bf16 v[108:111], a[124:127], v[200:203], v[108:111]
  v_exp_f32 v175, v175
  v_mfma_f32_16x16x32_bf16 v[140:143], a[124:127], v[204:207], v[140:143]
  ds_read_b128 a[120:123], v5 offset:14336
  buffer_load_dwordx4 v4, s[40:43], s53 offen offset:3072 sc1 lds
  v_mfma_f32_16x16x32_bf16 v[152:155], a[128:131], v[200:203], v[152:155]
  ds_read_b128 a[124:127], v5 offset:15360
  s_add_u32 s53, s53, 16384
  s_cmp_lg_u32 s48, s49
  v_mfma_f32_16x16x32_bf16 v[156:159], a[128:131], v[204:207], v[156:159]
  v_cvt_pk_bf16_f32 v199, v174, v175
  s_waitcnt lgkmcnt(8)
  s_cbranch_scc1 LA_T2
  s_branch LA_H
.p2align 6
LA_O2:
  v_mfma_f32_16x16x32_bf16 v[160:163], a[64:67], a[32:35], v[224:227]
  v_exp_f32 v176, v176
  v_mfma_f32_16x16x32_bf16 v[160:163], a[68:71], a[36:39], v[160:163]
  v_add_u32 v5, 0x4000, v5
  v_mfma_f32_16x16x32_bf16 v[160:163], a[72:75], a[40:43], v[160:163]
  v_exp_f32 v177, v177
  v_mfma_f32_16x16x32_bf16 v[160:163], a[76:79], a[44:47], v[160:163]
  v_and_b32 v5, 0x1ffff, v5
  v_mfma_f32_16x16x32_bf16 v[168:171], a[64:67], a[48:51], v[232:235]
  v_exp_f32 v178, v178
  v_mfma_f32_16x16x32_bf16 v[168:171], a[68:71], a[52:55], v[168:171]
  ds_read_b128 a[64:67], v5 offset:0
  v_cvt_pk_bf16_f32 v200, v176, v177
  v_mfma_f32_16x16x32_bf16 v[168:171], a[72:75], a[56:59], v[168:171]
  v_exp_f32 v179, v179
  v_mfma_f32_16x16x32_bf16 v[168:171], a[76:79], a[60:63], v[168:171]
  ds_read_b128 a[68:71], v5 offset:1024
  ds_read_b128 a[72:75], v5 offset:4096
  v_mfma_f32_16x16x32_bf16 v[164:167], a[80:83], a[32:35], v[228:231]
  v_exp_f32 v184, v184
  v_mfma_f32_16x16x32_bf16 v[164:167], a[84:87], a[36:39], v[164:167]
  ds_read_b128 a[76:79], v5 offset:5120
  v_cvt_pk_bf16_f32 v201, v178, v179
  v_mfma_f32_16x16x32_bf16 v[164:167], a[88:91], a[40:43], v[164:167]
  v_exp_f32 v185, v185
  v_mfma_f32_16x16x32_bf16 v[164:167], a[92:95], a[44:47], v[164:167]
  s_waitcnt vmcnt(8) lgkmcnt(4)
  s_barrier
  v_mfma_f32_16x16x32_bf16 v[172:175], a[80:83], a[48:51], v[236:239]
  v_exp_f32 v186, v186
  v_mfma_f32_16x16x32_bf16 v[172:175], a[84:87], a[52:55], v[172:175]
  ds_read_b128 a[80:83], v5 offset:8192
  v_cvt_pk_bf16_f32 v204, v184, v185
  v_mfma_f32_16x16x32_bf16 v[172:175], a[88:91], a[56:59], v[172:175]
  v_exp_f32 v187, v187
  v_mfma_f32_16x16x32_bf16 v[172:175], a[92:95], a[60:63], v[172:175]
  ds_read_b128 a[84:87], v5 offset:9216
  ds_read_b128 a[88:91], v5 offset:12288
  v_mfma_f32_16x16x32_bf16 v[80:83], a[96:99], v[192:195], v[80:83]
  v_exp_f32 v180, v180
  s_and_b32 m0, s53, 0x1ffff
  v_mfma_f32_16x16x32_bf16 v[112:115], a[96:99], v[196:199], v[112:115]
  ds_read_b128 a[92:95], v5 offset:13312
  v_cvt_pk_bf16_f32 v205, v186, v187
  v_mfma_f32_16x16x32_bf16 v[84:87], a[100:103], v[192:195], v[84:87]
  v_exp_f32 v181, v181
  v_mfma_f32_16x16x32_bf16 v[116:119], a[100:103], v[196:199], v[116:119]
  ds_read_b128 a[96:99], v5 offset:2048
  buffer_load_dwordx4 v4, s[40:43], s53 offen offset:0 sc1 lds
  v_mfma_f32_16x16x32_bf16 v[88:91], a[104:107], v[192:195], v[88:91]
  v_exp_f32 v182, v182
  v_mfma_f32_16x16x32_bf16 v[120:123], a[104:107], v[196:199], v[120:123]
  ds_read_b128 a[100:103], v5 offset:3072
  v_cvt_pk_bf16_f32 v202, v180, v181
  v_mfma_f32_16x16x32_bf16 v[92:95], a[108:111], v[192:195], v[92:95]
  v_exp_f32 v183, v183
  v_mfma_f32_16x16x32_bf16 v[124:127], a[108:111], v[196:199], v[124:127]
  ds_read_b128 a[104:107], v5 offset:6144
  buffer_load_dwordx4 v4, s[40:43], s53 offen offset:1024 sc1 lds
  v_mfma_f32_16x16x32_bf16 v[96:99], a[112:115], v[192:195], v[96:99]
  v_exp_f32 v188, v188
  v_mfma_f32_16x16x32_bf16 v[128:131], a[112:115], v[196:199], v[128:131]
  ds_read_b128 a[108:111], v5 offset:7168
  v_cvt_pk_bf16_f32 v203, v182, v183
  v_mfma_f32_16x16x32_bf16 v[100:103], a[116:119], v[192:195], v[100:103]
  v_exp_f32 v189, v189
  v_mfma_f32_16x16x32_bf16 v[132:135], a[116:119], v[196:199], v[132:135]
  ds_read_b128 a[112:115], v5 offset:10240
  buffer_load_dwordx4 v4, s[40:43], s53 offen offset:2048 sc1 lds
  v_mfma_f32_16x16x32_bf16 v[104:107], a[120:123], v[192:195], v[104:107]
  v_exp_f32 v190, v190
  v_mfma_f32_16x16x32_bf16 v[136:139], a[120:123], v[196:199], v[136:139]
  ds_read_b128 a[116:119], v5 offset:11264
  v_cvt_pk_bf16_f32 v206, v188, v189
  v_mfma_f32_16x16x32_bf16 v[108:111], a[124:127], v[192:195], v[108:111]
  v_exp_f32 v191, v191
  v_mfma_f32_16x16x32_bf16 v[140:143], a[124:127], v[196:199], v[140:143]
  ds_read_b128 a[120:123], v5 offset:14336
  buffer_load_dwordx4 v4, s[40:43], s53 offen offset:3072 sc1 lds
  v_mfma_f32_16x16x32_bf16 v[152:155], a[128:131], v[192:195], v[152:155]
  ds_read_b128 a[124:127], v5 offset:15360
  s_add_u32 s53, s53, 16384
  v_mfma_f32_16x16x32_bf16 v[156:159], a[128:131], v[196:199], v[156:159]
  v_cvt_pk_bf16_f32 v207, v190, v191
  s_add_u32 s48, s48, 1
  s_waitcnt lgkmcnt(8)
  v_mfma_f32_16x16x32_bf16 v[176:179], a[64:67], a[32:35], v[224:227]
  v_exp_f32 v160, v160
  v_mfma_f32_16x16x32_bf16 v[176:179], a[68:71], a[36:39], v[176:179]
  v_add_u32 v5, 0x4000, v5
  v_mfma_f32_16x16x32_bf16 v[176:179], a[72:75], a[40:43], v[176:179]
  v_exp_f32 v161, v161
  v_mfma_f32_16x16x32_bf16 v[176:179], a[76:79], a[44:47], v[176:179]
  v_and_b32 v5, 0x1ffff, v5
  v_mfma_f32_16x16x32_bf16 v[184:187], a[64:67], a[48:51], v[232:235]
  v_exp_f32 v162, v162
  v_mfma_f32_16x16x32_bf16 v[184:187], a[68:71], a[52:55], v[184:187]
  ds_read_b128 a[64:67], v5 offset:0
  v_cvt_pk_bf16_f32 v192, v160, v161
  v_mfma_f32_16x16x32_bf16 v[184:187], a[72:75], a[56:59], v[184:187]
  v_exp_f32 v163, v163
  v_mfma_f32_16x16x32_bf16 v[184:187], a[76:79], a[60:63], v[184:187]
  ds_read_b128 a[68:71], v5 offset:1024
  ds_read_b128 a[72:75], v5 offset:4096
  v_mfma_f32_16x16x32_bf16 v[180:183], a[80:83], a[32:35], v[228:231]
  v_exp_f32 v168, v168
  v_mfma_f32_16x16x32_bf16 v[180:183], a[84:87], a[36:39], v[180:183]
  ds_read_b128 a[76:79], v5 offset:5120
  v_cvt_pk_bf16_f32 v193, v162, v163
  v_mfma_f32_16x16x32_bf16 v[180:183], a[88:91], a[40:43], v[180:183]
  v_exp_f32 v169, v169
  v_mfma_f32_16x16x32_bf16 v[180:183], a[92:95], a[44:47], v[180:183]
  s_waitcnt vmcnt(8) lgkmcnt(4)
  s_barrier
  v_mfma_f32_16x16x32_bf16 v[188:191], a[80:83], a[48:51], v[236:239]
  v_exp_f32 v170, v170
  v_mfma_f32_16x16x32_bf16 v[188:191], a[84:87], a[52:55], v[188:191]
  ds_read_b128 a[80:83], v5 offset:8192
  v_cvt_pk_bf16_f32 v196, v168, v169
  v_mfma_f32_16x16x32_bf16 v[188:191], a[88:91], a[56:59], v[188:191]
  v_exp_f32 v171, v171
  v_mfma_f32_16x16x32_bf16 v[188:191], a[92:95], a[60:63], v[188:191]
  ds_read_b128 a[84:87], v5 offset:9216
  ds_read_b128 a[88:91], v5 offset:12288
  v_mfma_f32_16x16x32_bf16 v[80:83], a[96:99], v[200:203], v[80:83]
  v_exp_f32 v164, v164
  s_and_b32 m0, s53, 0x1ffff
  v_mfma_f32_16x16x32_bf16 v[112:115], a[96:99], v[204:207], v[112:115]
  ds_read_b128 a[92:95], v5 offset:13312
  v_cvt_pk_bf16_f32 v197, v170, v171
  v_mfma_f32_16x16x32_bf16 v[84:87], a[100:103], v[200:203], v[84:87]
  v_exp_f32 v165, v165
  v_mfma_f32_16x16x32_bf16 v[116:119], a[100:103], v[204:207], v[116:119]
  ds_read_b128 a[96:99], v5 offset:2048
  buffer_load_dwordx4 v4, s[40:43], s53 offen offset:0 sc1 lds
  v_mfma_f32_16x16x32_bf16 v[88:91], a[104:107], v[200:203], v[88:91]
  v_exp_f32 v166, v166
  v_mfma_f32_16x16x32_bf16 v[120:123], a[104:107], v[204:207], v[120:123]
  ds_read_b128 a[100:103], v5 offset:3072
  v_cvt_pk_bf16_f32 v194, v164, v165
  v_mfma_f32_16x16x32_bf16 v[92:95], a[108:111], v[200:203], v[92:95]
  v_exp_f32 v167, v167
  v_mfma_f32_16x16x32_bf16 v[124:127], a[108:111], v[204:207], v[124:127]
  ds_read_b128 a[104:107], v5 offset:6144
  buffer_load_dwordx4 v4, s[40:43], s53 offen offset:1024 sc1 lds
  v_mfma_f32_16x16x32_bf16 v[96:99], a[112:115], v[200:203], v[96:99]
  v_exp_f32 v172, v172
  v_mfma_f32_16x16x32_bf16 v[128:131], a[112:115], v[204:207], v[128:131]
  ds_read_b128 a[108:111], v5 offset:7168
  v_cvt_pk_bf16_f32 v195, v166, v167
  v_mfma_f32_16x16x32_bf16 v[100:103], a[116:119], v[200:203], v[100:103]
  v_exp_f32 v173, v173
  v_mfma_f32_16x16x32_bf16 v[132:135], a[116:119], v[204:207], v[132:135]
  ds_read_b128 a[112:115], v5 offset:10240
  buffer_load_dwordx4 v4, s[40:43], s53 offen offset:2048 sc1 lds
  v_mfma_f32_16x16x32_bf16 v[104:107], a[120:123], v[200:203], v[104:107]
  v_exp_f32 v174, v174
  v_mfma_f32_16x16x32_bf16 v[136:139], a[120:123], v[204:207], v[136:139]
  ds_read_b128 a[116:119], v5 offset:11264
  v_cvt_pk_bf16_f32 v198, v172, v173
  v_mfma_f32_16x16x32_bf16 v[108:111], a[124:127], v[200:203], v[108:111]
  v_exp_f32 v175, v175
  v_mfma_f32_16x16x32_bf16 v[140:143], a[124:127], v[204:207], v[140:143]
  ds_read_b128 a[120:123], v5 offset:14336
  buffer_load_dwordx4 v4, s[40:43], s53 offen offset:3072 sc1 lds
  v_mfma_f32_16x16x32_bf16 v[152:155], a[128:131], v[200:203], v[152:155]
  ds_read_b128 a[124:127], v5 offset:15360
  s_add_u32 s53, s53, 16384
  s_cmp_lg_u32 s48, s49
  v_mfma_f32_16x16x32_bf16 v[156:159], a[128:131], v[204:207], v[156:159]
  v_cvt_pk_bf16_f32 v199, v174, v175
  s_waitcnt lgkmcnt(8)
  s_cbranch_scc1 LA_O2
  s_branch LA_H
.p2align 6
LA_S0:
  v_mfma_f32_16x16x32_bf16 v[160:163], a[64:67], a[0:3], v[208:211]
  v_exp_f32 v176, v176
  v_mfma_f32_16x16x32_bf16 v[160:163], a[68:71], a[4:7], v[160:163]
  v_mfma_f32_16x16x32_bf16 v[160:163], a[72:75], a[8:11], v[160:163]
  v_exp_f32 v177, v177
  v_mfma_f32_16x16x32_bf16 v[160:163], a[76:79], a[12:15], v[160:163]
  v_mfma_f32_16x16x32_bf16 v[168:171], a[64:67], a[16:19], v[216:219]
  v_exp_f32 v178, v178
  v_mfma_f32_16x16x32_bf16 v[168:171], a[68:71], a[20:23], v[168:171]
  v_cvt_pk_bf16_f32 v200, v176, v177
  v_mfma_f32_16x16x32_bf16 v[168:171], a[72:75], a[24:27], v[168:171]
  v_exp_f32 v179, v179
  v_mfma_f32_16x16x32_bf16 v[168:171], a[76:79], a[28:31], v[168:171]
  v_mfma_f32_16x16x32_bf16 v[164:167], a[80:83], a[0:3], v[212:215]
  v_exp_f32 v184, v184
  v_mfma_f32_16x16x32_bf16 v[164:167], a[84:87], a[4:7], v[164:167]
  v_cvt_pk_bf16_f32 v201, v178, v179
  v_mfma_f32_16x16x32_bf16 v[164:167], a[88:91], a[8:11], v[164:167]
  v_exp_f32 v185, v185
  v_mfma_f32_16x16x32_bf16 v[164:167], a[92:95], a[12:15], v[164:167]
  s_waitcnt vmcnt(7) lgkmcnt(0)
  s_barrier
  v_mfma_f32_16x16x32_bf16 v[172:175], a[80:83], a[16:19], v[220:223]
  v_exp_f32 v186, v186
  v_mfma_f32_16x16x32_bf16 v[172:175], a[84:87], a[20:23], v[172:175]
  v_cvt_pk_bf16_f32 v204, v184, v185
  v_mfma_f32_16x16x32_bf16 v[172:175], a[88:91], a[24:27], v[172:175]
  v_exp_f32 v187, v187
  v_mfma_f32_16x16x32_bf16 v[172:175], a[92:95], a[28:31], v[172:175]
  v_mfma_f32_16x16x32_bf16 v[16:19], a[96:99], v[192:195], v[16:19]
  v_exp_f32 v180, v180
  v_mfma_f32_16x16x32_bf16 v[48:51], a[96:99], v[196:199], v[48:51]
  v_cvt_pk_bf16_f32 v205, v186, v187
  v_mfma_f32_16x16x32_bf16 v[20:23], a[100:103], v[192:195], v[20:23]
  v_exp_f32 v181, v181
  v_mfma_f32_16x16x32_bf16 v[52:55], a[100:103], v[196:199], v[52:55]
  v_mfma_f32_16x16x32_bf16 v[24:27], a[104:107], v[192:195], v[24:27]
  v_exp_f32 v182, v182
  v_mfma_f32_16x16x32_bf16 v[56:59], a[104:107], v[196:199], v[56:59]
  v_cvt_pk_bf16_f32 v202, v180, v181
  v_mfma_f32_16x16x32_bf16 v[28:31], a[108:111], v[192:195], v[28:31]
  v_exp_f32 v183, v183
  v_mfma_f32_16x16x32_bf16 v[60:63], a[108:111], v[196:199], v[60:63]
  v_mfma_f32_16x16x32_bf16 v[32:35], a[112:115], v[192:195], v[32:35]
  v_exp_f32 v188, v188
  v_mfma_f32_16x16x32_bf16 v[64:67], a[112:115], v[196:199], v[64:67]
  v_cvt_pk_bf16_f32 v203, v182, v183
  v_mfma_f32_16x16x32_bf16 v[36:39], a[116:119], v[192:195], v[36:39]
  v_exp_f32 v189, v189
  v_mfma_f32_16x16x32_bf16 v[68:71], a[116:119], v[196:199], v[68:71]
  v_mfma_f32_16x16x32_bf16 v[40:43], a[120:123], v[192:195], v[40:43]
  v_exp_f32 v190, v190
  v_mfma_f32_16x16x32_bf16 v[72:75], a[120:123], v[196:199], v[72:75]
  v_cvt_pk_bf16_f32 v206, v188, v189
  v_mfma_f32_16x16x32_bf16 v[44:47], a[124:127], v[192:195], v[44:47]
  v_exp_f32 v191, v191
  v_mfma_f32_16x16x32_bf16 v[76:79], a[124:127], v[196:199], v[76:79]
  v_mfma_f32_16x16x32_bf16 v[144:147], a[128:131], v[192:195], v[144:147]
  v_mfma_f32_16x16x32_bf16 v[148:151], a[128:131], v[196:199], v[148:151]
  v_cvt_pk_bf16_f32 v207, v190, v191
  s_add_u32 s48, s48, 1
  v_mfma_f32_16x16x32_bf16 v[176:179], a[64:67], a[32:35], v[224:227]
  v_exp_f32 v160, v160
  v_mfma_f32_16x16x32_bf16 v[176:179], a[68:71], a[36:39], v[176:179]
  v_mfma_f32_16x16x32_bf16 v[176:179], a[72:75], a[40:43], v[176:179]
  v_exp_f32 v161, v161
  v_mfma_f32_16x16x32_bf16 v[176:179], a[76:79], a[44:47], v[176:179]
  v_mfma_f32_16x16x32_bf16 v[184:187], a[64:67], a[48:51], v[232:235]
  v_exp_f32 v162, v162
  v_mfma_f32_16x16x32_bf16 v[184:187], a[68:71], a[52:55], v[184:187]
  ds_read_b128 a[64:67], v5 offset:0
  v_cvt_pk_bf16_f32 v192, v160, v161
  v_mfma_f32_16x16x32_bf16 v[184:187], a[72:75], a[56:59], v[184:187]
  v_exp_f32 v163, v163
  v_mfma_f32_16x16x32_bf16 v[184:187], a[76:79], a[60:63], v[184:187]
  ds_read_b128 a[68:71], v5 offset:1024
  ds_read_b128 a[72:75], v5 offset:4096
  v_mfma_f32_16x16x32_bf16 v[180:183], a[80:83], a[32:35], v[228:231]
  v_exp_f32 v168, v168
  v_mfma_f32_16x16x32_bf16 v[180:183], a[84:87], a[36:39], v[180:183]
  ds_read_b128 a[76:79], v5 offset:5120
  v_cvt_pk_bf16_f32 v193, v162, v163
  v_mfma_f32_16x16x32_bf16 v[180:183], a[88:91], a[40:43], v[180:183]
  v_exp_f32 v169, v169
  v_mfma_f32_16x16x32_bf16 v[180:183], a[92:95], a[44:47], v[180:183]
  s_waitcnt vmcnt(3) lgkmcnt(4)
  s_barrier
  v_mfma_f32_16x16x32_bf16 v[188:191], a[80:83], a[48:51], v[236:239]
  v_exp_f32 v170, v170
  v_mfma_f32_16x16x32_bf16 v[188:191], a[84:87], a[52:55], v[188:191]
  ds_read_b128 a[80:83], v5 offset:8192
  v_cvt_pk_bf16_f32 v196, v168, v169
  v_mfma_f32_16x16x32_bf16 v[188:191], a[88:91], a[56:59], v[188:191]
  v_exp_f32 v171, v171
  v_mfma_f32_16x16x32_bf16 v[188:191], a[92:95], a[60:63], v[188:191]
  ds_read_b128 a[84:87], v5 offset:9216
  ds_read_b128 a[88:91], v5 offset:12288
  v_mfma_f32_16x16x32_bf16 v[80:83], a[96:99], v[200:203], v[80:83]
  v_exp_f32 v164, v164
  v_mfma_f32_16x16x32_bf16 v[112:115], a[96:99], v[204:207], v[112:115]
  ds_read_b128 a[92:95], v5 offset:13312
  v_add_u32 v5, 0x4000, v5
  v_cvt_pk_bf16_f32 v197, v170, v171
  v_mfma_f32_16x16x32_bf16 v[84:87], a[100:103], v[200:203], v[84:87]
  v_exp_f32 v165, v165
  v_mfma_f32_16x16x32_bf16 v[116:119], a[100:103], v[204:207], v[116:119]
  v_and_b32 v5, 0x1ffff, v5
  ds_read_b128 a[96:99], v5 offset:2048
  v_mfma_f32_16x16x32_bf16 v[88:91], a[104:107], v[200:203], v[88:91]
  v_exp_f32 v166, v166
  v_mfma_f32_16x16x32_bf16 v[120:123], a[104:107], v[204:207], v[120:123]
  ds_read_b128 a[100:103], v5 offset:3072
  v_cvt_pk_bf16_f32 v194, v164, v165
  v_mfma_f32_16x16x32_bf16 v[92:95], a[108:111], v[200:203], v[92:95]
  v_exp_f32 v167, v167
  v_mfma_f32_16x16x32_bf16 v[124:127], a[108:111], v[204:207], v[124:127]
  ds_read_b128 a[104:107], v5 offset:6144
  v_mfma_f32_16x16x32_bf16 v[96:99], a[112:115], v[200:203], v[96:99]
  v_exp_f32 v172, v172
  v_mfma_f32_16x16x32_bf16 v[128:131], a[112:115], v[204:207], v[128:131]
  ds_read_b128 a[108:111], v5 offset:7168
  v_cvt_pk_bf16_f32 v195, v166, v167
  v_mfma_f32_16x16x32_bf16 v[100:103], a[116:119], v[200:203], v[100:103]
  v_exp_f32 v173, v173
  v_mfma_f32_16x16x32_bf16 v[132:135], a[116:119], v[204:207], v[132:135]
  ds_read_b128 a[112:115], v5 offset:10240
  v_mfma_f32_16x16x32_bf16 v[104:107], a[120:123], v[200:203], v[104:107]
  v_exp_f32 v174, v174
  v_mfma_f32_16x16x32_bf16 v[136:139], a[120:123], v[204:207], v[136:139]
  ds_read_b128 a[116:119], v5 offset:11264
  v_cvt_pk_bf16_f32 v198, v172, v173
  v_mfma_f32_16x16x32_bf16 v[108:111], a[124:127], v[200:203], v[108:111]
  v_exp_f32 v175, v175
  v_mfma_f32_16x16x32_bf16 v[140:143], a[124:127], v[204:207], v[140:143]
  ds_read_b128 a[120:123], v5 offset:14336
  v_mfma_f32_16x16x32_bf16 v[152:155], a[128:131], v[200:203], v[152:155]
  ds_read_b128 a[124:127], v5 offset:15360
  s_cmp_lg_u32 s48, s49
  v_mfma_f32_16x16x32_bf16 v[156:159], a[128:131], v[204:207], v[156:159]
  v_cvt_pk_bf16_f32 v199, v174, v175
  s_waitcnt lgkmcnt(8)
  s_cbranch_scc1 LA_S0
  s_branch LA_H
.p2align 6
LA_T0:
  v_mfma_f32_16x16x32_bf16 v[160:163], a[64:67], a[32:35], v[224:227]
  v_exp_f32 v176, v176
  v_mfma_f32_16x16x32_bf16 v[160:163], a[68:71], a[36:39], v[160:163]
  v_mfma_f32_16x16x32_bf16 v[160:163], a[72:75], a[40:43], v[160:163]
  v_exp_f32 v177, v177
  v_mfma_f32_16x16x32_bf16 v[160:163], a[76:79], a[44:47], v[160:163]
  v_mfma_f32_16x16x32_bf16 v[168:171], a[64:67], a[48:51], v[232:235]
  v_exp_f32 v178, v178
  v_mfma_f32_16x16x32_bf16 v[168:171], a[68:71], a[52:55], v[168:171]
  ds_read_b128 a[64:67], v5 offset:0
  v_cvt_pk_bf16_f32 v200, v176, v177
  v_mfma_f32_16x16x32_bf16 v[168:171], a[72:75], a[56:59], v[168:171]
  v_exp_f32 v179, v179
  v_mfma_f32_16x16x32_bf16 v[168:171], a[76:79], a[60:63], v[168:171]
  ds_read_b128 a[68:71], v5 offset:1024
  ds_read_b128 a[72:75], v5 offset:4096
  v_mfma_f32_16x16x32_bf16 v[164:167], a[80:83], a[32:35], v[228:231]
  v_exp_f32 v184, v184
  v_mfma_f32_16x16x32_bf16 v[164:167], a[84:87], a[36:39], v[164:167]
  ds_read_b128 a[76:79], v5 offset:5120
  v_cvt_pk_bf16_f32 v201, v178, v179
  v_mfma_f32_16x16x32_bf16 v[164:167], a[88:91], a[40:43], v[164:167]
  v_exp_f32 v185, v185
  v_mfma_f32_16x16x32_bf16 v[164:167], a[92:95], a[44:47], v[164:167]
  s_waitcnt vmcnt(7) lgkmcnt(4)
  s_barrier
  v_mfma_f32_16x16x32_bf16 v[172:175], a[80:83], a[48:51], v[236:239]
  v_exp_f32 v186, v186
  v_mfma_f32_16x16x32_bf16 v[172:175], a[84:87], a[52:55], v[172:175]
  ds_read_b128 a[80:83], v5 offset:8192
  v_cvt_pk_bf16_f32 v204, v184, v185
  v_mfma_f32_16x16x32_bf16 v[172:175], a[88:91], a[56:59], v[172:175]
  v_exp_f32 v187, v187
  v_mfma_f32_16x16x32_bf16 v[172:175], a[92:95], a[60:63], v[172:175]
  ds_read_b128 a[84:87], v5 offset:9216
  ds_read_b128 a[88:91], v5 offset:12288
  v_mfma_f32_16x16x32_bf16 v[16:19], a[96:99], v[192:195], v[16:19]
  v_exp_f32 v180, v180
  v_mfma_f32_16x16x32_bf16 v[48:51], a[96:99], v[196:199], v[48:51]
  ds_read_b128 a[92:95], v5 offset:13312
  v_cvt_pk_bf16_f32 v205, v186, v187
  v_mfma_f32_16x16x32_bf16 v[20:23], a[100:103], v[192:195], v[20:23]
  v_exp_f32 v181, v181
  v_mfma_f32_16x16x32_bf16 v[52:55], a[100:103], v[196:199], v[52:55]
  ds_read_b128 a[96:99], v5 offset:2048
  v_mfma_f32_16x16x32_bf16 v[24:27], a[104:107], v[192:195], v[24:27]
  v_exp_f32 v182, v182
  v_mfma_f32_16x16x32_bf16 v[56:59], a[104:107], v[196:199], v[56:59]
  ds_read_b128 a[100:103], v5 offset:3072
  v_cvt_pk_bf16_f32 v202, v180, v181
  v_mfma_f32_16x16x32_bf16 v[28:31], a[108:111], v[192:195], v[28:31]
  v_exp_f32 v183, v183
  v_mfma_f32_16x16x32_bf16 v[60:63], a[108:111], v[196:199], v[60:63]
  ds_read_b128 a[104:107], v5 offset:6144
  v_mfma_f32_16x16x32_bf16 v[32:35], a[112:115], v[192:195], v[32:35]
  v_exp_f32 v188, v188
  v_mfma_f32_16x16x32_bf16 v[64:67], a[112:115], v[196:199], v[64:67]
  ds_read_b128 a[108:111], v5 offset:7168
  v_cvt_pk_bf16_f32 v203, v182, v183
  v_mfma_f32_16x16x32_bf16 v[36:39], a[116:119], v[192:195], v[36:39]
  v_exp_f32 v189, v189
  v_mfma_f32_16x16x32_bf16 v[68:71], a[116:119], v[196:199], v[68:71]
  ds_read_b128 a[112:115], v5 offset:10240
  v_mfma_f32_16x16x32_bf16 v[40:43], a[120:123], v[192:195], v[40:43]
  v_exp_f32 v190, v190
  v_mfma_f32_16x16x32_bf16 v[72:75], a[120:123], v[196:199], v[72:75]
  ds_read_b128 a[116:119], v5 offset:11264
  v_cvt_pk_bf16_f32 v206, v188, v189
  v_mfma_f32_16x16x32_bf16 v[44:47], a[124:127], v[192:195], v[44:47]
  v_exp_f32 v191, v191
  v_mfma_f32_16x16x32_bf16 v[76:79], a[124:127], v[196:199], v[76:79]
  ds_read_b128 a[120:123], v5 offset:14336
  v_mfma_f32_16x16x32_bf16 v[144:147], a[128:131], v[192:195], v[144:147]
  ds_read_b128 a[124:127], v5 offset:15360
  v_mfma_f32_16x16x32_bf16 v[148:151], a[128:131], v[196:199], v[148:151]
  v_cvt_pk_bf16_f32 v207, v190, v191
  s_add_u32 s48, s48, 1
  s_waitcnt lgkmcnt(8)
  v_mfma_f32_16x16x32_bf16 v[176:179], a[64:67], a[32:35], v[224:227]
  v_exp_f32 v160, v160
  v_mfma_f32_16x16x32_bf16 v[176:179], a[68:71], a[36:39], v[176:179]
  v_add_u32 v5, 0x4000, v5
  v_mfma_f32_16x16x32_bf16 v[176:179], a[72:75], a[40:43], v[176:179]
  v_exp_f32 v161, v161
  v_mfma_f32_16x16x32_bf16 v[176:179], a[76:79], a[44:47], v[176:179]
  v_and_b32 v5, 0x1ffff, v5
  v_mfma_f32_16x16x32_bf16 v[184:187], a[64:67], a[48:51], v[232:235]
  v_exp_f32 v162, v162
  v_mfma_f32_16x16x32_bf16 v[184:187], a[68:71], a[52:55], v[184:187]
  ds_read_b128 a[64:67], v5 offset:0
  v_cvt_pk_bf16_f32 v192, v160, v161
  v_mfma_f32_16x16x32_bf16 v[184:187], a[72:75], a[56:59], v[184:187]
  v_exp_f32 v163, v163
  v_mfma_f32_16x16x32_bf16 v[184:187], a[76:79], a[60:63], v[184:187]
  ds_read_b128 a[68:71], v5 offset:1024
  ds_read_b128 a[72:75], v5 offset:4096
  v_mfma_f32_16x16x32_bf16 v[180:183], a[80:83], a[32:35], v[228:231]
  v_exp_f32 v168, v168
  v_mfma_f32_16x16x32_bf16 v[180:183], a[84:87], a[36:39], v[180:183]
  ds_read_b128 a[76:79], v5 offset:5120
  v_cvt_pk_bf16_f32 v193, v162, v163
  v_mfma_f32_16x16x32_bf16 v[180:183], a[88:91], a[40:43], v[180:183]
  v_exp_f32 v169, v169
  v_mfma_f32_16x16x32_bf16 v[180:183], a[92:95], a[44:47], v[180:183]
  s_waitcnt vmcnt(3) lgkmcnt(4)
  s_barrier
  v_mfma_f32_16x16x32_bf16 v[188:191], a[80:83], a[48:51], v[236:239]
  v_exp_f32 v170, v170
  v_mfma_f32_16x16x32_bf16 v[188:191], a[84:87], a[52:55], v[188:191]
  ds_read_b128 a[80:83], v5 offset:8192
  v_cvt_pk_bf16_f32 v196, v168, v169
  v_mfma_f32_16x16x32_bf16 v[188:191], a[88:91], a[56:59], v[188:191]
  v_exp_f32 v171, v171
  v_mfma_f32_16x16x32_bf16 v[188:191], a[92:95], a[60:63], v[188:191]
  ds_read_b128 a[84:87], v5 offset:9216
  ds_read_b128 a[88:91], v5 offset:12288
  v_mfma_f32_16x16x32_bf16 v[80:83], a[96:99], v[200:203], v[80:83]
  v_exp_f32 v164, v164
  v_mfma_f32_16x16x32_bf16 v[112:115], a[96:99], v[204:207], v[112:115]
  ds_read_b128 a[92:95], v5 offset:13312
  v_cvt_pk_bf16_f32 v197, v170, v171
  v_mfma_f32_16x16x32_bf16 v[84:87], a[100:103], v[200:203], v[84:87]
  v_exp_f32 v165, v165
  v_mfma_f32_16x16x32_bf16 v[116:119], a[100:103], v[204:207], v[116:119]
  ds_read_b128 a[96:99], v5 offset:2048
  v_mfma_f32_16x16x32_bf16 v[88:91], a[104:107], v[200:203], v[88:91]
  v_exp_f32 v166, v166
  v_mfma_f32_16x16x32_bf16 v[120:123], a[104:107], v[204:207], v[120:123]
  ds_read_b128 a[100:103], v5 offset:3072
  v_cvt_pk_bf16_f32 v194, v164, v165
  v_mfma_f32_16x16x32_bf16 v[92:95], a[108:111], v[200:203], v[92:95]
  v_exp_f32 v167, v167
  v_mfma_f32_16x16x32_bf16 v[124:127], a[108:111], v[204:207], v[124:127]
  ds_read_b128 a[104:107], v5 offset:6144
  v_mfma_f32_16x16x32_bf16 v[96:99], a[112:115], v[200:203], v[96:99]
  v_exp_f32 v172, v172
  v_mfma_f32_16x16x32_bf16 v[128:131], a[112:115], v[204:207], v[128:131]
  ds_read_b128 a[108:111], v5 offset:7168
  v_cvt_pk_bf16_f32 v195, v166, v167
  v_mfma_f32_16x16x32_bf16 v[100:103], a[116:119], v[200:203], v[100:103]
  v_exp_f32 v173, v173
  v_mfma_f32_16x16x32_bf16 v[132:135], a[116:119], v[204:207], v[132:135]
  ds_read_b128 a[112:115], v5 offset:10240
  v_mfma_f32_16x16x32_bf16 v[104:107], a[120:123], v[200:203], v[104:107]
  v_exp_f32 v174, v174
  v_mfma_f32_16x16x32_bf16 v[136:139], a[120:123], v[204:207], v[136:139]
  ds_read_b128 a[116:119], v5 offset:11264
  v_cvt_pk_bf16_f32 v198, v172, v173
  v_mfma_f32_16x16x32_bf16 v[108:111], a[124:127], v[200:203], v[108:111]
  v_exp_f32 v175, v175
  v_mfma_f32_16x16x32_bf16 v[140:143], a[124:127], v[204:207], v[140:143]
  ds_read_b128 a[120:123], v5 offset:14336
  v_mfma_f32_16x16x32_bf16 v[152:155], a[128:131], v[200:203], v[152:155]
  ds_read_b128 a[124:127], v5 offset:15360
  s_cmp_lg_u32 s48, s49
  v_mfma_f32_16x16x32_bf16 v[156:159], a[128:131], v[204:207], v[156:159]
  v_cvt_pk_bf16_f32 v199, v174, v175
  s_waitcnt lgkmcnt(8)
  s_cbranch_scc1 LA_T0
  s_branch LA_H
.p2align 6
LA_O0:
  v_mfma_f32_16x16x32_bf16 v[160:163], a[64:67], a[32:35], v[224:227]
  v_exp_f32 v176, v176
  v_mfma_f32_16x16x32_bf16 v[160:163], a[68:71], a[36:39], v[160:163]
  v_add_u32 v5, 0x4000, v5
  v_mfma_f32_16x16x32_bf16 v[160:163], a[72:75], a[40:43], v[160:163]
  v_exp_f32 v177, v177
  v_mfma_f32_16x16x32_bf16 v[160:163], a[76:79], a[44:47], v[160:163]
  v_and_b32 v5, 0x1ffff, v5
  v_mfma_f32_16x16x32_bf16 v[168:171], a[64:67], a[48:51], v[232:235]
  v_exp_f32 v178, v178
  v_mfma_f32_16x16x32_bf16 v[168:171], a[68:71], a[52:55], v[168:171]
  ds_read_b128 a[64:67], v5 offset:0
  v_cvt_pk_bf16_f32 v200, v176, v177
  v_mfma_f32_16x16x32_bf16 v[168:171], a[72:75], a[56:59], v[168:171]
  v_exp_f32 v179, v179
  v_mfma_f32_16x16x32_bf16 v[168:171], a[76:79], a[60:63], v[168:171]
  ds_read_b128 a[68:71], v5 offset:1024
  ds_read_b128 a[72:75], v5 offset:4096
  v_mfma_f32_16x16x32_bf16 v[164:167], a[80:83], a[32:35], v[228:231]
  v_exp_f32 v184, v184
  v_mfma_f32_16x16x32_bf16 v[164:167], a[84:87], a[36:39], v[164:167]
  ds_read_b128 a[76:79], v5 offset:5120
  v_cvt_pk_bf16_f32 v201, v178, v179
  v_mfma_f32_16x16x32_bf16 v[164:167], a[88:91], a[40:43], v[164:167]
  v_exp_f32 v185, v185
  v_mfma_f32_16x16x32_bf16 v[164:167], a[92:95], a[44:47], v[164:167]
  s_waitcnt vmcnt(7) lgkmcnt(4)
  s_barrier
  v_mfma_f32_16x16x32_bf16 v[172:175], a[80:83], a[48:51], v[236:239]
  v_exp_f32 v186, v186
  v_mfma_f32_16x16x32_bf16 v[172:175], a[84:87], a[52:55], v[172:175]
  ds_read_b128 a[80:83], v5 offset:8192
  v_cvt_pk_bf16_f32 v204, v184, v185
  v_mfma_f32_16x16x32_bf16 v[172:175], a[88:91], a[56:59], v[172:175]
  v_exp_f32 v187, v187
  v_mfma_f32_16x16x32_bf16 v[172:175], a[92:95], a[60:63], v[172:175]
  ds_read_b128 a[84:87], v5 offset:9216
  ds_read_b128 a[88:91], v5 offset:12288
  v_mfma_f32_16x16x32_bf16 v[80:83], a[96:99], v[192:195], v[80:83]
  v_exp_f32 v180, v180
  v_mfma_f32_16x16x32_bf16 v[112:115], a[96:99], v[196:199], v[112:115]
  ds_read_b128 a[92:95], v5 offset:13312
  v_cvt_pk_bf16_f32 v205, v186, v187
  v_mfma_f32_16x16x32_bf16 v[84:87], a[100:103], v[192:195], v[84:87]
  v_exp_f32 v181, v181
  v_mfma_f32_16x16x32_bf16 v[116:119], a[100:103], v[196:199], v[116:119]
  ds_read_b128 a[96:99], v5 offset:2048
  v_mfma_f32_16x16x32_bf16 v[88:91], a[104:107], v[192:195], v[88:91]
  v_exp_f32 v182, v182
  v_mfma_f32_16x16x32_bf16 v[120:123], a[104:107], v[196:199], v[120:123]
  ds_read_b128 a[100:103], v5 offset:3072
  v_cvt_pk_bf16_f32 v202, v180, v181
  v_mfma_f32_16x16x32_bf16 v[92:95], a[108:111], v[192:195], v[92:95]
  v_exp_f32 v183, v183
  v_mfma_f32_16x16x32_bf16 v[124:127], a[108:111], v[196:199], v[124:127]
  ds_read_b128 a[104:107], v5 offset:6144
  v_mfma_f32_16x16x32_bf16 v[96:99], a[112:115], v[192:195], v[96:99]
  v_exp_f32 v188, v188
  v_mfma_f32_16x16x32_bf16 v[128:131], a[112:115], v[196:199], v[128:131]
  ds_read_b128 a[108:111], v5 offset:7168
  v_cvt_pk_bf16_f32 v203, v182, v183
  v_mfma_f32_16x16x32_bf16 v[100:103], a[116:119], v[192:195], v[100:103]
  v_exp_f32 v189, v189
  v_mfma_f32_16x16x32_bf16 v[132:135], a[116:119], v[196:199], v[132:135]
  ds_read_b128 a[112:115], v5 offset:10240
  v_mfma_f32_16x16x32_bf16 v[104:107], a[120:123], v[192:195], v[104:107]
  v_exp_f32 v190, v190
  v_mfma_f32_16x16x32_bf16 v[136:139], a[120:123], v[196:199], v[136:139]
  ds_read_b128 a[116:119], v5 offset:11264
  v_cvt_pk_bf16_f32 v206, v188, v189
  v_mfma_f32_16x16x32_bf16 v[108:111], a[124:127], v[192:195], v[108:111]
  v_exp_f32 v191, v191
  v_mfma_f32_16x16x32_bf16 v[140:143], a[124:127], v[196:199], v[140:143]
  ds_read_b128 a[120:123], v5 offset:14336
  v_mfma_f32_16x16x32_bf16 v[152:155], a[128:131], v[192:195], v[152:155]
  ds_read_b128 a[124:127], v5 offset:15360
  v_mfma_f32_16x16x32_bf16 v[156:159], a[128:131], v[196:199], v[156:159]
  v_cvt_pk_bf16_f32 v207, v190, v191
  s_add_u32 s48, s48, 1
  s_waitcnt lgkmcnt(8)
  v_mfma_f32_16x16x32_bf16 v[176:179], a[64:67], a[32:35], v[224:227]
  v_exp_f32 v160, v160
  v_mfma_f32_16x16x32_bf16 v[176:179], a[68:71], a[36:39], v[176:179]
  v_add_u32 v5, 0x4000, v5
  v_mfma_f32_16x16x32_bf16 v[176:179], a[72:75], a[40:43], v[176:179]
  v_exp_f32 v161, v161
  v_mfma_f32_16x16x32_bf16 v[176:179], a[76:79], a[44:47], v[176:179]
  v_and_b32 v5, 0x1ffff, v5
  v_mfma_f32_16x16x32_bf16 v[184:187], a[64:67], a[48:51], v[232:235]
  v_exp_f32 v162, v162
  v_mfma_f32_16x16x32_bf16 v[184:187], a[68:71], a[52:55], v[184:187]
  ds_read_b128 a[64:67], v5 offset:0
  v_cvt_pk_bf16_f32 v192, v160, v161
  v_mfma_f32_16x16x32_bf16 v[184:187], a[72:75], a[56:59], v[184:187]
  v_exp_f32 v163, v163
  v_mfma_f32_16x16x32_bf16 v[184:187], a[76:79], a[60:63], v[184:187]
  ds_read_b128 a[68:71], v5 offset:1024
  ds_read_b128 a[72:75], v5 offset:4096
  v_mfma_f32_16x16x32_bf16 v[180:183], a[80:83], a[32:35], v[228:231]
  v_exp_f32 v168, v168
  v_mfma_f32_16x16x32_bf16 v[180:183], a[84:87], a[36:39], v[180:183]
  ds_read_b128 a[76:79], v5 offset:5120
  v_cvt_pk_bf16_f32 v193, v162, v163
  v_mfma_f32_16x16x32_bf16 v[180:183], a[88:91], a[40:43], v[180:183]
  v_exp_f32 v169, v169
  v_mfma_f32_16x16x32_bf16 v[180:183], a[92:95], a[44:47], v[180:183]
  s_waitcnt vmcnt(3) lgkmcnt(4)
  s_barrier
  v_mfma_f32_16x16x32_bf16 v[188:191], a[80:83], a[48:51], v[236:239]
  v_exp_f32 v170, v170
  v_mfma_f32_16x16x32_bf16 v[188:191], a[84:87], a[52:55], v[188:191]
  ds_read_b128 a[80:83], v5 offset:8192
  v_cvt_pk_bf16_f32 v196, v168, v169
  v_mfma_f32_16x16x32_bf16 v[188:191], a[88:91], a[56:59], v[188:191]
  v_exp_f32 v171, v171
  v_mfma_f32_16x16x32_bf16 v[188:191], a[92:95], a[60:63], v[188:191]
  ds_read_b128 a[84:87], v5 offset:9216
  ds_read_b128 a[88:91], v5 offset:12288
  v_mfma_f32_16x16x32_bf16 v[80:83], a[96:99], v[200:203], v[80:83]
  v_exp_f32 v164, v164
  v_mfma_f32_16x16x32_bf16 v[112:115], a[96:99], v[204:207], v[112:115]
  ds_read_b128 a[92:95], v5 offset:13312
  v_cvt_pk_bf16_f32 v197, v170, v171
  v_mfma_f32_16x16x32_bf16 v[84:87], a[100:103], v[200:203], v[84:87]
  v_exp_f32 v165, v165
  v_mfma_f32_16x16x32_bf16 v[116:119], a[100:103], v[204:207], v[116:119]
  ds_read_b128 a[96:99], v5 offset:2048
  v_mfma_f32_16x16x32_bf16 v[88:91], a[104:107], v[200:203], v[88:91]
  v_exp_f32 v166, v166
  v_mfma_f32_16x16x32_bf16 v[120:123], a[104:107], v[204:207], v[120:123]
  ds_read_b128 a[100:103], v5 offset:3072
  v_cvt_pk_bf16_f32 v194, v164, v165
  v_mfma_f32_16x16x32_bf16 v[92:95], a[108:111], v[200:203], v[92:95]
  v_exp_f32 v167, v167
  v_mfma_f32_16x16x32_bf16 v[124:127], a[108:111], v[204:207], v[124:127]
  ds_read_b128 a[104:107], v5 offset:6144
  v_mfma_f32_16x16x32_bf16 v[96:99], a[112:115], v[200:203], v[96:99]
  v_exp_f32 v172, v172
  v_mfma_f32_16x16x32_bf16 v[128:131], a[112:115], v[204:207], v[128:131]
  ds_read_b128 a[108:111], v5 offset:7168
  v_cvt_pk_bf16_f32 v195, v166, v167
  v_mfma_f32_16x16x32_bf16 v[100:103], a[116:119], v[200:203], v[100:103]
  v_exp_f32 v173, v173
  v_mfma_f32_16x16x32_bf16 v[132:135], a[116:119], v[204:207], v[132:135]
  ds_read_b128 a[112:115], v5 offset:10240
  v_mfma_f32_16x16x32_bf16 v[104:107], a[120:123], v[200:203], v[104:107]
  v_exp_f32 v174, v174
  v_mfma_f32_16x16x32_bf16 v[136:139], a[120:123], v[204:207], v[136:139]
  ds_read_b128 a[116:119], v5 offset:11264
  v_cvt_pk_bf16_f32 v198, v172, v173
  v_mfma_f32_16x16x32_bf16 v[108:111], a[124:127], v[200:203], v[108:111]
  v_exp_f32 v175, v175
  v_mfma_f32_16x16x32_bf16 v[140:143], a[124:127], v[204:207], v[140:143]
  ds_read_b128 a[120:123], v5 offset:14336
  v_mfma_f32_16x16x32_bf16 v[152:155], a[128:131], v[200:203], v[152:155]
  ds_read_b128 a[124:127], v5 offset:15360
  s_cmp_lg_u32 s48, s49
  v_mfma_f32_16x16x32_bf16 v[156:159], a[128:131], v[204:207], v[156:159]
  v_cvt_pk_bf16_f32 v199, v174, v175
  s_waitcnt lgkmcnt(8)
  s_cbranch_scc1 LA_O0
  s_branch LA_H
.p2align 6
LA_SK:
  v_mfma_f32_16x16x32_bf16 v[160:163], a[64:67], a[0:3], v[208:211]
  v_exp_f32 v176, v176
  v_mfma_f32_16x16x32_bf16 v[160:163], a[68:71], a[4:7], v[160:163]
  v_mfma_f32_16x16x32_bf16 v[160:163], a[72:75], a[8:11], v[160:163]
  v_exp_f32 v177, v177
  v_mfma_f32_16x16x32_bf16 v[160:163], a[76:79], a[12:15], v[160:163]
  v_mfma_f32_16x16x32_bf16 v[168:171], a[64:67], a[16:19], v[216:219]
  v_exp_f32 v178, v178
  v_mfma_f32_16x16x32_bf16 v[168:171], a[68:71], a[20:23], v[168:171]
  v_cvt_pk_bf16_f32 v200, v176, v177
  v_mfma_f32_16x16x32_bf16 v[168:171], a[72:75], a[24:27], v[168:171]
  v_exp_f32 v179, v179
  v_mfma_f32_16x16x32_bf16 v[168:171], a[76:79], a[28:31], v[168:171]
  v_mfma_f32_16x16x32_bf16 v[164:167], a[80:83], a[0:3], v[212:215]
  v_exp_f32 v184, v184
  v_mfma_f32_16x16x32_bf16 v[164:167], a[84:87], a[4:7], v[164:167]
  v_cvt_pk_bf16_f32 v201, v178, v179
  v_mfma_f32_16x16x32_bf16 v[164:167], a[88:91], a[8:11], v[164:167]
  v_exp_f32 v185, v185
  v_mfma_f32_16x16x32_bf16 v[164:167], a[92:95], a[12:15], v[164:167]
  v_mfma_f32_16x16x32_bf16 v[172:175], a[80:83], a[16:19], v[220:223]
  v_exp_f32 v186, v186
  s_and_b32 m0, s53, 0x1ffff
  v_mfma_f32_16x16x32_bf16 v[172:175], a[84:87], a[20:23], v[172:175]
  v_cvt_pk_bf16_f32 v204, v184, v185
  v_mfma_f32_16x16x32_bf16 v[172:175], a[88:91], a[24:27], v[172:175]
  v_exp_f32 v187, v187
  v_mfma_f32_16x16x32_bf16 v[172:175], a[92:95], a[28:31], v[172:175]
  buffer_load_dwordx4 v4, s[40:43], s53 offen offset:0 sc1 lds
  s_waitcnt lgkmcnt(0)
  v_mfma_f32_16x16x32_bf16 v[16:19], a[96:99], v[192:195], v[16:19]
  v_exp_f32 v180, v180
  v_mfma_f32_16x16x32_bf16 v[48:51], a[96:99], v[196:199], v[48:51]
  v_cvt_pk_bf16_f32 v205, v186, v187
  v_mfma_f32_16x16x32_bf16 v[20:23], a[100:103], v[192:195], v[20:23]
  v_exp_f32 v181, v181
  v_mfma_f32_16x16x32_bf16 v[52:55], a[100:103], v[196:199], v[52:55]
  buffer_load_dwordx4 v4, s[40:43], s53 offen offset:1024 sc1 lds
  v_mfma_f32_16x16x32_bf16 v[24:27], a[104:107], v[192:195], v[24:27]
  v_exp_f32 v182, v182
  v_mfma_f32_16x16x32_bf16 v[56:59], a[104:107], v[196:199], v[56:59]
  v_cvt_pk_bf16_f32 v202, v180, v181
  v_mfma_f32_16x16x32_bf16 v[28:31], a[108:111], v[192:195], v[28:31]
  v_exp_f32 v183, v183
  v_mfma_f32_16x16x32_bf16 v[60:63], a[108:111], v[196:199], v[60:63]
  buffer_load_dwordx4 v4, s[40:43], s53 offen offset:2048 sc1 lds
  v_mfma_f32_16x16x32_bf16 v[32:35], a[112:115], v[192:195], v[32:35]
  v_exp_f32 v188, v188
  v_mfma_f32_16x16x32_bf16 v[64:67], a[112:115], v[196:199], v[64:67]
  v_cvt_pk_bf16_f32 v203, v182, v183
  v_mfma_f32_16x16x32_bf16 v[36:39], a[116:119], v[192:195], v[36:39]
  v_exp_f32 v189, v189
  v_mfma_f32_16x16x32_bf16 v[68:71], a[116:119], v[196:199], v[68:71]
  buffer_load_dwordx4 v4, s[40:43], s53 offen offset:3072 sc1 lds
  v_mfma_f32_16x16x32_bf16 v[40:43], a[120:123], v[192:195], v[40:43]
  v_exp_f32 v190, v190
  v_mfma_f32_16x16x32_bf16 v[72:75], a[120:123], v[196:199], v[72:75]
  v_cvt_pk_bf16_f32 v206, v188, v189
  v_mfma_f32_16x16x32_bf16 v[44:47], a[124:127], v[192:195], v[44:47]
  v_exp_f32 v191, v191
  v_mfma_f32_16x16x32_bf16 v[76:79], a[124:127], v[196:199], v[76:79]
  v_mfma_f32_16x16x32_bf16 v[144:147], a[128:131], v[192:195], v[144:147]
  s_add_u32 s53, s53, 16384
  v_mfma_f32_16x16x32_bf16 v[148:151], a[128:131], v[196:199], v[148:151]
  v_cvt_pk_bf16_f32 v207, v190, v191
  s_add_u32 s48, s48, 1
  v_mfma_f32_16x16x32_bf16 v[176:179], a[64:67], a[32:35], v[224:227]
  v_exp_f32 v160, v160
  v_mfma_f32_16x16x32_bf16 v[176:179], a[68:71], a[36:39], v[176:179]
  v_mfma_f32_16x16x32_bf16 v[176:179], a[72:75], a[40:43], v[176:179]
  v_exp_f32 v161, v161
  v_mfma_f32_16x16x32_bf16 v[176:179], a[76:79], a[44:47], v[176:179]
  v_mfma_f32_16x16x32_bf16 v[184:187], a[64:67], a[48:51], v[232:235]
  v_exp_f32 v162, v162
  v_mfma_f32_16x16x32_bf16 v[184:187], a[68:71], a[52:55], v[184:187]
  ds_read_b128 a[64:67], v5 offset:0
  v_cvt_pk_bf16_f32 v192, v160, v161
  v_mfma_f32_16x16x32_bf16 v[184:187], a[72:75], a[56:59], v[184:187]
  v_exp_f32 v163, v163
  v_mfma_f32_16x16x32_bf16 v[184:187], a[76:79], a[60:63], v[184:187]
  ds_read_b128 a[68:71], v5 offset:1024
  ds_read_b128 a[72:75], v5 offset:4096
  v_mfma_f32_16x16x32_bf16 v[180:183], a[80:83], a[32:35], v[228:231]
  v_exp_f32 v168, v168
  v_mfma_f32_16x16x32_bf16 v[180:183], a[84:87], a[36:39], v[180:183]
  ds_read_b128 a[76:79], v5 offset:5120
  v_cvt_pk_bf16_f32 v193, v162, v163
  v_mfma_f32_16x16x32_bf16 v[180:183], a[88:91], a[40:43], v[180:183]
  v_exp_f32 v169, v169
  v_mfma_f32_16x16x32_bf16 v[180:183], a[92:95], a[44:47], v[180:183]
  s_waitcnt vmcnt(4) lgkmcnt(4)
  s_barrier
  v_mfma_f32_16x16x32_bf16 v[188:191], a[80:83], a[48:51], v[236:239]
  v_exp_f32 v170, v170
  s_add_u32 s52, s3, 53248
  v_mfma_f32_16x16x32_bf16 v[188:191], a[84:87], a[52:55], v[188:191]
  ds_read_b128 a[80:83], v5 offset:8192
  v_cvt_pk_bf16_f32 v196, v168, v169
  buffer_store_dwordx4 a[216:219], v4, s[40:43], s52 offen offset:0 sc1
  v_mfma_f32_16x16x32_bf16 v[188:191], a[88:91], a[56:59], v[188:191]
  v_exp_f32 v171, v171
  v_mfma_f32_16x16x32_bf16 v[188:191], a[92:95], a[60:63], v[188:191]
  ds_read_b128 a[84:87], v5 offset:9216
  ds_read_b128 a[88:91], v5 offset:12288
  v_mfma_f32_16x16x32_bf16 v[80:83], a[96:99], v[200:203], v[80:83]
  v_exp_f32 v164, v164
  v_mfma_f32_16x16x32_bf16 v[112:115], a[96:99], v[204:207], v[112:115]
  ds_read_b128 a[92:95], v5 offset:13312
  v_add_u32 v5, 0x4000, v5
  v_cvt_pk_bf16_f32 v197, v170, v171
  v_mfma_f32_16x16x32_bf16 v[84:87], a[100:103], v[200:203], v[84:87]
  v_exp_f32 v165, v165
  s_add_u32 s52, s3, 53248
  v_mfma_f32_16x16x32_bf16 v[116:119], a[100:103], v[204:207], v[116:119]
  v_and_b32 v5, 0x1ffff, v5
  ds_read_b128 a[96:99], v5 offset:2048
  buffer_store_dwordx4 a[212:215], v4, s[40:43], s52 offen offset:1024 sc1
  v_mfma_f32_16x16x32_bf16 v[88:91], a[104:107], v[200:203], v[88:91]
  v_exp_f32 v166, v166
  v_mfma_f32_16x16x32_bf16 v[120:123], a[104:107], v[204:207], v[120:123]
  ds_read_b128 a[100:103], v5 offset:3072
  v_cvt_pk_bf16_f32 v194, v164, v165
  v_mfma_f32_16x16x32_bf16 v[92:95], a[108:111], v[200:203], v[92:95]
  v_exp_f32 v167, v167
  s_add_u32 s52, s3, 57344
  v_mfma_f32_16x16x32_bf16 v[124:127], a[108:111], v[204:207], v[124:127]
  ds_read_b128 a[104:107], v5 offset:6144
  buffer_store_dwordx4 a[208:211], v4, s[40:43], s52 offen offset:0 sc1
  v_mfma_f32_16x16x32_bf16 v[96:99], a[112:115], v[200:203], v[96:99]
  v_exp_f32 v172, v172
  v_mfma_f32_16x16x32_bf16 v[128:131], a[112:115], v[204:207], v[128:131]
  ds_read_b128 a[108:111], v5 offset:7168
  v_cvt_pk_bf16_f32 v195, v166, v167
  v_mfma_f32_16x16x32_bf16 v[100:103], a[116:119], v[200:203], v[100:103]
  v_exp_f32 v173, v173
  s_add_u32 s52, s3, 57344
  v_mfma_f32_16x16x32_bf16 v[132:135], a[116:119], v[204:207], v[132:135]
  ds_read_b128 a[112:115], v5 offset:10240
  buffer_store_dwordx4 a[204:207], v4, s[40:43], s52 offen offset:1024 sc1
  v_mfma_f32_16x16x32_bf16 v[104:107], a[120:123], v[200:203], v[104:107]
  v_exp_f32 v174, v174
  v_mfma_f32_16x16x32_bf16 v[136:139], a[120:123], v[204:207], v[136:139]
  ds_read_b128 a[116:119], v5 offset:11264
  v_cvt_pk_bf16_f32 v198, v172, v173
  v_mfma_f32_16x16x32_bf16 v[108:111], a[124:127], v[200:203], v[108:111]
  v_exp_f32 v175, v175
  v_mfma_f32_16x16x32_bf16 v[140:143], a[124:127], v[204:207], v[140:143]
  ds_read_b128 a[120:123], v5 offset:14336
  v_mfma_f32_16x16x32_bf16 v[152:155], a[128:131], v[200:203], v[152:155]
  ds_read_b128 a[124:127], v5 offset:15360
  s_cmp_lg_u32 s48, s49
  v_mfma_f32_16x16x32_bf16 v[156:159], a[128:131], v[204:207], v[156:159]
  v_cvt_pk_bf16_f32 v199, v174, v175
  s_waitcnt lgkmcnt(8)
  v_mfma_f32_16x16x32_bf16 v[160:163], a[64:67], a[0:3], v[208:211]
  v_exp_f32 v176, v176
  v_mfma_f32_16x16x32_bf16 v[160:163], a[68:71], a[4:7], v[160:163]
  v_mfma_f32_16x16x32_bf16 v[160:163], a[72:75], a[8:11], v[160:163]
  v_exp_f32 v177, v177
  v_mfma_f32_16x16x32_bf16 v[160:163], a[76:79], a[12:15], v[160:163]
  v_mfma_f32_16x16x32_bf16 v[168:171], a[64:67], a[16:19], v[216:219]
  v_exp_f32 v178, v178
  v_mfma_f32_16x16x32_bf16 v[168:171], a[68:71], a[20:23], v[168:171]
  v_cvt_pk_bf16_f32 v200, v176, v177
  v_mfma_f32_16x16x32_bf16 v[168:171], a[72:75], a[24:27], v[168:171]
  v_exp_f32 v179, v179
  v_mfma_f32_16x16x32_bf16 v[168:171], a[76:79], a[28:31], v[168:171]
  v_mfma_f32_16x16x32_bf16 v[164:167], a[80:83], a[0:3], v[212:215]
  v_exp_f32 v184, v184
  v_mfma_f32_16x16x32_bf16 v[164:167], a[84:87], a[4:7], v[164:167]
  v_cvt_pk_bf16_f32 v201, v178, v179
  v_mfma_f32_16x16x32_bf16 v[164:167], a[88:91], a[8:11], v[164:167]
  v_exp_f32 v185, v185
  v_mfma_f32_16x16x32_bf16 v[164:167], a[92:95], a[12:15], v[164:167]
  v_mfma_f32_16x16x32_bf16 v[172:175], a[80:83], a[16:19], v[220:223]
  v_exp_f32 v186, v186
  s_and_b32 m0, s53, 0x1ffff
  v_mfma_f32_16x16x32_bf16 v[172:175], a[84:87], a[20:23], v[172:175]
  v_cvt_pk_bf16_f32 v204, v184, v185
  v_mfma_f32_16x16x32_bf16 v[172:175], a[88:91], a[24:27], v[172:175]
  v_exp_f32 v187, v187
  v_mfma_f32_16x16x32_bf16 v[172:175], a[92:95], a[28:31], v[172:175]
  buffer_load_dwordx4 v4, s[40:43], s53 offen offset:0 sc1 lds
  s_waitcnt lgkmcnt(0)
  v_mfma_f32_16x16x32_bf16 v[16:19], a[96:99], v[192:195], v[16:19]
  v_exp_f32 v180, v180
  v_mfma_f32_16x16x32_bf16 v[48:51], a[96:99], v[196:199], v[48:51]
  v_cvt_pk_bf16_f32 v205, v186, v187
  v_mfma_f32_16x16x32_bf16 v[20:23], a[100:103], v[192:195], v[20:23]
  v_exp_f32 v181, v181
  v_mfma_f32_16x16x32_bf16 v[52:55], a[100:103], v[196:199], v[52:55]
  buffer_load_dwordx4 v4, s[40:43], s53 offen offset:1024 sc1 lds
  v_mfma_f32_16x16x32_bf16 v[24:27], a[104:107], v[192:195], v[24:27]
  v_exp_f32 v182, v182
  v_mfma_f32_16x16x32_bf16 v[56:59], a[104:107], v[196:199], v[56:59]
  v_cvt_pk_bf16_f32 v202, v180, v181
  v_mfma_f32_16x16x32_bf16 v[28:31], a[108:111], v[192:195], v[28:31]
  v_exp_f32 v183, v183
  v_mfma_f32_16x16x32_bf16 v[60:63], a[108:111], v[196:199], v[60:63]
  buffer_load_dwordx4 v4, s[40:43], s53 offen offset:2048 sc1 lds
  v_mfma_f32_16x16x32_bf16 v[32:35], a[112:115], v[192:195], v[32:35]
  v_exp_f32 v188, v188
  v_mfma_f32_16x16x32_bf16 v[64:67], a[112:115], v[196:199], v[64:67]
  v_cvt_pk_bf16_f32 v203, v182, v183
  v_mfma_f32_16x16x32_bf16 v[36:39], a[116:119], v[192:195], v[36:39]
  v_exp_f32 v189, v189
  v_mfma_f32_16x16x32_bf16 v[68:71], a[116:119], v[196:199], v[68:71]
  buffer_load_dwordx4 v4, s[40:43], s53 offen offset:3072 sc1 lds
  v_mfma_f32_16x16x32_bf16 v[40:43], a[120:123], v[192:195], v[40:43]
  v_exp_f32 v190, v190
  v_mfma_f32_16x16x32_bf16 v[72:75], a[120:123], v[196:199], v[72:75]
  v_cvt_pk_bf16_f32 v206, v188, v189
  v_mfma_f32_16x16x32_bf16 v[44:47], a[124:127], v[192:195], v[44:47]
  v_exp_f32 v191, v191
  v_mfma_f32_16x16x32_bf16 v[76:79], a[124:127], v[196:199], v[76:79]
  v_mfma_f32_16x16x32_bf16 v[144:147], a[128:131], v[192:195], v[144:147]
  s_add_u32 s53, s53, 16384
  v_mfma_f32_16x16x32_bf16 v[148:151], a[128:131], v[196:199], v[148:151]
  v_cvt_pk_bf16_f32 v207, v190, v191
  s_add_u32 s48, s48, 1
  v_mfma_f32_16x16x32_bf16 v[176:179], a[64:67], a[32:35], v[224:227]
  v_exp_f32 v160, v160
  v_mfma_f32_16x16x32_bf16 v[176:179], a[68:71], a[36:39], v[176:179]
  v_mfma_f32_16x16x32_bf16 v[176:179], a[72:75], a[40:43], v[176:179]
  v_exp_f32 v161, v161
  v_mfma_f32_16x16x32_bf16 v[176:179], a[76:79], a[44:47], v[176:179]
  v_mfma_f32_16x16x32_bf16 v[184:187], a[64:67], a[48:51], v[232:235]
  v_exp_f32 v162, v162
  v_mfma_f32_16x16x32_bf16 v[184:187], a[68:71], a[52:55], v[184:187]
  ds_read_b128 a[64:67], v5 offset:0
  v_cvt_pk_bf16_f32 v192, v160, v161
  v_mfma_f32_16x16x32_bf16 v[184:187], a[72:75], a[56:59], v[184:187]
  v_exp_f32 v163, v163
  v_mfma_f32_16x16x32_bf16 v[184:187], a[76:79], a[60:63], v[184:187]
  ds_read_b128 a[68:71], v5 offset:1024
  ds_read_b128 a[72:75], v5 offset:4096
  v_mfma_f32_16x16x32_bf16 v[180:183], a[80:83], a[32:35], v[228:231]
  v_exp_f32 v168, v168
  v_mfma_f32_16x16x32_bf16 v[180:183], a[84:87], a[36:39], v[180:183]
  ds_read_b128 a[76:79], v5 offset:5120
  v_cvt_pk_bf16_f32 v193, v162, v163
  v_mfma_f32_16x16x32_bf16 v[180:183], a[88:91], a[40:43], v[180:183]
  v_exp_f32 v169, v169
  v_mfma_f32_16x16x32_bf16 v[180:183], a[92:95], a[44:47], v[180:183]
  s_waitcnt vmcnt(4) lgkmcnt(4)
  s_barrier
  v_mfma_f32_16x16x32_bf16 v[188:191], a[80:83], a[48:51], v[236:239]
  v_exp_f32 v170, v170
  s_add_u32 s52, s3, 61440
  v_mfma_f32_16x16x32_bf16 v[188:191], a[84:87], a[52:55], v[188:191]
  ds_read_b128 a[80:83], v5 offset:8192
  v_cvt_pk_bf16_f32 v196, v168, v169
  buffer_store_dwordx4 a[200:203], v4, s[40:43], s52 offen offset:0 sc1
  v_mfma_f32_16x16x32_bf16 v[188:191], a[88:91], a[56:59], v[188:191]
  v_exp_f32 v171, v171
  v_mfma_f32_16x16x32_bf16 v[188:191], a[92:95], a[60:63], v[188:191]
  ds_read_b128 a[84:87], v5 offset:9216
  ds_read_b128 a[88:91], v5 offset:12288
  v_mfma_f32_16x16x32_bf16 v[80:83], a[96:99], v[200:203], v[80:83]
  v_exp_f32 v164, v164
  v_mfma_f32_16x16x32_bf16 v[112:115], a[96:99], v[204:207], v[112:115]
  ds_read_b128 a[92:95], v5 offset:13312
  v_add_u32 v5, 0x4000, v5
  v_cvt_pk_bf16_f32 v197, v170, v171
  v_mfma_f32_16x16x32_bf16 v[84:87], a[100:103], v[200:203], v[84:87]
  v_exp_f32 v165, v165
  s_add_u32 s52, s3, 61440
  v_mfma_f32_16x16x32_bf16 v[116:119], a[100:103], v[204:207], v[116:119]
  v_and_b32 v5, 0x1ffff, v5
  ds_read_b128 a[96:99], v5 offset:2048
  buffer_store_dwordx4 a[196:199], v4, s[40:43], s52 offen offset:1024 sc1
  v_mfma_f32_16x16x32_bf16 v[88:91], a[104:107], v[200:203], v[88:91]
  v_exp_f32 v166, v166
  v_mfma_f32_16x16x32_bf16 v[120:123], a[104:107], v[204:207], v[120:123]
  ds_read_b128 a[100:103], v5 offset:3072
  v_cvt_pk_bf16_f32 v194, v164, v165
  v_mfma_f32_16x16x32_bf16 v[92:95], a[108:111], v[200:203], v[92:95]
  v_exp_f32 v167, v167
  s_add_u32 s52, s3, 16384
  v_mfma_f32_16x16x32_bf16 v[124:127], a[108:111], v[204:207], v[124:127]
  ds_read_b128 a[104:107], v5 offset:6144
  buffer_store_dwordx4 a[192:195], v4, s[40:43], s52 offen offset:0 sc1
  v_mfma_f32_16x16x32_bf16 v[96:99], a[112:115], v[200:203], v[96:99]
  v_exp_f32 v172, v172
  v_mfma_f32_16x16x32_bf16 v[128:131], a[112:115], v[204:207], v[128:131]
  ds_read_b128 a[108:111], v5 offset:7168
  v_cvt_pk_bf16_f32 v195, v166, v167
  v_mfma_f32_16x16x32_bf16 v[100:103], a[116:119], v[200:203], v[100:103]
  v_exp_f32 v173, v173
  s_add_u32 s52, s3, 16384
  v_mfma_f32_16x16x32_bf16 v[132:135], a[116:119], v[204:207], v[132:135]
  ds_read_b128 a[112:115], v5 offset:10240
  buffer_store_dwordx4 a[188:191], v4, s[40:43], s52 offen offset:1024 sc1
  v_mfma_f32_16x16x32_bf16 v[104:107], a[120:123], v[200:203], v[104:107]
  v_exp_f32 v174, v174
  v_mfma_f32_16x16x32_bf16 v[136:139], a[120:123], v[204:207], v[136:139]
  ds_read_b128 a[116:119], v5 offset:11264
  v_cvt_pk_bf16_f32 v198, v172, v173
  v_mfma_f32_16x16x32_bf16 v[108:111], a[124:127], v[200:203], v[108:111]
  v_exp_f32 v175, v175
  v_mfma_f32_16x16x32_bf16 v[140:143], a[124:127], v[204:207], v[140:143]
  ds_read_b128 a[120:123], v5 offset:14336
  v_mfma_f32_16x16x32_bf16 v[152:155], a[128:131], v[200:203], v[152:155]
  ds_read_b128 a[124:127], v5 offset:15360
  s_cmp_lg_u32 s48, s49
  v_mfma_f32_16x16x32_bf16 v[156:159], a[128:131], v[204:207], v[156:159]
  v_cvt_pk_bf16_f32 v199, v174, v175
  s_waitcnt lgkmcnt(8)
  v_mfma_f32_16x16x32_bf16 v[160:163], a[64:67], a[0:3], v[208:211]
  v_exp_f32 v176, v176
  v_mfma_f32_16x16x32_bf16 v[160:163], a[68:71], a[4:7], v[160:163]
  v_mfma_f32_16x16x32_bf16 v[160:163], a[72:75], a[8:11], v[160:163]
  v_exp_f32 v177, v177
  v_mfma_f32_16x16x32_bf16 v[160:163], a[76:79], a[12:15], v[160:163]
  v_mfma_f32_16x16x32_bf16 v[168:171], a[64:67], a[16:19], v[216:219]
  v_exp_f32 v178, v178
  v_mfma_f32_16x16x32_bf16 v[168:171], a[68:71], a[20:23], v[168:171]
  v_cvt_pk_bf16_f32 v200, v176, v177
  v_mfma_f32_16x16x32_bf16 v[168:171], a[72:75], a[24:27], v[168:171]
  v_exp_f32 v179, v179
  v_mfma_f32_16x16x32_bf16 v[168:171], a[76:79], a[28:31], v[168:171]
  v_mfma_f32_16x16x32_bf16 v[164:167], a[80:83], a[0:3], v[212:215]
  v_exp_f32 v184, v184
  v_mfma_f32_16x16x32_bf16 v[164:167], a[84:87], a[4:7], v[164:167]
  v_cvt_pk_bf16_f32 v201, v178, v179
  v_mfma_f32_16x16x32_bf16 v[164:167], a[88:91], a[8:11], v[164:167]
  v_exp_f32 v185, v185
  v_mfma_f32_16x16x32_bf16 v[164:167], a[92:95], a[12:15], v[164:167]
  v_mfma_f32_16x16x32_bf16 v[172:175], a[80:83], a[16:19], v[220:223]
  v_exp_f32 v186, v186
  s_and_b32 m0, s53, 0x1ffff
  v_mfma_f32_16x16x32_bf16 v[172:175], a[84:87], a[20:23], v[172:175]
  v_cvt_pk_bf16_f32 v204, v184, v185
  v_mfma_f32_16x16x32_bf16 v[172:175], a[88:91], a[24:27], v[172:175]
  v_exp_f32 v187, v187
  v_mfma_f32_16x16x32_bf16 v[172:175], a[92:95], a[28:31], v[172:175]
  buffer_load_dwordx4 v4, s[40:43], s53 offen offset:0 sc1 lds
  s_waitcnt lgkmcnt(0)
  v_mfma_f32_16x16x32_bf16 v[16:19], a[96:99], v[192:195], v[16:19]
  v_exp_f32 v180, v180
  v_mfma_f32_16x16x32_bf16 v[48:51], a[96:99], v[196:199], v[48:51]
  v_cvt_pk_bf16_f32 v205, v186, v187
  v_mfma_f32_16x16x32_bf16 v[20:23], a[100:103], v[192:195], v[20:23]
  v_exp_f32 v181, v181
  v_mfma_f32_16x16x32_bf16 v[52:55], a[100:103], v[196:199], v[52:55]
  buffer_load_dwordx4 v4, s[40:43], s53 offen offset:1024 sc1 lds
  v_mfma_f32_16x16x32_bf16 v[24:27], a[104:107], v[192:195], v[24:27]
  v_exp_f32 v182, v182
  v_mfma_f32_16x16x32_bf16 v[56:59], a[104:107], v[196:199], v[56:59]
  v_cvt_pk_bf16_f32 v202, v180, v181
  v_mfma_f32_16x16x32_bf16 v[28:31], a[108:111], v[192:195], v[28:31]
  v_exp_f32 v183, v183
  v_mfma_f32_16x16x32_bf16 v[60:63], a[108:111], v[196:199], v[60:63]
  buffer_load_dwordx4 v4, s[40:43], s53 offen offset:2048 sc1 lds
  v_mfma_f32_16x16x32_bf16 v[32:35], a[112:115], v[192:195], v[32:35]
  v_exp_f32 v188, v188
  v_mfma_f32_16x16x32_bf16 v[64:67], a[112:115], v[196:199], v[64:67]
  v_cvt_pk_bf16_f32 v203, v182, v183
  v_mfma_f32_16x16x32_bf16 v[36:39], a[116:119], v[192:195], v[36:39]
  v_exp_f32 v189, v189
  v_mfma_f32_16x16x32_bf16 v[68:71], a[116:119], v[196:199], v[68:71]
  buffer_load_dwordx4 v4, s[40:43], s53 offen offset:3072 sc1 lds
  v_mfma_f32_16x16x32_bf16 v[40:43], a[120:123], v[192:195], v[40:43]
  v_exp_f32 v190, v190
  v_mfma_f32_16x16x32_bf16 v[72:75], a[120:123], v[196:199], v[72:75]
  v_cvt_pk_bf16_f32 v206, v188, v189
  v_mfma_f32_16x16x32_bf16 v[44:47], a[124:127], v[192:195], v[44:47]
  v_exp_f32 v191, v191
  v_mfma_f32_16x16x32_bf16 v[76:79], a[124:127], v[196:199], v[76:79]
  v_mfma_f32_16x16x32_bf16 v[144:147], a[128:131], v[192:195], v[144:147]
  s_add_u32 s53, s53, 16384
  v_mfma_f32_16x16x32_bf16 v[148:151], a[128:131], v[196:199], v[148:151]
  v_cvt_pk_bf16_f32 v207, v190, v191
  s_add_u32 s48, s48, 1
  v_mfma_f32_16x16x32_bf16 v[176:179], a[64:67], a[32:35], v[224:227]
  v_exp_f32 v160, v160
  v_mfma_f32_16x16x32_bf16 v[176:179], a[68:71], a[36:39], v[176:179]
  v_mfma_f32_16x16x32_bf16 v[176:179], a[72:75], a[40:43], v[176:179]
  v_exp_f32 v161, v161
  v_mfma_f32_16x16x32_bf16 v[176:179], a[76:79], a[44:47], v[176:179]
  v_mfma_f32_16x16x32_bf16 v[184:187], a[64:67], a[48:51], v[232:235]
  v_exp_f32 v162, v162
  v_mfma_f32_16x16x32_bf16 v[184:187], a[68:71], a[52:55], v[184:187]
  ds_read_b128 a[64:67], v5 offset:0
  v_cvt_pk_bf16_f32 v192, v160, v161
  v_mfma_f32_16x16x32_bf16 v[184:187], a[72:75], a[56:59], v[184:187]
  v_exp_f32 v163, v163
  v_mfma_f32_16x16x32_bf16 v[184:187], a[76:79], a[60:63], v[184:187]
  ds_read_b128 a[68:71], v5 offset:1024
  ds_read_b128 a[72:75], v5 offset:4096
  v_mfma_f32_16x16x32_bf16 v[180:183], a[80:83], a[32:35], v[228:231]
  v_exp_f32 v168, v168
  v_mfma_f32_16x16x32_bf16 v[180:183], a[84:87], a[36:39], v[180:183]
  ds_read_b128 a[76:79], v5 offset:5120
  v_cvt_pk_bf16_f32 v193, v162, v163
  v_mfma_f32_16x16x32_bf16 v[180:183], a[88:91], a[40:43], v[180:183]
  v_exp_f32 v169, v169
  v_mfma_f32_16x16x32_bf16 v[180:183], a[92:95], a[44:47], v[180:183]
  s_waitcnt vmcnt(4) lgkmcnt(4)
  s_barrier
  v_mfma_f32_16x16x32_bf16 v[188:191], a[80:83], a[48:51], v[236:239]
  v_exp_f32 v170, v170
  s_add_u32 s52, s3, 20480
  v_mfma_f32_16x16x32_bf16 v[188:191], a[84:87], a[52:55], v[188:191]
  ds_read_b128 a[80:83], v5 offset:8192
  v_cvt_pk_bf16_f32 v196, v168, v169
  buffer_store_dwordx4 a[184:187], v4, s[40:43], s52 offen offset:0 sc1
  v_mfma_f32_16x16x32_bf16 v[188:191], a[88:91], a[56:59], v[188:191]
  v_exp_f32 v171, v171
  v_mfma_f32_16x16x32_bf16 v[188:191], a[92:95], a[60:63], v[188:191]
  ds_read_b128 a[84:87], v5 offset:9216
  ds_read_b128 a[88:91], v5 offset:12288
  v_mfma_f32_16x16x32_bf16 v[80:83], a[96:99], v[200:203], v[80:83]
  v_exp_f32 v164, v164
  v_mfma_f32_16x16x32_bf16 v[112:115], a[96:99], v[204:207], v[112:115]
  ds_read_b128 a[92:95], v5 offset:13312
  v_add_u32 v5, 0x4000, v5
  v_cvt_pk_bf16_f32 v197, v170, v171
  v_mfma_f32_16x16x32_bf16 v[84:87], a[100:103], v[200:203], v[84:87]
  v_exp_f32 v165, v165
  s_add_u32 s52, s3, 20480
  v_mfma_f32_16x16x32_bf16 v[116:119], a[100:103], v[204:207], v[116:119]
  v_and_b32 v5, 0x1ffff, v5
  ds_read_b128 a[96:99], v5 offset:2048
  buffer_store_dwordx4 a[180:183], v4, s[40:43], s52 offen offset:1024 sc1
  v_mfma_f32_16x16x32_bf16 v[88:91], a[104:107], v[200:203], v[88:91]
  v_exp_f32 v166, v166
  v_mfma_f32_16x16x32_bf16 v[120:123], a[104:107], v[204:207], v[120:123]
  ds_read_b128 a[100:103], v5 offset:3072
  v_cvt_pk_bf16_f32 v194, v164, v165
  v_mfma_f32_16x16x32_bf16 v[92:95], a[108:111], v[200:203], v[92:95]
  v_exp_f32 v167, v167
  s_add_u32 s52, s3, 24576
  v_mfma_f32_16x16x32_bf16 v[124:127], a[108:111], v[204:207], v[124:127]
  ds_read_b128 a[104:107], v5 offset:6144
  buffer_store_dwordx4 a[176:179], v4, s[40:43], s52 offen offset:0 sc1
  v_mfma_f32_16x16x32_bf16 v[96:99], a[112:115], v[200:203], v[96:99]
  v_exp_f32 v172, v172
  v_mfma_f32_16x16x32_bf16 v[128:131], a[112:115], v[204:207], v[128:131]
  ds_read_b128 a[108:111], v5 offset:7168
  v_cvt_pk_bf16_f32 v195, v166, v167
  v_mfma_f32_16x16x32_bf16 v[100:103], a[116:119], v[200:203], v[100:103]
  v_exp_f32 v173, v173
  s_add_u32 s52, s3, 24576
  v_mfma_f32_16x16x32_bf16 v[132:135], a[116:119], v[204:207], v[132:135]
  ds_read_b128 a[112:115], v5 offset:10240
  buffer_store_dwordx4 a[172:175], v4, s[40:43], s52 offen offset:1024 sc1
  v_mfma_f32_16x16x32_bf16 v[104:107], a[120:123], v[200:203], v[104:107]
  v_exp_f32 v174, v174
  v_mfma_f32_16x16x32_bf16 v[136:139], a[120:123], v[204:207], v[136:139]
  ds_read_b128 a[116:119], v5 offset:11264
  v_cvt_pk_bf16_f32 v198, v172, v173
  v_mfma_f32_16x16x32_bf16 v[108:111], a[124:127], v[200:203], v[108:111]
  v_exp_f32 v175, v175
  v_mfma_f32_16x16x32_bf16 v[140:143], a[124:127], v[204:207], v[140:143]
  ds_read_b128 a[120:123], v5 offset:14336
  v_mfma_f32_16x16x32_bf16 v[152:155], a[128:131], v[200:203], v[152:155]
  ds_read_b128 a[124:127], v5 offset:15360
  s_cmp_lg_u32 s48, s49
  v_mfma_f32_16x16x32_bf16 v[156:159], a[128:131], v[204:207], v[156:159]
  v_cvt_pk_bf16_f32 v199, v174, v175
  s_waitcnt lgkmcnt(8)
  v_mfma_f32_16x16x32_bf16 v[160:163], a[64:67], a[0:3], v[208:211]
  v_exp_f32 v176, v176
  v_mfma_f32_16x16x32_bf16 v[160:163], a[68:71], a[4:7], v[160:163]
  v_mfma_f32_16x16x32_bf16 v[160:163], a[72:75], a[8:11], v[160:163]
  v_exp_f32 v177, v177
  v_mfma_f32_16x16x32_bf16 v[160:163], a[76:79], a[12:15], v[160:163]
  v_mfma_f32_16x16x32_bf16 v[168:171], a[64:67], a[16:19], v[216:219]
  v_exp_f32 v178, v178
  v_mfma_f32_16x16x32_bf16 v[168:171], a[68:71], a[20:23], v[168:171]
  v_cvt_pk_bf16_f32 v200, v176, v177
  v_mfma_f32_16x16x32_bf16 v[168:171], a[72:75], a[24:27], v[168:171]
  v_exp_f32 v179, v179
  v_mfma_f32_16x16x32_bf16 v[168:171], a[76:79], a[28:31], v[168:171]
  v_mfma_f32_16x16x32_bf16 v[164:167], a[80:83], a[0:3], v[212:215]
  v_exp_f32 v184, v184
  v_mfma_f32_16x16x32_bf16 v[164:167], a[84:87], a[4:7], v[164:167]
  v_cvt_pk_bf16_f32 v201, v178, v179
  v_mfma_f32_16x16x32_bf16 v[164:167], a[88:91], a[8:11], v[164:167]
  v_exp_f32 v185, v185
  v_mfma_f32_16x16x32_bf16 v[164:167], a[92:95], a[12:15], v[164:167]
  v_mfma_f32_16x16x32_bf16 v[172:175], a[80:83], a[16:19], v[220:223]
  v_exp_f32 v186, v186
  s_and_b32 m0, s53, 0x1ffff
  v_mfma_f32_16x16x32_bf16 v[172:175], a[84:87], a[20:23], v[172:175]
  v_cvt_pk_bf16_f32 v204, v184, v185
  v_mfma_f32_16x16x32_bf16 v[172:175], a[88:91], a[24:27], v[172:175]
  v_exp_f32 v187, v187
  v_mfma_f32_16x16x32_bf16 v[172:175], a[92:95], a[28:31], v[172:175]
  buffer_load_dwordx4 v4, s[40:43], s53 offen offset:0 sc1 lds
  s_waitcnt lgkmcnt(0)
  v_mfma_f32_16x16x32_bf16 v[16:19], a[96:99], v[192:195], v[16:19]
  v_exp_f32 v180, v180
  v_mfma_f32_16x16x32_bf16 v[48:51], a[96:99], v[196:199], v[48:51]
  v_cvt_pk_bf16_f32 v205, v186, v187
  v_mfma_f32_16x16x32_bf16 v[20:23], a[100:103], v[192:195], v[20:23]
  v_exp_f32 v181, v181
  v_mfma_f32_16x16x32_bf16 v[52:55], a[100:103], v[196:199], v[52:55]
  buffer_load_dwordx4 v4, s[40:43], s53 offen offset:1024 sc1 lds
  v_mfma_f32_16x16x32_bf16 v[24:27], a[104:107], v[192:195], v[24:27]
  v_exp_f32 v182, v182
  v_mfma_f32_16x16x32_bf16 v[56:59], a[104:107], v[196:199], v[56:59]
  v_cvt_pk_bf16_f32 v202, v180, v181
  v_mfma_f32_16x16x32_bf16 v[28:31], a[108:111], v[192:195], v[28:31]
  v_exp_f32 v183, v183
  v_mfma_f32_16x16x32_bf16 v[60:63], a[108:111], v[196:199], v[60:63]
  buffer_load_dwordx4 v4, s[40:43], s53 offen offset:2048 sc1 lds
  v_mfma_f32_16x16x32_bf16 v[32:35], a[112:115], v[192:195], v[32:35]
  v_exp_f32 v188, v188
  v_mfma_f32_16x16x32_bf16 v[64:67], a[112:115], v[196:199], v[64:67]
  v_cvt_pk_bf16_f32 v203, v182, v183
  v_mfma_f32_16x16x32_bf16 v[36:39], a[116:119], v[192:195], v[36:39]
  v_exp_f32 v189, v189
  v_mfma_f32_16x16x32_bf16 v[68:71], a[116:119], v[196:199], v[68:71]
  buffer_load_dwordx4 v4, s[40:43], s53 offen offset:3072 sc1 lds
  v_mfma_f32_16x16x32_bf16 v[40:43], a[120:123], v[192:195], v[40:43]
  v_exp_f32 v190, v190
  v_mfma_f32_16x16x32_bf16 v[72:75], a[120:123], v[196:199], v[72:75]
  v_cvt_pk_bf16_f32 v206, v188, v189
  v_mfma_f32_16x16x32_bf16 v[44:47], a[124:127], v[192:195], v[44:47]
  v_exp_f32 v191, v191
  v_mfma_f32_16x16x32_bf16 v[76:79], a[124:127], v[196:199], v[76:79]
  v_mfma_f32_16x16x32_bf16 v[144:147], a[128:131], v[192:195], v[144:147]
  s_add_u32 s53, s53, 16384
  v_mfma_f32_16x16x32_bf16 v[148:151], a[128:131], v[196:199], v[148:151]
  v_cvt_pk_bf16_f32 v207, v190, v191
  s_add_u32 s48, s48, 1
  v_mfma_f32_16x16x32_bf16 v[176:179], a[64:67], a[32:35], v[224:227]
  v_exp_f32 v160, v160
  v_mfma_f32_16x16x32_bf16 v[176:179], a[68:71], a[36:39], v[176:179]
  v_mfma_f32_16x16x32_bf16 v[176:179], a[72:75], a[40:43], v[176:179]
  v_exp_f32 v161, v161
  v_mfma_f32_16x16x32_bf16 v[176:179], a[76:79], a[44:47], v[176:179]
  v_mfma_f32_16x16x32_bf16 v[184:187], a[64:67], a[48:51], v[232:235]
  v_exp_f32 v162, v162
  v_mfma_f32_16x16x32_bf16 v[184:187], a[68:71], a[52:55], v[184:187]
  ds_read_b128 a[64:67], v5 offset:0
  v_cvt_pk_bf16_f32 v192, v160, v161
  v_mfma_f32_16x16x32_bf16 v[184:187], a[72:75], a[56:59], v[184:187]
  v_exp_f32 v163, v163
  v_mfma_f32_16x16x32_bf16 v[184:187], a[76:79], a[60:63], v[184:187]
  ds_read_b128 a[68:71], v5 offset:1024
  ds_read_b128 a[72:75], v5 offset:4096
  v_mfma_f32_16x16x32_bf16 v[180:183], a[80:83], a[32:35], v[228:231]
  v_exp_f32 v168, v168
  v_mfma_f32_16x16x32_bf16 v[180:183], a[84:87], a[36:39], v[180:183]
  ds_read_b128 a[76:79], v5 offset:5120
  v_cvt_pk_bf16_f32 v193, v162, v163
  v_mfma_f32_16x16x32_bf16 v[180:183], a[88:91], a[40:43], v[180:183]
  v_exp_f32 v169, v169
  v_mfma_f32_16x16x32_bf16 v[180:183], a[92:95], a[44:47], v[180:183]
  s_waitcnt vmcnt(4) lgkmcnt(4)
  s_barrier
  v_mfma_f32_16x16x32_bf16 v[188:191], a[80:83], a[48:51], v[236:239]
  v_exp_f32 v170, v170
  s_add_u32 s52, s3, 28672
  v_mfma_f32_16x16x32_bf16 v[188:191], a[84:87], a[52:55], v[188:191]
  ds_read_b128 a[80:83], v5 offset:8192
  v_cvt_pk_bf16_f32 v196, v168, v169
  buffer_store_dwordx4 a[168:171], v4, s[40:43], s52 offen offset:0 sc1
  v_mfma_f32_16x16x32_bf16 v[188:191], a[88:91], a[56:59], v[188:191]
  v_exp_f32 v171, v171
  v_mfma_f32_16x16x32_bf16 v[188:191], a[92:95], a[60:63], v[188:191]
  ds_read_b128 a[84:87], v5 offset:9216
  ds_read_b128 a[88:91], v5 offset:12288
  v_mfma_f32_16x16x32_bf16 v[80:83], a[96:99], v[200:203], v[80:83]
  v_exp_f32 v164, v164
  v_mfma_f32_16x16x32_bf16 v[112:115], a[96:99], v[204:207], v[112:115]
  ds_read_b128 a[92:95], v5 offset:13312
  v_add_u32 v5, 0x4000, v5
  v_cvt_pk_bf16_f32 v197, v170, v171
  v_mfma_f32_16x16x32_bf16 v[84:87], a[100:103], v[200:203], v[84:87]
  v_exp_f32 v165, v165
  s_add_u32 s52, s3, 28672
  v_mfma_f32_16x16x32_bf16 v[116:119], a[100:103], v[204:207], v[116:119]
  v_and_b32 v5, 0x1ffff, v5
  ds_read_b128 a[96:99], v5 offset:2048
  buffer_store_dwordx4 a[164:167], v4, s[40:43], s52 offen offset:1024 sc1
  v_mfma_f32_16x16x32_bf16 v[88:91], a[104:107], v[200:203], v[88:91]
  v_exp_f32 v166, v166
  v_mfma_f32_16x16x32_bf16 v[120:123], a[104:107], v[204:207], v[120:123]
  ds_read_b128 a[100:103], v5 offset:3072
  v_cvt_pk_bf16_f32 v194, v164, v165
  v_mfma_f32_16x16x32_bf16 v[92:95], a[108:111], v[200:203], v[92:95]
  v_exp_f32 v167, v167
  s_add_u32 s52, s3, 32768
  v_mfma_f32_16x16x32_bf16 v[124:127], a[108:111], v[204:207], v[124:127]
  ds_read_b128 a[104:107], v5 offset:6144
  buffer_store_dwordx4 a[160:163], v4, s[40:43], s52 offen offset:0 sc1
  v_mfma_f32_16x16x32_bf16 v[96:99], a[112:115], v[200:203], v[96:99]
  v_exp_f32 v172, v172
  v_mfma_f32_16x16x32_bf16 v[128:131], a[112:115], v[204:207], v[128:131]
  ds_read_b128 a[108:111], v5 offset:7168
  v_cvt_pk_bf16_f32 v195, v166, v167
  v_mfma_f32_16x16x32_bf16 v[100:103], a[116:119], v[200:203], v[100:103]
  v_exp_f32 v173, v173
  s_add_u32 s52, s3, 32768
  v_mfma_f32_16x16x32_bf16 v[132:135], a[116:119], v[204:207], v[132:135]
  ds_read_b128 a[112:115], v5 offset:10240
  buffer_store_dwordx4 a[132:135], v4, s[40:43], s52 offen offset:1024 sc1
  v_mfma_f32_16x16x32_bf16 v[104:107], a[120:123], v[200:203], v[104:107]
  v_exp_f32 v174, v174
  v_mfma_f32_16x16x32_bf16 v[136:139], a[120:123], v[204:207], v[136:139]
  ds_read_b128 a[116:119], v5 offset:11264
  v_cvt_pk_bf16_f32 v198, v172, v173
  v_mfma_f32_16x16x32_bf16 v[108:111], a[124:127], v[200:203], v[108:111]
  v_exp_f32 v175, v175
  v_mfma_f32_16x16x32_bf16 v[140:143], a[124:127], v[204:207], v[140:143]
  ds_read_b128 a[120:123], v5 offset:14336
  v_mfma_f32_16x16x32_bf16 v[152:155], a[128:131], v[200:203], v[152:155]
  ds_read_b128 a[124:127], v5 offset:15360
  s_cmp_lg_u32 s48, s49
  v_mfma_f32_16x16x32_bf16 v[156:159], a[128:131], v[204:207], v[156:159]
  v_cvt_pk_bf16_f32 v199, v174, v175
  s_waitcnt lgkmcnt(8)
  v_mfma_f32_16x16x32_bf16 v[160:163], a[64:67], a[0:3], v[208:211]
  v_exp_f32 v176, v176
  v_mfma_f32_16x16x32_bf16 v[160:163], a[68:71], a[4:7], v[160:163]
  v_mfma_f32_16x16x32_bf16 v[160:163], a[72:75], a[8:11], v[160:163]
  v_exp_f32 v177, v177
  v_mfma_f32_16x16x32_bf16 v[160:163], a[76:79], a[12:15], v[160:163]
  v_mfma_f32_16x16x32_bf16 v[168:171], a[64:67], a[16:19], v[216:219]
  v_exp_f32 v178, v178
  v_mfma_f32_16x16x32_bf16 v[168:171], a[68:71], a[20:23], v[168:171]
  v_cvt_pk_bf16_f32 v200, v176, v177
  v_mfma_f32_16x16x32_bf16 v[168:171], a[72:75], a[24:27], v[168:171]
  v_exp_f32 v179, v179
  v_mfma_f32_16x16x32_bf16 v[168:171], a[76:79], a[28:31], v[168:171]
  v_mfma_f32_16x16x32_bf16 v[164:167], a[80:83], a[0:3], v[212:215]
  v_exp_f32 v184, v184
  v_mfma_f32_16x16x32_bf16 v[164:167], a[84:87], a[4:7], v[164:167]
  v_cvt_pk_bf16_f32 v201, v178, v179
  v_mfma_f32_16x16x32_bf16 v[164:167], a[88:91], a[8:11], v[164:167]
  v_exp_f32 v185, v185
  v_mfma_f32_16x16x32_bf16 v[164:167], a[92:95], a[12:15], v[164:167]
  v_mfma_f32_16x16x32_bf16 v[172:175], a[80:83], a[16:19], v[220:223]
  v_exp_f32 v186, v186
  s_and_b32 m0, s53, 0x1ffff
  v_mfma_f32_16x16x32_bf16 v[172:175], a[84:87], a[20:23], v[172:175]
  v_cvt_pk_bf16_f32 v204, v184, v185
  v_mfma_f32_16x16x32_bf16 v[172:175], a[88:91], a[24:27], v[172:175]
  v_exp_f32 v187, v187
  v_mfma_f32_16x16x32_bf16 v[172:175], a[92:95], a[28:31], v[172:175]
  buffer_load_dwordx4 v4, s[40:43], s53 offen offset:0 sc1 lds
  s_waitcnt lgkmcnt(0)
  v_mfma_f32_16x16x32_bf16 v[16:19], a[96:99], v[192:195], v[16:19]
  v_exp_f32 v180, v180
  v_mfma_f32_16x16x32_bf16 v[48:51], a[96:99], v[196:199], v[48:51]
  v_cvt_pk_bf16_f32 v205, v186, v187
  v_mfma_f32_16x16x32_bf16 v[20:23], a[100:103], v[192:195], v[20:23]
  v_exp_f32 v181, v181
  v_mfma_f32_16x16x32_bf16 v[52:55], a[100:103], v[196:199], v[52:55]
  buffer_load_dwordx4 v4, s[40:43], s53 offen offset:1024 sc1 lds
  v_mfma_f32_16x16x32_bf16 v[24:27], a[104:107], v[192:195], v[24:27]
  v_exp_f32 v182, v182
  v_mfma_f32_16x16x32_bf16 v[56:59], a[104:107], v[196:199], v[56:59]
  v_cvt_pk_bf16_f32 v202, v180, v181
  v_mfma_f32_16x16x32_bf16 v[28:31], a[108:111], v[192:195], v[28:31]
  v_exp_f32 v183, v183
  v_mfma_f32_16x16x32_bf16 v[60:63], a[108:111], v[196:199], v[60:63]
  buffer_load_dwordx4 v4, s[40:43], s53 offen offset:2048 sc1 lds
  v_mfma_f32_16x16x32_bf16 v[32:35], a[112:115], v[192:195], v[32:35]
  v_exp_f32 v188, v188
  v_mfma_f32_16x16x32_bf16 v[64:67], a[112:115], v[196:199], v[64:67]
  v_cvt_pk_bf16_f32 v203, v182, v183
  v_mfma_f32_16x16x32_bf16 v[36:39], a[116:119], v[192:195], v[36:39]
  v_exp_f32 v189, v189
  v_mfma_f32_16x16x32_bf16 v[68:71], a[116:119], v[196:199], v[68:71]
  buffer_load_dwordx4 v4, s[40:43], s53 offen offset:3072 sc1 lds
  v_mfma_f32_16x16x32_bf16 v[40:43], a[120:123], v[192:195], v[40:43]
  v_exp_f32 v190, v190
  v_mfma_f32_16x16x32_bf16 v[72:75], a[120:123], v[196:199], v[72:75]
  v_cvt_pk_bf16_f32 v206, v188, v189
  v_mfma_f32_16x16x32_bf16 v[44:47], a[124:127], v[192:195], v[44:47]
  v_exp_f32 v191, v191
  v_mfma_f32_16x16x32_bf16 v[76:79], a[124:127], v[196:199], v[76:79]
  v_mfma_f32_16x16x32_bf16 v[144:147], a[128:131], v[192:195], v[144:147]
  s_add_u32 s53, s53, 16384
  v_mfma_f32_16x16x32_bf16 v[148:151], a[128:131], v[196:199], v[148:151]
  v_cvt_pk_bf16_f32 v207, v190, v191
  s_add_u32 s48, s48, 1
  v_mfma_f32_16x16x32_bf16 v[176:179], a[64:67], a[32:35], v[224:227]
  v_exp_f32 v160, v160
  v_mfma_f32_16x16x32_bf16 v[176:179], a[68:71], a[36:39], v[176:179]
  v_mfma_f32_16x16x32_bf16 v[176:179], a[72:75], a[40:43], v[176:179]
  v_exp_f32 v161, v161
  v_mfma_f32_16x16x32_bf16 v[176:179], a[76:79], a[44:47], v[176:179]
  v_mfma_f32_16x16x32_bf16 v[184:187], a[64:67], a[48:51], v[232:235]
  v_exp_f32 v162, v162
  v_mfma_f32_16x16x32_bf16 v[184:187], a[68:71], a[52:55], v[184:187]
  ds_read_b128 a[64:67], v5 offset:0
  v_cvt_pk_bf16_f32 v192, v160, v161
  v_mfma_f32_16x16x32_bf16 v[184:187], a[72:75], a[56:59], v[184:187]
  v_exp_f32 v163, v163
  v_mfma_f32_16x16x32_bf16 v[184:187], a[76:79], a[60:63], v[184:187]
  ds_read_b128 a[68:71], v5 offset:1024
  ds_read_b128 a[72:75], v5 offset:4096
  v_mfma_f32_16x16x32_bf16 v[180:183], a[80:83], a[32:35], v[228:231]
  v_exp_f32 v168, v168
  v_mfma_f32_16x16x32_bf16 v[180:183], a[84:87], a[36:39], v[180:183]
  ds_read_b128 a[76:79], v5 offset:5120
  v_cvt_pk_bf16_f32 v193, v162, v163
  v_mfma_f32_16x16x32_bf16 v[180:183], a[88:91], a[40:43], v[180:183]
  v_exp_f32 v169, v169
  v_mfma_f32_16x16x32_bf16 v[180:183], a[92:95], a[44:47], v[180:183]
  s_waitcnt vmcnt(4) lgkmcnt(4)
  s_barrier
  v_mfma_f32_16x16x32_bf16 v[188:191], a[80:83], a[48:51], v[236:239]
  v_exp_f32 v170, v170
  s_add_u32 s52, s3, 36864
  v_mfma_f32_16x16x32_bf16 v[188:191], a[84:87], a[52:55], v[188:191]
  ds_read_b128 a[80:83], v5 offset:8192
  v_cvt_pk_bf16_f32 v196, v168, v169
  buffer_store_dwordx4 a[136:139], v4, s[40:43], s52 offen offset:0 sc1
  v_mfma_f32_16x16x32_bf16 v[188:191], a[88:91], a[56:59], v[188:191]
  v_exp_f32 v171, v171
  v_mfma_f32_16x16x32_bf16 v[188:191], a[92:95], a[60:63], v[188:191]
  ds_read_b128 a[84:87], v5 offset:9216
  ds_read_b128 a[88:91], v5 offset:12288
  v_mfma_f32_16x16x32_bf16 v[80:83], a[96:99], v[200:203], v[80:83]
  v_exp_f32 v164, v164
  v_mfma_f32_16x16x32_bf16 v[112:115], a[96:99], v[204:207], v[112:115]
  ds_read_b128 a[92:95], v5 offset:13312
  v_add_u32 v5, 0x4000, v5
  v_cvt_pk_bf16_f32 v197, v170, v171
  v_mfma_f32_16x16x32_bf16 v[84:87], a[100:103], v[200:203], v[84:87]
  v_exp_f32 v165, v165
  s_add_u32 s52, s3, 36864
  v_mfma_f32_16x16x32_bf16 v[116:119], a[100:103], v[204:207], v[116:119]
  v_and_b32 v5, 0x1ffff, v5
  ds_read_b128 a[96:99], v5 offset:2048
  buffer_store_dwordx4 a[140:143], v4, s[40:43], s52 offen offset:1024 sc1
  v_mfma_f32_16x16x32_bf16 v[88:91], a[104:107], v[200:203], v[88:91]
  v_exp_f32 v166, v166
  v_mfma_f32_16x16x32_bf16 v[120:123], a[104:107], v[204:207], v[120:123]
  ds_read_b128 a[100:103], v5 offset:3072
  v_cvt_pk_bf16_f32 v194, v164, v165
  v_mfma_f32_16x16x32_bf16 v[92:95], a[108:111], v[200:203], v[92:95]
  v_exp_f32 v167, v167
  s_add_u32 s52, s3, 40960
  v_mfma_f32_16x16x32_bf16 v[124:127], a[108:111], v[204:207], v[124:127]
  ds_read_b128 a[104:107], v5 offset:6144
  buffer_store_dwordx4 a[144:147], v4, s[40:43], s52 offen offset:0 sc1
  v_mfma_f32_16x16x32_bf16 v[96:99], a[112:115], v[200:203], v[96:99]
  v_exp_f32 v172, v172
  v_mfma_f32_16x16x32_bf16 v[128:131], a[112:115], v[204:207], v[128:131]
  ds_read_b128 a[108:111], v5 offset:7168
  v_cvt_pk_bf16_f32 v195, v166, v167
  v_mfma_f32_16x16x32_bf16 v[100:103], a[116:119], v[200:203], v[100:103]
  v_exp_f32 v173, v173
  s_add_u32 s52, s3, 40960
  v_mfma_f32_16x16x32_bf16 v[132:135], a[116:119], v[204:207], v[132:135]
  ds_read_b128 a[112:115], v5 offset:10240
  buffer_store_dwordx4 a[148:151], v4, s[40:43], s52 offen offset:1024 sc1
  v_mfma_f32_16x16x32_bf16 v[104:107], a[120:123], v[200:203], v[104:107]
  v_exp_f32 v174, v174
  v_mfma_f32_16x16x32_bf16 v[136:139], a[120:123], v[204:207], v[136:139]
  ds_read_b128 a[116:119], v5 offset:11264
  v_cvt_pk_bf16_f32 v198, v172, v173
  v_mfma_f32_16x16x32_bf16 v[108:111], a[124:127], v[200:203], v[108:111]
  v_exp_f32 v175, v175
  v_mfma_f32_16x16x32_bf16 v[140:143], a[124:127], v[204:207], v[140:143]
  ds_read_b128 a[120:123], v5 offset:14336
  v_mfma_f32_16x16x32_bf16 v[152:155], a[128:131], v[200:203], v[152:155]
  ds_read_b128 a[124:127], v5 offset:15360
  s_cmp_lg_u32 s48, s49
  v_mfma_f32_16x16x32_bf16 v[156:159], a[128:131], v[204:207], v[156:159]
  v_cvt_pk_bf16_f32 v199, v174, v175
  s_waitcnt lgkmcnt(8)
  v_mfma_f32_16x16x32_bf16 v[160:163], a[64:67], a[0:3], v[208:211]
  v_exp_f32 v176, v176
  v_mfma_f32_16x16x32_bf16 v[160:163], a[68:71], a[4:7], v[160:163]
  v_mfma_f32_16x16x32_bf16 v[160:163], a[72:75], a[8:11], v[160:163]
  v_exp_f32 v177, v177
  v_mfma_f32_16x16x32_bf16 v[160:163], a[76:79], a[12:15], v[160:163]
  v_mfma_f32_16x16x32_bf16 v[168:171], a[64:67], a[16:19], v[216:219]
  v_exp_f32 v178, v178
  v_mfma_f32_16x16x32_bf16 v[168:171], a[68:71], a[20:23], v[168:171]
  v_cvt_pk_bf16_f32 v200, v176, v177
  v_mfma_f32_16x16x32_bf16 v[168:171], a[72:75], a[24:27], v[168:171]
  v_exp_f32 v179, v179
  v_mfma_f32_16x16x32_bf16 v[168:171], a[76:79], a[28:31], v[168:171]
  v_mfma_f32_16x16x32_bf16 v[164:167], a[80:83], a[0:3], v[212:215]
  v_exp_f32 v184, v184
  v_mfma_f32_16x16x32_bf16 v[164:167], a[84:87], a[4:7], v[164:167]
  v_cvt_pk_bf16_f32 v201, v178, v179
  v_mfma_f32_16x16x32_bf16 v[164:167], a[88:91], a[8:11], v[164:167]
  v_exp_f32 v185, v185
  v_mfma_f32_16x16x32_bf16 v[164:167], a[92:95], a[12:15], v[164:167]
  v_mfma_f32_16x16x32_bf16 v[172:175], a[80:83], a[16:19], v[220:223]
  v_exp_f32 v186, v186
  s_and_b32 m0, s53, 0x1ffff
  v_mfma_f32_16x16x32_bf16 v[172:175], a[84:87], a[20:23], v[172:175]
  v_cvt_pk_bf16_f32 v204, v184, v185
  v_mfma_f32_16x16x32_bf16 v[172:175], a[88:91], a[24:27], v[172:175]
  v_exp_f32 v187, v187
  v_mfma_f32_16x16x32_bf16 v[172:175], a[92:95], a[28:31], v[172:175]
  buffer_load_dwordx4 v4, s[40:43], s53 offen offset:0 sc1 lds
  s_waitcnt lgkmcnt(0)
  v_mfma_f32_16x16x32_bf16 v[16:19], a[96:99], v[192:195], v[16:19]
  v_exp_f32 v180, v180
  v_mfma_f32_16x16x32_bf16 v[48:51], a[96:99], v[196:199], v[48:51]
  v_cvt_pk_bf16_f32 v205, v186, v187
  v_mfma_f32_16x16x32_bf16 v[20:23], a[100:103], v[192:195], v[20:23]
  v_exp_f32 v181, v181
  v_mfma_f32_16x16x32_bf16 v[52:55], a[100:103], v[196:199], v[52:55]
  buffer_load_dwordx4 v4, s[40:43], s53 offen offset:1024 sc1 lds
  v_mfma_f32_16x16x32_bf16 v[24:27], a[104:107], v[192:195], v[24:27]
  v_exp_f32 v182, v182
  v_mfma_f32_16x16x32_bf16 v[56:59], a[104:107], v[196:199], v[56:59]
  v_cvt_pk_bf16_f32 v202, v180, v181
  v_mfma_f32_16x16x32_bf16 v[28:31], a[108:111], v[192:195], v[28:31]
  v_exp_f32 v183, v183
  v_mfma_f32_16x16x32_bf16 v[60:63], a[108:111], v[196:199], v[60:63]
  buffer_load_dwordx4 v4, s[40:43], s53 offen offset:2048 sc1 lds
  v_mfma_f32_16x16x32_bf16 v[32:35], a[112:115], v[192:195], v[32:35]
  v_exp_f32 v188, v188
  v_mfma_f32_16x16x32_bf16 v[64:67], a[112:115], v[196:199], v[64:67]
  v_cvt_pk_bf16_f32 v203, v182, v183
  v_mfma_f32_16x16x32_bf16 v[36:39], a[116:119], v[192:195], v[36:39]
  v_exp_f32 v189, v189
  v_mfma_f32_16x16x32_bf16 v[68:71], a[116:119], v[196:199], v[68:71]
  buffer_load_dwordx4 v4, s[40:43], s53 offen offset:3072 sc1 lds
  v_mfma_f32_16x16x32_bf16 v[40:43], a[120:123], v[192:195], v[40:43]
  v_exp_f32 v190, v190
  v_mfma_f32_16x16x32_bf16 v[72:75], a[120:123], v[196:199], v[72:75]
  v_cvt_pk_bf16_f32 v206, v188, v189
  v_mfma_f32_16x16x32_bf16 v[44:47], a[124:127], v[192:195], v[44:47]
  v_exp_f32 v191, v191
  v_mfma_f32_16x16x32_bf16 v[76:79], a[124:127], v[196:199], v[76:79]
  v_mfma_f32_16x16x32_bf16 v[144:147], a[128:131], v[192:195], v[144:147]
  s_add_u32 s53, s53, 16384
  v_mfma_f32_16x16x32_bf16 v[148:151], a[128:131], v[196:199], v[148:151]
  v_cvt_pk_bf16_f32 v207, v190, v191
  s_add_u32 s48, s48, 1
  v_mfma_f32_16x16x32_bf16 v[176:179], a[64:67], a[32:35], v[224:227]
  v_exp_f32 v160, v160
  v_mfma_f32_16x16x32_bf16 v[176:179], a[68:71], a[36:39], v[176:179]
  v_mfma_f32_16x16x32_bf16 v[176:179], a[72:75], a[40:43], v[176:179]
  v_exp_f32 v161, v161
  v_mfma_f32_16x16x32_bf16 v[176:179], a[76:79], a[44:47], v[176:179]
  v_mfma_f32_16x16x32_bf16 v[184:187], a[64:67], a[48:51], v[232:235]
  v_exp_f32 v162, v162
  v_mfma_f32_16x16x32_bf16 v[184:187], a[68:71], a[52:55], v[184:187]
  ds_read_b128 a[64:67], v5 offset:0
  v_cvt_pk_bf16_f32 v192, v160, v161
  v_mfma_f32_16x16x32_bf16 v[184:187], a[72:75], a[56:59], v[184:187]
  v_exp_f32 v163, v163
  v_mfma_f32_16x16x32_bf16 v[184:187], a[76:79], a[60:63], v[184:187]
  ds_read_b128 a[68:71], v5 offset:1024
  ds_read_b128 a[72:75], v5 offset:4096
  v_mfma_f32_16x16x32_bf16 v[180:183], a[80:83], a[32:35], v[228:231]
  v_exp_f32 v168, v168
  v_mfma_f32_16x16x32_bf16 v[180:183], a[84:87], a[36:39], v[180:183]
  ds_read_b128 a[76:79], v5 offset:5120
  v_cvt_pk_bf16_f32 v193, v162, v163
  v_mfma_f32_16x16x32_bf16 v[180:183], a[88:91], a[40:43], v[180:183]
  v_exp_f32 v169, v169
  v_mfma_f32_16x16x32_bf16 v[180:183], a[92:95], a[44:47], v[180:183]
  s_waitcnt vmcnt(4) lgkmcnt(4)
  s_barrier
  v_mfma_f32_16x16x32_bf16 v[188:191], a[80:83], a[48:51], v[236:239]
  v_exp_f32 v170, v170
  s_add_u32 s52, s3, 45056
  v_mfma_f32_16x16x32_bf16 v[188:191], a[84:87], a[52:55], v[188:191]
  ds_read_b128 a[80:83], v5 offset:8192
  v_cvt_pk_bf16_f32 v196, v168, v169
  buffer_store_dwordx4 a[152:155], v4, s[40:43], s52 offen offset:0 sc1
  v_mfma_f32_16x16x32_bf16 v[188:191], a[88:91], a[56:59], v[188:191]
  v_exp_f32 v171, v171
  v_mfma_f32_16x16x32_bf16 v[188:191], a[92:95], a[60:63], v[188:191]
  ds_read_b128 a[84:87], v5 offset:9216
  ds_read_b128 a[88:91], v5 offset:12288
  v_mfma_f32_16x16x32_bf16 v[80:83], a[96:99], v[200:203], v[80:83]
  v_exp_f32 v164, v164
  v_mfma_f32_16x16x32_bf16 v[112:115], a[96:99], v[204:207], v[112:115]
  ds_read_b128 a[92:95], v5 offset:13312
  v_add_u32 v5, 0x4000, v5
  v_cvt_pk_bf16_f32 v197, v170, v171
  v_mfma_f32_16x16x32_bf16 v[84:87], a[100:103], v[200:203], v[84:87]
  v_exp_f32 v165, v165
  s_add_u32 s52, s3, 45056
  v_mfma_f32_16x16x32_bf16 v[116:119], a[100:103], v[204:207], v[116:119]
  v_and_b32 v5, 0x1ffff, v5
  ds_read_b128 a[96:99], v5 offset:2048
  buffer_store_dwordx4 a[156:159], v4, s[40:43], s52 offen offset:1024 sc1
  v_mfma_f32_16x16x32_bf16 v[88:91], a[104:107], v[200:203], v[88:91]
  v_exp_f32 v166, v166
  v_mfma_f32_16x16x32_bf16 v[120:123], a[104:107], v[204:207], v[120:123]
  ds_read_b128 a[100:103], v5 offset:3072
  v_cvt_pk_bf16_f32 v194, v164, v165
  v_mfma_f32_16x16x32_bf16 v[92:95], a[108:111], v[200:203], v[92:95]
  v_exp_f32 v167, v167
  v_mfma_f32_16x16x32_bf16 v[124:127], a[108:111], v[204:207], v[124:127]
  ds_read_b128 a[104:107], v5 offset:6144
  v_mfma_f32_16x16x32_bf16 v[96:99], a[112:115], v[200:203], v[96:99]
  v_exp_f32 v172, v172
  v_mfma_f32_16x16x32_bf16 v[128:131], a[112:115], v[204:207], v[128:131]
  ds_read_b128 a[108:111], v5 offset:7168
  v_cvt_pk_bf16_f32 v195, v166, v167
  v_mfma_f32_16x16x32_bf16 v[100:103], a[116:119], v[200:203], v[100:103]
  v_exp_f32 v173, v173
  v_mfma_f32_16x16x32_bf16 v[132:135], a[116:119], v[204:207], v[132:135]
  ds_read_b128 a[112:115], v5 offset:10240
  v_mfma_f32_16x16x32_bf16 v[104:107], a[120:123], v[200:203], v[104:107]
  v_exp_f32 v174, v174
  v_mfma_f32_16x16x32_bf16 v[136:139], a[120:123], v[204:207], v[136:139]
  ds_read_b128 a[116:119], v5 offset:11264
  v_cvt_pk_bf16_f32 v198, v172, v173
  v_mfma_f32_16x16x32_bf16 v[108:111], a[124:127], v[200:203], v[108:111]
  v_exp_f32 v175, v175
  v_mfma_f32_16x16x32_bf16 v[140:143], a[124:127], v[204:207], v[140:143]
  ds_read_b128 a[120:123], v5 offset:14336
  v_mfma_f32_16x16x32_bf16 v[152:155], a[128:131], v[200:203], v[152:155]
  ds_read_b128 a[124:127], v5 offset:15360
  s_cmp_lg_u32 s48, s49
  v_mfma_f32_16x16x32_bf16 v[156:159], a[128:131], v[204:207], v[156:159]
  v_cvt_pk_bf16_f32 v199, v174, v175
  s_waitcnt lgkmcnt(8)
  s_cbranch_scc1 LA_S1
  s_branch LA_H
LQ_nspin:
  s_mov_b32 s54, 0x10000
LQ_nspin_l:
  s_sleep 8
  global_load_dwordx2 v[20:21], v17, s[24:25] sc1
  s_sub_u32 s54, s54, 1
  s_waitcnt vmcnt(0)
  v_readfirstlane_b32 s0, v20
  v_readfirstlane_b32 s1, v21
  s_cmp_eq_u32 s54, 0
  s_cbranch_scc1 LQ_nspin_ret
  s_cmp_eq_u32 s0, 0
  s_cbranch_scc1 LQ_nspin_l
  s_branch LQ_nspin_ret
LQ_spin:
  s_mov_b32 s94, 0x10000
LQ_spin_l:
  s_sleep 2
  buffer_load_dwordx2 v[20:21], v17, s[40:43], s52 offen sc1
  s_sub_u32 s94, s94, 1
  s_cmp_eq_u32 s94, 0
  s_waitcnt vmcnt(0)
  s_cbranch_scc1 LQ_spin_ret
  v_cmp_ne_u64 vcc, s[0:1], v[20:21]
  s_nop 1
  s_cbranch_vccnz LQ_spin_l
  s_branch LQ_spin_ret
.p2align 6
LA_e1:
  v_mov_b32 v240, v208
  v_cndmask_b32 v208, v240, v255, s[92:93]
  v_cndmask_b32 v220, v216, v255, s[92:93]
  v_mov_b32 v212, v255
  v_cndmask_b32 v209, v240, v255, s[94:95]
  v_cndmask_b32 v221, v216, v255, s[94:95]
  v_mov_b32 v213, v255
  v_cndmask_b32 v210, v240, v255, s[96:97]
  v_cndmask_b32 v222, v216, v255, s[96:97]
  v_mov_b32 v214, v255
  v_cndmask_b32 v211, v240, v255, s[98:99]
  v_cndmask_b32 v223, v216, v255, s[98:99]
  v_mov_b32 v215, v255
  s_branch LA_e1r
.p2align 6
LA_fa:
  s_lshl_b32 s54, s29, 12
  s_add_u32 s54, s54, 41943040
  s_mul_i32 s55, s50, 264192
  s_add_u32 s54, s54, s55
  v_rcp_f32 v248, v144
  v_rcp_f32 v250, v148
  v_mov_b32 v249, v248
  v_mov_b32 v251, v250
  v_pk_mul_f32 v[16:17], v[16:17], v[248:249]
  v_pk_mul_f32 v[18:19], v[18:19], v[248:249]
  v_pk_mul_f32 v[20:21], v[20:21], v[248:249]
  v_pk_mul_f32 v[22:23], v[22:23], v[248:249]
  v_cvt_pk_bf16_f32 v16, v16, v17
  v_cvt_pk_bf16_f32 v17, v18, v19
  v_cvt_pk_bf16_f32 v18, v20, v21
  v_cvt_pk_bf16_f32 v19, v22, v23
  buffer_store_dwordx4 v[16:19], v4, s[40:43], s54 offen offset:0 sc1
  v_pk_mul_f32 v[24:25], v[24:25], v[248:249]
  v_pk_mul_f32 v[26:27], v[26:27], v[248:249]
  v_pk_mul_f32 v[28:29], v[28:29], v[248:249]
  v_pk_mul_f32 v[30:31], v[30:31], v[248:249]
  v_cvt_pk_bf16_f32 v20, v24, v25
  v_cvt_pk_bf16_f32 v21, v26, v27
  v_cvt_pk_bf16_f32 v22, v28, v29
  v_cvt_pk_bf16_f32 v23, v30, v31
  buffer_store_dwordx4 v[20:23], v4, s[40:43], s54 offen offset:1024 sc1
  v_pk_mul_f32 v[32:33], v[32:33], v[248:249]
  v_pk_mul_f32 v[34:35], v[34:35], v[248:249]
  v_pk_mul_f32 v[36:37], v[36:37], v[248:249]
  v_pk_mul_f32 v[38:39], v[38:39], v[248:249]
  v_cvt_pk_bf16_f32 v24, v32, v33
  v_cvt_pk_bf16_f32 v25, v34, v35
  v_cvt_pk_bf16_f32 v26, v36, v37
  v_cvt_pk_bf16_f32 v27, v38, v39
  buffer_store_dwordx4 v[24:27], v4, s[40:43], s54 offen offset:2048 sc1
  v_pk_mul_f32 v[40:41], v[40:41], v[248:249]
  v_pk_mul_f32 v[42:43], v[42:43], v[248:249]
  v_pk_mul_f32 v[44:45], v[44:45], v[248:249]
  v_pk_mul_f32 v[46:47], v[46:47], v[248:249]
  v_cvt_pk_bf16_f32 v28, v40, v41
  v_cvt_pk_bf16_f32 v29, v42, v43
  v_cvt_pk_bf16_f32 v30, v44, v45
  v_cvt_pk_bf16_f32 v31, v46, v47
  buffer_store_dwordx4 v[28:31], v4, s[40:43], s54 offen offset:3072 sc1
  s_add_u32 s54, s54, 132096
  v_pk_mul_f32 v[48:49], v[48:49], v[250:251]
  v_pk_mul_f32 v[50:51], v[50:51], v[250:251]
  v_pk_mul_f32 v[52:53], v[52:53], v[250:251]
  v_pk_mul_f32 v[54:55], v[54:55], v[250:251]
  v_cvt_pk_bf16_f32 v32, v48, v49
  v_cvt_pk_bf16_f32 v33, v50, v51
  v_cvt_pk_bf16_f32 v34, v52, v53
  v_cvt_pk_bf16_f32 v35, v54, v55
  buffer_store_dwordx4 v[32:35], v4, s[40:43], s54 offen offset:0 sc1
  v_pk_mul_f32 v[56:57], v[56:57], v[250:251]
  v_pk_mul_f32 v[58:59], v[58:59], v[250:251]
  v_pk_mul_f32 v[60:61], v[60:61], v[250:251]
  v_pk_mul_f32 v[62:63], v[62:63], v[250:251]
  v_cvt_pk_bf16_f32 v36, v56, v57
  v_cvt_pk_bf16_f32 v37, v58, v59
  v_cvt_pk_bf16_f32 v38, v60, v61
  v_cvt_pk_bf16_f32 v39, v62, v63
  buffer_store_dwordx4 v[36:39], v4, s[40:43], s54 offen offset:1024 sc1
  v_pk_mul_f32 v[64:65], v[64:65], v[250:251]
  v_pk_mul_f32 v[66:67], v[66:67], v[250:251]
  v_pk_mul_f32 v[68:69], v[68:69], v[250:251]
  v_pk_mul_f32 v[70:71], v[70:71], v[250:251]
  v_cvt_pk_bf16_f32 v40, v64, v65
  v_cvt_pk_bf16_f32 v41, v66, v67
  v_cvt_pk_bf16_f32 v42, v68, v69
  v_cvt_pk_bf16_f32 v43, v70, v71
  buffer_store_dwordx4 v[40:43], v4, s[40:43], s54 offen offset:2048 sc1
  v_pk_mul_f32 v[72:73], v[72:73], v[250:251]
  v_pk_mul_f32 v[74:75], v[74:75], v[250:251]
  v_pk_mul_f32 v[76:77], v[76:77], v[250:251]
  v_pk_mul_f32 v[78:79], v[78:79], v[250:251]
  v_cvt_pk_bf16_f32 v44, v72, v73
  v_cvt_pk_bf16_f32 v45, v74, v75
  v_cvt_pk_bf16_f32 v46, v76, v77
  v_cvt_pk_bf16_f32 v47, v78, v79
  buffer_store_dwordx4 v[44:47], v4, s[40:43], s54 offen offset:3072 sc1
  s_branch LA_far
LA_ks:
  s_mov_b32 s54, 0x10000
LA_ks_l:
  s_sleep 2
  buffer_load_dwordx2 v[6:7], v8, s[40:43], s52 offen sc1
  s_sub_u32 s54, s54, 1
  s_cmp_eq_u32 s54, 0
  s_waitcnt vmcnt(0)
  s_cbranch_scc1 LA_ks_ret
  v_cmp_ne_u64 vcc, s[0:1], v[6:7]
  s_nop 1
  s_cbranch_vccnz LA_ks_l
  s_branch LA_ks_ret
LA_ks2:
  s_mov_b32 s54, 0x10000
LA_ks2_l:
  s_sleep 2
  buffer_load_dwordx2 v[6:7], v8, s[40:43], s52 offen sc1
  s_sub_u32 s54, s54, 1
  s_cmp_eq_u32 s54, 0
  s_waitcnt vmcnt(0)
  s_cbranch_scc1 LA_ks2_ret
  v_cmp_ne_u64 vcc, s[0:1], v[6:7]
  s_nop 1
  s_cbranch_vccnz LA_ks2_l
  s_branch LA_ks2_ret
.p2align 6
LA_act:
  s_cmp_eq_u32 s48, 7
  s_cbranch_scc1 LA_act7
  s_cmp_eq_u32 s48, 8
  s_cbranch_scc1 LA_act8
  s_cmp_eq_u32 s48, 9
  s_cbranch_scc1 LA_act9
  s_cmp_eq_u32 s48, 14
  s_cbranch_scc1 LA_act14
  s_cmp_eq_u32 s48, 15
  s_cbranch_scc1 LA_act15
  s_cmp_eq_u32 s48, 30
  s_cbranch_scc1 LA_act30
LA_act31:
  v_mov_b32 v240, v224
  v_cndmask_b32 v224, v240, v255, s[92:93]
  v_cndmask_b32 v236, v232, v255, s[92:93]
  v_mov_b32 v228, v255
  v_cndmask_b32 v225, v240, v255, s[94:95]
  v_cndmask_b32 v237, v232, v255, s[94:95]
  v_mov_b32 v229, v255
  v_cndmask_b32 v226, v240, v255, s[96:97]
  v_cndmask_b32 v238, v232, v255, s[96:97]
  v_mov_b32 v230, v255
  v_cndmask_b32 v227, v240, v255, s[98:99]
  v_cndmask_b32 v239, v232, v255, s[98:99]
  v_mov_b32 v231, v255
  s_branch LA_sel
LA_act30:
  s_getpc_b64 s[54:55]
L_ctb:
  s_lshl_b32 s56, s28, 13
  s_add_u32 s56, s56, LA_fin - L_ctb
  v_lshlrev_b32 v8, 7, v1
  v_add_u32 v8, s56, v8
  s_mov_b32 s56, L_codeend - L_ctb - 4
  v_min_u32 v9, s56, v8
  global_load_dword a252, v9, s[54:55]
  v_lshlrev_b32 v13, 3, v1
  s_lshl_b32 s39, s28, 9
  s_add_u32 s39, s39, 73412608
  buffer_load_dwordx2 v[10:11], v13, s[40:43], s39 offen sc1
  buffer_load_dword a251, v12, s[44:47], s57 offen
  s_branch LA_sel
LA_act15:
  s_waitcnt vmcnt(4)
  v_cmp_ne_u64 vcc, s[0:1], v[6:7]
  s_nop 1
  s_cbranch_vccnz LA_ks2
LA_ks2_ret:
  s_branch LA_sel
LA_act14:
  s_lshl_b32 s52, s29, 7
  s_add_u32 s52, s52, 73404416
  v_and_b32 v8, 7, v1
  v_lshlrev_b32 v8, 3, v8
  buffer_load_dwordx2 v[6:7], v8, s[40:43], s52 offen sc1
  s_branch LA_sel
LA_act9:
  s_waitcnt vmcnt(4)
  v_cmp_ne_u64 vcc, s[0:1], v[6:7]
  s_nop 1
  s_cbranch_vccnz LA_ks
LA_ks_ret:
  s_branch LA_sel
LA_act8:
  s_lshl_b32 s52, s29, 7
  s_add_u32 s52, s52, 73404416
  v_and_b32 v8, 7, v1
  v_lshlrev_b32 v8, 3, v8
  buffer_load_dwordx2 v[6:7], v8, s[40:43], s52 offen sc1
  s_lshl_b32 s54, s2, 3
  s_add_u32 s54, s54, 73412608
  s_cmp_lg_u32 s28, 0
  s_cbranch_scc1 LA_wf2
  v_mov_b32 v2, s0
  v_mov_b32 v3, s1
  v_mov_b32 v0, 0
  s_mov_b64 exec, 1
  buffer_store_dwordx2 v[2:3], v0, s[40:43], s54 offen sc1
  s_mov_b64 exec, -1
LA_wf2:
  s_branch LA_sel
LA_act7:
  s_lshl_b32 s54, s29, 7
  s_lshl_b32 s55, s30, 3
  s_add_u32 s54, s54, s55
  s_add_u32 s54, s54, 73404416
  s_cmp_lg_u32 s28, 0
  s_cbranch_scc1 LA_kf
  v_mov_b32 v2, s0
  v_mov_b32 v3, s1
  v_mov_b32 v0, 0
  s_mov_b64 exec, 1
  buffer_store_dwordx2 v[2:3], v0, s[40:43], s54 offen sc1
  s_mov_b64 exec, -1
LA_kf:
  s_lshl_b32 s54, s2, 3
  s_add_u32 s54, s54, 73412608
  s_cmp_lg_u32 s28, 0
  s_cbranch_scc1 LA_wf1
  v_mov_b32 v2, s0
  v_mov_b32 v3, s1
  v_mov_b32 v0, 0
  s_mov_b64 exec, 1
  buffer_store_dwordx2 v[2:3], v0, s[40:43], s54 offen sc1
  s_mov_b64 exec, -1
LA_wf1:
  s_branch LA_sel
LA_fin:
  s_mov_b32 s32, s16
  s_mov_b32 s33, s17
  s_mov_b32 s34, 2621440
  s_mov_b32 s35, 0x20000
  s_lshl_b32 s48, s100, 6
  s_mul_i32 s49, s28, 3072
  s_mov_b32 s53, 0
  v_accvgpr_read_b32 v200, a234
  v_accvgpr_read_b32 v201, a235
  v_accvgpr_read_b32 v202, a236
  v_accvgpr_read_b32 v203, a237
  v_accvgpr_read_b32 v204, a238
  v_accvgpr_read_b32 v205, a239
  v_accvgpr_read_b32 v206, a240
  v_accvgpr_read_b32 v207, a241
  s_waitcnt vmcnt(1) lgkmcnt(0)
  v_cmp_ne_u64 vcc, s[0:1], v[10:11]
  s_nop 1
  s_cbranch_vccnz LA_ws
LA_ws_ret:
  s_barrier
  s_cmp_lg_u32 s30, 7
  s_cbranch_scc1 LA_fin2
  s_lshl_b32 s54, s29, 12
  s_add_u32 s54, s54, 41943040
  s_mul_i32 s55, s50, 264192
  s_add_u32 s54, s54, s55
  v_rcp_f32 v248, v144
  v_rcp_f32 v250, v148
  v_mov_b32 v249, v248
  v_mov_b32 v251, v250
  v_pk_mul_f32 v[16:17], v[16:17], v[248:249]
  v_pk_mul_f32 v[18:19], v[18:19], v[248:249]
  v_pk_mul_f32 v[20:21], v[20:21], v[248:249]
  v_pk_mul_f32 v[22:23], v[22:23], v[248:249]
  v_cvt_pk_bf16_f32 v16, v16, v17
  v_cvt_pk_bf16_f32 v17, v18, v19
  v_cvt_pk_bf16_f32 v18, v20, v21
  v_cvt_pk_bf16_f32 v19, v22, v23
  buffer_store_dwordx4 v[16:19], v4, s[40:43], s54 offen offset:0 sc1
  v_pk_mul_f32 v[24:25], v[24:25], v[248:249]
  v_pk_mul_f32 v[26:27], v[26:27], v[248:249]
  v_pk_mul_f32 v[28:29], v[28:29], v[248:249]
  v_pk_mul_f32 v[30:31], v[30:31], v[248:249]
  v_cvt_pk_bf16_f32 v20, v24, v25
  v_cvt_pk_bf16_f32 v21, v26, v27
  v_cvt_pk_bf16_f32 v22, v28, v29
  v_cvt_pk_bf16_f32 v23, v30, v31
  buffer_store_dwordx4 v[20:23], v4, s[40:43], s54 offen offset:1024 sc1
  v_pk_mul_f32 v[32:33], v[32:33], v[248:249]
  v_pk_mul_f32 v[34:35], v[34:35], v[248:249]
  v_pk_mul_f32 v[36:37], v[36:37], v[248:249]
  v_pk_mul_f32 v[38:39], v[38:39], v[248:249]
  v_cvt_pk_bf16_f32 v24, v32, v33
  v_cvt_pk_bf16_f32 v25, v34, v35
  v_cvt_pk_bf16_f32 v26, v36, v37
  v_cvt_pk_bf16_f32 v27, v38, v39
  buffer_store_dwordx4 v[24:27], v4, s[40:43], s54 offen offset:2048 sc1
  v_pk_mul_f32 v[40:41], v[40:41], v[248:249]
  v_pk_mul_f32 v[42:43], v[42:43], v[248:249]
  v_pk_mul_f32 v[44:45], v[44:45], v[248:249]
  v_pk_mul_f32 v[46:47], v[46:47], v[248:249]
  v_cvt_pk_bf16_f32 v28, v40, v41
  v_cvt_pk_bf16_f32 v29, v42, v43
  v_cvt_pk_bf16_f32 v30, v44, v45
  v_cvt_pk_bf16_f32 v31, v46, v47
  buffer_store_dwordx4 v[28:31], v4, s[40:43], s54 offen offset:3072 sc1
  s_add_u32 s54, s54, 132096
  v_pk_mul_f32 v[48:49], v[48:49], v[250:251]
  v_pk_mul_f32 v[50:51], v[50:51], v[250:251]
  v_pk_mul_f32 v[52:53], v[52:53], v[250:251]
  v_pk_mul_f32 v[54:55], v[54:55], v[250:251]
  v_cvt_pk_bf16_f32 v32, v48, v49
  v_cvt_pk_bf16_f32 v33, v50, v51
  v_cvt_pk_bf16_f32 v34, v52, v53
  v_cvt_pk_bf16_f32 v35, v54, v55
  buffer_store_dwordx4 v[32:35], v4, s[40:43], s54 offen offset:0 sc1
  v_pk_mul_f32 v[56:57], v[56:57], v[250:251]
  v_pk_mul_f32 v[58:59], v[58:59], v[250:251]
  v_pk_mul_f32 v[60:61], v[60:61], v[250:251]
  v_pk_mul_f32 v[62:63], v[62:63], v[250:251]
  v_cvt_pk_bf16_f32 v36, v56, v57
  v_cvt_pk_bf16_f32 v37, v58, v59
  v_cvt_pk_bf16_f32 v38, v60, v61
  v_cvt_pk_bf16_f32 v39, v62, v63
  buffer_store_dwordx4 v[36:39], v4, s[40:43], s54 offen offset:1024 sc1
  v_pk_mul_f32 v[64:65], v[64:65], v[250:251]
  v_pk_mul_f32 v[66:67], v[66:67], v[250:251]
  v_pk_mul_f32 v[68:69], v[68:69], v[250:251]
  v_pk_mul_f32 v[70:71], v[70:71], v[250:251]
  v_cvt_pk_bf16_f32 v40, v64, v65
  v_cvt_pk_bf16_f32 v41, v66, v67
  v_cvt_pk_bf16_f32 v42, v68, v69
  v_cvt_pk_bf16_f32 v43, v70, v71
  buffer_store_dwordx4 v[40:43], v4, s[40:43], s54 offen offset:2048 sc1
  v_pk_mul_f32 v[72:73], v[72:73], v[250:251]
  v_pk_mul_f32 v[74:75], v[74:75], v[250:251]
  v_pk_mul_f32 v[76:77], v[76:77], v[250:251]
  v_pk_mul_f32 v[78:79], v[78:79], v[250:251]
  v_cvt_pk_bf16_f32 v44, v72, v73
  v_cvt_pk_bf16_f32 v45, v74, v75
  v_cvt_pk_bf16_f32 v46, v76, v77
  v_cvt_pk_bf16_f32 v47, v78, v79
  buffer_store_dwordx4 v[44:47], v4, s[40:43], s54 offen offset:3072 sc1
LA_fin2:
  v_mfma_f32_16x16x32_bf16 v[80:83], a[96:99], v[192:195], v[80:83]
  s_mov_b32 s52, 0
  s_add_u32 m0, s49, 0
  v_mfma_f32_16x16x32_bf16 v[112:115], a[96:99], v[196:199], v[112:115]
  buffer_load_dwordx4 v200, s[32:35], s52 offen lds
  v_mfma_f32_16x16x32_bf16 v[84:87], a[100:103], v[192:195], v[84:87]
  s_add_u32 m0, s49, 1024
  v_mfma_f32_16x16x32_bf16 v[116:119], a[100:103], v[196:199], v[116:119]
  buffer_load_dwordx4 v201, s[32:35], s52 offen lds
  v_mfma_f32_16x16x32_bf16 v[88:91], a[104:107], v[192:195], v[88:91]
  s_add_u32 m0, s49, 2048
  v_mfma_f32_16x16x32_bf16 v[120:123], a[104:107], v[196:199], v[120:123]
  buffer_load_dwordx4 v202, s[32:35], s52 offen lds
  v_mfma_f32_16x16x32_bf16 v[92:95], a[108:111], v[192:195], v[92:95]
  v_mfma_f32_16x16x32_bf16 v[124:127], a[108:111], v[196:199], v[124:127]
  buffer_load_dwordx4 a[132:135], v203, s[40:43], s53 offen offset:0 sc1
  v_mfma_f32_16x16x32_bf16 v[96:99], a[112:115], v[192:195], v[96:99]
  v_mfma_f32_16x16x32_bf16 v[128:131], a[112:115], v[196:199], v[128:131]
  buffer_load_dwordx4 a[136:139], v204, s[40:43], s53 offen offset:0 sc1
  v_mfma_f32_16x16x32_bf16 v[100:103], a[116:119], v[192:195], v[100:103]
  v_mfma_f32_16x16x32_bf16 v[132:135], a[116:119], v[196:199], v[132:135]
  buffer_load_dwordx4 a[140:143], v205, s[40:43], s53 offen offset:0 sc1
  v_mfma_f32_16x16x32_bf16 v[104:107], a[120:123], v[192:195], v[104:107]
  v_mfma_f32_16x16x32_bf16 v[136:139], a[120:123], v[196:199], v[136:139]
  buffer_load_dwordx4 a[144:147], v206, s[40:43], s53 offen offset:0 sc1
  v_mfma_f32_16x16x32_bf16 v[108:111], a[124:127], v[192:195], v[108:111]
  v_mfma_f32_16x16x32_bf16 v[140:143], a[124:127], v[196:199], v[140:143]
  buffer_load_dwordx4 a[148:151], v203, s[40:43], s53 offen offset:1024 sc1
  v_mfma_f32_16x16x32_bf16 v[152:155], a[128:131], v[192:195], v[152:155]
  v_mfma_f32_16x16x32_bf16 v[156:159], a[128:131], v[196:199], v[156:159]
  buffer_load_dwordx4 a[152:155], v204, s[40:43], s53 offen offset:1024 sc1
  v_add_f32 v241, v144, v148
  v_mov_b32 v242, 0x5d800000
  v_cmp_nle_f32 vcc, v241, v242
  s_nop 1
  s_cbranch_vccnz LA_slowA
LA_slowA_ret:
  v_mov_b32 v242, 0x5d800000
  s_nop 0
  v_add_f32 v241, v152, v156
  v_cmp_nle_f32 vcc, v241, v242
  s_nop 1
  s_cbranch_vccnz LA_slowB
LA_slowB_ret:
  s_lshl_b32 s54, s29, 12
  s_add_u32 s54, s54, 41943040
  s_mul_i32 s55, s50, 264192
  s_sub_u32 s55, 16644096, s55
  s_add_u32 s59, s54, s55
  buffer_load_dwordx4 a[156:159], v205, s[40:43], s53 offen offset:1024 sc1
  buffer_load_dwordx4 a[160:163], v206, s[40:43], s53 offen offset:1024 sc1
  v_rcp_f32 v248, v152
  v_rcp_f32 v250, v156
  v_mov_b32 v249, v248
  v_mov_b32 v251, v250
  v_pk_mul_f32 v[80:81], v[80:81], v[248:249]
  v_pk_mul_f32 v[82:83], v[82:83], v[248:249]
  v_pk_mul_f32 v[84:85], v[84:85], v[248:249]
  v_pk_mul_f32 v[86:87], v[86:87], v[248:249]
  s_mov_b32 s52, 128
  s_add_u32 m0, s49, 12288
  s_nop 0
  buffer_load_dwordx4 v200, s[32:35], s52 offen lds
  v_cvt_pk_bf16_f32 v80, v80, v81
  v_cvt_pk_bf16_f32 v81, v82, v83
  v_cvt_pk_bf16_f32 v82, v84, v85
  v_cvt_pk_bf16_f32 v83, v86, v87
  s_add_u32 m0, s49, 13312
  s_nop 0
  buffer_load_dwordx4 v201, s[32:35], s52 offen lds
  v_pk_mul_f32 v[88:89], v[88:89], v[248:249]
  v_pk_mul_f32 v[90:91], v[90:91], v[248:249]
  v_pk_mul_f32 v[92:93], v[92:93], v[248:249]
  v_pk_mul_f32 v[94:95], v[94:95], v[248:249]
  s_add_u32 m0, s49, 14336
  s_nop 0
  buffer_load_dwordx4 v202, s[32:35], s52 offen lds
  buffer_store_dwordx4 v[80:83], v4, s[40:43], s59 offen offset:0 sc1
  v_cvt_pk_bf16_f32 v84, v88, v89
  v_cvt_pk_bf16_f32 v85, v90, v91
  v_cvt_pk_bf16_f32 v86, v92, v93
  v_cvt_pk_bf16_f32 v87, v94, v95
  buffer_load_dwordx4 a[164:167], v203, s[40:43], s53 offen offset:2048 sc1
  v_pk_mul_f32 v[96:97], v[96:97], v[248:249]
  v_pk_mul_f32 v[98:99], v[98:99], v[248:249]
  v_pk_mul_f32 v[100:101], v[100:101], v[248:249]
  v_pk_mul_f32 v[102:103], v[102:103], v[248:249]
  buffer_load_dwordx4 a[168:171], v204, s[40:43], s53 offen offset:2048 sc1
  v_cvt_pk_bf16_f32 v88, v96, v97
  v_cvt_pk_bf16_f32 v89, v98, v99
  v_cvt_pk_bf16_f32 v90, v100, v101
  v_cvt_pk_bf16_f32 v91, v102, v103
  buffer_load_dwordx4 a[172:175], v205, s[40:43], s53 offen offset:2048 sc1
  v_pk_mul_f32 v[104:105], v[104:105], v[248:249]
  v_pk_mul_f32 v[106:107], v[106:107], v[248:249]
  v_pk_mul_f32 v[108:109], v[108:109], v[248:249]
  v_pk_mul_f32 v[110:111], v[110:111], v[248:249]
  buffer_load_dwordx4 a[176:179], v206, s[40:43], s53 offen offset:2048 sc1
  buffer_store_dwordx4 v[84:87], v4, s[40:43], s59 offen offset:1024 sc1
  v_cvt_pk_bf16_f32 v92, v104, v105
  v_cvt_pk_bf16_f32 v93, v106, v107
  v_cvt_pk_bf16_f32 v94, v108, v109
  v_cvt_pk_bf16_f32 v95, v110, v111
  buffer_load_dwordx4 a[180:183], v203, s[40:43], s53 offen offset:3072 sc1
  v_pk_mul_f32 v[112:113], v[112:113], v[250:251]
  v_pk_mul_f32 v[114:115], v[114:115], v[250:251]
  v_pk_mul_f32 v[116:117], v[116:117], v[250:251]
  v_pk_mul_f32 v[118:119], v[118:119], v[250:251]
  buffer_load_dwordx4 a[184:187], v204, s[40:43], s53 offen offset:3072 sc1
  v_cvt_pk_bf16_f32 v96, v112, v113
  v_cvt_pk_bf16_f32 v97, v114, v115
  v_cvt_pk_bf16_f32 v98, v116, v117
  v_cvt_pk_bf16_f32 v99, v118, v119
  buffer_load_dwordx4 a[188:191], v205, s[40:43], s53 offen offset:3072 sc1
  v_pk_mul_f32 v[120:121], v[120:121], v[250:251]
  v_pk_mul_f32 v[122:123], v[122:123], v[250:251]
  v_pk_mul_f32 v[124:125], v[124:125], v[250:251]
  v_pk_mul_f32 v[126:127], v[126:127], v[250:251]
  buffer_load_dwordx4 a[192:195], v206, s[40:43], s53 offen offset:3072 sc1
  buffer_store_dwordx4 v[88:91], v4, s[40:43], s59 offen offset:2048 sc1
  v_cvt_pk_bf16_f32 v100, v120, v121
  v_cvt_pk_bf16_f32 v101, v122, v123
  v_cvt_pk_bf16_f32 v102, v124, v125
  v_cvt_pk_bf16_f32 v103, v126, v127
  s_mov_b32 s52, 256
  s_add_u32 m0, s49, 24576
  s_nop 0
  buffer_load_dwordx4 v200, s[32:35], s52 offen lds
  v_pk_mul_f32 v[128:129], v[128:129], v[250:251]
  v_pk_mul_f32 v[130:131], v[130:131], v[250:251]
  v_pk_mul_f32 v[132:133], v[132:133], v[250:251]
  v_pk_mul_f32 v[134:135], v[134:135], v[250:251]
  s_add_u32 m0, s49, 25600
  s_nop 0
  buffer_load_dwordx4 v201, s[32:35], s52 offen lds
  v_cvt_pk_bf16_f32 v104, v128, v129
  v_cvt_pk_bf16_f32 v105, v130, v131
  v_cvt_pk_bf16_f32 v106, v132, v133
  v_cvt_pk_bf16_f32 v107, v134, v135
  s_add_u32 m0, s49, 26624
  s_nop 0
  buffer_load_dwordx4 v202, s[32:35], s52 offen lds
  v_pk_mul_f32 v[136:137], v[136:137], v[250:251]
  v_pk_mul_f32 v[138:139], v[138:139], v[250:251]
  v_pk_mul_f32 v[140:141], v[140:141], v[250:251]
  v_pk_mul_f32 v[142:143], v[142:143], v[250:251]
  s_add_u32 s53, s53, 4096
  s_nop 0
  buffer_load_dwordx4 a[196:199], v203, s[40:43], s53 offen offset:0 sc1
  buffer_store_dwordx4 v[92:95], v4, s[40:43], s59 offen offset:3072 sc1
  v_cvt_pk_bf16_f32 v108, v136, v137
  v_cvt_pk_bf16_f32 v109, v138, v139
  v_cvt_pk_bf16_f32 v110, v140, v141
  v_cvt_pk_bf16_f32 v111, v142, v143
  buffer_load_dwordx4 a[200:203], v204, s[40:43], s53 offen offset:0 sc1
  buffer_load_dwordx4 a[204:207], v205, s[40:43], s53 offen offset:0 sc1
  buffer_load_dwordx4 a[208:211], v206, s[40:43], s53 offen offset:0 sc1
  s_mov_b32 s52, 384
  s_add_u32 m0, s49, 36864
  s_nop 0
  buffer_load_dwordx4 v200, s[32:35], s52 offen lds
  s_add_u32 m0, s49, 37888
  s_nop 0
  buffer_load_dwordx4 v201, s[32:35], s52 offen lds
  s_add_u32 m0, s49, 38912
  s_nop 0
  buffer_load_dwordx4 v202, s[32:35], s52 offen lds
  v_xor_b32 v208, 64, v207
  s_lshl_b32 s54, s30, 8
  s_lshl_b32 s55, s29, 3
  s_add_u32 s50, s54, s55
  s_add_u32 s50, s50, 73400320
  s_waitcnt vmcnt(33)
  s_barrier
  ds_read_b128 a[0:3], v207 offset:0
  ds_read_b128 a[4:7], v207 offset:2048
  ds_read_b128 a[8:11], v207 offset:4096
  ds_read_b128 a[12:15], v207 offset:6144
  ds_read_b128 a[16:19], v207 offset:8192
  s_waitcnt vmcnt(29)
  s_waitcnt lgkmcnt(4)
  v_mfma_f32_16x16x32_bf16 v[112:115], a[132:135], a[0:3], 0
  s_waitcnt lgkmcnt(3)
  v_mfma_f32_16x16x32_bf16 v[116:119], a[132:135], a[4:7], 0
  s_waitcnt lgkmcnt(2)
  v_mfma_f32_16x16x32_bf16 v[120:123], a[132:135], a[8:11], 0
  ds_read_b128 a[20:23], v208 offset:0
  v_lshlrev_b32 v252, 4, v1
  s_waitcnt lgkmcnt(2)
  v_mfma_f32_16x16x32_bf16 v[124:127], a[132:135], a[12:15], 0
  s_and_b32 s56, s2, 1
  buffer_load_dwordx4 a[212:215], v203, s[40:43], s53 offen offset:1024 sc1
  s_waitcnt lgkmcnt(1)
  v_mfma_f32_16x16x32_bf16 v[128:131], a[132:135], a[16:19], 0
  ds_read_b128 a[24:27], v208 offset:2048
  v_mfma_f32_16x16x32_bf16 v[132:135], a[136:139], a[0:3], 0
  s_lshl_b32 s57, s30, 1
  s_add_u32 s59, s59, 132096
  v_mfma_f32_16x16x32_bf16 v[136:139], a[136:139], a[4:7], 0
  ds_read_b128 a[28:31], v208 offset:4096
  s_sub_u32 s57, 15, s57
  buffer_store_dwordx4 v[96:99], v4, s[40:43], s59 offen offset:0 sc1
  v_mfma_f32_16x16x32_bf16 v[140:143], a[136:139], a[8:11], 0
  buffer_load_dwordx4 a[216:219], v204, s[40:43], s53 offen offset:1024 sc1
  v_mfma_f32_16x16x32_bf16 v[144:147], a[136:139], a[12:15], 0
  ds_read_b128 a[32:35], v208 offset:6144
  s_mul_i32 s57, s57, s56
  v_mfma_f32_16x16x32_bf16 v[148:151], a[136:139], a[16:19], 0
  s_add_u32 s96, s57, s30
  v_mfma_f32_16x16x32_bf16 v[152:155], a[140:143], a[0:3], 0
  ds_read_b128 a[36:39], v208 offset:8192
  buffer_store_dwordx4 v[100:103], v4, s[40:43], s59 offen offset:1024 sc1
  v_mfma_f32_16x16x32_bf16 v[156:159], a[140:143], a[4:7], 0
  s_lshr_b32 s97, s2, 1
  buffer_load_dwordx4 a[220:223], v205, s[40:43], s53 offen offset:1024 sc1
  v_mfma_f32_16x16x32_bf16 v[160:163], a[140:143], a[8:11], 0
  s_and_b32 s97, s97, 3
  v_mfma_f32_16x16x32_bf16 v[164:167], a[140:143], a[12:15], 0
  v_mfma_f32_16x16x32_bf16 v[168:171], a[140:143], a[16:19], 0
  s_and_b32 s99, s31, 3
  buffer_store_dwordx4 v[104:107], v4, s[40:43], s59 offen offset:2048 sc1
  v_mfma_f32_16x16x32_bf16 v[172:175], a[144:147], a[0:3], 0
  s_mul_i32 s56, s28, 9
  buffer_load_dwordx4 a[224:227], v206, s[40:43], s53 offen offset:1024 sc1
  v_mfma_f32_16x16x32_bf16 v[176:179], a[144:147], a[4:7], 0
  v_mfma_f32_16x16x32_bf16 v[180:183], a[144:147], a[8:11], 0
  v_add_u32 v237, s56, v1
  v_mfma_f32_16x16x32_bf16 v[184:187], a[144:147], a[12:15], 0
  v_lshrrev_b32 v238, 1, v237
  buffer_store_dwordx4 v[108:111], v4, s[40:43], s59 offen offset:3072 sc1
  v_mfma_f32_16x16x32_bf16 v[188:191], a[144:147], a[16:19], 0
  s_waitcnt vmcnt(33)
  s_waitcnt lgkmcnt(0)
  v_mfma_f32_16x16x32_bf16 v[112:115], a[148:151], a[20:23], v[112:115]
  v_mfma_f32_16x16x32_bf16 v[116:119], a[148:151], a[24:27], v[116:119]
  s_waitcnt vmcnt(30) lgkmcnt(0)
  s_barrier
  v_mfma_f32_16x16x32_bf16 v[120:123], a[148:151], a[28:31], v[120:123]
  ds_read_b128 a[0:3], v207 offset:12288
  v_and_b32 v237, 1, v237
  v_mfma_f32_16x16x32_bf16 v[124:127], a[148:151], a[32:35], v[124:127]
  v_and_b32 v239, 3, v1
  buffer_load_dwordx4 a[132:135], v203, s[40:43], s53 offen offset:2048 sc1
  v_mfma_f32_16x16x32_bf16 v[128:131], a[148:151], a[36:39], v[128:131]
  ds_read_b128 a[4:7], v207 offset:14336
  s_mov_b32 s52, 512
  s_add_u32 m0, s49, 0
  v_mfma_f32_16x16x32_bf16 v[132:135], a[152:155], a[20:23], v[132:135]
  v_sub_u32 v237, v237, v239
  buffer_load_dwordx4 v200, s[32:35], s52 offen lds
  v_mfma_f32_16x16x32_bf16 v[136:139], a[152:155], a[24:27], v[136:139]
  ds_read_b128 a[8:11], v207 offset:16384
  v_lshlrev_b32 v237, 10, v237
  v_mfma_f32_16x16x32_bf16 v[140:143], a[152:155], a[28:31], v[140:143]
  buffer_load_dwordx4 a[136:139], v204, s[40:43], s53 offen offset:2048 sc1
  v_mfma_f32_16x16x32_bf16 v[144:147], a[152:155], a[32:35], v[144:147]
  ds_read_b128 a[12:15], v207 offset:18432
  v_add_u32 v239, s97, v238
  s_add_u32 m0, s49, 1024
  v_mfma_f32_16x16x32_bf16 v[148:151], a[152:155], a[36:39], v[148:151]
  v_and_b32 v239, 3, v239
  buffer_load_dwordx4 v201, s[32:35], s52 offen lds
  v_mfma_f32_16x16x32_bf16 v[152:155], a[156:159], a[20:23], v[152:155]
  ds_read_b128 a[16:19], v207 offset:20480
  v_mfma_f32_16x16x32_bf16 v[156:159], a[156:159], a[24:27], v[156:159]
  v_and_b32 v240, 4, v238
  buffer_load_dwordx4 a[140:143], v205, s[40:43], s53 offen offset:2048 sc1
  v_mfma_f32_16x16x32_bf16 v[160:163], a[156:159], a[28:31], v[160:163]
  s_lshl_b32 s56, s96, 3
  s_add_u32 m0, s49, 2048
  v_mfma_f32_16x16x32_bf16 v[164:167], a[156:159], a[32:35], v[164:167]
  buffer_load_dwordx4 v202, s[32:35], s52 offen lds
  v_mfma_f32_16x16x32_bf16 v[168:171], a[156:159], a[36:39], v[168:171]
  v_add3_u32 v239, v239, v240, s56
  v_mfma_f32_16x16x32_bf16 v[172:175], a[160:163], a[20:23], v[172:175]
  s_mul_i32 s56, s99, 10
  buffer_load_dwordx4 a[144:147], v206, s[40:43], s53 offen offset:2048 sc1
  v_mfma_f32_16x16x32_bf16 v[176:179], a[160:163], a[24:27], v[176:179]
  v_mfma_f32_16x16x32_bf16 v[180:183], a[160:163], a[28:31], v[180:183]
  s_add_u32 s56, s56, 124
  v_mfma_f32_16x16x32_bf16 v[184:187], a[160:163], a[32:35], v[184:187]
  v_add_u32 v240, s56, v238
  v_mfma_f32_16x16x32_bf16 v[188:191], a[160:163], a[36:39], v[188:191]
  s_waitcnt vmcnt(32)
  s_waitcnt lgkmcnt(0)
  v_mfma_f32_16x16x32_bf16 v[112:115], a[164:167], a[0:3], v[112:115]
  v_mfma_f32_16x16x32_bf16 v[116:119], a[164:167], a[4:7], v[116:119]
  v_mfma_f32_16x16x32_bf16 v[120:123], a[164:167], a[8:11], v[120:123]
  ds_read_b128 a[20:23], v208 offset:12288
  v_cmp_gt_u32 vcc, 8, v238
  v_mfma_f32_16x16x32_bf16 v[124:127], a[164:167], a[12:15], v[124:127]
  s_mov_b32 s57, 132096
  buffer_load_dwordx4 a[148:151], v203, s[40:43], s53 offen offset:3072 sc1
  v_mfma_f32_16x16x32_bf16 v[128:131], a[164:167], a[16:19], v[128:131]
  ds_read_b128 a[24:27], v208 offset:14336
  v_mfma_f32_16x16x32_bf16 v[132:135], a[168:171], a[0:3], v[132:135]
  s_nop 0
  v_mfma_f32_16x16x32_bf16 v[136:139], a[168:171], a[4:7], v[136:139]
  ds_read_b128 a[28:31], v208 offset:16384
  v_cndmask_b32 v239, v240, v239, vcc
  v_mfma_f32_16x16x32_bf16 v[140:143], a[168:171], a[8:11], v[140:143]
  buffer_load_dwordx4 a[152:155], v204, s[40:43], s53 offen offset:3072 sc1
  v_mfma_f32_16x16x32_bf16 v[144:147], a[168:171], a[12:15], v[144:147]
  ds_read_b128 a[32:35], v208 offset:18432
  v_mul_lo_u32 v239, v239, s57
  v_mfma_f32_16x16x32_bf16 v[148:151], a[168:171], a[16:19], v[148:151]
  v_add_u32 v237, 41943040, v237
  v_mfma_f32_16x16x32_bf16 v[152:155], a[172:175], a[0:3], v[152:155]
  ds_read_b128 a[36:39], v208 offset:20480
  v_mfma_f32_16x16x32_bf16 v[156:159], a[172:175], a[4:7], v[156:159]
  v_add_u32 v239, v239, v237
  buffer_load_dwordx4 a[156:159], v205, s[40:43], s53 offen offset:3072 sc1
  v_mfma_f32_16x16x32_bf16 v[160:163], a[172:175], a[8:11], v[160:163]
  v_readlane_b32 s56, v239, 0
  s_nop 1
  v_add_u32 v224, s56, v252
  v_mfma_f32_16x16x32_bf16 v[164:167], a[172:175], a[12:15], v[164:167]
  v_mfma_f32_16x16x32_bf16 v[168:171], a[172:175], a[16:19], v[168:171]
  v_readlane_b32 s56, v239, 1
  s_nop 1
  v_add_u32 v225, s56, v252
  v_mfma_f32_16x16x32_bf16 v[172:175], a[176:179], a[0:3], v[172:175]
  v_readlane_b32 s56, v239, 2
  s_nop 1
  v_add_u32 v226, s56, v252
  buffer_load_dwordx4 a[160:163], v206, s[40:43], s53 offen offset:3072 sc1
  v_mfma_f32_16x16x32_bf16 v[176:179], a[176:179], a[4:7], v[176:179]
  v_mfma_f32_16x16x32_bf16 v[180:183], a[176:179], a[8:11], v[180:183]
  v_readlane_b32 s56, v239, 3
  s_nop 1
  v_add_u32 v227, s56, v252
  v_mfma_f32_16x16x32_bf16 v[184:187], a[176:179], a[12:15], v[184:187]
  v_readlane_b32 s56, v239, 4
  s_nop 1
  v_add_u32 v228, s56, v252
  v_mfma_f32_16x16x32_bf16 v[188:191], a[176:179], a[16:19], v[188:191]
  s_waitcnt vmcnt(31)
  s_waitcnt lgkmcnt(0)
  v_mfma_f32_16x16x32_bf16 v[112:115], a[180:183], a[20:23], v[112:115]
  v_mfma_f32_16x16x32_bf16 v[116:119], a[180:183], a[24:27], v[116:119]
  s_waitcnt vmcnt(11) lgkmcnt(0)
  s_barrier
  s_cmp_lg_u32 s28, 0
  s_cbranch_scc1 LB_cf
  v_mov_b32 v2, s0
  v_mov_b32 v3, s1
  v_mov_b32 v0, 0
  s_mov_b64 exec, 1
  buffer_store_dwordx2 v[2:3], v0, s[40:43], s50 offen sc1
  s_mov_b64 exec, -1
LB_cf:
  v_mfma_f32_16x16x32_bf16 v[120:123], a[180:183], a[28:31], v[120:123]
  ds_read_b128 a[0:3], v207 offset:24576
  v_readlane_b32 s56, v239, 5
  s_nop 1
  v_add_u32 v229, s56, v252
  s_add_u32 s53, s53, 4096
  v_mfma_f32_16x16x32_bf16 v[124:127], a[180:183], a[32:35], v[124:127]
  v_readlane_b32 s56, v239, 6
  s_nop 1
  v_add_u32 v230, s56, v252
  buffer_load_dwordx4 a[164:167], v203, s[40:43], s53 offen offset:0 sc1
  v_mfma_f32_16x16x32_bf16 v[128:131], a[180:183], a[36:39], v[128:131]
  ds_read_b128 a[4:7], v207 offset:26624
  s_mov_b32 s52, 640
  s_add_u32 m0, s49, 12288
  v_mfma_f32_16x16x32_bf16 v[132:135], a[184:187], a[20:23], v[132:135]
  v_readlane_b32 s56, v239, 7
  s_nop 1
  v_add_u32 v231, s56, v252
  buffer_load_dwordx4 v200, s[32:35], s52 offen lds
  v_mfma_f32_16x16x32_bf16 v[136:139], a[184:187], a[24:27], v[136:139]
  ds_read_b128 a[8:11], v207 offset:28672
  v_readlane_b32 s56, v239, 8
  s_nop 1
  v_add_u32 v232, s56, v252
  v_mfma_f32_16x16x32_bf16 v[140:143], a[184:187], a[28:31], v[140:143]
  buffer_load_dwordx4 a[168:171], v204, s[40:43], s53 offen offset:0 sc1
  v_mfma_f32_16x16x32_bf16 v[144:147], a[184:187], a[32:35], v[144:147]
  ds_read_b128 a[12:15], v207 offset:30720
  s_lshr_b32 s56, s28, 1
  s_add_u32 m0, s49, 13312
  v_mfma_f32_16x16x32_bf16 v[148:151], a[184:187], a[36:39], v[148:151]
  s_lshl_b32 s56, s56, 13
  buffer_load_dwordx4 v201, s[32:35], s52 offen lds
  v_mfma_f32_16x16x32_bf16 v[152:155], a[188:191], a[20:23], v[152:155]
  ds_read_b128 a[16:19], v207 offset:32768
  v_mfma_f32_16x16x32_bf16 v[156:159], a[188:191], a[24:27], v[156:159]
  s_add_u32 s56, s56, 49152
  buffer_load_dwordx4 a[172:175], v205, s[40:43], s53 offen offset:0 sc1
  v_mfma_f32_16x16x32_bf16 v[160:163], a[188:191], a[28:31], v[160:163]
  v_add_u32 v233, s56, v252
  s_add_u32 m0, s49, 14336
  v_mfma_f32_16x16x32_bf16 v[164:167], a[188:191], a[32:35], v[164:167]
  buffer_load_dwordx4 v202, s[32:35], s52 offen lds
  v_mfma_f32_16x16x32_bf16 v[168:171], a[188:191], a[36:39], v[168:171]
  s_and_b32 s56, s28, 1
  v_mfma_f32_16x16x32_bf16 v[172:175], a[192:195], a[20:23], v[172:175]
  s_mul_i32 s56, s56, 10240
  buffer_load_dwordx4 a[176:179], v206, s[40:43], s53 offen offset:0 sc1
  v_mfma_f32_16x16x32_bf16 v[176:179], a[192:195], a[24:27], v[176:179]
  v_mfma_f32_16x16x32_bf16 v[180:183], a[192:195], a[28:31], v[180:183]
  s_add_u32 s56, s56, 65536
  v_mfma_f32_16x16x32_bf16 v[184:187], a[192:195], a[32:35], v[184:187]
  v_add_u32 v234, s56, v252
  v_mfma_f32_16x16x32_bf16 v[188:191], a[192:195], a[36:39], v[188:191]
  s_waitcnt vmcnt(29)
  s_waitcnt lgkmcnt(0)
  v_mfma_f32_16x16x32_bf16 v[112:115], a[196:199], a[0:3], v[112:115]
  v_mfma_f32_16x16x32_bf16 v[116:119], a[196:199], a[4:7], v[116:119]
  v_mfma_f32_16x16x32_bf16 v[120:123], a[196:199], a[8:11], v[120:123]
  ds_read_b128 a[20:23], v208 offset:24576
  v_add_u32 v235, 73728, v233
  v_mfma_f32_16x16x32_bf16 v[124:127], a[196:199], a[12:15], v[124:127]
  v_add_u32 v236, 73728, v234
  buffer_load_dwordx4 a[180:183], v203, s[40:43], s53 offen offset:1024 sc1
  v_mfma_f32_16x16x32_bf16 v[128:131], a[196:199], a[16:19], v[128:131]
  ds_read_b128 a[24:27], v208 offset:26624
  v_mfma_f32_16x16x32_bf16 v[132:135], a[200:203], a[0:3], v[132:135]
  s_mul_i32 s98, s28, 9216
  v_mfma_f32_16x16x32_bf16 v[136:139], a[200:203], a[4:7], v[136:139]
  ds_read_b128 a[28:31], v208 offset:28672
  s_lshl_b32 s92, s97, 15
  v_mfma_f32_16x16x32_bf16 v[140:143], a[200:203], a[8:11], v[140:143]
  buffer_load_dwordx4 a[184:187], v204, s[40:43], s53 offen offset:1024 sc1
  v_mfma_f32_16x16x32_bf16 v[144:147], a[200:203], a[12:15], v[144:147]
  ds_read_b128 a[32:35], v208 offset:30720
  s_mul_i32 s56, s100, 86016
  v_mfma_f32_16x16x32_bf16 v[148:151], a[200:203], a[16:19], v[148:151]
  s_add_u32 s56, s56, 66060288
  v_mfma_f32_16x16x32_bf16 v[152:155], a[204:207], a[0:3], v[152:155]
  ds_read_b128 a[36:39], v208 offset:32768
  v_mfma_f32_16x16x32_bf16 v[156:159], a[204:207], a[4:7], v[156:159]
  s_add_u32 s57, s28, 0
  buffer_load_dwordx4 a[188:191], v205, s[40:43], s53 offen offset:1024 sc1
  v_mfma_f32_16x16x32_bf16 v[160:163], a[204:207], a[8:11], v[160:163]
  s_and_b32 s57, s57, 3
  v_mfma_f32_16x16x32_bf16 v[164:167], a[204:207], a[12:15], v[164:167]
  v_mfma_f32_16x16x32_bf16 v[168:171], a[204:207], a[16:19], v[168:171]
  s_mul_i32 s57, s57, 21504
  v_mfma_f32_16x16x32_bf16 v[172:175], a[208:211], a[0:3], v[172:175]
  s_add_u32 s57, s57, s56
  buffer_load_dwordx4 a[192:195], v206, s[40:43], s53 offen offset:1024 sc1
  v_mfma_f32_16x16x32_bf16 v[176:179], a[208:211], a[4:7], v[176:179]
  v_mfma_f32_16x16x32_bf16 v[180:183], a[208:211], a[8:11], v[180:183]
  v_add_u32 v237, s57, v252
  v_mfma_f32_16x16x32_bf16 v[184:187], a[208:211], a[12:15], v[184:187]
  s_add_u32 s57, s28, 1
  v_mfma_f32_16x16x32_bf16 v[188:191], a[208:211], a[16:19], v[188:191]
  s_waitcnt vmcnt(23)
  s_waitcnt lgkmcnt(0)
  v_mfma_f32_16x16x32_bf16 v[112:115], a[212:215], a[20:23], v[112:115]
  v_mfma_f32_16x16x32_bf16 v[116:119], a[212:215], a[24:27], v[116:119]
  s_waitcnt vmcnt(30) lgkmcnt(0)
  s_barrier
  v_mfma_f32_16x16x32_bf16 v[120:123], a[212:215], a[28:31], v[120:123]
  ds_read_b128 a[0:3], v207 offset:36864
  s_and_b32 s57, s57, 3
  v_mfma_f32_16x16x32_bf16 v[124:127], a[212:215], a[32:35], v[124:127]
  s_mul_i32 s57, s57, 21504
  buffer_load_dwordx4 a[196:199], v203, s[40:43], s53 offen offset:2048 sc1
  v_mfma_f32_16x16x32_bf16 v[128:131], a[212:215], a[36:39], v[128:131]
  ds_read_b128 a[4:7], v207 offset:38912
  s_mov_b32 s52, 768
  s_add_u32 m0, s49, 24576
  v_mfma_f32_16x16x32_bf16 v[132:135], a[216:219], a[20:23], v[132:135]
  s_add_u32 s57, s57, s56
  buffer_load_dwordx4 v200, s[32:35], s52 offen lds
  v_mfma_f32_16x16x32_bf16 v[136:139], a[216:219], a[24:27], v[136:139]
  ds_read_b128 a[8:11], v207 offset:40960
  v_add_u32 v238, s57, v252
  v_mfma_f32_16x16x32_bf16 v[140:143], a[216:219], a[28:31], v[140:143]
  buffer_load_dwordx4 a[200:203], v204, s[40:43], s53 offen offset:2048 sc1
  v_mfma_f32_16x16x32_bf16 v[144:147], a[216:219], a[32:35], v[144:147]
  ds_read_b128 a[12:15], v207 offset:43008
  s_add_u32 s57, s28, 2
  s_add_u32 m0, s49, 25600
  v_mfma_f32_16x16x32_bf16 v[148:151], a[216:219], a[36:39], v[148:151]
  s_and_b32 s57, s57, 3
  buffer_load_dwordx4 v201, s[32:35], s52 offen lds
  v_mfma_f32_16x16x32_bf16 v[152:155], a[220:223], a[20:23], v[152:155]
  ds_read_b128 a[16:19], v207 offset:45056
  v_mfma_f32_16x16x32_bf16 v[156:159], a[220:223], a[24:27], v[156:159]
  s_mul_i32 s57, s57, 21504
  buffer_load_dwordx4 a[204:207], v205, s[40:43], s53 offen offset:2048 sc1
  v_mfma_f32_16x16x32_bf16 v[160:163], a[220:223], a[28:31], v[160:163]
  s_add_u32 s57, s57, s56
  s_add_u32 m0, s49, 26624
  v_mfma_f32_16x16x32_bf16 v[164:167], a[220:223], a[32:35], v[164:167]
  buffer_load_dwordx4 v202, s[32:35], s52 offen lds
  v_mfma_f32_16x16x32_bf16 v[168:171], a[220:223], a[36:39], v[168:171]
  v_add_u32 v239, s57, v252
  v_mfma_f32_16x16x32_bf16 v[172:175], a[224:227], a[20:23], v[172:175]
  s_add_u32 s57, s28, 3
  buffer_load_dwordx4 a[208:211], v206, s[40:43], s53 offen offset:2048 sc1
  v_mfma_f32_16x16x32_bf16 v[176:179], a[224:227], a[24:27], v[176:179]
  v_mfma_f32_16x16x32_bf16 v[180:183], a[224:227], a[28:31], v[180:183]
  s_and_b32 s57, s57, 3
  v_mfma_f32_16x16x32_bf16 v[184:187], a[224:227], a[32:35], v[184:187]
  s_mul_i32 s57, s57, 21504
  v_mfma_f32_16x16x32_bf16 v[188:191], a[224:227], a[36:39], v[188:191]
  s_waitcnt vmcnt(22)
  s_waitcnt lgkmcnt(0)
  v_mfma_f32_16x16x32_bf16 v[112:115], a[132:135], a[0:3], v[112:115]
  v_mfma_f32_16x16x32_bf16 v[116:119], a[132:135], a[4:7], v[116:119]
  v_mfma_f32_16x16x32_bf16 v[120:123], a[132:135], a[8:11], v[120:123]
  ds_read_b128 a[20:23], v208 offset:36864
  s_add_u32 s57, s57, s56
  v_mfma_f32_16x16x32_bf16 v[124:127], a[132:135], a[12:15], v[124:127]
  v_add_u32 v240, s57, v252
  buffer_load_dwordx4 a[212:215], v203, s[40:43], s53 offen offset:3072 sc1
  v_mfma_f32_16x16x32_bf16 v[128:131], a[132:135], a[16:19], v[128:131]
  ds_read_b128 a[24:27], v208 offset:38912
  v_mfma_f32_16x16x32_bf16 v[132:135], a[136:139], a[0:3], v[132:135]
  s_mul_i32 s57, s101, 107520
  v_mfma_f32_16x16x32_bf16 v[136:139], a[136:139], a[4:7], v[136:139]
  ds_read_b128 a[28:31], v208 offset:40960
  s_add_u32 s57, s57, 69206016
  v_mfma_f32_16x16x32_bf16 v[140:143], a[136:139], a[8:11], v[140:143]
  buffer_load_dwordx4 a[216:219], v204, s[40:43], s53 offen offset:3072 sc1
  v_mfma_f32_16x16x32_bf16 v[144:147], a[136:139], a[12:15], v[144:147]
  ds_read_b128 a[32:35], v208 offset:43008
  v_add_u32 v241, s57, v252
  v_mfma_f32_16x16x32_bf16 v[148:151], a[136:139], a[16:19], v[148:151]
  v_add_u32 v242, 21504, v241
  v_mfma_f32_16x16x32_bf16 v[152:155], a[140:143], a[0:3], v[152:155]
  ds_read_b128 a[36:39], v208 offset:45056
  v_mfma_f32_16x16x32_bf16 v[156:159], a[140:143], a[4:7], v[156:159]
  v_add_u32 v243, 43008, v241
  buffer_load_dwordx4 a[220:223], v205, s[40:43], s53 offen offset:3072 sc1
  v_mfma_f32_16x16x32_bf16 v[160:163], a[140:143], a[8:11], v[160:163]
  v_add_u32 v244, 64512, v241
  v_mfma_f32_16x16x32_bf16 v[164:167], a[140:143], a[12:15], v[164:167]
  v_mfma_f32_16x16x32_bf16 v[168:171], a[140:143], a[16:19], v[168:171]
  v_add_u32 v245, 86016, v241
  v_mfma_f32_16x16x32_bf16 v[172:175], a[144:147], a[0:3], v[172:175]
  s_lshl_b32 s56, s96, 7
  buffer_load_dwordx4 a[224:227], v206, s[40:43], s53 offen offset:3072 sc1
  v_mfma_f32_16x16x32_bf16 v[176:179], a[144:147], a[4:7], v[176:179]
  v_mfma_f32_16x16x32_bf16 v[180:183], a[144:147], a[8:11], v[180:183]
  s_lshr_b32 s57, s28, 1
  v_mfma_f32_16x16x32_bf16 v[184:187], a[144:147], a[12:15], v[184:187]
  s_lshl_b32 s57, s57, 6
  v_mfma_f32_16x16x32_bf16 v[188:191], a[144:147], a[16:19], v[188:191]
  s_waitcnt vmcnt(22)
  s_waitcnt lgkmcnt(0)
  v_mfma_f32_16x16x32_bf16 v[112:115], a[148:151], a[20:23], v[112:115]
  v_mfma_f32_16x16x32_bf16 v[116:119], a[148:151], a[24:27], v[116:119]
  s_waitcnt vmcnt(27) lgkmcnt(0)
  s_barrier
  v_mfma_f32_16x16x32_bf16 v[120:123], a[148:151], a[28:31], v[120:123]
  ds_read_b128 a[0:3], v207 offset:0
  s_add_u32 s56, s56, s57
  s_add_u32 s53, s53, 4096
  v_mfma_f32_16x16x32_bf16 v[124:127], a[148:151], a[32:35], v[124:127]
  s_lshl_b32 s57, s97, 4
  buffer_load_dwordx4 a[132:135], v203, s[40:43], s53 offen offset:0 sc1
  v_mfma_f32_16x16x32_bf16 v[128:131], a[148:151], a[36:39], v[128:131]
  ds_read_b128 a[4:7], v207 offset:2048
  s_mov_b32 s52, 896
  s_add_u32 m0, s49, 36864
  v_mfma_f32_16x16x32_bf16 v[132:135], a[152:155], a[20:23], v[132:135]
  s_add_u32 s56, s56, s57
  buffer_load_dwordx4 v200, s[32:35], s52 offen lds
  v_mfma_f32_16x16x32_bf16 v[136:139], a[152:155], a[24:27], v[136:139]
  ds_read_b128 a[8:11], v207 offset:4096
  v_and_b32 v253, 15, v1
  v_mfma_f32_16x16x32_bf16 v[140:143], a[152:155], a[28:31], v[140:143]
  buffer_load_dwordx4 a[136:139], v204, s[40:43], s53 offen offset:0 sc1
  v_mfma_f32_16x16x32_bf16 v[144:147], a[152:155], a[32:35], v[144:147]
  ds_read_b128 a[12:15], v207 offset:6144
  v_add_u32 v253, s56, v253
  s_add_u32 m0, s49, 37888
  v_mfma_f32_16x16x32_bf16 v[148:151], a[152:155], a[36:39], v[148:151]
  v_mul_u32_u24 v253, 2560, v253
  buffer_load_dwordx4 v201, s[32:35], s52 offen lds
  v_mfma_f32_16x16x32_bf16 v[152:155], a[156:159], a[20:23], v[152:155]
  ds_read_b128 a[16:19], v207 offset:8192
  v_mfma_f32_16x16x32_bf16 v[156:159], a[156:159], a[24:27], v[156:159]
  v_lshrrev_b32 v254, 4, v1
  buffer_load_dwordx4 a[140:143], v205, s[40:43], s53 offen offset:0 sc1
  v_mfma_f32_16x16x32_bf16 v[160:163], a[156:159], a[28:31], v[160:163]
  v_lshl_add_u32 v253, v254, 3, v253
  s_add_u32 m0, s49, 38912
  v_mfma_f32_16x16x32_bf16 v[164:167], a[156:159], a[32:35], v[164:167]
  buffer_load_dwordx4 v202, s[32:35], s52 offen lds
  v_mfma_f32_16x16x32_bf16 v[168:171], a[156:159], a[36:39], v[168:171]
  s_mul_i32 s56, s99, 320
  v_mfma_f32_16x16x32_bf16 v[172:175], a[160:163], a[20:23], v[172:175]
  s_and_b32 s57, s28, 1
  buffer_load_dwordx4 a[144:147], v206, s[40:43], s53 offen offset:0 sc1
  v_mfma_f32_16x16x32_bf16 v[176:179], a[160:163], a[24:27], v[176:179]
  v_mfma_f32_16x16x32_bf16 v[180:183], a[160:163], a[28:31], v[180:183]
  s_mul_i32 s57, s57, 160
  v_mfma_f32_16x16x32_bf16 v[184:187], a[160:163], a[32:35], v[184:187]
  s_add_u32 s56, s56, s57
  v_mfma_f32_16x16x32_bf16 v[188:191], a[160:163], a[36:39], v[188:191]
  s_waitcnt vmcnt(22)
  s_waitcnt lgkmcnt(0)
  v_mfma_f32_16x16x32_bf16 v[112:115], a[164:167], a[0:3], v[112:115]
  v_mfma_f32_16x16x32_bf16 v[116:119], a[164:167], a[4:7], v[116:119]
  v_mfma_f32_16x16x32_bf16 v[120:123], a[164:167], a[8:11], v[120:123]
  ds_read_b128 a[20:23], v208 offset:0
  v_add_u32 v253, s56, v253
  v_mfma_f32_16x16x32_bf16 v[124:127], a[164:167], a[12:15], v[124:127]
  s_mul_i32 s93, s28, 5120
  buffer_load_dwordx4 a[148:151], v203, s[40:43], s53 offen offset:1024 sc1
  v_mfma_f32_16x16x32_bf16 v[128:131], a[164:167], a[16:19], v[128:131]
  ds_read_b128 a[24:27], v208 offset:2048
  v_mfma_f32_16x16x32_bf16 v[132:135], a[168:171], a[0:3], v[132:135]
  s_lshl_b32 s95, s30, 8
  v_mfma_f32_16x16x32_bf16 v[136:139], a[168:171], a[4:7], v[136:139]
  ds_read_b128 a[28:31], v208 offset:4096
  s_lshl_b32 s56, s97, 6
  v_mfma_f32_16x16x32_bf16 v[140:143], a[168:171], a[8:11], v[140:143]
  buffer_load_dwordx4 a[152:155], v204, s[40:43], s53 offen offset:1024 sc1
  v_mfma_f32_16x16x32_bf16 v[144:147], a[168:171], a[12:15], v[144:147]
  ds_read_b128 a[32:35], v208 offset:6144
  s_add_u32 s95, s95, s56
  v_mfma_f32_16x16x32_bf16 v[148:151], a[168:171], a[16:19], v[148:151]
  s_add_u32 s95, s95, 73400320
  v_mfma_f32_16x16x32_bf16 v[152:155], a[172:175], a[0:3], v[152:155]
  ds_read_b128 a[36:39], v208 offset:8192
  v_mfma_f32_16x16x32_bf16 v[156:159], a[172:175], a[4:7], v[156:159]
  v_and_b32 v247, 7, v1
  buffer_load_dwordx4 a[156:159], v205, s[40:43], s53 offen offset:1024 sc1
  v_mfma_f32_16x16x32_bf16 v[160:163], a[172:175], a[8:11], v[160:163]
  v_lshlrev_b32 v247, 3, v247
  v_mfma_f32_16x16x32_bf16 v[164:167], a[172:175], a[12:15], v[164:167]
  v_mfma_f32_16x16x32_bf16 v[168:171], a[172:175], a[16:19], v[168:171]
  s_lshl_b32 s99, s31, 1
  v_mfma_f32_16x16x32_bf16 v[172:175], a[176:179], a[0:3], v[172:175]
  s_and_b32 s56, s2, 1
  buffer_load_dwordx4 a[160:163], v206, s[40:43], s53 offen offset:1024 sc1
  v_mfma_f32_16x16x32_bf16 v[176:179], a[176:179], a[4:7], v[176:179]
  v_mfma_f32_16x16x32_bf16 v[180:183], a[176:179], a[8:11], v[180:183]
  s_add_u32 s99, s99, s56
  v_mfma_f32_16x16x32_bf16 v[184:187], a[176:179], a[12:15], v[184:187]
  s_lshl_b32 s99, s99, 7
  v_mfma_f32_16x16x32_bf16 v[188:191], a[176:179], a[16:19], v[188:191]
  s_waitcnt vmcnt(22)
  s_waitcnt lgkmcnt(0)
  v_mfma_f32_16x16x32_bf16 v[112:115], a[180:183], a[20:23], v[112:115]
  v_mfma_f32_16x16x32_bf16 v[116:119], a[180:183], a[24:27], v[116:119]
  s_waitcnt vmcnt(27) lgkmcnt(0)
  s_barrier
  v_mfma_f32_16x16x32_bf16 v[120:123], a[180:183], a[28:31], v[120:123]
  ds_read_b128 a[0:3], v207 offset:12288
  s_add_u32 s99, s99, 73424896
  v_mfma_f32_16x16x32_bf16 v[124:127], a[180:183], a[32:35], v[124:127]
  buffer_load_dwordx4 a[164:167], v203, s[40:43], s53 offen offset:2048 sc1
  v_mfma_f32_16x16x32_bf16 v[128:131], a[180:183], a[36:39], v[128:131]
  ds_read_b128 a[4:7], v207 offset:14336
  s_lshl_b32 s96, s100, 7
  s_mov_b32 s52, 1024
  s_add_u32 m0, s49, 0
  v_mfma_f32_16x16x32_bf16 v[132:135], a[184:187], a[20:23], v[132:135]
  buffer_load_dwordx4 v200, s[32:35], s52 offen lds
  v_mfma_f32_16x16x32_bf16 v[136:139], a[184:187], a[24:27], v[136:139]
  ds_read_b128 a[8:11], v207 offset:16384
  s_add_u32 s96, s96, 73416704
  v_mfma_f32_16x16x32_bf16 v[140:143], a[184:187], a[28:31], v[140:143]
  buffer_load_dwordx4 a[168:171], v204, s[40:43], s53 offen offset:2048 sc1
  v_mfma_f32_16x16x32_bf16 v[144:147], a[184:187], a[32:35], v[144:147]
  ds_read_b128 a[12:15], v207 offset:18432
  s_lshl_b32 s97, s101, 3
  s_add_u32 m0, s49, 1024
  v_mfma_f32_16x16x32_bf16 v[148:151], a[184:187], a[36:39], v[148:151]
  buffer_load_dwordx4 v201, s[32:35], s52 offen lds
  v_mfma_f32_16x16x32_bf16 v[152:155], a[188:191], a[20:23], v[152:155]
  ds_read_b128 a[16:19], v207 offset:20480
  s_add_u32 s97, s97, s96
  v_mfma_f32_16x16x32_bf16 v[156:159], a[188:191], a[24:27], v[156:159]
  buffer_load_dwordx4 a[172:175], v205, s[40:43], s53 offen offset:2048 sc1
  v_mfma_f32_16x16x32_bf16 v[160:163], a[188:191], a[28:31], v[160:163]
  s_mov_b32 s44, s22
  s_add_u32 m0, s49, 2048
  v_mfma_f32_16x16x32_bf16 v[164:167], a[188:191], a[32:35], v[164:167]
  buffer_load_dwordx4 v202, s[32:35], s52 offen lds
  v_mfma_f32_16x16x32_bf16 v[168:171], a[188:191], a[36:39], v[168:171]
  s_mov_b32 s45, s23
  v_mfma_f32_16x16x32_bf16 v[172:175], a[192:195], a[20:23], v[172:175]
  buffer_load_dwordx4 a[176:179], v206, s[40:43], s53 offen offset:2048 sc1
  v_mfma_f32_16x16x32_bf16 v[176:179], a[192:195], a[24:27], v[176:179]
  s_mov_b32 s46, 5242880
  v_mfma_f32_16x16x32_bf16 v[180:183], a[192:195], a[28:31], v[180:183]
  v_mfma_f32_16x16x32_bf16 v[184:187], a[192:195], a[32:35], v[184:187]
  s_mov_b32 s47, 0x20000
  v_mfma_f32_16x16x32_bf16 v[188:191], a[192:195], a[36:39], v[188:191]
  s_waitcnt vmcnt(22)
  s_waitcnt lgkmcnt(0)
  v_mfma_f32_16x16x32_bf16 v[112:115], a[196:199], a[0:3], v[112:115]
  v_mfma_f32_16x16x32_bf16 v[116:119], a[196:199], a[4:7], v[116:119]
  v_mfma_f32_16x16x32_bf16 v[120:123], a[196:199], a[8:11], v[120:123]
  ds_read_b128 a[20:23], v208 offset:12288
  v_mfma_f32_16x16x32_bf16 v[124:127], a[196:199], a[12:15], v[124:127]
  buffer_load_dwordx4 a[180:183], v203, s[40:43], s53 offen offset:3072 sc1
  v_mfma_f32_16x16x32_bf16 v[128:131], a[196:199], a[16:19], v[128:131]
  ds_read_b128 a[24:27], v208 offset:14336
  v_mfma_f32_16x16x32_bf16 v[132:135], a[200:203], a[0:3], v[132:135]
  v_mfma_f32_16x16x32_bf16 v[136:139], a[200:203], a[4:7], v[136:139]
  ds_read_b128 a[28:31], v208 offset:16384
  v_mfma_f32_16x16x32_bf16 v[140:143], a[200:203], a[8:11], v[140:143]
  buffer_load_dwordx4 a[184:187], v204, s[40:43], s53 offen offset:3072 sc1
  v_mfma_f32_16x16x32_bf16 v[144:147], a[200:203], a[12:15], v[144:147]
  ds_read_b128 a[32:35], v208 offset:18432
  v_mfma_f32_16x16x32_bf16 v[148:151], a[200:203], a[16:19], v[148:151]
  v_mfma_f32_16x16x32_bf16 v[152:155], a[204:207], a[0:3], v[152:155]
  ds_read_b128 a[36:39], v208 offset:20480
  v_mfma_f32_16x16x32_bf16 v[156:159], a[204:207], a[4:7], v[156:159]
  buffer_load_dwordx4 a[188:191], v205, s[40:43], s53 offen offset:3072 sc1
  v_mfma_f32_16x16x32_bf16 v[160:163], a[204:207], a[8:11], v[160:163]
  v_mfma_f32_16x16x32_bf16 v[164:167], a[204:207], a[12:15], v[164:167]
  v_mfma_f32_16x16x32_bf16 v[168:171], a[204:207], a[16:19], v[168:171]
  v_mfma_f32_16x16x32_bf16 v[172:175], a[208:211], a[0:3], v[172:175]
  buffer_load_dwordx4 a[192:195], v206, s[40:43], s53 offen offset:3072 sc1
  v_mfma_f32_16x16x32_bf16 v[176:179], a[208:211], a[4:7], v[176:179]
  v_mfma_f32_16x16x32_bf16 v[180:183], a[208:211], a[8:11], v[180:183]
  v_mfma_f32_16x16x32_bf16 v[184:187], a[208:211], a[12:15], v[184:187]
  v_mfma_f32_16x16x32_bf16 v[188:191], a[208:211], a[16:19], v[188:191]
  s_waitcnt vmcnt(22)
  s_waitcnt lgkmcnt(1)
  v_mfma_f32_16x16x32_bf16 v[112:115], a[212:215], a[20:23], v[112:115]
  v_mfma_f32_16x16x32_bf16 v[116:119], a[212:215], a[24:27], v[116:119]
  s_waitcnt vmcnt(27) lgkmcnt(0)
  s_barrier
  v_mfma_f32_16x16x32_bf16 v[120:123], a[212:215], a[28:31], v[120:123]
  ds_read_b128 a[0:3], v207 offset:24576
  s_add_u32 s53, s53, 4096
  v_mfma_f32_16x16x32_bf16 v[124:127], a[212:215], a[32:35], v[124:127]
  buffer_load_dwordx4 a[196:199], v203, s[40:43], s53 offen offset:0 sc1
  v_mfma_f32_16x16x32_bf16 v[128:131], a[212:215], a[36:39], v[128:131]
  ds_read_b128 a[4:7], v207 offset:26624
  s_mov_b32 s52, 1152
  s_add_u32 m0, s49, 12288
  v_mfma_f32_16x16x32_bf16 v[132:135], a[216:219], a[20:23], v[132:135]
  buffer_load_dwordx4 v200, s[32:35], s52 offen lds
  v_mfma_f32_16x16x32_bf16 v[136:139], a[216:219], a[24:27], v[136:139]
  ds_read_b128 a[8:11], v207 offset:28672
  v_mfma_f32_16x16x32_bf16 v[140:143], a[216:219], a[28:31], v[140:143]
  buffer_load_dwordx4 a[200:203], v204, s[40:43], s53 offen offset:0 sc1
  v_mfma_f32_16x16x32_bf16 v[144:147], a[216:219], a[32:35], v[144:147]
  ds_read_b128 a[12:15], v207 offset:30720
  s_add_u32 m0, s49, 13312
  v_mfma_f32_16x16x32_bf16 v[148:151], a[216:219], a[36:39], v[148:151]
  buffer_load_dwordx4 v201, s[32:35], s52 offen lds
  v_mfma_f32_16x16x32_bf16 v[152:155], a[220:223], a[20:23], v[152:155]
  ds_read_b128 a[16:19], v207 offset:32768
  v_mfma_f32_16x16x32_bf16 v[156:159], a[220:223], a[24:27], v[156:159]
  buffer_load_dwordx4 a[204:207], v205, s[40:43], s53 offen offset:0 sc1
  v_mfma_f32_16x16x32_bf16 v[160:163], a[220:223], a[28:31], v[160:163]
  s_add_u32 m0, s49, 14336
  v_mfma_f32_16x16x32_bf16 v[164:167], a[220:223], a[32:35], v[164:167]
  buffer_load_dwordx4 v202, s[32:35], s52 offen lds
  v_mfma_f32_16x16x32_bf16 v[168:171], a[220:223], a[36:39], v[168:171]
  v_mfma_f32_16x16x32_bf16 v[172:175], a[224:227], a[20:23], v[172:175]
  buffer_load_dwordx4 a[208:211], v206, s[40:43], s53 offen offset:0 sc1
  v_mfma_f32_16x16x32_bf16 v[176:179], a[224:227], a[24:27], v[176:179]
  v_mfma_f32_16x16x32_bf16 v[180:183], a[224:227], a[28:31], v[180:183]
  v_mfma_f32_16x16x32_bf16 v[184:187], a[224:227], a[32:35], v[184:187]
  v_mfma_f32_16x16x32_bf16 v[188:191], a[224:227], a[36:39], v[188:191]
  s_waitcnt vmcnt(22)
  s_waitcnt lgkmcnt(0)
  v_mfma_f32_16x16x32_bf16 v[112:115], a[132:135], a[0:3], v[112:115]
  v_mfma_f32_16x16x32_bf16 v[116:119], a[132:135], a[4:7], v[116:119]
  v_mfma_f32_16x16x32_bf16 v[120:123], a[132:135], a[8:11], v[120:123]
  ds_read_b128 a[20:23], v208 offset:24576
  v_and_b32 v2, 15, v1
  v_mfma_f32_16x16x32_bf16 v[124:127], a[132:135], a[12:15], v[124:127]
  v_mul_u32_u24 v8, 520, v2
  buffer_load_dwordx4 a[212:215], v203, s[40:43], s53 offen offset:1024 sc1
  v_mfma_f32_16x16x32_bf16 v[128:131], a[132:135], a[16:19], v[128:131]
  ds_read_b128 a[24:27], v208 offset:26624
  v_lshrrev_b32 v3, 4, v1
  v_mfma_f32_16x16x32_bf16 v[132:135], a[136:139], a[0:3], v[132:135]
  v_mfma_f32_16x16x32_bf16 v[136:139], a[136:139], a[4:7], v[136:139]
  ds_read_b128 a[28:31], v208 offset:28672
  v_lshl_add_u32 v8, v3, 3, v8
  v_mfma_f32_16x16x32_bf16 v[140:143], a[136:139], a[8:11], v[140:143]
  s_lshl_b32 s54, s28, 7
  buffer_load_dwordx4 a[216:219], v204, s[40:43], s53 offen offset:1024 sc1
  v_mfma_f32_16x16x32_bf16 v[144:147], a[136:139], a[12:15], v[144:147]
  ds_read_b128 a[32:35], v208 offset:30720
  v_add_u32 v8, s54, v8
  v_mfma_f32_16x16x32_bf16 v[148:151], a[136:139], a[16:19], v[148:151]
  v_mfma_f32_16x16x32_bf16 v[152:155], a[140:143], a[0:3], v[152:155]
  ds_read_b128 a[36:39], v208 offset:32768
  s_mul_i32 s54, s28, 40
  v_mfma_f32_16x16x32_bf16 v[156:159], a[140:143], a[4:7], v[156:159]
  v_mul_u32_u24 v4, 1040, v2
  buffer_load_dwordx4 a[220:223], v205, s[40:43], s53 offen offset:1024 sc1
  v_mfma_f32_16x16x32_bf16 v[160:163], a[140:143], a[8:11], v[160:163]
  v_mfma_f32_16x16x32_bf16 v[164:167], a[140:143], a[12:15], v[164:167]
  v_lshl_add_u32 v4, v3, 4, v4
  v_mfma_f32_16x16x32_bf16 v[168:171], a[140:143], a[16:19], v[168:171]
  v_add_u32 v4, s54, v4
  v_mfma_f32_16x16x32_bf16 v[172:175], a[144:147], a[0:3], v[172:175]
  v_min_u32 v5, 7, v2
  buffer_load_dwordx4 a[224:227], v206, s[40:43], s53 offen offset:1024 sc1
  v_mfma_f32_16x16x32_bf16 v[176:179], a[144:147], a[4:7], v[176:179]
  v_mfma_f32_16x16x32_bf16 v[180:183], a[144:147], a[8:11], v[180:183]
  v_mul_u32_u24 v5, 1040, v5
  buffer_load_dwordx2 v[250:251], v247, s[40:43], s95 offen sc1
  v_mfma_f32_16x16x32_bf16 v[184:187], a[144:147], a[12:15], v[184:187]
  v_lshl_add_u32 v5, v3, 4, v5
  v_mfma_f32_16x16x32_bf16 v[188:191], a[144:147], a[16:19], v[188:191]
  s_waitcnt vmcnt(23)
  s_waitcnt lgkmcnt(0)
  v_mfma_f32_16x16x32_bf16 v[112:115], a[148:151], a[20:23], v[112:115]
  v_mfma_f32_16x16x32_bf16 v[116:119], a[148:151], a[24:27], v[116:119]
  s_waitcnt vmcnt(28) lgkmcnt(0)
  s_barrier
  v_mfma_f32_16x16x32_bf16 v[120:123], a[148:151], a[28:31], v[120:123]
  ds_read_b128 a[0:3], v207 offset:36864
  v_add_u32 v5, s54, v5
  v_mfma_f32_16x16x32_bf16 v[124:127], a[148:151], a[32:35], v[124:127]
  v_lshrrev_b32 v6, 2, v1
  buffer_load_dwordx4 a[132:135], v203, s[40:43], s53 offen offset:2048 sc1
  v_mfma_f32_16x16x32_bf16 v[128:131], a[148:151], a[36:39], v[128:131]
  ds_read_b128 a[4:7], v207 offset:38912
  v_min_u32 v7, 7, v6
  v_mfma_f32_16x16x32_bf16 v[132:135], a[152:155], a[20:23], v[132:135]
  v_mfma_f32_16x16x32_bf16 v[136:139], a[152:155], a[24:27], v[136:139]
  ds_read_b128 a[8:11], v207 offset:40960
  v_mul_u32_u24 v6, 1040, v6
  v_mfma_f32_16x16x32_bf16 v[140:143], a[152:155], a[28:31], v[140:143]
  v_mul_u32_u24 v7, 1040, v7
  buffer_load_dwordx4 a[136:139], v204, s[40:43], s53 offen offset:2048 sc1
  v_mfma_f32_16x16x32_bf16 v[144:147], a[152:155], a[32:35], v[144:147]
  ds_read_b128 a[12:15], v207 offset:43008
  v_and_b32 v11, 3, v1
  v_mfma_f32_16x16x32_bf16 v[148:151], a[152:155], a[36:39], v[148:151]
  v_mfma_f32_16x16x32_bf16 v[152:155], a[156:159], a[20:23], v[152:155]
  ds_read_b128 a[16:19], v207 offset:45056
  v_lshlrev_b32 v11, 3, v11
  v_mfma_f32_16x16x32_bf16 v[156:159], a[156:159], a[24:27], v[156:159]
  v_add3_u32 v6, v6, v11, s54
  buffer_load_dwordx4 a[140:143], v205, s[40:43], s53 offen offset:2048 sc1
  v_mfma_f32_16x16x32_bf16 v[160:163], a[156:159], a[28:31], v[160:163]
  v_mfma_f32_16x16x32_bf16 v[164:167], a[156:159], a[32:35], v[164:167]
  v_add3_u32 v7, v7, v11, s54
  v_mfma_f32_16x16x32_bf16 v[168:171], a[156:159], a[36:39], v[168:171]
  v_mul_u32_u24 v9, 1040, v2
  v_mfma_f32_16x16x32_bf16 v[172:175], a[160:163], a[20:23], v[172:175]
  v_add_u32 v10, 512, v9
  buffer_load_dwordx4 a[144:147], v206, s[40:43], s53 offen offset:2048 sc1
  v_mfma_f32_16x16x32_bf16 v[176:179], a[160:163], a[24:27], v[176:179]
  v_mfma_f32_16x16x32_bf16 v[180:183], a[160:163], a[28:31], v[180:183]
  v_add_u32 v11, s54, v9
  v_mfma_f32_16x16x32_bf16 v[184:187], a[160:163], a[32:35], v[184:187]
  v_lshl_add_u32 v9, v3, 3, v11
  v_mfma_f32_16x16x32_bf16 v[188:191], a[160:163], a[36:39], v[188:191]
  s_waitcnt vmcnt(20)
  s_waitcnt lgkmcnt(0)
  v_mfma_f32_16x16x32_bf16 v[112:115], a[164:167], a[0:3], v[112:115]
  v_mfma_f32_16x16x32_bf16 v[116:119], a[164:167], a[4:7], v[116:119]
  v_mfma_f32_16x16x32_bf16 v[120:123], a[164:167], a[8:11], v[120:123]
  ds_read_b128 a[20:23], v208 offset:36864
  v_add_u32 v11, 32, v11
  v_mfma_f32_16x16x32_bf16 v[124:127], a[164:167], a[12:15], v[124:127]
  v_cmp_eq_u32 vcc, 0, v3
  buffer_load_dwordx4 a[148:151], v203, s[40:43], s53 offen offset:3072 sc1
  v_mfma_f32_16x16x32_bf16 v[128:131], a[164:167], a[16:19], v[128:131]
  ds_read_b128 a[24:27], v208 offset:38912
  v_lshlrev_b32 v12, 2, v3
  v_mfma_f32_16x16x32_bf16 v[132:135], a[168:171], a[0:3], v[132:135]
  v_mfma_f32_16x16x32_bf16 v[136:139], a[168:171], a[4:7], v[136:139]
  ds_read_b128 a[28:31], v208 offset:40960
  v_sub_u32 v13, v12, v2
  v_mfma_f32_16x16x32_bf16 v[140:143], a[168:171], a[8:11], v[140:143]
  v_cndmask_b32 v10, v10, v11, vcc
  buffer_load_dwordx4 a[152:155], v204, s[40:43], s53 offen offset:3072 sc1
  v_mfma_f32_16x16x32_bf16 v[144:147], a[168:171], a[12:15], v[144:147]
  ds_read_b128 a[32:35], v208 offset:43008
  v_cmp_gt_u32 s[38:39], 3, v3
  v_mfma_f32_16x16x32_bf16 v[148:151], a[168:171], a[16:19], v[148:151]
  v_mfma_f32_16x16x32_bf16 v[152:155], a[172:175], a[0:3], v[152:155]
  ds_read_b128 a[36:39], v208 offset:45056
  v_cmp_gt_u32 s[50:51], 2, v3
  v_mfma_f32_16x16x32_bf16 v[156:159], a[172:175], a[4:7], v[156:159]
  s_min_u32 s54, s100, 1
  buffer_load_dwordx4 a[156:159], v205, s[40:43], s53 offen offset:3072 sc1
  v_mfma_f32_16x16x32_bf16 v[160:163], a[172:175], a[8:11], v[160:163]
  v_mfma_f32_16x16x32_bf16 v[164:167], a[172:175], a[12:15], v[164:167]
  s_lshl_b32 s54, s54, 3
  v_mfma_f32_16x16x32_bf16 v[168:171], a[172:175], a[16:19], v[168:171]
  s_sub_u32 s54, 8, s54
  v_mfma_f32_16x16x32_bf16 v[172:175], a[176:179], a[0:3], v[172:175]
  v_add_u32 v11, 4294967295, v13
  buffer_load_dwordx4 a[160:163], v206, s[40:43], s53 offen offset:3072 sc1
  v_mfma_f32_16x16x32_bf16 v[176:179], a[176:179], a[4:7], v[176:179]
  v_mfma_f32_16x16x32_bf16 v[180:183], a[176:179], a[8:11], v[180:183]
  v_cmp_gt_u32 s[4:5], 8, v11
  v_mfma_f32_16x16x32_bf16 v[184:187], a[176:179], a[12:15], v[184:187]
  v_add_u32 v11, 0, v13
  v_mfma_f32_16x16x32_bf16 v[188:191], a[176:179], a[16:19], v[188:191]
  s_waitcnt vmcnt(20)
  s_waitcnt lgkmcnt(0)
  v_mfma_f32_16x16x32_bf16 v[112:115], a[180:183], a[20:23], v[112:115]
  v_mfma_f32_16x16x32_bf16 v[116:119], a[180:183], a[24:27], v[116:119]
  s_waitcnt vmcnt(8) lgkmcnt(0)
  v_cmp_ne_u64 vcc, s[0:1], v[250:251]
  s_nop 1
  s_cbranch_vccnz LO_s2
LO_s2_ret:
  s_barrier
  v_mfma_f32_16x16x32_bf16 v[120:123], a[180:183], a[28:31], v[120:123]
  ds_read_b128 a[0:3], v207 offset:0
  v_cmp_gt_u32 s[6:7], 8, v11
  s_add_u32 m0, s98, 49152
  v_mfma_f32_16x16x32_bf16 v[124:127], a[180:183], a[32:35], v[124:127]
  v_add_u32 v11, 1, v13
  buffer_load_dwordx4 v224, s[40:43], s92 offen offset:0 sc1 lds
  v_mfma_f32_16x16x32_bf16 v[128:131], a[180:183], a[36:39], v[128:131]
  ds_read_b128 a[4:7], v207 offset:2048
  v_cmp_gt_u32 s[8:9], 8, v11
  v_mfma_f32_16x16x32_bf16 v[132:135], a[184:187], a[20:23], v[132:135]
  buffer_load_dwordx4 v225, s[40:43], s92 offen offset:1024 sc1 lds
  v_mfma_f32_16x16x32_bf16 v[136:139], a[184:187], a[24:27], v[136:139]
  ds_read_b128 a[8:11], v207 offset:4096
  v_add_u32 v11, 2, v13
  v_mfma_f32_16x16x32_bf16 v[140:143], a[184:187], a[28:31], v[140:143]
  v_cmp_gt_u32 s[10:11], 8, v11
  v_mfma_f32_16x16x32_bf16 v[144:147], a[184:187], a[32:35], v[144:147]
  ds_read_b128 a[12:15], v207 offset:6144
  v_add_u32 v11, 15, v13
  buffer_load_dwordx4 v226, s[40:43], s92 offen offset:2048 sc1 lds
  v_mfma_f32_16x16x32_bf16 v[148:151], a[184:187], a[36:39], v[148:151]
  v_mfma_f32_16x16x32_bf16 v[152:155], a[188:191], a[20:23], v[152:155]
  ds_read_b128 a[16:19], v207 offset:8192
  v_cmp_gt_u32 s[12:13], 8, v11
  v_mfma_f32_16x16x32_bf16 v[156:159], a[188:191], a[24:27], v[156:159]
  v_add_u32 v11, 16, v13
  buffer_load_dwordx4 v227, s[40:43], s92 offen offset:3072 sc1 lds
  v_mfma_f32_16x16x32_bf16 v[160:163], a[188:191], a[28:31], v[160:163]
  s_add_u32 m0, s98, 53248
  v_mfma_f32_16x16x32_bf16 v[164:167], a[188:191], a[32:35], v[164:167]
  v_cmp_gt_u32 s[14:15], 8, v11
  buffer_load_dwordx4 v228, s[40:43], s92 offen offset:0 sc1 lds
  v_mfma_f32_16x16x32_bf16 v[168:171], a[188:191], a[36:39], v[168:171]
  v_add_u32 v11, 17, v13
  v_mfma_f32_16x16x32_bf16 v[172:175], a[192:195], a[20:23], v[172:175]
  v_cmp_gt_u32 s[16:17], 8, v11
  v_mfma_f32_16x16x32_bf16 v[176:179], a[192:195], a[24:27], v[176:179]
  buffer_load_dwordx4 v229, s[40:43], s92 offen offset:1024 sc1 lds
  v_mfma_f32_16x16x32_bf16 v[180:183], a[192:195], a[28:31], v[180:183]
  v_add_u32 v11, 18, v13
  v_mfma_f32_16x16x32_bf16 v[184:187], a[192:195], a[32:35], v[184:187]
  v_cmp_gt_u32 s[18:19], 8, v11
  v_mfma_f32_16x16x32_bf16 v[188:191], a[192:195], a[36:39], v[188:191]
  s_waitcnt vmcnt(19)
  s_waitcnt lgkmcnt(0)
  v_mfma_f32_16x16x32_bf16 v[112:115], a[196:199], a[0:3], v[112:115]
  v_mfma_f32_16x16x32_bf16 v[116:119], a[196:199], a[4:7], v[116:119]
  v_mfma_f32_16x16x32_bf16 v[120:123], a[196:199], a[8:11], v[120:123]
  ds_read_b128 a[20:23], v208 offset:0
  v_add_u32 v11, 0, v12
  v_mfma_f32_16x16x32_bf16 v[124:127], a[196:199], a[12:15], v[124:127]
  v_cmp_le_u32 vcc, s54, v11
  buffer_load_dwordx4 v230, s[40:43], s92 offen offset:2048 sc1 lds
  v_mfma_f32_16x16x32_bf16 v[128:131], a[196:199], a[16:19], v[128:131]
  ds_read_b128 a[24:27], v208 offset:2048
  s_nop 0
  v_mfma_f32_16x16x32_bf16 v[132:135], a[200:203], a[0:3], v[132:135]
  buffer_load_dwordx4 v231, s[40:43], s92 offen offset:3072 sc1 lds
  v_mfma_f32_16x16x32_bf16 v[136:139], a[200:203], a[4:7], v[136:139]
  ds_read_b128 a[28:31], v208 offset:4096
  s_and_b64 s[20:21], vcc, s[4:5]
  v_mfma_f32_16x16x32_bf16 v[140:143], a[200:203], a[8:11], v[140:143]
  v_add_u32 v11, 1, v12
  s_add_u32 m0, s98, 57344
  v_mfma_f32_16x16x32_bf16 v[144:147], a[200:203], a[12:15], v[144:147]
  ds_read_b128 a[32:35], v208 offset:6144
  v_cmp_le_u32 vcc, s54, v11
  buffer_load_dwordx4 v232, s[40:43], s92 offen offset:0 sc1 lds
  v_mfma_f32_16x16x32_bf16 v[148:151], a[200:203], a[16:19], v[148:151]
  v_mfma_f32_16x16x32_bf16 v[152:155], a[204:207], a[0:3], v[152:155]
  ds_read_b128 a[36:39], v208 offset:8192
  s_nop 0
  s_add_u32 s92, s92, 2048
  s_add_u32 m0, s98, 86016
  v_mfma_f32_16x16x32_bf16 v[156:159], a[204:207], a[4:7], v[156:159]
  s_and_b64 s[22:23], vcc, s[6:7]
  buffer_load_dwordx4 v224, s[40:43], s92 offen offset:0 sc1 lds
  v_mfma_f32_16x16x32_bf16 v[160:163], a[204:207], a[8:11], v[160:163]
  v_mfma_f32_16x16x32_bf16 v[164:167], a[204:207], a[12:15], v[164:167]
  v_add_u32 v11, 2, v12
  buffer_load_dwordx4 v225, s[40:43], s92 offen offset:1024 sc1 lds
  v_mfma_f32_16x16x32_bf16 v[168:171], a[204:207], a[16:19], v[168:171]
  v_cmp_le_u32 vcc, s54, v11
  v_mfma_f32_16x16x32_bf16 v[172:175], a[208:211], a[0:3], v[172:175]
  s_nop 0
  v_mfma_f32_16x16x32_bf16 v[176:179], a[208:211], a[4:7], v[176:179]
  buffer_load_dwordx4 v226, s[40:43], s92 offen offset:2048 sc1 lds
  v_mfma_f32_16x16x32_bf16 v[180:183], a[208:211], a[8:11], v[180:183]
  s_and_b64 s[36:37], vcc, s[8:9]
  v_mfma_f32_16x16x32_bf16 v[184:187], a[208:211], a[12:15], v[184:187]
  v_add_u32 v11, 3, v12
  v_mfma_f32_16x16x32_bf16 v[188:191], a[208:211], a[16:19], v[188:191]
  s_waitcnt vmcnt(21)
  s_waitcnt lgkmcnt(0)
  v_mfma_f32_16x16x32_bf16 v[112:115], a[212:215], a[20:23], v[112:115]
  v_mfma_f32_16x16x32_bf16 v[116:119], a[212:215], a[24:27], v[116:119]
  s_waitcnt vmcnt(26) lgkmcnt(0)
  s_barrier
  v_mfma_f32_16x16x32_bf16 v[120:123], a[212:215], a[28:31], v[120:123]
  ds_read_b128 a[0:3], v207 offset:12288
  v_cmp_le_u32 vcc, s54, v11
  v_mfma_f32_16x16x32_bf16 v[124:127], a[212:215], a[32:35], v[124:127]
  s_nop 0
  buffer_load_dwordx4 v227, s[40:43], s92 offen offset:3072 sc1 lds
  v_mfma_f32_16x16x32_bf16 v[128:131], a[212:215], a[36:39], v[128:131]
  ds_read_b128 a[4:7], v207 offset:14336
  s_and_b64 s[24:25], vcc, s[10:11]
  s_add_u32 m0, s98, 90112
  v_mfma_f32_16x16x32_bf16 v[132:135], a[216:219], a[20:23], v[132:135]
  buffer_load_dwordx4 v228, s[40:43], s92 offen offset:0 sc1 lds
  v_mfma_f32_16x16x32_bf16 v[136:139], a[216:219], a[24:27], v[136:139]
  ds_read_b128 a[8:11], v207 offset:16384
  v_mov_b32 v14, 0xf149f2ca
  v_mfma_f32_16x16x32_bf16 v[140:143], a[216:219], a[28:31], v[140:143]
  v_mov_b32 v28, 0x3f803f80
  v_mfma_f32_16x16x32_bf16 v[144:147], a[216:219], a[32:35], v[144:147]
  ds_read_b128 a[12:15], v207 offset:18432
  v_mov_b32 v29, 0x3f803f80
  buffer_load_dwordx4 v229, s[40:43], s92 offen offset:1024 sc1 lds
  v_mfma_f32_16x16x32_bf16 v[148:151], a[216:219], a[36:39], v[148:151]
  v_mfma_f32_16x16x32_bf16 v[152:155], a[220:223], a[20:23], v[152:155]
  ds_read_b128 a[16:19], v207 offset:20480
  v_mov_b32 v30, 0x3f803f80
  v_mfma_f32_16x16x32_bf16 v[156:159], a[220:223], a[24:27], v[156:159]
  v_mov_b32 v31, 0x3f803f80
  buffer_load_dwordx4 v230, s[40:43], s92 offen offset:2048 sc1 lds
  v_mfma_f32_16x16x32_bf16 v[160:163], a[220:223], a[28:31], v[160:163]
  v_mfma_f32_16x16x32_bf16 v[164:167], a[220:223], a[32:35], v[164:167]
  s_mov_b32 s58, 1051011932
  buffer_load_dwordx4 v231, s[40:43], s92 offen offset:3072 sc1 lds
  v_mfma_f32_16x16x32_bf16 v[168:171], a[220:223], a[36:39], v[168:171]
  v_mul_u32_u24 v15, 520, v1
  v_mfma_f32_16x16x32_bf16 v[172:175], a[224:227], a[20:23], v[172:175]
  s_lshl_b32 s54, s28, 4
  s_add_u32 m0, s98, 94208
  v_mfma_f32_16x16x32_bf16 v[176:179], a[224:227], a[24:27], v[176:179]
  buffer_load_dwordx4 v232, s[40:43], s92 offen offset:0 sc1 lds
  v_mfma_f32_16x16x32_bf16 v[180:183], a[224:227], a[28:31], v[180:183]
  s_add_u32 s54, s54, 8320
  v_mfma_f32_16x16x32_bf16 v[184:187], a[224:227], a[32:35], v[184:187]
  v_add_u32 v15, s54, v15
  v_mfma_f32_16x16x32_bf16 v[188:191], a[224:227], a[36:39], v[188:191]
  s_waitcnt vmcnt(22)
  s_waitcnt lgkmcnt(0)
  v_mfma_f32_16x16x32_bf16 v[112:115], a[132:135], a[0:3], v[112:115]
  v_mfma_f32_16x16x32_bf16 v[116:119], a[132:135], a[4:7], v[116:119]
  v_mfma_f32_16x16x32_bf16 v[120:123], a[132:135], a[8:11], v[120:123]
  ds_read_b128 a[20:23], v208 offset:12288
  v_add_u32 v2, s48, v1
  s_add_u32 s92, s92, 2048
  s_add_u32 m0, s98, 122880
  v_mfma_f32_16x16x32_bf16 v[124:127], a[132:135], a[12:15], v[124:127]
  v_lshrrev_b32 v2, 4, v2
  buffer_load_dwordx4 v224, s[40:43], s92 offen offset:0 sc1 lds
  v_mfma_f32_16x16x32_bf16 v[128:131], a[132:135], a[16:19], v[128:131]
  ds_read_b128 a[24:27], v208 offset:14336
  v_mul_u32_u24 v2, 21504, v2
  v_mfma_f32_16x16x32_bf16 v[132:135], a[136:139], a[0:3], v[132:135]
  buffer_load_dwordx4 v225, s[40:43], s92 offen offset:1024 sc1 lds
  v_mfma_f32_16x16x32_bf16 v[136:139], a[136:139], a[4:7], v[136:139]
  ds_read_b128 a[28:31], v208 offset:16384
  v_and_b32 v3, 15, v1
  v_mfma_f32_16x16x32_bf16 v[140:143], a[136:139], a[8:11], v[140:143]
  v_lshl_add_u32 v255, v3, 4, v2
  v_mfma_f32_16x16x32_bf16 v[144:147], a[136:139], a[12:15], v[144:147]
  ds_read_b128 a[32:35], v208 offset:18432
  s_mul_i32 s54, s101, 10
  buffer_load_dwordx4 v226, s[40:43], s92 offen offset:2048 sc1 lds
  v_mfma_f32_16x16x32_bf16 v[148:151], a[136:139], a[16:19], v[148:151]
  v_mfma_f32_16x16x32_bf16 v[152:155], a[140:143], a[0:3], v[152:155]
  ds_read_b128 a[36:39], v208 offset:20480
  s_add_u32 s54, s54, s28
  v_mfma_f32_16x16x32_bf16 v[156:159], a[140:143], a[4:7], v[156:159]
  s_lshl_b32 s52, s54, 8
  buffer_load_dwordx4 v227, s[40:43], s92 offen offset:3072 sc1 lds
  v_mfma_f32_16x16x32_bf16 v[160:163], a[140:143], a[8:11], v[160:163]
  s_add_u32 m0, s98, 126976
  v_mfma_f32_16x16x32_bf16 v[164:167], a[140:143], a[12:15], v[164:167]
  s_add_u32 s52, s52, 66060288
  buffer_load_dwordx4 v228, s[40:43], s92 offen offset:0 sc1 lds
  v_mfma_f32_16x16x32_bf16 v[168:171], a[140:143], a[16:19], v[168:171]
  s_lshr_b32 s54, s28, 1
  v_mfma_f32_16x16x32_bf16 v[172:175], a[144:147], a[0:3], v[172:175]
  s_mul_i32 s54, s54, 82837504
  v_mfma_f32_16x16x32_bf16 v[176:179], a[144:147], a[4:7], v[176:179]
  buffer_load_dwordx4 v229, s[40:43], s92 offen offset:1024 sc1 lds
  v_mfma_f32_16x16x32_bf16 v[180:183], a[144:147], a[8:11], v[180:183]
  s_add_u32 s53, s52, 2048
  v_mfma_f32_16x16x32_bf16 v[184:187], a[144:147], a[12:15], v[184:187]
  s_max_u32 s53, s53, s54
  v_mfma_f32_16x16x32_bf16 v[188:191], a[144:147], a[16:19], v[188:191]
  s_waitcnt vmcnt(24)
  s_waitcnt lgkmcnt(0)
  v_mfma_f32_16x16x32_bf16 v[112:115], a[148:151], a[20:23], v[112:115]
  v_mfma_f32_16x16x32_bf16 v[116:119], a[148:151], a[24:27], v[116:119]
  s_waitcnt lgkmcnt(0)
  s_barrier
  v_mfma_f32_16x16x32_bf16 v[120:123], a[148:151], a[28:31], v[120:123]
  v_mfma_f32_16x16x32_bf16 v[124:127], a[148:151], a[32:35], v[124:127]
  buffer_load_dwordx4 v230, s[40:43], s92 offen offset:2048 sc1 lds
  v_mfma_f32_16x16x32_bf16 v[128:131], a[148:151], a[36:39], v[128:131]
  v_mfma_f32_16x16x32_bf16 v[132:135], a[152:155], a[20:23], v[132:135]
  buffer_load_dwordx4 v231, s[40:43], s92 offen offset:3072 sc1 lds
  v_mfma_f32_16x16x32_bf16 v[136:139], a[152:155], a[24:27], v[136:139]
  v_mfma_f32_16x16x32_bf16 v[140:143], a[152:155], a[28:31], v[140:143]
  s_add_u32 m0, s98, 131072
  v_mfma_f32_16x16x32_bf16 v[144:147], a[152:155], a[32:35], v[144:147]
  buffer_load_dwordx4 v232, s[40:43], s92 offen offset:0 sc1 lds
  v_mfma_f32_16x16x32_bf16 v[148:151], a[152:155], a[36:39], v[148:151]
  v_mfma_f32_16x16x32_bf16 v[152:155], a[156:159], a[20:23], v[152:155]
  v_mfma_f32_16x16x32_bf16 v[156:159], a[156:159], a[24:27], v[156:159]
  v_mfma_f32_16x16x32_bf16 v[160:163], a[156:159], a[28:31], v[160:163]
  v_cvt_pk_bf16_f32 v112, v112, v113
  v_cvt_pk_bf16_f32 v113, v114, v115
  ds_write_b64 v8, v[112:113] offset:0
  v_mfma_f32_16x16x32_bf16 v[164:167], a[156:159], a[32:35], v[164:167]
  v_cvt_pk_bf16_f32 v116, v116, v117
  v_cvt_pk_bf16_f32 v117, v118, v119
  ds_write_b64 v8, v[116:117] offset:8320
  v_mfma_f32_16x16x32_bf16 v[168:171], a[156:159], a[36:39], v[168:171]
  v_cvt_pk_bf16_f32 v120, v120, v121
  v_cvt_pk_bf16_f32 v121, v122, v123
  ds_write_b64 v8, v[120:121] offset:16640
  v_mfma_f32_16x16x32_bf16 v[172:175], a[160:163], a[20:23], v[172:175]
  v_cvt_pk_bf16_f32 v124, v124, v125
  v_cvt_pk_bf16_f32 v125, v126, v127
  ds_write_b64 v8, v[124:125] offset:24960
  v_mfma_f32_16x16x32_bf16 v[176:179], a[160:163], a[24:27], v[176:179]
  v_cvt_pk_bf16_f32 v128, v128, v129
  v_cvt_pk_bf16_f32 v129, v130, v131
  ds_write_b64 v8, v[128:129] offset:33280
  v_mfma_f32_16x16x32_bf16 v[180:183], a[160:163], a[28:31], v[180:183]
  v_cvt_pk_bf16_f32 v132, v132, v133
  v_cvt_pk_bf16_f32 v133, v134, v135
  ds_write_b64 v8, v[132:133] offset:32
  v_mfma_f32_16x16x32_bf16 v[184:187], a[160:163], a[32:35], v[184:187]
  v_cvt_pk_bf16_f32 v136, v136, v137
  v_cvt_pk_bf16_f32 v137, v138, v139
  ds_write_b64 v8, v[136:137] offset:8352
  v_mfma_f32_16x16x32_bf16 v[188:191], a[160:163], a[36:39], v[188:191]
  v_cvt_pk_bf16_f32 v140, v140, v141
  v_cvt_pk_bf16_f32 v141, v142, v143
  ds_write_b64 v8, v[140:141] offset:16672
  v_cvt_pk_bf16_f32 v144, v144, v145
  v_cvt_pk_bf16_f32 v145, v146, v147
  ds_write_b64 v8, v[144:145] offset:24992
  v_cvt_pk_bf16_f32 v148, v148, v149
  v_cvt_pk_bf16_f32 v149, v150, v151
  ds_write_b64 v8, v[148:149] offset:33312
  v_cvt_pk_bf16_f32 v152, v152, v153
  v_cvt_pk_bf16_f32 v153, v154, v155
  ds_write_b64 v8, v[152:153] offset:64
  v_cvt_pk_bf16_f32 v156, v156, v157
  v_cvt_pk_bf16_f32 v157, v158, v159
  ds_write_b64 v8, v[156:157] offset:8384
  v_cvt_pk_bf16_f32 v160, v160, v161
  v_cvt_pk_bf16_f32 v161, v162, v163
  ds_write_b64 v8, v[160:161] offset:16704
  v_cvt_pk_bf16_f32 v164, v164, v165
  v_cvt_pk_bf16_f32 v165, v166, v167
  ds_write_b64 v8, v[164:165] offset:25024
  v_cvt_pk_bf16_f32 v168, v168, v169
  v_cvt_pk_bf16_f32 v169, v170, v171
  ds_write_b64 v8, v[168:169] offset:33344
  v_cvt_pk_bf16_f32 v172, v172, v173
  v_cvt_pk_bf16_f32 v173, v174, v175
  ds_write_b64 v8, v[172:173] offset:96
  v_cvt_pk_bf16_f32 v176, v176, v177
  v_cvt_pk_bf16_f32 v177, v178, v179
  ds_write_b64 v8, v[176:177] offset:8416
  v_cvt_pk_bf16_f32 v180, v180, v181
  v_cvt_pk_bf16_f32 v181, v182, v183
  ds_write_b64 v8, v[180:181] offset:16736
  v_cvt_pk_bf16_f32 v184, v184, v185
  v_cvt_pk_bf16_f32 v185, v186, v187
  ds_write_b64 v8, v[184:185] offset:25056
  v_cvt_pk_bf16_f32 v188, v188, v189
  v_cvt_pk_bf16_f32 v189, v190, v191
  ds_write_b64 v8, v[188:189] offset:33376
  s_mov_b32 s94, s93
  s_waitcnt lgkmcnt(0)
  s_barrier
  ds_read_b64 v[112:113], v4 offset:8320
  ds_read_b64 v[114:115], v4 offset:8328
  ds_read_b64 v[116:117], v4 offset:160
  ds_read_b64 v[118:119], v4 offset:168
  ds_read_b64 v[120:121], v4 offset:16800
  ds_read_b64 v[122:123], v4 offset:16808
  ds_read_b64_tr_b16 v[132:133], v6 offset:320
  ds_read_b64_tr_b16 v[134:135], v6 offset:16960
  ds_read_b64_tr_b16 v[136:137], v6 offset:352
  ds_read_b64_tr_b16 v[138:139], v6 offset:16992
  ds_read_b64 v[140:141], v4 offset:24960
  buffer_load_dwordx4 a[16:19], v241, s[40:43], s93 offen offset:0 sc1
  ds_read_b64 v[142:143], v4 offset:24968
  ds_read_b64 v[144:145], v4 offset:16800
  ds_read_b64 v[146:147], v4 offset:16808
  ds_read_b64 v[148:149], v5 offset:33440
  ds_read_b64 v[150:151], v5 offset:33448
  ds_read_b64_tr_b16 v[160:161], v6 offset:16960
  ds_read_b64_tr_b16 v[162:163], v7 offset:33600
  ds_read_b64_tr_b16 v[164:165], v6 offset:16992
  ds_read_b64_tr_b16 v[166:167], v7 offset:33632
  ds_read_b64 v[168:169], v4 offset:8840
  ds_read_b64 v[170:171], v4 offset:8848
  buffer_load_dwordx4 a[20:23], v242, s[40:43], s93 offen offset:0 sc1
  ds_read_b64 v[172:173], v4 offset:680
  ds_read_b64 v[174:175], v4 offset:688
  ds_read_b64 v[176:177], v4 offset:17320
  ds_read_b64 v[178:179], v4 offset:17328
  ds_read_b64_tr_b16 v[188:189], v6 offset:840
  ds_read_b64_tr_b16 v[190:191], v6 offset:17480
  ds_read_b64_tr_b16 v[192:193], v6 offset:872
  ds_read_b64_tr_b16 v[194:195], v6 offset:17512
  ds_read_b64 v[196:197], v4 offset:25480
  ds_read_b64 v[198:199], v4 offset:25488
  ds_read_b64 v[200:201], v4 offset:17320
  buffer_load_dwordx4 a[24:27], v243, s[40:43], s93 offen offset:0 sc1
  ds_read_b64 v[202:203], v4 offset:17328
  ds_read_b64 v[204:205], v5 offset:33960
  ds_read_b64 v[206:207], v5 offset:33968
  ds_read_b64_tr_b16 v[216:217], v6 offset:17480
  ds_read_b64_tr_b16 v[218:219], v7 offset:34120
  ds_read_b64_tr_b16 v[220:221], v6 offset:17512
  ds_read_b64_tr_b16 v[222:223], v7 offset:34152
  s_waitcnt lgkmcnt(12)
  v_cndmask_b32 v112, 0, v112, s[38:39]
  v_cndmask_b32 v113, 0, v113, s[38:39]
  v_cndmask_b32 v114, 0, v114, s[50:51]
  v_cndmask_b32 v115, 0, v115, s[50:51]
  buffer_load_dwordx4 a[28:31], v244, s[40:43], s93 offen offset:0 sc1
  v_cndmask_b32 v140, 0, v140, s[38:39]
  v_cndmask_b32 v141, 0, v141, s[38:39]
  v_cndmask_b32 v142, 0, v142, s[50:51]
  v_cndmask_b32 v143, 0, v143, s[50:51]
  v_cndmask_b32 v168, 0, v168, s[38:39]
  v_cndmask_b32 v169, 0, v169, s[38:39]
  v_cndmask_b32 v170, 0, v170, s[50:51]
  v_cndmask_b32 v171, 0, v171, s[50:51]
  s_waitcnt lgkmcnt(0)
  v_cndmask_b32 v196, 0, v196, s[38:39]
  v_cndmask_b32 v197, 0, v197, s[38:39]
  v_cndmask_b32 v198, 0, v198, s[50:51]
  buffer_load_dwordx4 a[32:35], v245, s[40:43], s93 offen offset:0 sc1
  v_cndmask_b32 v199, 0, v199, s[50:51]
  s_nop 1
  v_mfma_f32_16x16x32_bf16 v[124:127], v[116:119], v[112:115], 0
  v_mfma_f32_16x16x32_bf16 v[128:131], v[120:123], v[112:115], 0
  v_mfma_f32_16x16x32_bf16 v[152:155], v[144:147], v[140:143], 0
  v_mfma_f32_16x16x32_bf16 v[156:159], v[148:151], v[140:143], 0
  v_mfma_f32_16x16x32_bf16 v[180:183], v[172:175], v[168:171], 0
  v_mfma_f32_16x16x32_bf16 v[184:187], v[176:179], v[168:171], 0
  v_mfma_f32_16x16x32_bf16 v[208:211], v[200:203], v[196:199], 0
  v_mfma_f32_16x16x32_bf16 v[212:215], v[204:207], v[196:199], 0
  s_nop 1
  v_cndmask_b32 v124, v14, v124, s[20:21]
  v_cndmask_b32 v125, v14, v125, s[22:23]
  v_cndmask_b32 v126, v14, v126, s[36:37]
  v_cndmask_b32 v127, v14, v127, s[24:25]
  v_cndmask_b32 v128, v14, v128, s[12:13]
  v_cndmask_b32 v129, v14, v129, s[14:15]
  v_cndmask_b32 v130, v14, v130, s[16:17]
  v_cndmask_b32 v131, v14, v131, s[18:19]
  v_max3_f32 v112, v124, v125, v126
  v_max3_f32 v113, v127, v128, v129
  v_max3_f32 v112, v112, v130, v131
  buffer_load_dwordx4 a[52:55], v241, s[40:43], s93 offen offset:1024 sc1
  v_max_f32 v112, v112, v113
  v_mov_b32 v113, v112
  v_cndmask_b32 v152, v14, v152, s[4:5]
  v_cndmask_b32 v153, v14, v153, s[6:7]
  v_cndmask_b32 v154, v14, v154, s[8:9]
  v_cndmask_b32 v155, v14, v155, s[10:11]
  v_cndmask_b32 v156, v14, v156, s[12:13]
  v_cndmask_b32 v157, v14, v157, s[14:15]
  v_cndmask_b32 v158, v14, v158, s[16:17]
  v_cndmask_b32 v159, v14, v159, s[18:19]
  v_max3_f32 v140, v152, v153, v154
  buffer_load_dwordx4 a[56:59], v242, s[40:43], s93 offen offset:1024 sc1
  v_max3_f32 v141, v155, v156, v157
  v_max3_f32 v140, v140, v158, v159
  v_max_f32 v140, v140, v141
  v_mov_b32 v141, v140
  v_cndmask_b32 v180, v14, v180, s[20:21]
  v_cndmask_b32 v181, v14, v181, s[22:23]
  v_cndmask_b32 v182, v14, v182, s[36:37]
  v_cndmask_b32 v183, v14, v183, s[24:25]
  v_cndmask_b32 v184, v14, v184, s[12:13]
  v_cndmask_b32 v185, v14, v185, s[14:15]
  v_cndmask_b32 v186, v14, v186, s[16:17]
  buffer_load_dwordx4 a[60:63], v243, s[40:43], s93 offen offset:1024 sc1
  v_cndmask_b32 v187, v14, v187, s[18:19]
  v_max3_f32 v168, v180, v181, v182
  v_max3_f32 v169, v183, v184, v185
  v_max3_f32 v168, v168, v186, v187
  v_max_f32 v168, v168, v169
  v_mov_b32 v169, v168
  v_cndmask_b32 v208, v14, v208, s[4:5]
  v_cndmask_b32 v209, v14, v209, s[6:7]
  v_cndmask_b32 v210, v14, v210, s[8:9]
  v_cndmask_b32 v211, v14, v211, s[10:11]
  v_cndmask_b32 v212, v14, v212, s[12:13]
  buffer_load_dwordx4 a[64:67], v244, s[40:43], s93 offen offset:1024 sc1
  v_cndmask_b32 v213, v14, v213, s[14:15]
  v_cndmask_b32 v214, v14, v214, s[16:17]
  v_cndmask_b32 v215, v14, v215, s[18:19]
  v_max3_f32 v196, v208, v209, v210
  v_max3_f32 v197, v211, v212, v213
  v_max3_f32 v196, v196, v214, v215
  v_max_f32 v196, v196, v197
  v_mov_b32 v197, v196
  s_nop 0
  v_permlane32_swap_b32 v112, v113
  v_permlane32_swap_b32 v140, v141
  buffer_load_dwordx4 a[68:71], v245, s[40:43], s93 offen offset:1024 sc1
  v_permlane32_swap_b32 v168, v169
  v_permlane32_swap_b32 v196, v197
  v_max_f32 v112, v112, v113
  v_mov_b32 v113, v112
  v_max_f32 v140, v140, v141
  v_mov_b32 v141, v140
  v_max_f32 v168, v168, v169
  v_mov_b32 v169, v168
  v_max_f32 v196, v196, v197
  v_mov_b32 v197, v196
  s_nop 0
  v_permlane16_swap_b32 v112, v113
  v_permlane16_swap_b32 v140, v141
  v_permlane16_swap_b32 v168, v169
  v_permlane16_swap_b32 v196, v197
  v_max_f32 v112, v112, v113
  v_mov_b32 v113, v112
  v_max_f32 v140, v140, v141
  v_mov_b32 v141, v140
  v_max_f32 v168, v168, v169
  v_mov_b32 v169, v168
  v_max_f32 v196, v196, v197
  buffer_load_dwordx4 a[88:91], v241, s[40:43], s93 offen offset:2048 sc1
  v_mov_b32 v197, v196
  v_mul_f32 v112, s58, v112
  v_fma_f32 v124, v124, s58, -v112
  v_fma_f32 v125, v125, s58, -v112
  v_fma_f32 v126, v126, s58, -v112
  v_fma_f32 v127, v127, s58, -v112
  v_fma_f32 v128, v128, s58, -v112
  v_fma_f32 v129, v129, s58, -v112
  v_fma_f32 v130, v130, s58, -v112
  v_fma_f32 v131, v131, s58, -v112
  v_exp_f32 v124, v124
  v_exp_f32 v125, v125
  v_exp_f32 v126, v126
  v_exp_f32 v127, v127
  v_exp_f32 v128, v128
  v_exp_f32 v129, v129
  v_exp_f32 v130, v130
  v_exp_f32 v131, v131
  s_nop 0
  v_cvt_pk_bf16_f32 v112, v124, v125
  v_cvt_pk_bf16_f32 v113, v126, v127
  v_cvt_pk_bf16_f32 v114, v128, v129
  buffer_load_dwordx4 a[92:95], v242, s[40:43], s93 offen offset:2048 sc1
  v_cvt_pk_bf16_f32 v115, v130, v131
  v_mul_f32 v140, s58, v140
  v_fma_f32 v152, v152, s58, -v140
  v_fma_f32 v153, v153, s58, -v140
  v_fma_f32 v154, v154, s58, -v140
  v_fma_f32 v155, v155, s58, -v140
  v_fma_f32 v156, v156, s58, -v140
  v_fma_f32 v157, v157, s58, -v140
  v_fma_f32 v158, v158, s58, -v140
  v_fma_f32 v159, v159, s58, -v140
  v_exp_f32 v152, v152
  v_exp_f32 v153, v153
  v_exp_f32 v154, v154
  v_exp_f32 v155, v155
  v_exp_f32 v156, v156
  v_exp_f32 v157, v157
  v_exp_f32 v158, v158
  v_exp_f32 v159, v159
  s_nop 0
  v_cvt_pk_bf16_f32 v140, v152, v153
  v_cvt_pk_bf16_f32 v141, v154, v155
  v_cvt_pk_bf16_f32 v142, v156, v157
  buffer_load_dwordx4 a[96:99], v243, s[40:43], s93 offen offset:2048 sc1
  v_cvt_pk_bf16_f32 v143, v158, v159
  v_mul_f32 v168, s58, v168
  v_fma_f32 v180, v180, s58, -v168
  v_fma_f32 v181, v181, s58, -v168
  v_fma_f32 v182, v182, s58, -v168
  v_fma_f32 v183, v183, s58, -v168
  v_fma_f32 v184, v184, s58, -v168
  v_fma_f32 v185, v185, s58, -v168
  v_fma_f32 v186, v186, s58, -v168
  v_fma_f32 v187, v187, s58, -v168
  v_exp_f32 v180, v180
  v_exp_f32 v181, v181
  v_exp_f32 v182, v182
  v_exp_f32 v183, v183
  v_exp_f32 v184, v184
  v_exp_f32 v185, v185
  v_exp_f32 v186, v186
  v_exp_f32 v187, v187
  s_nop 0
  v_cvt_pk_bf16_f32 v168, v180, v181
  v_cvt_pk_bf16_f32 v169, v182, v183
  v_cvt_pk_bf16_f32 v170, v184, v185
  buffer_load_dwordx4 a[100:103], v244, s[40:43], s93 offen offset:2048 sc1
  v_cvt_pk_bf16_f32 v171, v186, v187
  v_mul_f32 v196, s58, v196
  v_fma_f32 v208, v208, s58, -v196
  v_fma_f32 v209, v209, s58, -v196
  v_fma_f32 v210, v210, s58, -v196
  v_fma_f32 v211, v211, s58, -v196
  v_fma_f32 v212, v212, s58, -v196
  v_fma_f32 v213, v213, s58, -v196
  v_fma_f32 v214, v214, s58, -v196
  v_fma_f32 v215, v215, s58, -v196
  v_exp_f32 v208, v208
  v_exp_f32 v209, v209
  v_exp_f32 v210, v210
  v_exp_f32 v211, v211
  v_exp_f32 v212, v212
  v_exp_f32 v213, v213
  v_exp_f32 v214, v214
  v_exp_f32 v215, v215
  s_nop 0
  v_cvt_pk_bf16_f32 v196, v208, v209
  v_cvt_pk_bf16_f32 v197, v210, v211
  v_cvt_pk_bf16_f32 v198, v212, v213
  buffer_load_dwordx4 a[104:107], v245, s[40:43], s93 offen offset:2048 sc1
  v_cvt_pk_bf16_f32 v199, v214, v215
  s_nop 0
  v_mfma_f32_16x16x32_bf16 v[124:127], v[28:31], v[112:115], 0
  v_mfma_f32_16x16x32_bf16 v[116:119], v[132:135], v[112:115], 0
  v_mfma_f32_16x16x32_bf16 v[120:123], v[136:139], v[112:115], 0
  v_mfma_f32_16x16x32_bf16 v[152:155], v[28:31], v[140:143], 0
  v_mfma_f32_16x16x32_bf16 v[144:147], v[160:163], v[140:143], 0
  v_mfma_f32_16x16x32_bf16 v[148:151], v[164:167], v[140:143], 0
  v_mfma_f32_16x16x32_bf16 v[180:183], v[28:31], v[168:171], 0
  v_mfma_f32_16x16x32_bf16 v[172:175], v[188:191], v[168:171], 0
  v_mfma_f32_16x16x32_bf16 v[176:179], v[192:195], v[168:171], 0
  buffer_load_dwordx4 a[124:127], v241, s[40:43], s93 offen offset:3072 sc1
  v_mfma_f32_16x16x32_bf16 v[208:211], v[28:31], v[196:199], 0
  v_mfma_f32_16x16x32_bf16 v[200:203], v[216:219], v[196:199], 0
  v_mfma_f32_16x16x32_bf16 v[204:207], v[220:223], v[196:199], 0
  s_nop 1
  v_rcp_f32 v124, v124
  s_nop 0
  v_mul_f32 v116, v116, v124
  v_mul_f32 v117, v117, v124
  v_mul_f32 v118, v118, v124
  v_mul_f32 v119, v119, v124
  v_mul_f32 v120, v120, v124
  buffer_load_dwordx4 a[128:131], v242, s[40:43], s93 offen offset:3072 sc1
  v_mul_f32 v121, v121, v124
  v_mul_f32 v122, v122, v124
  v_mul_f32 v123, v123, v124
  v_cvt_pk_bf16_f32 v116, v116, v117
  v_cvt_pk_bf16_f32 v117, v118, v119
  v_cvt_pk_bf16_f32 v118, v120, v121
  v_cvt_pk_bf16_f32 v119, v122, v123
  ds_write_b64 v9, v[116:117] offset:8320
  ds_write_b64 v10, v[118:119] offset:8320
  v_rcp_f32 v152, v152
  s_nop 0
  v_mul_f32 v144, v144, v152
  v_mul_f32 v145, v145, v152
  v_mul_f32 v146, v146, v152
  v_mul_f32 v147, v147, v152
  v_mul_f32 v148, v148, v152
  v_mul_f32 v149, v149, v152
  v_mul_f32 v150, v150, v152
  v_mul_f32 v151, v151, v152
  v_cvt_pk_bf16_f32 v144, v144, v145
  v_cvt_pk_bf16_f32 v145, v146, v147
  v_cvt_pk_bf16_f32 v146, v148, v149
  buffer_load_dwordx4 a[132:135], v243, s[40:43], s93 offen offset:3072 sc1
  v_cvt_pk_bf16_f32 v147, v150, v151
  ds_write_b64 v9, v[144:145] offset:24960
  ds_write_b64 v10, v[146:147] offset:24960
  v_rcp_f32 v180, v180
  s_nop 0
  v_mul_f32 v172, v172, v180
  v_mul_f32 v173, v173, v180
  v_mul_f32 v174, v174, v180
  v_mul_f32 v175, v175, v180
  v_mul_f32 v176, v176, v180
  v_mul_f32 v177, v177, v180
  buffer_load_dwordx4 a[136:139], v244, s[40:43], s93 offen offset:3072 sc1
  v_mul_f32 v178, v178, v180
  v_mul_f32 v179, v179, v180
  v_cvt_pk_bf16_f32 v172, v172, v173
  v_cvt_pk_bf16_f32 v173, v174, v175
  v_cvt_pk_bf16_f32 v174, v176, v177
  v_cvt_pk_bf16_f32 v175, v178, v179
  ds_write_b64 v9, v[172:173] offset:8840
  ds_write_b64 v10, v[174:175] offset:8840
  v_rcp_f32 v208, v208
  s_nop 0
  v_mul_f32 v200, v200, v208
  buffer_load_dwordx4 a[140:143], v245, s[40:43], s93 offen offset:3072 sc1
  v_mul_f32 v201, v201, v208
  v_mul_f32 v202, v202, v208
  v_mul_f32 v203, v203, v208
  v_mul_f32 v204, v204, v208
  v_mul_f32 v205, v205, v208
  v_mul_f32 v206, v206, v208
  v_mul_f32 v207, v207, v208
  v_cvt_pk_bf16_f32 v200, v200, v201
  v_cvt_pk_bf16_f32 v201, v202, v203
  v_cvt_pk_bf16_f32 v202, v204, v205
  v_cvt_pk_bf16_f32 v203, v206, v207
  s_add_u32 s93, s93, 4096
  buffer_load_dwordx4 a[160:163], v241, s[40:43], s93 offen offset:0 sc1
  ds_write_b64 v9, v[200:201] offset:25480
  ds_write_b64 v10, v[202:203] offset:25480
  buffer_load_dwordx4 a[164:167], v242, s[40:43], s93 offen offset:0 sc1
  buffer_load_dwordx4 a[168:171], v243, s[40:43], s93 offen offset:0 sc1
  buffer_load_dwordx4 a[172:175], v244, s[40:43], s93 offen offset:0 sc1
  buffer_load_dwordx4 a[176:179], v245, s[40:43], s93 offen offset:0 sc1
  s_waitcnt lgkmcnt(0)
  s_waitcnt vmcnt(43)
  s_barrier
  ds_read_b128 a[196:199], v234 offset:0
  ds_read_b128 a[180:183], v233 offset:0
  ds_read_b128 a[184:187], v233 offset:2048
  ds_read_b128 a[188:191], v233 offset:4096
  ds_read_b128 a[192:195], v233 offset:6144
  ds_read_b128 a[200:203], v234 offset:2048
  ds_read_b128 a[204:207], v234 offset:4096
  ds_read_b128 a[208:211], v234 offset:6144
  ds_read_b128 a[212:215], v234 offset:8192
  ds_read_b64 v[112:113], v15 offset:0
  ds_read_b64 v[114:115], v15 offset:8
  ds_read_b64 v[116:117], v15 offset:64
  ds_read_b64 v[118:119], v15 offset:72
  ds_read_b64 v[120:121], v15 offset:128
  ds_read_b64 v[122:123], v15 offset:136
  s_waitcnt lgkmcnt(0)
  buffer_store_dwordx4 v[112:115], v255, s[40:43], s52 offen sc1
  buffer_store_dwordx4 v[116:119], v255, s[40:43], s52 offen offset:1024 sc1
  buffer_store_dwordx4 v[120:123], v255, s[40:43], s53 offen sc1
  s_waitcnt lgkmcnt(7)
  v_mfma_f32_16x16x32_bf16 v[32:35], a[196:199], a[180:183], 0
  s_waitcnt lgkmcnt(6)
  v_mfma_f32_16x16x32_bf16 v[52:55], a[196:199], a[184:187], 0
  s_waitcnt lgkmcnt(5)
  v_mfma_f32_16x16x32_bf16 v[72:75], a[196:199], a[188:191], 0
  ds_read_b128 a[232:235], v234 offset:1024
  s_waitcnt lgkmcnt(5)
  v_mfma_f32_16x16x32_bf16 v[92:95], a[196:199], a[192:195], 0
  s_waitcnt lgkmcnt(4)
  v_mfma_f32_16x16x32_bf16 v[36:39], a[200:203], a[180:183], 0
  ds_read_b128 a[216:219], v233 offset:1024
  v_mfma_f32_16x16x32_bf16 v[56:59], a[200:203], a[184:187], 0
  v_mfma_f32_16x16x32_bf16 v[76:79], a[200:203], a[188:191], 0
  ds_read_b128 a[220:223], v233 offset:3072
  v_mfma_f32_16x16x32_bf16 v[96:99], a[200:203], a[192:195], 0
  s_waitcnt lgkmcnt(5)
  v_mfma_f32_16x16x32_bf16 v[40:43], a[204:207], a[180:183], 0
  ds_read_b128 a[224:227], v233 offset:5120
  v_mfma_f32_16x16x32_bf16 v[60:63], a[204:207], a[184:187], 0
  v_mfma_f32_16x16x32_bf16 v[80:83], a[204:207], a[188:191], 0
  ds_read_b128 a[228:231], v233 offset:7168
  v_mfma_f32_16x16x32_bf16 v[100:103], a[204:207], a[192:195], 0
  s_waitcnt lgkmcnt(4)
  v_mfma_f32_16x16x32_bf16 v[44:47], a[208:211], a[180:183], 0
  ds_read_b128 a[236:239], v234 offset:3072
  v_mfma_f32_16x16x32_bf16 v[64:67], a[208:211], a[184:187], 0
  ds_read_b128 a[240:243], v234 offset:5120
  v_mfma_f32_16x16x32_bf16 v[84:87], a[208:211], a[188:191], 0
  ds_read_b128 a[244:247], v234 offset:7168
  v_mfma_f32_16x16x32_bf16 v[104:107], a[208:211], a[192:195], 0
  ds_read_b128 a[248:251], v234 offset:9216
  v_mfma_f32_16x16x32_bf16 v[48:51], a[212:215], a[180:183], 0
  v_mfma_f32_16x16x32_bf16 v[68:71], a[212:215], a[184:187], 0
  v_mfma_f32_16x16x32_bf16 v[88:91], a[212:215], a[188:191], 0
  v_mfma_f32_16x16x32_bf16 v[108:111], a[212:215], a[192:195], 0
  s_waitcnt lgkmcnt(4)
  v_mfma_f32_16x16x32_bf16 v[32:35], a[232:235], a[216:219], v[32:35]
  v_mfma_f32_16x16x32_bf16 v[52:55], a[232:235], a[220:223], v[52:55]
  s_waitcnt vmcnt(37) lgkmcnt(0)
  s_barrier
  v_mfma_f32_16x16x32_bf16 v[72:75], a[232:235], a[224:227], v[72:75]
  ds_read_b128 a[196:199], v234 offset:36864
  s_add_u32 s92, s92, 2048
  s_add_u32 m0, s98, 49152
  v_mfma_f32_16x16x32_bf16 v[92:95], a[232:235], a[228:231], v[92:95]
  buffer_load_dwordx4 v224, s[40:43], s92 offen offset:0 sc1 lds
  v_mfma_f32_16x16x32_bf16 v[36:39], a[236:239], a[216:219], v[36:39]
  ds_read_b128 a[180:183], v233 offset:36864
  v_mfma_f32_16x16x32_bf16 v[56:59], a[236:239], a[220:223], v[56:59]
  v_mfma_f32_16x16x32_bf16 v[76:79], a[236:239], a[224:227], v[76:79]
  ds_read_b128 a[184:187], v233 offset:38912
  v_mfma_f32_16x16x32_bf16 v[96:99], a[236:239], a[228:231], v[96:99]
  buffer_load_dwordx4 v225, s[40:43], s92 offen offset:1024 sc1 lds
  v_mfma_f32_16x16x32_bf16 v[40:43], a[240:243], a[216:219], v[40:43]
  ds_read_b128 a[188:191], v233 offset:40960
  v_mfma_f32_16x16x32_bf16 v[60:63], a[240:243], a[220:223], v[60:63]
  v_mfma_f32_16x16x32_bf16 v[80:83], a[240:243], a[224:227], v[80:83]
  ds_read_b128 a[192:195], v233 offset:43008
  v_mfma_f32_16x16x32_bf16 v[100:103], a[240:243], a[228:231], v[100:103]
  buffer_load_dwordx4 v226, s[40:43], s92 offen offset:2048 sc1 lds
  v_mfma_f32_16x16x32_bf16 v[44:47], a[244:247], a[216:219], v[44:47]
  ds_read_b128 a[200:203], v234 offset:38912
  v_mfma_f32_16x16x32_bf16 v[64:67], a[244:247], a[220:223], v[64:67]
  ds_read_b128 a[204:207], v234 offset:40960
  v_mfma_f32_16x16x32_bf16 v[84:87], a[244:247], a[224:227], v[84:87]
  ds_read_b128 a[208:211], v234 offset:43008
  v_mfma_f32_16x16x32_bf16 v[104:107], a[244:247], a[228:231], v[104:107]
  ds_read_b128 a[212:215], v234 offset:45056
  buffer_load_dwordx4 v227, s[40:43], s92 offen offset:3072 sc1 lds
  v_mfma_f32_16x16x32_bf16 v[48:51], a[248:251], a[216:219], v[48:51]
  v_mfma_f32_16x16x32_bf16 v[68:71], a[248:251], a[220:223], v[68:71]
  v_mfma_f32_16x16x32_bf16 v[88:91], a[248:251], a[224:227], v[88:91]
  s_add_u32 m0, s98, 53248
  v_mfma_f32_16x16x32_bf16 v[108:111], a[248:251], a[228:231], v[108:111]
  buffer_load_dwordx4 v228, s[40:43], s92 offen offset:0 sc1 lds
  s_waitcnt lgkmcnt(3)
  v_mfma_f32_16x16x32_bf16 v[32:35], a[196:199], a[180:183], v[32:35]
  v_mfma_f32_16x16x32_bf16 v[52:55], a[196:199], a[184:187], v[52:55]
  v_mfma_f32_16x16x32_bf16 v[72:75], a[196:199], a[188:191], v[72:75]
  ds_read_b128 a[232:235], v234 offset:37888
  s_add_u32 m0, s98, 53248
  v_mfma_f32_16x16x32_bf16 v[92:95], a[196:199], a[192:195], v[92:95]
  buffer_load_dwordx4 v229, s[40:43], s92 offen offset:1024 sc1 lds
  v_mfma_f32_16x16x32_bf16 v[36:39], a[200:203], a[180:183], v[36:39]
  ds_read_b128 a[216:219], v233 offset:37888
  v_mfma_f32_16x16x32_bf16 v[56:59], a[200:203], a[184:187], v[56:59]
  v_mfma_f32_16x16x32_bf16 v[76:79], a[200:203], a[188:191], v[76:79]
  ds_read_b128 a[220:223], v233 offset:39936
  v_mfma_f32_16x16x32_bf16 v[96:99], a[200:203], a[192:195], v[96:99]
  buffer_load_dwordx4 v230, s[40:43], s92 offen offset:2048 sc1 lds
  s_waitcnt lgkmcnt(3)
  v_mfma_f32_16x16x32_bf16 v[40:43], a[204:207], a[180:183], v[40:43]
  ds_read_b128 a[224:227], v233 offset:41984
  v_mfma_f32_16x16x32_bf16 v[60:63], a[204:207], a[184:187], v[60:63]
  v_mfma_f32_16x16x32_bf16 v[80:83], a[204:207], a[188:191], v[80:83]
  ds_read_b128 a[228:231], v233 offset:44032
  v_mfma_f32_16x16x32_bf16 v[100:103], a[204:207], a[192:195], v[100:103]
  buffer_load_dwordx4 v231, s[40:43], s92 offen offset:3072 sc1 lds
  v_mfma_f32_16x16x32_bf16 v[44:47], a[208:211], a[180:183], v[44:47]
  ds_read_b128 a[236:239], v234 offset:39936
  v_mfma_f32_16x16x32_bf16 v[64:67], a[208:211], a[184:187], v[64:67]
  ds_read_b128 a[240:243], v234 offset:41984
  v_mfma_f32_16x16x32_bf16 v[84:87], a[208:211], a[188:191], v[84:87]
  ds_read_b128 a[244:247], v234 offset:44032
  s_add_u32 m0, s98, 57344
  v_mfma_f32_16x16x32_bf16 v[104:107], a[208:211], a[192:195], v[104:107]
  ds_read_b128 a[248:251], v234 offset:46080
  buffer_load_dwordx4 v232, s[40:43], s92 offen offset:0 sc1 lds
  v_mfma_f32_16x16x32_bf16 v[48:51], a[212:215], a[180:183], v[48:51]
  v_mfma_f32_16x16x32_bf16 v[68:71], a[212:215], a[184:187], v[68:71]
  v_mfma_f32_16x16x32_bf16 v[88:91], a[212:215], a[188:191], v[88:91]
  v_mfma_f32_16x16x32_bf16 v[108:111], a[212:215], a[192:195], v[108:111]
  s_waitcnt lgkmcnt(4)
  v_mfma_f32_16x16x32_bf16 v[32:35], a[232:235], a[216:219], v[32:35]
  v_mfma_f32_16x16x32_bf16 v[52:55], a[232:235], a[220:223], v[52:55]
  s_waitcnt vmcnt(9) lgkmcnt(0)
  s_barrier
  s_cmp_lg_u32 s28, 0
  s_cbranch_scc1 LO_of
  v_mov_b32 v2, s0
  v_mov_b32 v3, s1
  v_mov_b32 v0, 0
  s_mov_b64 exec, 1
  buffer_store_dwordx2 v[2:3], v0, s[40:43], s97 offen sc1
  s_mov_b64 exec, -1
LO_of:
  v_mfma_f32_16x16x32_bf16 v[72:75], a[232:235], a[224:227], v[72:75]
  ds_read_b128 a[196:199], v236 offset:0
  s_add_u32 s92, s92, 2048
  s_add_u32 m0, s98, 86016
  v_mfma_f32_16x16x32_bf16 v[92:95], a[232:235], a[228:231], v[92:95]
  buffer_load_dwordx4 v224, s[40:43], s92 offen offset:0 sc1 lds
  v_mfma_f32_16x16x32_bf16 v[36:39], a[236:239], a[216:219], v[36:39]
  ds_read_b128 a[180:183], v235 offset:0
  v_mfma_f32_16x16x32_bf16 v[56:59], a[236:239], a[220:223], v[56:59]
  v_mfma_f32_16x16x32_bf16 v[76:79], a[236:239], a[224:227], v[76:79]
  ds_read_b128 a[184:187], v235 offset:2048
  v_mfma_f32_16x16x32_bf16 v[96:99], a[236:239], a[228:231], v[96:99]
  buffer_load_dwordx4 v225, s[40:43], s92 offen offset:1024 sc1 lds
  v_mfma_f32_16x16x32_bf16 v[40:43], a[240:243], a[216:219], v[40:43]
  ds_read_b128 a[188:191], v235 offset:4096
  v_mfma_f32_16x16x32_bf16 v[60:63], a[240:243], a[220:223], v[60:63]
  v_mfma_f32_16x16x32_bf16 v[80:83], a[240:243], a[224:227], v[80:83]
  ds_read_b128 a[192:195], v235 offset:6144
  v_mfma_f32_16x16x32_bf16 v[100:103], a[240:243], a[228:231], v[100:103]
  buffer_load_dwordx4 v226, s[40:43], s92 offen offset:2048 sc1 lds
  v_mfma_f32_16x16x32_bf16 v[44:47], a[244:247], a[216:219], v[44:47]
  ds_read_b128 a[200:203], v236 offset:2048
  v_mfma_f32_16x16x32_bf16 v[64:67], a[244:247], a[220:223], v[64:67]
  ds_read_b128 a[204:207], v236 offset:4096
  v_mfma_f32_16x16x32_bf16 v[84:87], a[244:247], a[224:227], v[84:87]
  ds_read_b128 a[208:211], v236 offset:6144
  v_mfma_f32_16x16x32_bf16 v[104:107], a[244:247], a[228:231], v[104:107]
  ds_read_b128 a[212:215], v236 offset:8192
  buffer_load_dwordx4 v227, s[40:43], s92 offen offset:3072 sc1 lds
  v_mfma_f32_16x16x32_bf16 v[48:51], a[248:251], a[216:219], v[48:51]
  v_mfma_f32_16x16x32_bf16 v[68:71], a[248:251], a[220:223], v[68:71]
  v_mfma_f32_16x16x32_bf16 v[88:91], a[248:251], a[224:227], v[88:91]
  s_add_u32 m0, s98, 90112
  v_mfma_f32_16x16x32_bf16 v[108:111], a[248:251], a[228:231], v[108:111]
  buffer_load_dwordx4 v228, s[40:43], s92 offen offset:0 sc1 lds
  s_waitcnt lgkmcnt(3)
  v_mfma_f32_16x16x32_bf16 v[32:35], a[196:199], a[180:183], v[32:35]
  v_mfma_f32_16x16x32_bf16 v[52:55], a[196:199], a[184:187], v[52:55]
  v_mfma_f32_16x16x32_bf16 v[72:75], a[196:199], a[188:191], v[72:75]
  ds_read_b128 a[232:235], v236 offset:1024
  s_add_u32 m0, s98, 90112
  v_mfma_f32_16x16x32_bf16 v[92:95], a[196:199], a[192:195], v[92:95]
  buffer_load_dwordx4 v229, s[40:43], s92 offen offset:1024 sc1 lds
  v_mfma_f32_16x16x32_bf16 v[36:39], a[200:203], a[180:183], v[36:39]
  ds_read_b128 a[216:219], v235 offset:1024
  v_mfma_f32_16x16x32_bf16 v[56:59], a[200:203], a[184:187], v[56:59]
  v_mfma_f32_16x16x32_bf16 v[76:79], a[200:203], a[188:191], v[76:79]
  ds_read_b128 a[220:223], v235 offset:3072
  v_mfma_f32_16x16x32_bf16 v[96:99], a[200:203], a[192:195], v[96:99]
  buffer_load_dwordx4 v230, s[40:43], s92 offen offset:2048 sc1 lds
  s_waitcnt lgkmcnt(3)
  v_mfma_f32_16x16x32_bf16 v[40:43], a[204:207], a[180:183], v[40:43]
  ds_read_b128 a[224:227], v235 offset:5120
  v_mfma_f32_16x16x32_bf16 v[60:63], a[204:207], a[184:187], v[60:63]
  v_mfma_f32_16x16x32_bf16 v[80:83], a[204:207], a[188:191], v[80:83]
  ds_read_b128 a[228:231], v235 offset:7168
  v_mfma_f32_16x16x32_bf16 v[100:103], a[204:207], a[192:195], v[100:103]
  buffer_load_dwordx4 v231, s[40:43], s92 offen offset:3072 sc1 lds
  v_mfma_f32_16x16x32_bf16 v[44:47], a[208:211], a[180:183], v[44:47]
  ds_read_b128 a[236:239], v236 offset:3072
  v_mfma_f32_16x16x32_bf16 v[64:67], a[208:211], a[184:187], v[64:67]
  ds_read_b128 a[240:243], v236 offset:5120
  v_mfma_f32_16x16x32_bf16 v[84:87], a[208:211], a[188:191], v[84:87]
  ds_read_b128 a[244:247], v236 offset:7168
  s_add_u32 m0, s98, 94208
  v_mfma_f32_16x16x32_bf16 v[104:107], a[208:211], a[192:195], v[104:107]
  ds_read_b128 a[248:251], v236 offset:9216
  buffer_load_dwordx4 v232, s[40:43], s92 offen offset:0 sc1 lds
  v_mfma_f32_16x16x32_bf16 v[48:51], a[212:215], a[180:183], v[48:51]
  v_mfma_f32_16x16x32_bf16 v[68:71], a[212:215], a[184:187], v[68:71]
  v_mfma_f32_16x16x32_bf16 v[88:91], a[212:215], a[188:191], v[88:91]
  v_mfma_f32_16x16x32_bf16 v[108:111], a[212:215], a[192:195], v[108:111]
  s_waitcnt lgkmcnt(4)
  v_mfma_f32_16x16x32_bf16 v[32:35], a[232:235], a[216:219], v[32:35]
  v_mfma_f32_16x16x32_bf16 v[52:55], a[232:235], a[220:223], v[52:55]
  s_waitcnt vmcnt(9) lgkmcnt(0)
  s_barrier
  v_mfma_f32_16x16x32_bf16 v[72:75], a[232:235], a[224:227], v[72:75]
  ds_read_b128 a[196:199], v234 offset:0
  s_add_u32 s92, s92, 2048
  s_add_u32 m0, s98, 122880
  s_add_u32 s56, s28, 1
  v_mfma_f32_16x16x32_bf16 v[92:95], a[232:235], a[228:231], v[92:95]
  buffer_load_dwordx4 v224, s[40:43], s92 offen offset:0 sc1 lds
  v_mfma_f32_16x16x32_bf16 v[36:39], a[236:239], a[216:219], v[36:39]
  ds_read_b128 a[180:183], v233 offset:0
  s_and_b32 s56, s56, 3
  v_mfma_f32_16x16x32_bf16 v[56:59], a[236:239], a[220:223], v[56:59]
  v_mfma_f32_16x16x32_bf16 v[76:79], a[236:239], a[224:227], v[76:79]
  ds_read_b128 a[184:187], v233 offset:2048
  s_mul_i32 s56, s56, 15360
  v_mfma_f32_16x16x32_bf16 v[96:99], a[236:239], a[228:231], v[96:99]
  buffer_load_dwordx4 v225, s[40:43], s92 offen offset:1024 sc1 lds
  v_mfma_f32_16x16x32_bf16 v[40:43], a[240:243], a[216:219], v[40:43]
  ds_read_b128 a[188:191], v233 offset:4096
  s_add_u32 s56, s56, 0
  v_mfma_f32_16x16x32_bf16 v[60:63], a[240:243], a[220:223], v[60:63]
  v_mfma_f32_16x16x32_bf16 v[80:83], a[240:243], a[224:227], v[80:83]
  ds_read_b128 a[192:195], v233 offset:6144
  v_add_u32 v17, s56, v252
  v_mfma_f32_16x16x32_bf16 v[100:103], a[240:243], a[228:231], v[100:103]
  buffer_load_dwordx4 v226, s[40:43], s92 offen offset:2048 sc1 lds
  v_mfma_f32_16x16x32_bf16 v[44:47], a[244:247], a[216:219], v[44:47]
  ds_read_b128 a[200:203], v234 offset:2048
  s_add_u32 s56, s28, 2
  v_mfma_f32_16x16x32_bf16 v[64:67], a[244:247], a[220:223], v[64:67]
  ds_read_b128 a[204:207], v234 offset:4096
  v_mfma_f32_16x16x32_bf16 v[84:87], a[244:247], a[224:227], v[84:87]
  ds_read_b128 a[208:211], v234 offset:6144
  s_and_b32 s56, s56, 3
  v_mfma_f32_16x16x32_bf16 v[104:107], a[244:247], a[228:231], v[104:107]
  ds_read_b128 a[212:215], v234 offset:8192
  buffer_load_dwordx4 v227, s[40:43], s92 offen offset:3072 sc1 lds
  v_mfma_f32_16x16x32_bf16 v[48:51], a[248:251], a[216:219], v[48:51]
  s_mul_i32 s56, s56, 15360
  v_mfma_f32_16x16x32_bf16 v[68:71], a[248:251], a[220:223], v[68:71]
  v_mfma_f32_16x16x32_bf16 v[88:91], a[248:251], a[224:227], v[88:91]
  s_add_u32 m0, s98, 126976
  s_add_u32 s56, s56, 5120
  v_mfma_f32_16x16x32_bf16 v[108:111], a[248:251], a[228:231], v[108:111]
  buffer_load_dwordx4 v228, s[40:43], s92 offen offset:0 sc1 lds
  s_waitcnt lgkmcnt(2)
  v_mfma_f32_16x16x32_bf16 v[32:35], a[196:199], a[180:183], v[32:35]
  v_mfma_f32_16x16x32_bf16 v[52:55], a[196:199], a[184:187], v[52:55]
  v_mfma_f32_16x16x32_bf16 v[72:75], a[196:199], a[188:191], v[72:75]
  ds_read_b128 a[232:235], v234 offset:1024
  s_add_u32 m0, s98, 126976
  v_add_u32 v18, s56, v252
  v_mfma_f32_16x16x32_bf16 v[92:95], a[196:199], a[192:195], v[92:95]
  buffer_load_dwordx4 v229, s[40:43], s92 offen offset:1024 sc1 lds
  v_mfma_f32_16x16x32_bf16 v[36:39], a[200:203], a[180:183], v[36:39]
  ds_read_b128 a[216:219], v233 offset:1024
  s_add_u32 s56, s28, 3
  v_mfma_f32_16x16x32_bf16 v[56:59], a[200:203], a[184:187], v[56:59]
  v_mfma_f32_16x16x32_bf16 v[76:79], a[200:203], a[188:191], v[76:79]
  ds_read_b128 a[220:223], v233 offset:3072
  s_and_b32 s56, s56, 3
  v_mfma_f32_16x16x32_bf16 v[96:99], a[200:203], a[192:195], v[96:99]
  buffer_load_dwordx4 v230, s[40:43], s92 offen offset:2048 sc1 lds
  v_mfma_f32_16x16x32_bf16 v[40:43], a[204:207], a[180:183], v[40:43]
  ds_read_b128 a[224:227], v233 offset:5120
  s_mul_i32 s56, s56, 15360
  v_mfma_f32_16x16x32_bf16 v[60:63], a[204:207], a[184:187], v[60:63]
  v_mfma_f32_16x16x32_bf16 v[80:83], a[204:207], a[188:191], v[80:83]
  ds_read_b128 a[228:231], v233 offset:7168
  s_add_u32 s56, s56, 10240
  v_mfma_f32_16x16x32_bf16 v[100:103], a[204:207], a[192:195], v[100:103]
  buffer_load_dwordx4 v231, s[40:43], s92 offen offset:3072 sc1 lds
  s_waitcnt lgkmcnt(3)
  v_mfma_f32_16x16x32_bf16 v[44:47], a[208:211], a[180:183], v[44:47]
  ds_read_b128 a[236:239], v234 offset:3072
  v_add_u32 v19, s56, v252
  v_mfma_f32_16x16x32_bf16 v[64:67], a[208:211], a[184:187], v[64:67]
  ds_read_b128 a[240:243], v234 offset:5120
  v_mfma_f32_16x16x32_bf16 v[84:87], a[208:211], a[188:191], v[84:87]
  ds_read_b128 a[244:247], v234 offset:7168
  s_add_u32 m0, s98, 131072
  s_mul_i32 s56, s28, 15360
  v_mfma_f32_16x16x32_bf16 v[104:107], a[208:211], a[192:195], v[104:107]
  ds_read_b128 a[248:251], v234 offset:9216
  buffer_load_dwordx4 v232, s[40:43], s92 offen offset:0 sc1 lds
  v_mfma_f32_16x16x32_bf16 v[48:51], a[212:215], a[180:183], v[48:51]
  v_add_u32 v16, s56, v252
  v_mfma_f32_16x16x32_bf16 v[68:71], a[212:215], a[184:187], v[68:71]
  v_mfma_f32_16x16x32_bf16 v[88:91], a[212:215], a[188:191], v[88:91]
  s_lshl_b32 s56, s100, 6
  v_mfma_f32_16x16x32_bf16 v[108:111], a[212:215], a[192:195], v[108:111]
  v_mfma_f32_16x16x32_bf16 v[32:35], a[232:235], a[216:219], v[32:35]
  s_waitcnt lgkmcnt(2)
  v_mfma_f32_16x16x32_bf16 v[52:55], a[232:235], a[220:223], v[52:55]
  s_waitcnt vmcnt(9) lgkmcnt(0)
  s_barrier
  v_mfma_f32_16x16x32_bf16 v[72:75], a[232:235], a[224:227], v[72:75]
  ds_read_b128 a[196:199], v234 offset:36864
  s_add_u32 s92, s92, 2048
  s_add_u32 m0, s98, 49152
  s_lshl_b32 s57, s28, 4
  v_mfma_f32_16x16x32_bf16 v[92:95], a[232:235], a[228:231], v[92:95]
  buffer_load_dwordx4 v224, s[40:43], s92 offen offset:0 sc1 lds
  v_mfma_f32_16x16x32_bf16 v[36:39], a[236:239], a[216:219], v[36:39]
  ds_read_b128 a[180:183], v233 offset:36864
  s_add_u32 s56, s56, s57
  v_mfma_f32_16x16x32_bf16 v[56:59], a[236:239], a[220:223], v[56:59]
  v_mfma_f32_16x16x32_bf16 v[76:79], a[236:239], a[224:227], v[76:79]
  ds_read_b128 a[184:187], v233 offset:38912
  v_and_b32 v20, 15, v1
  v_mfma_f32_16x16x32_bf16 v[96:99], a[236:239], a[228:231], v[96:99]
  buffer_load_dwordx4 v225, s[40:43], s92 offen offset:1024 sc1 lds
  v_mfma_f32_16x16x32_bf16 v[40:43], a[240:243], a[216:219], v[40:43]
  ds_read_b128 a[188:191], v233 offset:40960
  v_add_u32 v20, s56, v20
  v_mfma_f32_16x16x32_bf16 v[60:63], a[240:243], a[220:223], v[60:63]
  v_mfma_f32_16x16x32_bf16 v[80:83], a[240:243], a[224:227], v[80:83]
  ds_read_b128 a[192:195], v233 offset:43008
  v_mul_u32_u24 v20, 2560, v20
  v_mfma_f32_16x16x32_bf16 v[100:103], a[240:243], a[228:231], v[100:103]
  buffer_load_dwordx4 v226, s[40:43], s92 offen offset:2048 sc1 lds
  v_mfma_f32_16x16x32_bf16 v[44:47], a[244:247], a[216:219], v[44:47]
  ds_read_b128 a[200:203], v234 offset:38912
  v_lshrrev_b32 v21, 4, v1
  v_mfma_f32_16x16x32_bf16 v[64:67], a[244:247], a[220:223], v[64:67]
  ds_read_b128 a[204:207], v234 offset:40960
  v_mfma_f32_16x16x32_bf16 v[84:87], a[244:247], a[224:227], v[84:87]
  ds_read_b128 a[208:211], v234 offset:43008
  v_lshl_add_u32 v20, v21, 3, v20
  v_mfma_f32_16x16x32_bf16 v[104:107], a[244:247], a[228:231], v[104:107]
  ds_read_b128 a[212:215], v234 offset:45056
  buffer_load_dwordx4 v227, s[40:43], s92 offen offset:3072 sc1 lds
  v_mfma_f32_16x16x32_bf16 v[48:51], a[248:251], a[216:219], v[48:51]
  s_mul_i32 s56, s101, 160
  v_mfma_f32_16x16x32_bf16 v[68:71], a[248:251], a[220:223], v[68:71]
  v_mfma_f32_16x16x32_bf16 v[88:91], a[248:251], a[224:227], v[88:91]
  s_add_u32 m0, s98, 53248
  v_add_u32 v20, s56, v20
  v_mfma_f32_16x16x32_bf16 v[108:111], a[248:251], a[228:231], v[108:111]
  buffer_load_dwordx4 v228, s[40:43], s92 offen offset:0 sc1 lds
  s_waitcnt lgkmcnt(2)
  v_mfma_f32_16x16x32_bf16 v[32:35], a[196:199], a[180:183], v[32:35]
  v_mfma_f32_16x16x32_bf16 v[52:55], a[196:199], a[184:187], v[52:55]
  v_mfma_f32_16x16x32_bf16 v[72:75], a[196:199], a[188:191], v[72:75]
  ds_read_b128 a[232:235], v234 offset:37888
  s_add_u32 m0, s98, 53248
  v_and_b32 v22, 1, v21
  v_mfma_f32_16x16x32_bf16 v[92:95], a[196:199], a[192:195], v[92:95]
  buffer_load_dwordx4 v229, s[40:43], s92 offen offset:1024 sc1 lds
  v_mfma_f32_16x16x32_bf16 v[36:39], a[200:203], a[180:183], v[36:39]
  ds_read_b128 a[216:219], v233 offset:37888
  v_mul_u32_u24 v22, 24, v22
  v_mfma_f32_16x16x32_bf16 v[56:59], a[200:203], a[184:187], v[56:59]
  v_mfma_f32_16x16x32_bf16 v[76:79], a[200:203], a[188:191], v[76:79]
  ds_read_b128 a[220:223], v233 offset:39936
  v_add_u32 v23, v22, v20
  v_mfma_f32_16x16x32_bf16 v[96:99], a[200:203], a[192:195], v[96:99]
  buffer_load_dwordx4 v230, s[40:43], s92 offen offset:2048 sc1 lds
  v_mfma_f32_16x16x32_bf16 v[40:43], a[204:207], a[180:183], v[40:43]
  ds_read_b128 a[224:227], v233 offset:41984
  v_add_u32 v24, v22, v253
  v_mfma_f32_16x16x32_bf16 v[60:63], a[204:207], a[184:187], v[60:63]
  v_mfma_f32_16x16x32_bf16 v[80:83], a[204:207], a[188:191], v[80:83]
  ds_read_b128 a[228:231], v233 offset:44032
  v_lshlrev_b32 v21, 3, v1
  v_mfma_f32_16x16x32_bf16 v[100:103], a[204:207], a[192:195], v[100:103]
  buffer_load_dwordx4 v231, s[40:43], s92 offen offset:3072 sc1 lds
  s_waitcnt lgkmcnt(3)
  v_mfma_f32_16x16x32_bf16 v[44:47], a[208:211], a[180:183], v[44:47]
  ds_read_b128 a[236:239], v234 offset:39936
  v_and_b32 v246, 3, v1
  v_mfma_f32_16x16x32_bf16 v[64:67], a[208:211], a[184:187], v[64:67]
  ds_read_b128 a[240:243], v234 offset:41984
  v_mfma_f32_16x16x32_bf16 v[84:87], a[208:211], a[188:191], v[84:87]
  ds_read_b128 a[244:247], v234 offset:44032
  s_add_u32 m0, s98, 57344
  v_lshlrev_b32 v246, 3, v246
  v_mfma_f32_16x16x32_bf16 v[104:107], a[208:211], a[192:195], v[104:107]
  ds_read_b128 a[248:251], v234 offset:46080
  buffer_load_dwordx4 v232, s[40:43], s92 offen offset:0 sc1 lds
  v_mfma_f32_16x16x32_bf16 v[48:51], a[212:215], a[180:183], v[48:51]
  s_lshr_b32 s54, s2, 1
  v_mfma_f32_16x16x32_bf16 v[68:71], a[212:215], a[184:187], v[68:71]
  v_mfma_f32_16x16x32_bf16 v[88:91], a[212:215], a[188:191], v[88:91]
  s_and_b32 s54, s54, 3
  v_mfma_f32_16x16x32_bf16 v[108:111], a[212:215], a[192:195], v[108:111]
  v_mfma_f32_16x16x32_bf16 v[32:35], a[232:235], a[216:219], v[32:35]
  s_waitcnt lgkmcnt(2)
  v_mfma_f32_16x16x32_bf16 v[52:55], a[232:235], a[220:223], v[52:55]
  s_waitcnt vmcnt(9) lgkmcnt(0)
  s_barrier
  v_mfma_f32_16x16x32_bf16 v[72:75], a[232:235], a[224:227], v[72:75]
  ds_read_b128 a[196:199], v236 offset:0
  s_add_u32 s92, s92, 2048
  s_add_u32 m0, s98, 86016
  s_and_b32 s55, s2, 0xfffffff9
  v_mfma_f32_16x16x32_bf16 v[92:95], a[232:235], a[228:231], v[92:95]
  buffer_load_dwordx4 v224, s[40:43], s92 offen offset:0 sc1 lds
  v_mfma_f32_16x16x32_bf16 v[36:39], a[236:239], a[216:219], v[36:39]
  ds_read_b128 a[180:183], v235 offset:0
  s_lshl_b32 s95, s54, 3
  v_mfma_f32_16x16x32_bf16 v[56:59], a[236:239], a[220:223], v[56:59]
  v_mfma_f32_16x16x32_bf16 v[76:79], a[236:239], a[224:227], v[76:79]
  ds_read_b128 a[184:187], v235 offset:2048
  s_add_u32 s95, s95, s99
  v_mfma_f32_16x16x32_bf16 v[96:99], a[236:239], a[228:231], v[96:99]
  buffer_load_dwordx4 v225, s[40:43], s92 offen offset:1024 sc1 lds
  v_mfma_f32_16x16x32_bf16 v[40:43], a[240:243], a[216:219], v[40:43]
  ds_read_b128 a[188:191], v235 offset:4096
  s_mul_i32 s59, s2, 12
  v_mfma_f32_16x16x32_bf16 v[60:63], a[240:243], a[220:223], v[60:63]
  v_mfma_f32_16x16x32_bf16 v[80:83], a[240:243], a[224:227], v[80:83]
  ds_read_b128 a[192:195], v235 offset:6144
  s_add_u32 s59, s59, s28
  v_mfma_f32_16x16x32_bf16 v[100:103], a[240:243], a[228:231], v[100:103]
  buffer_load_dwordx4 v226, s[40:43], s92 offen offset:2048 sc1 lds
  v_mfma_f32_16x16x32_bf16 v[44:47], a[244:247], a[216:219], v[44:47]
  ds_read_b128 a[200:203], v236 offset:2048
  s_mul_i32 s59, s59, 2560
  v_mfma_f32_16x16x32_bf16 v[64:67], a[244:247], a[220:223], v[64:67]
  ds_read_b128 a[204:207], v236 offset:4096
  v_mfma_f32_16x16x32_bf16 v[84:87], a[244:247], a[224:227], v[84:87]
  ds_read_b128 a[208:211], v236 offset:6144
  s_add_u32 s59, s59, 74448896
  v_mfma_f32_16x16x32_bf16 v[104:107], a[244:247], a[228:231], v[104:107]
  ds_read_b128 a[212:215], v236 offset:8192
  buffer_load_dwordx4 v227, s[40:43], s92 offen offset:3072 sc1 lds
  v_mfma_f32_16x16x32_bf16 v[48:51], a[248:251], a[216:219], v[48:51]
  s_add_u32 s56, s54, 1
  v_mfma_f32_16x16x32_bf16 v[68:71], a[248:251], a[220:223], v[68:71]
  v_mfma_f32_16x16x32_bf16 v[88:91], a[248:251], a[224:227], v[88:91]
  s_add_u32 m0, s98, 90112
  s_and_b32 s56, s56, 3
  v_mfma_f32_16x16x32_bf16 v[108:111], a[248:251], a[228:231], v[108:111]
  buffer_load_dwordx4 v228, s[40:43], s92 offen offset:0 sc1 lds
  s_waitcnt lgkmcnt(2)
  v_mfma_f32_16x16x32_bf16 v[32:35], a[196:199], a[180:183], v[32:35]
  v_mfma_f32_16x16x32_bf16 v[52:55], a[196:199], a[184:187], v[52:55]
  v_mfma_f32_16x16x32_bf16 v[72:75], a[196:199], a[188:191], v[72:75]
  ds_read_b128 a[232:235], v236 offset:1024
  s_add_u32 m0, s98, 90112
  s_lshl_b32 s56, s56, 1
  v_mfma_f32_16x16x32_bf16 v[92:95], a[196:199], a[192:195], v[92:95]
  buffer_load_dwordx4 v229, s[40:43], s92 offen offset:1024 sc1 lds
  v_mfma_f32_16x16x32_bf16 v[36:39], a[200:203], a[180:183], v[36:39]
  ds_read_b128 a[216:219], v235 offset:1024
  s_add_u32 s56, s56, s55
  v_mfma_f32_16x16x32_bf16 v[56:59], a[200:203], a[184:187], v[56:59]
  v_mfma_f32_16x16x32_bf16 v[76:79], a[200:203], a[188:191], v[76:79]
  ds_read_b128 a[220:223], v235 offset:3072
  s_mul_i32 s56, s56, 12
  v_mfma_f32_16x16x32_bf16 v[96:99], a[200:203], a[192:195], v[96:99]
  buffer_load_dwordx4 v230, s[40:43], s92 offen offset:2048 sc1 lds
  v_mfma_f32_16x16x32_bf16 v[40:43], a[204:207], a[180:183], v[40:43]
  ds_read_b128 a[224:227], v235 offset:5120
  s_add_u32 s56, s56, s28
  v_mfma_f32_16x16x32_bf16 v[60:63], a[204:207], a[184:187], v[60:63]
  v_mfma_f32_16x16x32_bf16 v[80:83], a[204:207], a[188:191], v[80:83]
  ds_read_b128 a[228:231], v235 offset:7168
  s_mul_i32 s56, s56, 2560
  v_mfma_f32_16x16x32_bf16 v[100:103], a[204:207], a[192:195], v[100:103]
  buffer_load_dwordx4 v231, s[40:43], s92 offen offset:3072 sc1 lds
  s_waitcnt lgkmcnt(3)
  v_mfma_f32_16x16x32_bf16 v[44:47], a[208:211], a[180:183], v[44:47]
  ds_read_b128 a[236:239], v236 offset:3072
  s_add_u32 s48, s56, 74448896
  v_mfma_f32_16x16x32_bf16 v[64:67], a[208:211], a[184:187], v[64:67]
  ds_read_b128 a[240:243], v236 offset:5120
  v_mfma_f32_16x16x32_bf16 v[84:87], a[208:211], a[188:191], v[84:87]
  ds_read_b128 a[244:247], v236 offset:7168
  s_add_u32 m0, s98, 94208
  s_add_u32 s56, s54, 2
  v_mfma_f32_16x16x32_bf16 v[104:107], a[208:211], a[192:195], v[104:107]
  ds_read_b128 a[248:251], v236 offset:9216
  buffer_load_dwordx4 v232, s[40:43], s92 offen offset:0 sc1 lds
  v_mfma_f32_16x16x32_bf16 v[48:51], a[212:215], a[180:183], v[48:51]
  s_and_b32 s56, s56, 3
  v_mfma_f32_16x16x32_bf16 v[68:71], a[212:215], a[184:187], v[68:71]
  v_mfma_f32_16x16x32_bf16 v[88:91], a[212:215], a[188:191], v[88:91]
  s_lshl_b32 s56, s56, 1
  v_mfma_f32_16x16x32_bf16 v[108:111], a[212:215], a[192:195], v[108:111]
  v_mfma_f32_16x16x32_bf16 v[32:35], a[232:235], a[216:219], v[32:35]
  s_waitcnt lgkmcnt(2)
  v_mfma_f32_16x16x32_bf16 v[52:55], a[232:235], a[220:223], v[52:55]
  s_waitcnt vmcnt(9) lgkmcnt(0)
  s_barrier
  v_mfma_f32_16x16x32_bf16 v[72:75], a[232:235], a[224:227], v[72:75]
  ds_read_b128 a[196:199], v234 offset:0
  s_add_u32 s92, s92, 2048
  s_add_u32 m0, s98, 122880
  s_add_u32 s56, s56, s55
  v_mfma_f32_16x16x32_bf16 v[92:95], a[232:235], a[228:231], v[92:95]
  buffer_load_dwordx4 v224, s[40:43], s92 offen offset:0 sc1 lds
  v_mfma_f32_16x16x32_bf16 v[36:39], a[236:239], a[216:219], v[36:39]
  ds_read_b128 a[180:183], v233 offset:0
  s_mul_i32 s56, s56, 12
  v_mfma_f32_16x16x32_bf16 v[56:59], a[236:239], a[220:223], v[56:59]
  v_mfma_f32_16x16x32_bf16 v[76:79], a[236:239], a[224:227], v[76:79]
  ds_read_b128 a[184:187], v233 offset:2048
  s_add_u32 s56, s56, s28
  v_mfma_f32_16x16x32_bf16 v[96:99], a[236:239], a[228:231], v[96:99]
  buffer_load_dwordx4 v225, s[40:43], s92 offen offset:1024 sc1 lds
  v_mfma_f32_16x16x32_bf16 v[40:43], a[240:243], a[216:219], v[40:43]
  ds_read_b128 a[188:191], v233 offset:4096
  s_mul_i32 s56, s56, 2560
  v_mfma_f32_16x16x32_bf16 v[60:63], a[240:243], a[220:223], v[60:63]
  v_mfma_f32_16x16x32_bf16 v[80:83], a[240:243], a[224:227], v[80:83]
  ds_read_b128 a[192:195], v233 offset:6144
  s_add_u32 s49, s56, 74459136
  v_mfma_f32_16x16x32_bf16 v[100:103], a[240:243], a[228:231], v[100:103]
  buffer_load_dwordx4 v226, s[40:43], s92 offen offset:2048 sc1 lds
  v_mfma_f32_16x16x32_bf16 v[44:47], a[244:247], a[216:219], v[44:47]
  ds_read_b128 a[200:203], v234 offset:2048
  s_add_u32 s56, s54, 3
  v_mfma_f32_16x16x32_bf16 v[64:67], a[244:247], a[220:223], v[64:67]
  ds_read_b128 a[204:207], v234 offset:4096
  v_mfma_f32_16x16x32_bf16 v[84:87], a[244:247], a[224:227], v[84:87]
  ds_read_b128 a[208:211], v234 offset:6144
  s_and_b32 s56, s56, 3
  v_mfma_f32_16x16x32_bf16 v[104:107], a[244:247], a[228:231], v[104:107]
  ds_read_b128 a[212:215], v234 offset:8192
  buffer_load_dwordx4 v227, s[40:43], s92 offen offset:3072 sc1 lds
  v_mfma_f32_16x16x32_bf16 v[48:51], a[248:251], a[216:219], v[48:51]
  s_lshl_b32 s56, s56, 1
  v_mfma_f32_16x16x32_bf16 v[68:71], a[248:251], a[220:223], v[68:71]
  v_mfma_f32_16x16x32_bf16 v[88:91], a[248:251], a[224:227], v[88:91]
  s_add_u32 m0, s98, 126976
  s_add_u32 s56, s56, s55
  v_mfma_f32_16x16x32_bf16 v[108:111], a[248:251], a[228:231], v[108:111]
  buffer_load_dwordx4 v228, s[40:43], s92 offen offset:0 sc1 lds
  s_waitcnt lgkmcnt(2)
  v_mfma_f32_16x16x32_bf16 v[32:35], a[196:199], a[180:183], v[32:35]
  v_mfma_f32_16x16x32_bf16 v[52:55], a[196:199], a[184:187], v[52:55]
  v_mfma_f32_16x16x32_bf16 v[72:75], a[196:199], a[188:191], v[72:75]
  ds_read_b128 a[232:235], v234 offset:1024
  s_add_u32 m0, s98, 126976
  s_mul_i32 s56, s56, 12
  v_mfma_f32_16x16x32_bf16 v[92:95], a[196:199], a[192:195], v[92:95]
  buffer_load_dwordx4 v229, s[40:43], s92 offen offset:1024 sc1 lds
  v_mfma_f32_16x16x32_bf16 v[36:39], a[200:203], a[180:183], v[36:39]
  ds_read_b128 a[216:219], v233 offset:1024
  v_mfma_f32_16x16x32_bf16 v[56:59], a[200:203], a[184:187], v[56:59]
  v_mfma_f32_16x16x32_bf16 v[76:79], a[200:203], a[188:191], v[76:79]
  ds_read_b128 a[220:223], v233 offset:3072
  s_add_u32 s56, s56, s28
  v_mfma_f32_16x16x32_bf16 v[96:99], a[200:203], a[192:195], v[96:99]
  buffer_load_dwordx4 v230, s[40:43], s92 offen offset:2048 sc1 lds
  v_mfma_f32_16x16x32_bf16 v[40:43], a[204:207], a[180:183], v[40:43]
  ds_read_b128 a[224:227], v233 offset:5120
  v_mfma_f32_16x16x32_bf16 v[60:63], a[204:207], a[184:187], v[60:63]
  v_mfma_f32_16x16x32_bf16 v[80:83], a[204:207], a[188:191], v[80:83]
  ds_read_b128 a[228:231], v233 offset:7168
  v_mfma_f32_16x16x32_bf16 v[100:103], a[204:207], a[192:195], v[100:103]
  buffer_load_dwordx4 v231, s[40:43], s92 offen offset:3072 sc1 lds
  s_mul_i32 s56, s56, 2560
  s_waitcnt lgkmcnt(3)
  v_mfma_f32_16x16x32_bf16 v[44:47], a[208:211], a[180:183], v[44:47]
  ds_read_b128 a[236:239], v234 offset:3072
  v_mfma_f32_16x16x32_bf16 v[64:67], a[208:211], a[184:187], v[64:67]
  ds_read_b128 a[240:243], v234 offset:5120
  v_mfma_f32_16x16x32_bf16 v[84:87], a[208:211], a[188:191], v[84:87]
  ds_read_b128 a[244:247], v234 offset:7168
  s_add_u32 m0, s98, 131072
  v_mfma_f32_16x16x32_bf16 v[104:107], a[208:211], a[192:195], v[104:107]
  ds_read_b128 a[248:251], v234 offset:9216
  buffer_load_dwordx4 v232, s[40:43], s92 offen offset:0 sc1 lds
  s_add_u32 s50, s56, 74469376
  v_mfma_f32_16x16x32_bf16 v[48:51], a[212:215], a[180:183], v[48:51]
  v_mfma_f32_16x16x32_bf16 v[68:71], a[212:215], a[184:187], v[68:71]
  v_mfma_f32_16x16x32_bf16 v[88:91], a[212:215], a[188:191], v[88:91]
  v_mfma_f32_16x16x32_bf16 v[108:111], a[212:215], a[192:195], v[108:111]
  v_mfma_f32_16x16x32_bf16 v[32:35], a[232:235], a[216:219], v[32:35]
  s_waitcnt lgkmcnt(3)
  v_mfma_f32_16x16x32_bf16 v[52:55], a[232:235], a[220:223], v[52:55]
  s_waitcnt vmcnt(9) lgkmcnt(0)
  s_barrier
  v_mfma_f32_16x16x32_bf16 v[72:75], a[232:235], a[224:227], v[72:75]
  ds_read_b128 a[196:199], v234 offset:36864
  s_add_u32 s92, s92, 2048
  s_add_u32 m0, s98, 49152
  v_mfma_f32_16x16x32_bf16 v[92:95], a[232:235], a[228:231], v[92:95]
  buffer_load_dwordx4 v224, s[40:43], s92 offen offset:0 sc1 lds
  v_mfma_f32_16x16x32_bf16 v[36:39], a[236:239], a[216:219], v[36:39]
  ds_read_b128 a[180:183], v233 offset:36864
  v_mfma_f32_16x16x32_bf16 v[56:59], a[236:239], a[220:223], v[56:59]
  v_mfma_f32_16x16x32_bf16 v[76:79], a[236:239], a[224:227], v[76:79]
  ds_read_b128 a[184:187], v233 offset:38912
  v_mfma_f32_16x16x32_bf16 v[96:99], a[236:239], a[228:231], v[96:99]
  buffer_load_dwordx4 v225, s[40:43], s92 offen offset:1024 sc1 lds
  v_mfma_f32_16x16x32_bf16 v[40:43], a[240:243], a[216:219], v[40:43]
  ds_read_b128 a[188:191], v233 offset:40960
  v_mfma_f32_16x16x32_bf16 v[60:63], a[240:243], a[220:223], v[60:63]
  v_mfma_f32_16x16x32_bf16 v[80:83], a[240:243], a[224:227], v[80:83]
  ds_read_b128 a[192:195], v233 offset:43008
  v_mfma_f32_16x16x32_bf16 v[100:103], a[240:243], a[228:231], v[100:103]
  buffer_load_dwordx4 v226, s[40:43], s92 offen offset:2048 sc1 lds
  v_mfma_f32_16x16x32_bf16 v[44:47], a[244:247], a[216:219], v[44:47]
  ds_read_b128 a[200:203], v234 offset:38912
  v_mfma_f32_16x16x32_bf16 v[64:67], a[244:247], a[220:223], v[64:67]
  ds_read_b128 a[204:207], v234 offset:40960
  v_mfma_f32_16x16x32_bf16 v[84:87], a[244:247], a[224:227], v[84:87]
  ds_read_b128 a[208:211], v234 offset:43008
  v_mfma_f32_16x16x32_bf16 v[104:107], a[244:247], a[228:231], v[104:107]
  ds_read_b128 a[212:215], v234 offset:45056
  buffer_load_dwordx4 v227, s[40:43], s92 offen offset:3072 sc1 lds
  v_mfma_f32_16x16x32_bf16 v[48:51], a[248:251], a[216:219], v[48:51]
  v_mfma_f32_16x16x32_bf16 v[68:71], a[248:251], a[220:223], v[68:71]
  v_mfma_f32_16x16x32_bf16 v[88:91], a[248:251], a[224:227], v[88:91]
  s_add_u32 m0, s98, 53248
  v_mfma_f32_16x16x32_bf16 v[108:111], a[248:251], a[228:231], v[108:111]
  buffer_load_dwordx4 v228, s[40:43], s92 offen offset:0 sc1 lds
  s_waitcnt lgkmcnt(3)
  v_mfma_f32_16x16x32_bf16 v[32:35], a[196:199], a[180:183], v[32:35]
  v_mfma_f32_16x16x32_bf16 v[52:55], a[196:199], a[184:187], v[52:55]
  v_mfma_f32_16x16x32_bf16 v[72:75], a[196:199], a[188:191], v[72:75]
  ds_read_b128 a[232:235], v234 offset:37888
  s_add_u32 m0, s98, 53248
  v_mfma_f32_16x16x32_bf16 v[92:95], a[196:199], a[192:195], v[92:95]
  buffer_load_dwordx4 v229, s[40:43], s92 offen offset:1024 sc1 lds
  v_mfma_f32_16x16x32_bf16 v[36:39], a[200:203], a[180:183], v[36:39]
  ds_read_b128 a[216:219], v233 offset:37888
  v_mfma_f32_16x16x32_bf16 v[56:59], a[200:203], a[184:187], v[56:59]
  v_mfma_f32_16x16x32_bf16 v[76:79], a[200:203], a[188:191], v[76:79]
  ds_read_b128 a[220:223], v233 offset:39936
  v_mfma_f32_16x16x32_bf16 v[96:99], a[200:203], a[192:195], v[96:99]
  buffer_load_dwordx4 v230, s[40:43], s92 offen offset:2048 sc1 lds
  s_waitcnt lgkmcnt(3)
  v_mfma_f32_16x16x32_bf16 v[40:43], a[204:207], a[180:183], v[40:43]
  ds_read_b128 a[224:227], v233 offset:41984
  v_mfma_f32_16x16x32_bf16 v[60:63], a[204:207], a[184:187], v[60:63]
  v_mfma_f32_16x16x32_bf16 v[80:83], a[204:207], a[188:191], v[80:83]
  ds_read_b128 a[228:231], v233 offset:44032
  v_mfma_f32_16x16x32_bf16 v[100:103], a[204:207], a[192:195], v[100:103]
  buffer_load_dwordx4 v231, s[40:43], s92 offen offset:3072 sc1 lds
  v_mfma_f32_16x16x32_bf16 v[44:47], a[208:211], a[180:183], v[44:47]
  ds_read_b128 a[236:239], v234 offset:39936
  v_mfma_f32_16x16x32_bf16 v[64:67], a[208:211], a[184:187], v[64:67]
  ds_read_b128 a[240:243], v234 offset:41984
  v_mfma_f32_16x16x32_bf16 v[84:87], a[208:211], a[188:191], v[84:87]
  ds_read_b128 a[244:247], v234 offset:44032
  s_add_u32 m0, s98, 57344
  v_mfma_f32_16x16x32_bf16 v[104:107], a[208:211], a[192:195], v[104:107]
  ds_read_b128 a[248:251], v234 offset:46080
  buffer_load_dwordx4 v232, s[40:43], s92 offen offset:0 sc1 lds
  v_mfma_f32_16x16x32_bf16 v[48:51], a[212:215], a[180:183], v[48:51]
  v_mfma_f32_16x16x32_bf16 v[68:71], a[212:215], a[184:187], v[68:71]
  v_mfma_f32_16x16x32_bf16 v[88:91], a[212:215], a[188:191], v[88:91]
  v_mfma_f32_16x16x32_bf16 v[108:111], a[212:215], a[192:195], v[108:111]
  s_waitcnt lgkmcnt(4)
  v_mfma_f32_16x16x32_bf16 v[32:35], a[232:235], a[216:219], v[32:35]
  v_mfma_f32_16x16x32_bf16 v[52:55], a[232:235], a[220:223], v[52:55]
  s_waitcnt vmcnt(9) lgkmcnt(0)
  s_barrier
  v_mfma_f32_16x16x32_bf16 v[72:75], a[232:235], a[224:227], v[72:75]
  ds_read_b128 a[196:199], v236 offset:0
  s_add_u32 s92, s92, 2048
  s_add_u32 m0, s98, 86016
  v_mfma_f32_16x16x32_bf16 v[92:95], a[232:235], a[228:231], v[92:95]
  buffer_load_dwordx4 v224, s[40:43], s92 offen offset:0 sc1 lds
  v_mfma_f32_16x16x32_bf16 v[36:39], a[236:239], a[216:219], v[36:39]
  ds_read_b128 a[180:183], v235 offset:0
  v_mfma_f32_16x16x32_bf16 v[56:59], a[236:239], a[220:223], v[56:59]
  v_mfma_f32_16x16x32_bf16 v[76:79], a[236:239], a[224:227], v[76:79]
  ds_read_b128 a[184:187], v235 offset:2048
  v_mfma_f32_16x16x32_bf16 v[96:99], a[236:239], a[228:231], v[96:99]
  buffer_load_dwordx4 v225, s[40:43], s92 offen offset:1024 sc1 lds
  v_mfma_f32_16x16x32_bf16 v[40:43], a[240:243], a[216:219], v[40:43]
  ds_read_b128 a[188:191], v235 offset:4096
  v_mfma_f32_16x16x32_bf16 v[60:63], a[240:243], a[220:223], v[60:63]
  v_mfma_f32_16x16x32_bf16 v[80:83], a[240:243], a[224:227], v[80:83]
  ds_read_b128 a[192:195], v235 offset:6144
  v_mfma_f32_16x16x32_bf16 v[100:103], a[240:243], a[228:231], v[100:103]
  buffer_load_dwordx4 v226, s[40:43], s92 offen offset:2048 sc1 lds
  v_mfma_f32_16x16x32_bf16 v[44:47], a[244:247], a[216:219], v[44:47]
  ds_read_b128 a[200:203], v236 offset:2048
  v_mfma_f32_16x16x32_bf16 v[64:67], a[244:247], a[220:223], v[64:67]
  ds_read_b128 a[204:207], v236 offset:4096
  v_mfma_f32_16x16x32_bf16 v[84:87], a[244:247], a[224:227], v[84:87]
  ds_read_b128 a[208:211], v236 offset:6144
  v_mfma_f32_16x16x32_bf16 v[104:107], a[244:247], a[228:231], v[104:107]
  ds_read_b128 a[212:215], v236 offset:8192
  buffer_load_dwordx4 v227, s[40:43], s92 offen offset:3072 sc1 lds
  v_mfma_f32_16x16x32_bf16 v[48:51], a[248:251], a[216:219], v[48:51]
  v_mfma_f32_16x16x32_bf16 v[68:71], a[248:251], a[220:223], v[68:71]
  v_mfma_f32_16x16x32_bf16 v[88:91], a[248:251], a[224:227], v[88:91]
  s_add_u32 m0, s98, 90112
  v_mfma_f32_16x16x32_bf16 v[108:111], a[248:251], a[228:231], v[108:111]
  buffer_load_dwordx4 v228, s[40:43], s92 offen offset:0 sc1 lds
  s_waitcnt lgkmcnt(3)
  v_mfma_f32_16x16x32_bf16 v[32:35], a[196:199], a[180:183], v[32:35]
  v_mfma_f32_16x16x32_bf16 v[52:55], a[196:199], a[184:187], v[52:55]
  v_mfma_f32_16x16x32_bf16 v[72:75], a[196:199], a[188:191], v[72:75]
  ds_read_b128 a[232:235], v236 offset:1024
  s_add_u32 m0, s98, 90112
  v_mfma_f32_16x16x32_bf16 v[92:95], a[196:199], a[192:195], v[92:95]
  buffer_load_dwordx4 v229, s[40:43], s92 offen offset:1024 sc1 lds
  v_mfma_f32_16x16x32_bf16 v[36:39], a[200:203], a[180:183], v[36:39]
  ds_read_b128 a[216:219], v235 offset:1024
  v_mfma_f32_16x16x32_bf16 v[56:59], a[200:203], a[184:187], v[56:59]
  v_mfma_f32_16x16x32_bf16 v[76:79], a[200:203], a[188:191], v[76:79]
  ds_read_b128 a[220:223], v235 offset:3072
  v_mfma_f32_16x16x32_bf16 v[96:99], a[200:203], a[192:195], v[96:99]
  buffer_load_dwordx4 v230, s[40:43], s92 offen offset:2048 sc1 lds
  s_waitcnt lgkmcnt(3)
  v_mfma_f32_16x16x32_bf16 v[40:43], a[204:207], a[180:183], v[40:43]
  ds_read_b128 a[224:227], v235 offset:5120
  v_mfma_f32_16x16x32_bf16 v[60:63], a[204:207], a[184:187], v[60:63]
  v_mfma_f32_16x16x32_bf16 v[80:83], a[204:207], a[188:191], v[80:83]
  ds_read_b128 a[228:231], v235 offset:7168
  v_mfma_f32_16x16x32_bf16 v[100:103], a[204:207], a[192:195], v[100:103]
  buffer_load_dwordx4 v231, s[40:43], s92 offen offset:3072 sc1 lds
  v_mfma_f32_16x16x32_bf16 v[44:47], a[208:211], a[180:183], v[44:47]
  ds_read_b128 a[236:239], v236 offset:3072
  v_mfma_f32_16x16x32_bf16 v[64:67], a[208:211], a[184:187], v[64:67]
  ds_read_b128 a[240:243], v236 offset:5120
  v_mfma_f32_16x16x32_bf16 v[84:87], a[208:211], a[188:191], v[84:87]
  ds_read_b128 a[244:247], v236 offset:7168
  s_add_u32 m0, s98, 94208
  v_mfma_f32_16x16x32_bf16 v[104:107], a[208:211], a[192:195], v[104:107]
  ds_read_b128 a[248:251], v236 offset:9216
  buffer_load_dwordx4 v232, s[40:43], s92 offen offset:0 sc1 lds
  v_mfma_f32_16x16x32_bf16 v[48:51], a[212:215], a[180:183], v[48:51]
  v_mfma_f32_16x16x32_bf16 v[68:71], a[212:215], a[184:187], v[68:71]
  v_mfma_f32_16x16x32_bf16 v[88:91], a[212:215], a[188:191], v[88:91]
  v_mfma_f32_16x16x32_bf16 v[108:111], a[212:215], a[192:195], v[108:111]
  s_waitcnt lgkmcnt(4)
  v_mfma_f32_16x16x32_bf16 v[32:35], a[232:235], a[216:219], v[32:35]
  v_mfma_f32_16x16x32_bf16 v[52:55], a[232:235], a[220:223], v[52:55]
  s_waitcnt vmcnt(9) lgkmcnt(0)
  s_barrier
  v_mfma_f32_16x16x32_bf16 v[72:75], a[232:235], a[224:227], v[72:75]
  ds_read_b128 a[196:199], v234 offset:0
  s_add_u32 s92, s92, 2048
  s_add_u32 m0, s98, 122880
  v_mfma_f32_16x16x32_bf16 v[92:95], a[232:235], a[228:231], v[92:95]
  buffer_load_dwordx4 v224, s[40:43], s92 offen offset:0 sc1 lds
  v_mfma_f32_16x16x32_bf16 v[36:39], a[236:239], a[216:219], v[36:39]
  ds_read_b128 a[180:183], v233 offset:0
  v_mfma_f32_16x16x32_bf16 v[56:59], a[236:239], a[220:223], v[56:59]
  v_mfma_f32_16x16x32_bf16 v[76:79], a[236:239], a[224:227], v[76:79]
  ds_read_b128 a[184:187], v233 offset:2048
  v_mfma_f32_16x16x32_bf16 v[96:99], a[236:239], a[228:231], v[96:99]
  buffer_load_dwordx4 v225, s[40:43], s92 offen offset:1024 sc1 lds
  v_mfma_f32_16x16x32_bf16 v[40:43], a[240:243], a[216:219], v[40:43]
  ds_read_b128 a[188:191], v233 offset:4096
  v_mfma_f32_16x16x32_bf16 v[60:63], a[240:243], a[220:223], v[60:63]
  v_mfma_f32_16x16x32_bf16 v[80:83], a[240:243], a[224:227], v[80:83]
  ds_read_b128 a[192:195], v233 offset:6144
  v_mfma_f32_16x16x32_bf16 v[100:103], a[240:243], a[228:231], v[100:103]
  buffer_load_dwordx4 v226, s[40:43], s92 offen offset:2048 sc1 lds
  v_mfma_f32_16x16x32_bf16 v[44:47], a[244:247], a[216:219], v[44:47]
  ds_read_b128 a[200:203], v234 offset:2048
  v_mfma_f32_16x16x32_bf16 v[64:67], a[244:247], a[220:223], v[64:67]
  ds_read_b128 a[204:207], v234 offset:4096
  v_mfma_f32_16x16x32_bf16 v[84:87], a[244:247], a[224:227], v[84:87]
  ds_read_b128 a[208:211], v234 offset:6144
  v_mfma_f32_16x16x32_bf16 v[104:107], a[244:247], a[228:231], v[104:107]
  ds_read_b128 a[212:215], v234 offset:8192
  buffer_load_dwordx4 v227, s[40:43], s92 offen offset:3072 sc1 lds
  v_mfma_f32_16x16x32_bf16 v[48:51], a[248:251], a[216:219], v[48:51]
  v_mfma_f32_16x16x32_bf16 v[68:71], a[248:251], a[220:223], v[68:71]
  v_mfma_f32_16x16x32_bf16 v[88:91], a[248:251], a[224:227], v[88:91]
  s_add_u32 m0, s98, 126976
  v_mfma_f32_16x16x32_bf16 v[108:111], a[248:251], a[228:231], v[108:111]
  buffer_load_dwordx4 v228, s[40:43], s92 offen offset:0 sc1 lds
  s_waitcnt lgkmcnt(3)
  v_mfma_f32_16x16x32_bf16 v[32:35], a[196:199], a[180:183], v[32:35]
  v_mfma_f32_16x16x32_bf16 v[52:55], a[196:199], a[184:187], v[52:55]
  v_mfma_f32_16x16x32_bf16 v[72:75], a[196:199], a[188:191], v[72:75]
  ds_read_b128 a[232:235], v234 offset:1024
  s_add_u32 m0, s98, 126976
  v_mfma_f32_16x16x32_bf16 v[92:95], a[196:199], a[192:195], v[92:95]
  buffer_load_dwordx4 v229, s[40:43], s92 offen offset:1024 sc1 lds
  v_mfma_f32_16x16x32_bf16 v[36:39], a[200:203], a[180:183], v[36:39]
  ds_read_b128 a[216:219], v233 offset:1024
  v_mfma_f32_16x16x32_bf16 v[56:59], a[200:203], a[184:187], v[56:59]
  v_mfma_f32_16x16x32_bf16 v[76:79], a[200:203], a[188:191], v[76:79]
  ds_read_b128 a[220:223], v233 offset:3072
  v_mfma_f32_16x16x32_bf16 v[96:99], a[200:203], a[192:195], v[96:99]
  buffer_load_dwordx4 v230, s[40:43], s92 offen offset:2048 sc1 lds
  s_waitcnt lgkmcnt(3)
  v_mfma_f32_16x16x32_bf16 v[40:43], a[204:207], a[180:183], v[40:43]
  ds_read_b128 a[224:227], v233 offset:5120
  v_mfma_f32_16x16x32_bf16 v[60:63], a[204:207], a[184:187], v[60:63]
  v_mfma_f32_16x16x32_bf16 v[80:83], a[204:207], a[188:191], v[80:83]
  ds_read_b128 a[228:231], v233 offset:7168
  v_mfma_f32_16x16x32_bf16 v[100:103], a[204:207], a[192:195], v[100:103]
  buffer_load_dwordx4 v231, s[40:43], s92 offen offset:3072 sc1 lds
  v_mfma_f32_16x16x32_bf16 v[44:47], a[208:211], a[180:183], v[44:47]
  ds_read_b128 a[236:239], v234 offset:3072
  v_mfma_f32_16x16x32_bf16 v[64:67], a[208:211], a[184:187], v[64:67]
  ds_read_b128 a[240:243], v234 offset:5120
  v_mfma_f32_16x16x32_bf16 v[84:87], a[208:211], a[188:191], v[84:87]
  ds_read_b128 a[244:247], v234 offset:7168
  s_add_u32 m0, s98, 131072
  v_mfma_f32_16x16x32_bf16 v[104:107], a[208:211], a[192:195], v[104:107]
  ds_read_b128 a[248:251], v234 offset:9216
  buffer_load_dwordx4 v232, s[40:43], s92 offen offset:0 sc1 lds
  v_mfma_f32_16x16x32_bf16 v[48:51], a[212:215], a[180:183], v[48:51]
  v_mfma_f32_16x16x32_bf16 v[68:71], a[212:215], a[184:187], v[68:71]
  v_mfma_f32_16x16x32_bf16 v[88:91], a[212:215], a[188:191], v[88:91]
  v_mfma_f32_16x16x32_bf16 v[108:111], a[212:215], a[192:195], v[108:111]
  s_waitcnt lgkmcnt(4)
  v_mfma_f32_16x16x32_bf16 v[32:35], a[232:235], a[216:219], v[32:35]
  v_mfma_f32_16x16x32_bf16 v[52:55], a[232:235], a[220:223], v[52:55]
  s_waitcnt vmcnt(9) lgkmcnt(0)
  s_barrier
  v_mfma_f32_16x16x32_bf16 v[72:75], a[232:235], a[224:227], v[72:75]
  ds_read_b128 a[196:199], v234 offset:36864
  s_add_u32 s92, s92, 2048
  s_add_u32 m0, s98, 49152
  v_mfma_f32_16x16x32_bf16 v[92:95], a[232:235], a[228:231], v[92:95]
  buffer_load_dwordx4 v224, s[40:43], s92 offen offset:0 sc1 lds
  v_mfma_f32_16x16x32_bf16 v[36:39], a[236:239], a[216:219], v[36:39]
  ds_read_b128 a[180:183], v233 offset:36864
  v_mfma_f32_16x16x32_bf16 v[56:59], a[236:239], a[220:223], v[56:59]
  v_mfma_f32_16x16x32_bf16 v[76:79], a[236:239], a[224:227], v[76:79]
  ds_read_b128 a[184:187], v233 offset:38912
  v_mfma_f32_16x16x32_bf16 v[96:99], a[236:239], a[228:231], v[96:99]
  buffer_load_dwordx4 v225, s[40:43], s92 offen offset:1024 sc1 lds
  v_mfma_f32_16x16x32_bf16 v[40:43], a[240:243], a[216:219], v[40:43]
  ds_read_b128 a[188:191], v233 offset:40960
  v_mfma_f32_16x16x32_bf16 v[60:63], a[240:243], a[220:223], v[60:63]
  v_mfma_f32_16x16x32_bf16 v[80:83], a[240:243], a[224:227], v[80:83]
  ds_read_b128 a[192:195], v233 offset:43008
  v_mfma_f32_16x16x32_bf16 v[100:103], a[240:243], a[228:231], v[100:103]
  buffer_load_dwordx4 v226, s[40:43], s92 offen offset:2048 sc1 lds
  v_mfma_f32_16x16x32_bf16 v[44:47], a[244:247], a[216:219], v[44:47]
  ds_read_b128 a[200:203], v234 offset:38912
  v_mfma_f32_16x16x32_bf16 v[64:67], a[244:247], a[220:223], v[64:67]
  ds_read_b128 a[204:207], v234 offset:40960
  v_mfma_f32_16x16x32_bf16 v[84:87], a[244:247], a[224:227], v[84:87]
  ds_read_b128 a[208:211], v234 offset:43008
  v_mfma_f32_16x16x32_bf16 v[104:107], a[244:247], a[228:231], v[104:107]
  ds_read_b128 a[212:215], v234 offset:45056
  buffer_load_dwordx4 v227, s[40:43], s92 offen offset:3072 sc1 lds
  v_mfma_f32_16x16x32_bf16 v[48:51], a[248:251], a[216:219], v[48:51]
  v_mfma_f32_16x16x32_bf16 v[68:71], a[248:251], a[220:223], v[68:71]
  v_mfma_f32_16x16x32_bf16 v[88:91], a[248:251], a[224:227], v[88:91]
  s_add_u32 m0, s98, 53248
  v_mfma_f32_16x16x32_bf16 v[108:111], a[248:251], a[228:231], v[108:111]
  buffer_load_dwordx4 v228, s[40:43], s92 offen offset:0 sc1 lds
  s_waitcnt lgkmcnt(3)
  v_mfma_f32_16x16x32_bf16 v[32:35], a[196:199], a[180:183], v[32:35]
  v_mfma_f32_16x16x32_bf16 v[52:55], a[196:199], a[184:187], v[52:55]
  v_mfma_f32_16x16x32_bf16 v[72:75], a[196:199], a[188:191], v[72:75]
  ds_read_b128 a[232:235], v234 offset:37888
  s_add_u32 m0, s98, 53248
  v_mfma_f32_16x16x32_bf16 v[92:95], a[196:199], a[192:195], v[92:95]
  buffer_load_dwordx4 v229, s[40:43], s92 offen offset:1024 sc1 lds
  v_mfma_f32_16x16x32_bf16 v[36:39], a[200:203], a[180:183], v[36:39]
  ds_read_b128 a[216:219], v233 offset:37888
  v_mfma_f32_16x16x32_bf16 v[56:59], a[200:203], a[184:187], v[56:59]
  v_mfma_f32_16x16x32_bf16 v[76:79], a[200:203], a[188:191], v[76:79]
  ds_read_b128 a[220:223], v233 offset:39936
  v_mfma_f32_16x16x32_bf16 v[96:99], a[200:203], a[192:195], v[96:99]
  buffer_load_dwordx4 v230, s[40:43], s92 offen offset:2048 sc1 lds
  s_waitcnt lgkmcnt(3)
  v_mfma_f32_16x16x32_bf16 v[40:43], a[204:207], a[180:183], v[40:43]
  ds_read_b128 a[224:227], v233 offset:41984
  v_mfma_f32_16x16x32_bf16 v[60:63], a[204:207], a[184:187], v[60:63]
  v_mfma_f32_16x16x32_bf16 v[80:83], a[204:207], a[188:191], v[80:83]
  ds_read_b128 a[228:231], v233 offset:44032
  v_mfma_f32_16x16x32_bf16 v[100:103], a[204:207], a[192:195], v[100:103]
  buffer_load_dwordx4 v231, s[40:43], s92 offen offset:3072 sc1 lds
  v_mfma_f32_16x16x32_bf16 v[44:47], a[208:211], a[180:183], v[44:47]
  ds_read_b128 a[236:239], v234 offset:39936
  v_mfma_f32_16x16x32_bf16 v[64:67], a[208:211], a[184:187], v[64:67]
  ds_read_b128 a[240:243], v234 offset:41984
  v_mfma_f32_16x16x32_bf16 v[84:87], a[208:211], a[188:191], v[84:87]
  ds_read_b128 a[244:247], v234 offset:44032
  s_add_u32 m0, s98, 57344
  v_mfma_f32_16x16x32_bf16 v[104:107], a[208:211], a[192:195], v[104:107]
  ds_read_b128 a[248:251], v234 offset:46080
  buffer_load_dwordx4 v232, s[40:43], s92 offen offset:0 sc1 lds
  v_mfma_f32_16x16x32_bf16 v[48:51], a[212:215], a[180:183], v[48:51]
  v_mfma_f32_16x16x32_bf16 v[68:71], a[212:215], a[184:187], v[68:71]
  v_mfma_f32_16x16x32_bf16 v[88:91], a[212:215], a[188:191], v[88:91]
  v_mfma_f32_16x16x32_bf16 v[108:111], a[212:215], a[192:195], v[108:111]
  s_waitcnt lgkmcnt(4)
  v_mfma_f32_16x16x32_bf16 v[32:35], a[232:235], a[216:219], v[32:35]
  v_mfma_f32_16x16x32_bf16 v[52:55], a[232:235], a[220:223], v[52:55]
  s_waitcnt vmcnt(9) lgkmcnt(0)
  s_barrier
  v_mfma_f32_16x16x32_bf16 v[72:75], a[232:235], a[224:227], v[72:75]
  ds_read_b128 a[196:199], v236 offset:0
  s_add_u32 s92, s92, 2048
  s_add_u32 m0, s98, 86016
  v_mfma_f32_16x16x32_bf16 v[92:95], a[232:235], a[228:231], v[92:95]
  buffer_load_dwordx4 v224, s[40:43], s92 offen offset:0 sc1 lds
  v_mfma_f32_16x16x32_bf16 v[36:39], a[236:239], a[216:219], v[36:39]
  ds_read_b128 a[180:183], v235 offset:0
  v_mfma_f32_16x16x32_bf16 v[56:59], a[236:239], a[220:223], v[56:59]
  v_mfma_f32_16x16x32_bf16 v[76:79], a[236:239], a[224:227], v[76:79]
  ds_read_b128 a[184:187], v235 offset:2048
  v_mfma_f32_16x16x32_bf16 v[96:99], a[236:239], a[228:231], v[96:99]
  buffer_load_dwordx4 v225, s[40:43], s92 offen offset:1024 sc1 lds
  v_mfma_f32_16x16x32_bf16 v[40:43], a[240:243], a[216:219], v[40:43]
  ds_read_b128 a[188:191], v235 offset:4096
  v_mfma_f32_16x16x32_bf16 v[60:63], a[240:243], a[220:223], v[60:63]
  v_mfma_f32_16x16x32_bf16 v[80:83], a[240:243], a[224:227], v[80:83]
  ds_read_b128 a[192:195], v235 offset:6144
  v_mfma_f32_16x16x32_bf16 v[100:103], a[240:243], a[228:231], v[100:103]
  buffer_load_dwordx4 v226, s[40:43], s92 offen offset:2048 sc1 lds
  v_mfma_f32_16x16x32_bf16 v[44:47], a[244:247], a[216:219], v[44:47]
  ds_read_b128 a[200:203], v236 offset:2048
  v_mfma_f32_16x16x32_bf16 v[64:67], a[244:247], a[220:223], v[64:67]
  ds_read_b128 a[204:207], v236 offset:4096
  v_mfma_f32_16x16x32_bf16 v[84:87], a[244:247], a[224:227], v[84:87]
  ds_read_b128 a[208:211], v236 offset:6144
  v_mfma_f32_16x16x32_bf16 v[104:107], a[244:247], a[228:231], v[104:107]
  ds_read_b128 a[212:215], v236 offset:8192
  buffer_load_dwordx4 v227, s[40:43], s92 offen offset:3072 sc1 lds
  v_mfma_f32_16x16x32_bf16 v[48:51], a[248:251], a[216:219], v[48:51]
  v_mfma_f32_16x16x32_bf16 v[68:71], a[248:251], a[220:223], v[68:71]
  v_mfma_f32_16x16x32_bf16 v[88:91], a[248:251], a[224:227], v[88:91]
  s_add_u32 m0, s98, 90112
  v_mfma_f32_16x16x32_bf16 v[108:111], a[248:251], a[228:231], v[108:111]
  buffer_load_dwordx4 v228, s[40:43], s92 offen offset:0 sc1 lds
  s_waitcnt lgkmcnt(3)
  v_mfma_f32_16x16x32_bf16 v[32:35], a[196:199], a[180:183], v[32:35]
  v_mfma_f32_16x16x32_bf16 v[52:55], a[196:199], a[184:187], v[52:55]
  v_mfma_f32_16x16x32_bf16 v[72:75], a[196:199], a[188:191], v[72:75]
  ds_read_b128 a[232:235], v236 offset:1024
  s_add_u32 m0, s98, 90112
  v_mfma_f32_16x16x32_bf16 v[92:95], a[196:199], a[192:195], v[92:95]
  buffer_load_dwordx4 v229, s[40:43], s92 offen offset:1024 sc1 lds
  v_mfma_f32_16x16x32_bf16 v[36:39], a[200:203], a[180:183], v[36:39]
  ds_read_b128 a[216:219], v235 offset:1024
  v_mfma_f32_16x16x32_bf16 v[56:59], a[200:203], a[184:187], v[56:59]
  v_mfma_f32_16x16x32_bf16 v[76:79], a[200:203], a[188:191], v[76:79]
  ds_read_b128 a[220:223], v235 offset:3072
  v_mfma_f32_16x16x32_bf16 v[96:99], a[200:203], a[192:195], v[96:99]
  buffer_load_dwordx4 v230, s[40:43], s92 offen offset:2048 sc1 lds
  s_waitcnt lgkmcnt(3)
  v_mfma_f32_16x16x32_bf16 v[40:43], a[204:207], a[180:183], v[40:43]
  ds_read_b128 a[224:227], v235 offset:5120
  v_mfma_f32_16x16x32_bf16 v[60:63], a[204:207], a[184:187], v[60:63]
  v_mfma_f32_16x16x32_bf16 v[80:83], a[204:207], a[188:191], v[80:83]
  ds_read_b128 a[228:231], v235 offset:7168
  v_mfma_f32_16x16x32_bf16 v[100:103], a[204:207], a[192:195], v[100:103]
  buffer_load_dwordx4 v231, s[40:43], s92 offen offset:3072 sc1 lds
  v_mfma_f32_16x16x32_bf16 v[44:47], a[208:211], a[180:183], v[44:47]
  ds_read_b128 a[236:239], v236 offset:3072
  v_mfma_f32_16x16x32_bf16 v[64:67], a[208:211], a[184:187], v[64:67]
  ds_read_b128 a[240:243], v236 offset:5120
  v_mfma_f32_16x16x32_bf16 v[84:87], a[208:211], a[188:191], v[84:87]
  ds_read_b128 a[244:247], v236 offset:7168
  s_add_u32 m0, s98, 94208
  v_mfma_f32_16x16x32_bf16 v[104:107], a[208:211], a[192:195], v[104:107]
  ds_read_b128 a[248:251], v236 offset:9216
  buffer_load_dwordx4 v232, s[40:43], s92 offen offset:0 sc1 lds
  v_mfma_f32_16x16x32_bf16 v[48:51], a[212:215], a[180:183], v[48:51]
  v_mfma_f32_16x16x32_bf16 v[68:71], a[212:215], a[184:187], v[68:71]
  v_mfma_f32_16x16x32_bf16 v[88:91], a[212:215], a[188:191], v[88:91]
  buffer_load_dwordx2 v[248:249], v247, s[40:43], s96 offen sc1
  v_mfma_f32_16x16x32_bf16 v[108:111], a[212:215], a[192:195], v[108:111]
  s_waitcnt lgkmcnt(3)
  v_mfma_f32_16x16x32_bf16 v[32:35], a[232:235], a[216:219], v[32:35]
  v_mfma_f32_16x16x32_bf16 v[52:55], a[232:235], a[220:223], v[52:55]
  s_waitcnt vmcnt(10) lgkmcnt(0)
  s_barrier
  v_mfma_f32_16x16x32_bf16 v[72:75], a[232:235], a[224:227], v[72:75]
  ds_read_b128 a[196:199], v234 offset:0
  s_add_u32 s92, s92, 2048
  s_add_u32 m0, s98, 122880
  v_mfma_f32_16x16x32_bf16 v[92:95], a[232:235], a[228:231], v[92:95]
  buffer_load_dwordx4 v224, s[40:43], s92 offen offset:0 sc1 lds
  v_mfma_f32_16x16x32_bf16 v[36:39], a[236:239], a[216:219], v[36:39]
  ds_read_b128 a[180:183], v233 offset:0
  v_mfma_f32_16x16x32_bf16 v[56:59], a[236:239], a[220:223], v[56:59]
  v_mfma_f32_16x16x32_bf16 v[76:79], a[236:239], a[224:227], v[76:79]
  ds_read_b128 a[184:187], v233 offset:2048
  v_mfma_f32_16x16x32_bf16 v[96:99], a[236:239], a[228:231], v[96:99]
  buffer_load_dwordx4 v225, s[40:43], s92 offen offset:1024 sc1 lds
  v_mfma_f32_16x16x32_bf16 v[40:43], a[240:243], a[216:219], v[40:43]
  ds_read_b128 a[188:191], v233 offset:4096
  v_mfma_f32_16x16x32_bf16 v[60:63], a[240:243], a[220:223], v[60:63]
  v_mfma_f32_16x16x32_bf16 v[80:83], a[240:243], a[224:227], v[80:83]
  ds_read_b128 a[192:195], v233 offset:6144
  v_mfma_f32_16x16x32_bf16 v[100:103], a[240:243], a[228:231], v[100:103]
  buffer_load_dwordx4 v226, s[40:43], s92 offen offset:2048 sc1 lds
  v_mfma_f32_16x16x32_bf16 v[44:47], a[244:247], a[216:219], v[44:47]
  ds_read_b128 a[200:203], v234 offset:2048
  v_mfma_f32_16x16x32_bf16 v[64:67], a[244:247], a[220:223], v[64:67]
  ds_read_b128 a[204:207], v234 offset:4096
  v_mfma_f32_16x16x32_bf16 v[84:87], a[244:247], a[224:227], v[84:87]
  ds_read_b128 a[208:211], v234 offset:6144
  v_mfma_f32_16x16x32_bf16 v[104:107], a[244:247], a[228:231], v[104:107]
  ds_read_b128 a[212:215], v234 offset:8192
  buffer_load_dwordx4 v227, s[40:43], s92 offen offset:3072 sc1 lds
  v_mfma_f32_16x16x32_bf16 v[48:51], a[248:251], a[216:219], v[48:51]
  v_mfma_f32_16x16x32_bf16 v[68:71], a[248:251], a[220:223], v[68:71]
  v_mfma_f32_16x16x32_bf16 v[88:91], a[248:251], a[224:227], v[88:91]
  s_add_u32 m0, s98, 126976
  v_mfma_f32_16x16x32_bf16 v[108:111], a[248:251], a[228:231], v[108:111]
  buffer_load_dwordx4 v228, s[40:43], s92 offen offset:0 sc1 lds
  s_waitcnt lgkmcnt(3)
  v_mfma_f32_16x16x32_bf16 v[32:35], a[196:199], a[180:183], v[32:35]
  v_mfma_f32_16x16x32_bf16 v[52:55], a[196:199], a[184:187], v[52:55]
  v_mfma_f32_16x16x32_bf16 v[72:75], a[196:199], a[188:191], v[72:75]
  ds_read_b128 a[232:235], v234 offset:1024
  s_add_u32 m0, s98, 126976
  v_mfma_f32_16x16x32_bf16 v[92:95], a[196:199], a[192:195], v[92:95]
  buffer_load_dwordx4 v229, s[40:43], s92 offen offset:1024 sc1 lds
  v_mfma_f32_16x16x32_bf16 v[36:39], a[200:203], a[180:183], v[36:39]
  ds_read_b128 a[216:219], v233 offset:1024
  v_mfma_f32_16x16x32_bf16 v[56:59], a[200:203], a[184:187], v[56:59]
  v_mfma_f32_16x16x32_bf16 v[76:79], a[200:203], a[188:191], v[76:79]
  ds_read_b128 a[220:223], v233 offset:3072
  v_mfma_f32_16x16x32_bf16 v[96:99], a[200:203], a[192:195], v[96:99]
  buffer_load_dwordx4 v230, s[40:43], s92 offen offset:2048 sc1 lds
  s_waitcnt lgkmcnt(3)
  v_mfma_f32_16x16x32_bf16 v[40:43], a[204:207], a[180:183], v[40:43]
  ds_read_b128 a[224:227], v233 offset:5120
  v_mfma_f32_16x16x32_bf16 v[60:63], a[204:207], a[184:187], v[60:63]
  v_mfma_f32_16x16x32_bf16 v[80:83], a[204:207], a[188:191], v[80:83]
  ds_read_b128 a[228:231], v233 offset:7168
  v_mfma_f32_16x16x32_bf16 v[100:103], a[204:207], a[192:195], v[100:103]
  buffer_load_dwordx4 v231, s[40:43], s92 offen offset:3072 sc1 lds
  v_mfma_f32_16x16x32_bf16 v[44:47], a[208:211], a[180:183], v[44:47]
  ds_read_b128 a[236:239], v234 offset:3072
  v_mfma_f32_16x16x32_bf16 v[64:67], a[208:211], a[184:187], v[64:67]
  ds_read_b128 a[240:243], v234 offset:5120
  v_mfma_f32_16x16x32_bf16 v[84:87], a[208:211], a[188:191], v[84:87]
  ds_read_b128 a[244:247], v234 offset:7168
  s_add_u32 m0, s98, 131072
  v_mfma_f32_16x16x32_bf16 v[104:107], a[208:211], a[192:195], v[104:107]
  ds_read_b128 a[248:251], v234 offset:9216
  buffer_load_dwordx4 v232, s[40:43], s92 offen offset:0 sc1 lds
  v_mfma_f32_16x16x32_bf16 v[48:51], a[212:215], a[180:183], v[48:51]
  v_mfma_f32_16x16x32_bf16 v[68:71], a[212:215], a[184:187], v[68:71]
  v_mfma_f32_16x16x32_bf16 v[88:91], a[212:215], a[188:191], v[88:91]
  v_mfma_f32_16x16x32_bf16 v[108:111], a[212:215], a[192:195], v[108:111]
  s_waitcnt lgkmcnt(4)
  v_mfma_f32_16x16x32_bf16 v[32:35], a[232:235], a[216:219], v[32:35]
  v_mfma_f32_16x16x32_bf16 v[52:55], a[232:235], a[220:223], v[52:55]
  s_waitcnt vmcnt(9) lgkmcnt(0)
  v_cmp_ne_u64 vcc, s[0:1], v[248:249]
  s_nop 1
  s_cbranch_vccnz LO_s3
LO_s3_ret:
  s_barrier
  v_mfma_f32_16x16x32_bf16 v[72:75], a[232:235], a[224:227], v[72:75]
  ds_read_b128 a[196:199], v234 offset:36864
  s_add_u32 s92, s92, 2048
  s_add_u32 m0, s98, 49152
  v_mfma_f32_16x16x32_bf16 v[92:95], a[232:235], a[228:231], v[92:95]
  buffer_load_dwordx4 v224, s[40:43], s92 offen offset:0 sc1 lds
  v_mfma_f32_16x16x32_bf16 v[36:39], a[236:239], a[216:219], v[36:39]
  ds_read_b128 a[180:183], v233 offset:36864
  v_mfma_f32_16x16x32_bf16 v[56:59], a[236:239], a[220:223], v[56:59]
  buffer_load_dwordx4 a[0:3], v237, s[40:43], s94 offen offset:0 sc1
  v_mfma_f32_16x16x32_bf16 v[76:79], a[236:239], a[224:227], v[76:79]
  ds_read_b128 a[184:187], v233 offset:38912
  v_mfma_f32_16x16x32_bf16 v[96:99], a[236:239], a[228:231], v[96:99]
  buffer_load_dwordx4 v225, s[40:43], s92 offen offset:1024 sc1 lds
  v_mfma_f32_16x16x32_bf16 v[40:43], a[240:243], a[216:219], v[40:43]
  ds_read_b128 a[188:191], v233 offset:40960
  v_mfma_f32_16x16x32_bf16 v[60:63], a[240:243], a[220:223], v[60:63]
  v_mfma_f32_16x16x32_bf16 v[80:83], a[240:243], a[224:227], v[80:83]
  ds_read_b128 a[192:195], v233 offset:43008
  v_mfma_f32_16x16x32_bf16 v[100:103], a[240:243], a[228:231], v[100:103]
  buffer_load_dwordx4 v226, s[40:43], s92 offen offset:2048 sc1 lds
  v_mfma_f32_16x16x32_bf16 v[44:47], a[244:247], a[216:219], v[44:47]
  ds_read_b128 a[200:203], v234 offset:38912
  v_mfma_f32_16x16x32_bf16 v[64:67], a[244:247], a[220:223], v[64:67]
  ds_read_b128 a[204:207], v234 offset:40960
  v_mfma_f32_16x16x32_bf16 v[84:87], a[244:247], a[224:227], v[84:87]
  ds_read_b128 a[208:211], v234 offset:43008
  v_mfma_f32_16x16x32_bf16 v[104:107], a[244:247], a[228:231], v[104:107]
  ds_read_b128 a[212:215], v234 offset:45056
  buffer_load_dwordx4 v227, s[40:43], s92 offen offset:3072 sc1 lds
  v_mfma_f32_16x16x32_bf16 v[48:51], a[248:251], a[216:219], v[48:51]
  v_mfma_f32_16x16x32_bf16 v[68:71], a[248:251], a[220:223], v[68:71]
  v_mfma_f32_16x16x32_bf16 v[88:91], a[248:251], a[224:227], v[88:91]
  s_add_u32 m0, s98, 53248
  v_mfma_f32_16x16x32_bf16 v[108:111], a[248:251], a[228:231], v[108:111]
  buffer_load_dwordx4 v228, s[40:43], s92 offen offset:0 sc1 lds
  s_waitcnt lgkmcnt(3)
  v_mfma_f32_16x16x32_bf16 v[32:35], a[196:199], a[180:183], v[32:35]
  v_mfma_f32_16x16x32_bf16 v[52:55], a[196:199], a[184:187], v[52:55]
  v_mfma_f32_16x16x32_bf16 v[72:75], a[196:199], a[188:191], v[72:75]
  ds_read_b128 a[232:235], v234 offset:37888
  s_add_u32 m0, s98, 53248
  v_mfma_f32_16x16x32_bf16 v[92:95], a[196:199], a[192:195], v[92:95]
  buffer_load_dwordx4 v229, s[40:43], s92 offen offset:1024 sc1 lds
  v_mfma_f32_16x16x32_bf16 v[36:39], a[200:203], a[180:183], v[36:39]
  ds_read_b128 a[216:219], v233 offset:37888
  v_mfma_f32_16x16x32_bf16 v[56:59], a[200:203], a[184:187], v[56:59]
  buffer_load_dwordx4 a[4:7], v238, s[40:43], s94 offen offset:0 sc1
  v_mfma_f32_16x16x32_bf16 v[76:79], a[200:203], a[188:191], v[76:79]
  ds_read_b128 a[220:223], v233 offset:39936
  v_mfma_f32_16x16x32_bf16 v[96:99], a[200:203], a[192:195], v[96:99]
  buffer_load_dwordx4 v230, s[40:43], s92 offen offset:2048 sc1 lds
  s_waitcnt lgkmcnt(3)
  v_mfma_f32_16x16x32_bf16 v[40:43], a[204:207], a[180:183], v[40:43]
  ds_read_b128 a[224:227], v233 offset:41984
  v_mfma_f32_16x16x32_bf16 v[60:63], a[204:207], a[184:187], v[60:63]
  v_mfma_f32_16x16x32_bf16 v[80:83], a[204:207], a[188:191], v[80:83]
  ds_read_b128 a[228:231], v233 offset:44032
  v_mfma_f32_16x16x32_bf16 v[100:103], a[204:207], a[192:195], v[100:103]
  buffer_load_dwordx4 v231, s[40:43], s92 offen offset:3072 sc1 lds
  v_mfma_f32_16x16x32_bf16 v[44:47], a[208:211], a[180:183], v[44:47]
  ds_read_b128 a[236:239], v234 offset:39936
  v_mfma_f32_16x16x32_bf16 v[64:67], a[208:211], a[184:187], v[64:67]
  ds_read_b128 a[240:243], v234 offset:41984
  v_mfma_f32_16x16x32_bf16 v[84:87], a[208:211], a[188:191], v[84:87]
  ds_read_b128 a[244:247], v234 offset:44032
  s_add_u32 m0, s98, 57344
  v_mfma_f32_16x16x32_bf16 v[104:107], a[208:211], a[192:195], v[104:107]
  ds_read_b128 a[248:251], v234 offset:46080
  buffer_load_dwordx4 v232, s[40:43], s92 offen offset:0 sc1 lds
  v_mfma_f32_16x16x32_bf16 v[48:51], a[212:215], a[180:183], v[48:51]
  v_mfma_f32_16x16x32_bf16 v[68:71], a[212:215], a[184:187], v[68:71]
  v_mfma_f32_16x16x32_bf16 v[88:91], a[212:215], a[188:191], v[88:91]
  v_mfma_f32_16x16x32_bf16 v[108:111], a[212:215], a[192:195], v[108:111]
  s_waitcnt lgkmcnt(4)
  v_mfma_f32_16x16x32_bf16 v[32:35], a[232:235], a[216:219], v[32:35]
  v_mfma_f32_16x16x32_bf16 v[52:55], a[232:235], a[220:223], v[52:55]
  s_waitcnt vmcnt(11) lgkmcnt(0)
  s_barrier
  v_mfma_f32_16x16x32_bf16 v[72:75], a[232:235], a[224:227], v[72:75]
  ds_read_b128 a[196:199], v236 offset:0
  v_mfma_f32_16x16x32_bf16 v[92:95], a[232:235], a[228:231], v[92:95]
  v_mfma_f32_16x16x32_bf16 v[36:39], a[236:239], a[216:219], v[36:39]
  ds_read_b128 a[180:183], v235 offset:0
  v_mfma_f32_16x16x32_bf16 v[56:59], a[236:239], a[220:223], v[56:59]
  buffer_load_dwordx4 a[8:11], v239, s[40:43], s94 offen offset:0 sc1
  v_mfma_f32_16x16x32_bf16 v[76:79], a[236:239], a[224:227], v[76:79]
  ds_read_b128 a[184:187], v235 offset:2048
  v_mfma_f32_16x16x32_bf16 v[96:99], a[236:239], a[228:231], v[96:99]
  v_mfma_f32_16x16x32_bf16 v[40:43], a[240:243], a[216:219], v[40:43]
  ds_read_b128 a[188:191], v235 offset:4096
  buffer_load_dwordx4 a[12:15], v240, s[40:43], s94 offen offset:0 sc1
  v_mfma_f32_16x16x32_bf16 v[60:63], a[240:243], a[220:223], v[60:63]
  v_mfma_f32_16x16x32_bf16 v[80:83], a[240:243], a[224:227], v[80:83]
  ds_read_b128 a[192:195], v235 offset:6144
  v_mfma_f32_16x16x32_bf16 v[100:103], a[240:243], a[228:231], v[100:103]
  buffer_load_dwordx4 a[36:39], v237, s[40:43], s94 offen offset:1024 sc1
  v_mfma_f32_16x16x32_bf16 v[44:47], a[244:247], a[216:219], v[44:47]
  ds_read_b128 a[200:203], v236 offset:2048
  v_mfma_f32_16x16x32_bf16 v[64:67], a[244:247], a[220:223], v[64:67]
  ds_read_b128 a[204:207], v236 offset:4096
  v_mfma_f32_16x16x32_bf16 v[84:87], a[244:247], a[224:227], v[84:87]
  ds_read_b128 a[208:211], v236 offset:6144
  buffer_load_dwordx4 a[40:43], v238, s[40:43], s94 offen offset:1024 sc1
  v_mfma_f32_16x16x32_bf16 v[104:107], a[244:247], a[228:231], v[104:107]
  ds_read_b128 a[212:215], v236 offset:8192
  v_mfma_f32_16x16x32_bf16 v[48:51], a[248:251], a[216:219], v[48:51]
  v_mfma_f32_16x16x32_bf16 v[68:71], a[248:251], a[220:223], v[68:71]
  v_mfma_f32_16x16x32_bf16 v[88:91], a[248:251], a[224:227], v[88:91]
  v_mfma_f32_16x16x32_bf16 v[108:111], a[248:251], a[228:231], v[108:111]
  s_waitcnt lgkmcnt(4)
  v_mfma_f32_16x16x32_bf16 v[32:35], a[196:199], a[180:183], v[32:35]
  v_mfma_f32_16x16x32_bf16 v[52:55], a[196:199], a[184:187], v[52:55]
  v_mfma_f32_16x16x32_bf16 v[72:75], a[196:199], a[188:191], v[72:75]
  ds_read_b128 a[232:235], v236 offset:1024
  v_mfma_f32_16x16x32_bf16 v[92:95], a[196:199], a[192:195], v[92:95]
  s_waitcnt lgkmcnt(3)
  v_mfma_f32_16x16x32_bf16 v[36:39], a[200:203], a[180:183], v[36:39]
  ds_read_b128 a[216:219], v235 offset:1024
  v_mfma_f32_16x16x32_bf16 v[56:59], a[200:203], a[184:187], v[56:59]
  buffer_load_dwordx4 a[44:47], v239, s[40:43], s94 offen offset:1024 sc1
  v_mfma_f32_16x16x32_bf16 v[76:79], a[200:203], a[188:191], v[76:79]
  ds_read_b128 a[220:223], v235 offset:3072
  v_mfma_f32_16x16x32_bf16 v[96:99], a[200:203], a[192:195], v[96:99]
  v_mfma_f32_16x16x32_bf16 v[40:43], a[204:207], a[180:183], v[40:43]
  ds_read_b128 a[224:227], v235 offset:5120
  buffer_load_dwordx4 a[48:51], v240, s[40:43], s94 offen offset:1024 sc1
  v_mfma_f32_16x16x32_bf16 v[60:63], a[204:207], a[184:187], v[60:63]
  v_mfma_f32_16x16x32_bf16 v[80:83], a[204:207], a[188:191], v[80:83]
  ds_read_b128 a[228:231], v235 offset:7168
  v_mfma_f32_16x16x32_bf16 v[100:103], a[204:207], a[192:195], v[100:103]
  buffer_load_dwordx4 a[72:75], v237, s[40:43], s94 offen offset:2048 sc1
  s_waitcnt lgkmcnt(3)
  v_mfma_f32_16x16x32_bf16 v[44:47], a[208:211], a[180:183], v[44:47]
  ds_read_b128 a[236:239], v236 offset:3072
  v_mfma_f32_16x16x32_bf16 v[64:67], a[208:211], a[184:187], v[64:67]
  ds_read_b128 a[240:243], v236 offset:5120
  v_mfma_f32_16x16x32_bf16 v[84:87], a[208:211], a[188:191], v[84:87]
  ds_read_b128 a[244:247], v236 offset:7168
  buffer_load_dwordx4 a[76:79], v238, s[40:43], s94 offen offset:2048 sc1
  v_mfma_f32_16x16x32_bf16 v[104:107], a[208:211], a[192:195], v[104:107]
  ds_read_b128 a[248:251], v236 offset:9216
  v_mfma_f32_16x16x32_bf16 v[48:51], a[212:215], a[180:183], v[48:51]
  v_mfma_f32_16x16x32_bf16 v[68:71], a[212:215], a[184:187], v[68:71]
  v_mfma_f32_16x16x32_bf16 v[88:91], a[212:215], a[188:191], v[88:91]
  v_mfma_f32_16x16x32_bf16 v[108:111], a[212:215], a[192:195], v[108:111]
  v_mfma_f32_16x16x32_bf16 v[32:35], a[232:235], a[216:219], v[32:35]
  s_waitcnt lgkmcnt(4)
  v_mfma_f32_16x16x32_bf16 v[52:55], a[232:235], a[220:223], v[52:55]
  s_waitcnt vmcnt(8) lgkmcnt(0)
  s_barrier
  v_mfma_f32_16x16x32_bf16 v[72:75], a[232:235], a[224:227], v[72:75]
  ds_read_b128 a[196:199], v234 offset:0
  v_mfma_f32_16x16x32_bf16 v[92:95], a[232:235], a[228:231], v[92:95]
  v_mfma_f32_16x16x32_bf16 v[36:39], a[236:239], a[216:219], v[36:39]
  ds_read_b128 a[180:183], v233 offset:0
  v_mfma_f32_16x16x32_bf16 v[56:59], a[236:239], a[220:223], v[56:59]
  buffer_load_dwordx4 a[80:83], v239, s[40:43], s94 offen offset:2048 sc1
  v_mfma_f32_16x16x32_bf16 v[76:79], a[236:239], a[224:227], v[76:79]
  ds_read_b128 a[184:187], v233 offset:2048
  v_mfma_f32_16x16x32_bf16 v[96:99], a[236:239], a[228:231], v[96:99]
  v_mfma_f32_16x16x32_bf16 v[40:43], a[240:243], a[216:219], v[40:43]
  ds_read_b128 a[188:191], v233 offset:4096
  buffer_load_dwordx4 a[84:87], v240, s[40:43], s94 offen offset:2048 sc1
  v_mfma_f32_16x16x32_bf16 v[60:63], a[240:243], a[220:223], v[60:63]
  v_mfma_f32_16x16x32_bf16 v[80:83], a[240:243], a[224:227], v[80:83]
  ds_read_b128 a[192:195], v233 offset:6144
  v_mfma_f32_16x16x32_bf16 v[100:103], a[240:243], a[228:231], v[100:103]
  buffer_load_dwordx4 a[108:111], v237, s[40:43], s94 offen offset:3072 sc1
  v_mfma_f32_16x16x32_bf16 v[44:47], a[244:247], a[216:219], v[44:47]
  ds_read_b128 a[200:203], v234 offset:2048
  v_mfma_f32_16x16x32_bf16 v[64:67], a[244:247], a[220:223], v[64:67]
  ds_read_b128 a[204:207], v234 offset:4096
  v_mfma_f32_16x16x32_bf16 v[84:87], a[244:247], a[224:227], v[84:87]
  ds_read_b128 a[208:211], v234 offset:6144
  buffer_load_dwordx4 a[112:115], v238, s[40:43], s94 offen offset:3072 sc1
  v_mfma_f32_16x16x32_bf16 v[104:107], a[244:247], a[228:231], v[104:107]
  ds_read_b128 a[212:215], v234 offset:8192
  v_mfma_f32_16x16x32_bf16 v[48:51], a[248:251], a[216:219], v[48:51]
  v_mfma_f32_16x16x32_bf16 v[68:71], a[248:251], a[220:223], v[68:71]
  v_mfma_f32_16x16x32_bf16 v[88:91], a[248:251], a[224:227], v[88:91]
  v_mfma_f32_16x16x32_bf16 v[108:111], a[248:251], a[228:231], v[108:111]
  s_waitcnt lgkmcnt(4)
  v_mfma_f32_16x16x32_bf16 v[32:35], a[196:199], a[180:183], v[32:35]
  v_mfma_f32_16x16x32_bf16 v[52:55], a[196:199], a[184:187], v[52:55]
  v_mfma_f32_16x16x32_bf16 v[72:75], a[196:199], a[188:191], v[72:75]
  ds_read_b128 a[232:235], v234 offset:1024
  v_mfma_f32_16x16x32_bf16 v[92:95], a[196:199], a[192:195], v[92:95]
  s_waitcnt lgkmcnt(3)
  v_mfma_f32_16x16x32_bf16 v[36:39], a[200:203], a[180:183], v[36:39]
  ds_read_b128 a[216:219], v233 offset:1024
  v_mfma_f32_16x16x32_bf16 v[56:59], a[200:203], a[184:187], v[56:59]
  buffer_load_dwordx4 a[116:119], v239, s[40:43], s94 offen offset:3072 sc1
  v_mfma_f32_16x16x32_bf16 v[76:79], a[200:203], a[188:191], v[76:79]
  ds_read_b128 a[220:223], v233 offset:3072
  v_mfma_f32_16x16x32_bf16 v[96:99], a[200:203], a[192:195], v[96:99]
  v_mfma_f32_16x16x32_bf16 v[40:43], a[204:207], a[180:183], v[40:43]
  ds_read_b128 a[224:227], v233 offset:5120
  buffer_load_dwordx4 a[120:123], v240, s[40:43], s94 offen offset:3072 sc1
  v_mfma_f32_16x16x32_bf16 v[60:63], a[204:207], a[184:187], v[60:63]
  v_mfma_f32_16x16x32_bf16 v[80:83], a[204:207], a[188:191], v[80:83]
  ds_read_b128 a[228:231], v233 offset:7168
  v_mfma_f32_16x16x32_bf16 v[100:103], a[204:207], a[192:195], v[100:103]
  s_add_u32 s94, s94, 4096
  buffer_load_dwordx4 a[144:147], v237, s[40:43], s94 offen offset:0 sc1
  s_waitcnt lgkmcnt(3)
  v_mfma_f32_16x16x32_bf16 v[44:47], a[208:211], a[180:183], v[44:47]
  ds_read_b128 a[236:239], v234 offset:3072
  v_mfma_f32_16x16x32_bf16 v[64:67], a[208:211], a[184:187], v[64:67]
  ds_read_b128 a[240:243], v234 offset:5120
  v_mfma_f32_16x16x32_bf16 v[84:87], a[208:211], a[188:191], v[84:87]
  ds_read_b128 a[244:247], v234 offset:7168
  buffer_load_dwordx4 a[148:151], v238, s[40:43], s94 offen offset:0 sc1
  v_mfma_f32_16x16x32_bf16 v[104:107], a[208:211], a[192:195], v[104:107]
  ds_read_b128 a[248:251], v234 offset:9216
  v_mfma_f32_16x16x32_bf16 v[48:51], a[212:215], a[180:183], v[48:51]
  v_mfma_f32_16x16x32_bf16 v[68:71], a[212:215], a[184:187], v[68:71]
  v_mfma_f32_16x16x32_bf16 v[88:91], a[212:215], a[188:191], v[88:91]
  v_mfma_f32_16x16x32_bf16 v[108:111], a[212:215], a[192:195], v[108:111]
  s_waitcnt lgkmcnt(4)
  v_mfma_f32_16x16x32_bf16 v[52:55], a[232:235], a[220:223], v[52:55]
  s_waitcnt lgkmcnt(3)
  v_mfma_f32_16x16x32_bf16 v[56:59], a[236:239], a[220:223], v[56:59]
  s_waitcnt lgkmcnt(2)
  v_mfma_f32_16x16x32_bf16 v[60:63], a[240:243], a[220:223], v[60:63]
  s_waitcnt lgkmcnt(1)
  v_mfma_f32_16x16x32_bf16 v[64:67], a[244:247], a[220:223], v[64:67]
  s_waitcnt lgkmcnt(0)
  v_mfma_f32_16x16x32_bf16 v[68:71], a[248:251], a[220:223], v[68:71]
  v_mfma_f32_16x16x32_bf16 v[72:75], a[232:235], a[224:227], v[72:75]
  buffer_load_dwordx4 a[152:155], v239, s[40:43], s94 offen offset:0 sc1
  v_mfma_f32_16x16x32_bf16 v[76:79], a[236:239], a[224:227], v[76:79]
  v_mfma_f32_16x16x32_bf16 v[80:83], a[240:243], a[224:227], v[80:83]
  v_mfma_f32_16x16x32_bf16 v[84:87], a[244:247], a[224:227], v[84:87]
  v_mfma_f32_16x16x32_bf16 v[88:91], a[248:251], a[224:227], v[88:91]
  v_mfma_f32_16x16x32_bf16 v[92:95], a[232:235], a[228:231], v[92:95]
  v_mfma_f32_16x16x32_bf16 v[96:99], a[236:239], a[228:231], v[96:99]
  buffer_load_dwordx4 a[156:159], v240, s[40:43], s94 offen offset:0 sc1
  v_mfma_f32_16x16x32_bf16 v[100:103], a[240:243], a[228:231], v[100:103]
  v_mfma_f32_16x16x32_bf16 v[104:107], a[244:247], a[228:231], v[104:107]
  v_mfma_f32_16x16x32_bf16 v[108:111], a[248:251], a[228:231], v[108:111]
  v_mfma_f32_16x16x32_bf16 v[32:35], a[232:235], a[216:219], v[32:35]
  v_mfma_f32_16x16x32_bf16 v[36:39], a[236:239], a[216:219], v[36:39]
  v_mfma_f32_16x16x32_bf16 v[40:43], a[240:243], a[216:219], v[40:43]
  v_mfma_f32_16x16x32_bf16 v[44:47], a[244:247], a[216:219], v[44:47]
  v_mfma_f32_16x16x32_bf16 v[48:51], a[248:251], a[216:219], v[48:51]
  s_waitcnt vmcnt(16)
  v_mfma_f32_16x16x32_bf16 v[112:115], a[16:19], a[0:3], 0
  v_cvt_pk_bf16_f32 v52, v52, v53
  v_cvt_pk_bf16_f32 v53, v54, v55
  v_mfma_f32_16x16x32_bf16 v[132:135], a[16:19], a[4:7], 0
  v_cvt_pk_bf16_f32 v54, v56, v57
  v_cvt_pk_bf16_f32 v55, v58, v59
  v_mfma_f32_16x16x32_bf16 v[152:155], a[16:19], a[8:11], 0
  v_cvt_pk_bf16_f32 v56, v60, v61
  v_cvt_pk_bf16_f32 v57, v62, v63
  v_mfma_f32_16x16x32_bf16 v[172:175], a[16:19], a[12:15], 0
  v_cvt_pk_bf16_f32 v58, v64, v65
  v_cvt_pk_bf16_f32 v59, v66, v67
  v_mfma_f32_16x16x32_bf16 v[116:119], a[20:23], a[0:3], 0
  v_cvt_pk_bf16_f32 v60, v68, v69
  v_cvt_pk_bf16_f32 v61, v70, v71
  v_mfma_f32_16x16x32_bf16 v[136:139], a[20:23], a[4:7], 0
  buffer_store_dwordx4 v[52:55], v252, s[40:43], s48 offen sc1
  buffer_store_dwordx4 v[56:59], v252, s[40:43], s48 offen offset:1024 sc1
  v_mfma_f32_16x16x32_bf16 v[156:159], a[20:23], a[8:11], 0
  buffer_store_dwordx2 v[60:61], v21, s[40:43], s48 offen offset:2048 sc1
  v_cvt_pk_bf16_f32 v72, v72, v73
  v_mfma_f32_16x16x32_bf16 v[176:179], a[20:23], a[12:15], 0
  v_cvt_pk_bf16_f32 v73, v74, v75
  v_cvt_pk_bf16_f32 v74, v76, v77
  v_mfma_f32_16x16x32_bf16 v[120:123], a[24:27], a[0:3], 0
  v_cvt_pk_bf16_f32 v75, v78, v79
  v_cvt_pk_bf16_f32 v76, v80, v81
  v_mfma_f32_16x16x32_bf16 v[140:143], a[24:27], a[4:7], 0
  v_cvt_pk_bf16_f32 v77, v82, v83
  v_cvt_pk_bf16_f32 v78, v84, v85
  v_mfma_f32_16x16x32_bf16 v[160:163], a[24:27], a[8:11], 0
  v_cvt_pk_bf16_f32 v79, v86, v87
  v_cvt_pk_bf16_f32 v80, v88, v89
  v_mfma_f32_16x16x32_bf16 v[180:183], a[24:27], a[12:15], 0
  v_cvt_pk_bf16_f32 v81, v90, v91
  buffer_store_dwordx4 v[72:75], v252, s[40:43], s49 offen sc1
  v_mfma_f32_16x16x32_bf16 v[124:127], a[28:31], a[0:3], 0
  buffer_store_dwordx4 v[76:79], v252, s[40:43], s49 offen offset:1024 sc1
  buffer_store_dwordx2 v[80:81], v21, s[40:43], s49 offen offset:2048 sc1
  v_mfma_f32_16x16x32_bf16 v[144:147], a[28:31], a[4:7], 0
  v_cvt_pk_bf16_f32 v92, v92, v93
  v_cvt_pk_bf16_f32 v93, v94, v95
  v_mfma_f32_16x16x32_bf16 v[164:167], a[28:31], a[8:11], 0
  v_cvt_pk_bf16_f32 v94, v96, v97
  v_cvt_pk_bf16_f32 v95, v98, v99
  v_mfma_f32_16x16x32_bf16 v[184:187], a[28:31], a[12:15], 0
  v_cvt_pk_bf16_f32 v96, v100, v101
  v_cvt_pk_bf16_f32 v97, v102, v103
  v_mfma_f32_16x16x32_bf16 v[128:131], a[32:35], a[0:3], 0
  v_cvt_pk_bf16_f32 v98, v104, v105
  v_cvt_pk_bf16_f32 v99, v106, v107
  v_mfma_f32_16x16x32_bf16 v[148:151], a[32:35], a[4:7], 0
  v_cvt_pk_bf16_f32 v100, v108, v109
  v_cvt_pk_bf16_f32 v101, v110, v111
  v_mfma_f32_16x16x32_bf16 v[168:171], a[32:35], a[8:11], 0
  buffer_store_dwordx4 v[92:95], v252, s[40:43], s50 offen sc1
  buffer_store_dwordx4 v[96:99], v252, s[40:43], s50 offen offset:1024 sc1
  v_mfma_f32_16x16x32_bf16 v[188:191], a[32:35], a[12:15], 0
  buffer_store_dwordx2 v[100:101], v21, s[40:43], s50 offen offset:2048 sc1
  s_waitcnt vmcnt(9)
  v_mfma_f32_16x16x32_bf16 v[112:115], a[52:55], a[36:39], v[112:115]
  v_mfma_f32_16x16x32_bf16 v[132:135], a[52:55], a[40:43], v[132:135]
  v_mfma_f32_16x16x32_bf16 v[152:155], a[52:55], a[44:47], v[152:155]
  v_mfma_f32_16x16x32_bf16 v[172:175], a[52:55], a[48:51], v[172:175]
  v_mfma_f32_16x16x32_bf16 v[116:119], a[56:59], a[36:39], v[116:119]
  v_mfma_f32_16x16x32_bf16 v[136:139], a[56:59], a[40:43], v[136:139]
  v_mfma_f32_16x16x32_bf16 v[156:159], a[56:59], a[44:47], v[156:159]
  v_mfma_f32_16x16x32_bf16 v[176:179], a[56:59], a[48:51], v[176:179]
  v_mfma_f32_16x16x32_bf16 v[120:123], a[60:63], a[36:39], v[120:123]
  v_mfma_f32_16x16x32_bf16 v[140:143], a[60:63], a[40:43], v[140:143]
  v_mfma_f32_16x16x32_bf16 v[160:163], a[60:63], a[44:47], v[160:163]
  v_mfma_f32_16x16x32_bf16 v[180:183], a[60:63], a[48:51], v[180:183]
  v_mfma_f32_16x16x32_bf16 v[124:127], a[64:67], a[36:39], v[124:127]
  v_mfma_f32_16x16x32_bf16 v[144:147], a[64:67], a[40:43], v[144:147]
  v_mfma_f32_16x16x32_bf16 v[164:167], a[64:67], a[44:47], v[164:167]
  v_mfma_f32_16x16x32_bf16 v[184:187], a[64:67], a[48:51], v[184:187]
  v_mfma_f32_16x16x32_bf16 v[128:131], a[68:71], a[36:39], v[128:131]
  v_mfma_f32_16x16x32_bf16 v[148:151], a[68:71], a[40:43], v[148:151]
  v_mfma_f32_16x16x32_bf16 v[168:171], a[68:71], a[44:47], v[168:171]
  v_mfma_f32_16x16x32_bf16 v[188:191], a[68:71], a[48:51], v[188:191]
  v_mfma_f32_16x16x32_bf16 v[112:115], a[88:91], a[72:75], v[112:115]
  v_mfma_f32_16x16x32_bf16 v[132:135], a[88:91], a[76:79], v[132:135]
  v_mfma_f32_16x16x32_bf16 v[152:155], a[88:91], a[80:83], v[152:155]
  v_mfma_f32_16x16x32_bf16 v[172:175], a[88:91], a[84:87], v[172:175]
  v_mfma_f32_16x16x32_bf16 v[116:119], a[92:95], a[72:75], v[116:119]
  v_mfma_f32_16x16x32_bf16 v[136:139], a[92:95], a[76:79], v[136:139]
  v_mfma_f32_16x16x32_bf16 v[156:159], a[92:95], a[80:83], v[156:159]
  v_mfma_f32_16x16x32_bf16 v[176:179], a[92:95], a[84:87], v[176:179]
  v_mfma_f32_16x16x32_bf16 v[120:123], a[96:99], a[72:75], v[120:123]
  v_mfma_f32_16x16x32_bf16 v[140:143], a[96:99], a[76:79], v[140:143]
  v_mfma_f32_16x16x32_bf16 v[160:163], a[96:99], a[80:83], v[160:163]
  v_mfma_f32_16x16x32_bf16 v[180:183], a[96:99], a[84:87], v[180:183]
  v_mfma_f32_16x16x32_bf16 v[124:127], a[100:103], a[72:75], v[124:127]
  v_mfma_f32_16x16x32_bf16 v[144:147], a[100:103], a[76:79], v[144:147]
  v_mfma_f32_16x16x32_bf16 v[164:167], a[100:103], a[80:83], v[164:167]
  v_mfma_f32_16x16x32_bf16 v[184:187], a[100:103], a[84:87], v[184:187]
  v_mfma_f32_16x16x32_bf16 v[128:131], a[104:107], a[72:75], v[128:131]
  v_mfma_f32_16x16x32_bf16 v[148:151], a[104:107], a[76:79], v[148:151]
  v_mfma_f32_16x16x32_bf16 v[168:171], a[104:107], a[80:83], v[168:171]
  v_mfma_f32_16x16x32_bf16 v[188:191], a[104:107], a[84:87], v[188:191]
  s_waitcnt vmcnt(0)
  s_barrier
  s_cmp_lg_u32 s28, 0
  s_cbranch_scc1 LO_xf
  v_mov_b32 v2, s0
  v_mov_b32 v3, s1
  v_mov_b32 v0, 0
  s_mov_b64 exec, 1
  buffer_store_dwordx2 v[2:3], v0, s[40:43], s95 offen sc1
  s_mov_b64 exec, -1
LO_xf:
  v_mfma_f32_16x16x32_bf16 v[112:115], a[124:127], a[108:111], v[112:115]
  v_mfma_f32_16x16x32_bf16 v[132:135], a[124:127], a[112:115], v[132:135]
  v_mfma_f32_16x16x32_bf16 v[152:155], a[124:127], a[116:119], v[152:155]
  v_mfma_f32_16x16x32_bf16 v[172:175], a[124:127], a[120:123], v[172:175]
  v_mfma_f32_16x16x32_bf16 v[116:119], a[128:131], a[108:111], v[116:119]
  v_mfma_f32_16x16x32_bf16 v[136:139], a[128:131], a[112:115], v[136:139]
  v_mfma_f32_16x16x32_bf16 v[156:159], a[128:131], a[116:119], v[156:159]
  v_mfma_f32_16x16x32_bf16 v[176:179], a[128:131], a[120:123], v[176:179]
  v_mfma_f32_16x16x32_bf16 v[120:123], a[132:135], a[108:111], v[120:123]
  v_mfma_f32_16x16x32_bf16 v[140:143], a[132:135], a[112:115], v[140:143]
  v_mfma_f32_16x16x32_bf16 v[160:163], a[132:135], a[116:119], v[160:163]
  v_mfma_f32_16x16x32_bf16 v[180:183], a[132:135], a[120:123], v[180:183]
  v_mfma_f32_16x16x32_bf16 v[124:127], a[136:139], a[108:111], v[124:127]
  v_mfma_f32_16x16x32_bf16 v[144:147], a[136:139], a[112:115], v[144:147]
  v_mfma_f32_16x16x32_bf16 v[164:167], a[136:139], a[116:119], v[164:167]
  v_mfma_f32_16x16x32_bf16 v[184:187], a[136:139], a[120:123], v[184:187]
  v_mfma_f32_16x16x32_bf16 v[128:131], a[140:143], a[108:111], v[128:131]
  v_mfma_f32_16x16x32_bf16 v[148:151], a[140:143], a[112:115], v[148:151]
  v_mfma_f32_16x16x32_bf16 v[168:171], a[140:143], a[116:119], v[168:171]
  v_mfma_f32_16x16x32_bf16 v[188:191], a[140:143], a[120:123], v[188:191]
  buffer_load_dwordx2 v[248:249], v246, s[40:43], s99 offen sc1
  v_mfma_f32_16x16x32_bf16 v[132:135], a[160:163], a[148:151], v[132:135]
  v_mfma_f32_16x16x32_bf16 v[136:139], a[164:167], a[148:151], v[136:139]
  v_mfma_f32_16x16x32_bf16 v[140:143], a[168:171], a[148:151], v[140:143]
  v_mfma_f32_16x16x32_bf16 v[144:147], a[172:175], a[148:151], v[144:147]
  v_mfma_f32_16x16x32_bf16 v[148:151], a[176:179], a[148:151], v[148:151]
  v_mfma_f32_16x16x32_bf16 v[152:155], a[160:163], a[152:155], v[152:155]
  v_mfma_f32_16x16x32_bf16 v[156:159], a[164:167], a[152:155], v[156:159]
  v_mfma_f32_16x16x32_bf16 v[160:163], a[168:171], a[152:155], v[160:163]
  v_mfma_f32_16x16x32_bf16 v[164:167], a[172:175], a[152:155], v[164:167]
  v_mfma_f32_16x16x32_bf16 v[168:171], a[176:179], a[152:155], v[168:171]
  v_mfma_f32_16x16x32_bf16 v[172:175], a[160:163], a[156:159], v[172:175]
  v_mfma_f32_16x16x32_bf16 v[176:179], a[164:167], a[156:159], v[176:179]
  v_mfma_f32_16x16x32_bf16 v[180:183], a[168:171], a[156:159], v[180:183]
  v_mfma_f32_16x16x32_bf16 v[184:187], a[172:175], a[156:159], v[184:187]
  v_mfma_f32_16x16x32_bf16 v[188:191], a[176:179], a[156:159], v[188:191]
  v_mfma_f32_16x16x32_bf16 v[112:115], a[160:163], a[144:147], v[112:115]
  v_mfma_f32_16x16x32_bf16 v[116:119], a[164:167], a[144:147], v[116:119]
  v_mfma_f32_16x16x32_bf16 v[120:123], a[168:171], a[144:147], v[120:123]
  v_mfma_f32_16x16x32_bf16 v[124:127], a[172:175], a[144:147], v[124:127]
  v_mfma_f32_16x16x32_bf16 v[128:131], a[176:179], a[144:147], v[128:131]
  ds_write_b128 v17, v[132:135] offset:0
  ds_write_b128 v17, v[136:139] offset:1024
  ds_write_b128 v17, v[140:143] offset:2048
  ds_write_b128 v17, v[144:147] offset:3072
  ds_write_b128 v17, v[148:151] offset:4096
  ds_write_b128 v18, v[152:155] offset:0
  ds_write_b128 v18, v[156:159] offset:1024
  ds_write_b128 v18, v[160:163] offset:2048
  ds_write_b128 v18, v[164:167] offset:3072
  ds_write_b128 v18, v[168:171] offset:4096
  ds_write_b128 v19, v[172:175] offset:0
  ds_write_b128 v19, v[176:179] offset:1024
  ds_write_b128 v19, v[180:183] offset:2048
  ds_write_b128 v19, v[184:187] offset:3072
  ds_write_b128 v19, v[188:191] offset:4096
  s_waitcnt vmcnt(0)
  v_cmp_ne_u64 vcc, s[0:1], v[248:249]
  s_nop 1
  s_cbranch_vccnz LO_s4
LO_s4_ret:
  buffer_load_dwordx4 v[52:55], v252, s[40:43], s59 offen sc1
  buffer_load_dwordx4 v[56:59], v252, s[40:43], s59 offen offset:1024 sc1
  buffer_load_dwordx2 v[60:61], v21, s[40:43], s59 offen offset:2048 sc1
  s_add_u32 s59, s59, 10240
  buffer_load_dwordx4 v[64:67], v252, s[40:43], s59 offen sc1
  buffer_load_dwordx4 v[68:71], v252, s[40:43], s59 offen offset:1024 sc1
  buffer_load_dwordx2 v[72:73], v21, s[40:43], s59 offen offset:2048 sc1
  s_add_u32 s59, s59, 10240
  buffer_load_dwordx4 v[76:79], v252, s[40:43], s59 offen sc1
  buffer_load_dwordx4 v[80:83], v252, s[40:43], s59 offen offset:1024 sc1
  buffer_load_dwordx2 v[84:85], v21, s[40:43], s59 offen offset:2048 sc1
  s_waitcnt lgkmcnt(0)
  s_barrier
  ds_read_b128 v[132:135], v16 offset:0
  ds_read_b128 v[152:155], v16 offset:5120
  ds_read_b128 v[172:175], v16 offset:10240
  ds_read_b128 v[136:139], v16 offset:1024
  ds_read_b128 v[156:159], v16 offset:6144
  ds_read_b128 v[176:179], v16 offset:11264
  ds_read_b128 v[140:143], v16 offset:2048
  ds_read_b128 v[160:163], v16 offset:7168
  ds_read_b128 v[180:183], v16 offset:12288
  ds_read_b128 v[144:147], v16 offset:3072
  ds_read_b128 v[164:167], v16 offset:8192
  ds_read_b128 v[184:187], v16 offset:13312
  ds_read_b128 v[148:151], v16 offset:4096
  ds_read_b128 v[168:171], v16 offset:9216
  ds_read_b128 v[188:191], v16 offset:14336
  s_waitcnt lgkmcnt(0)
  v_pk_add_f32 v[112:113], v[112:113], v[132:133]
  v_pk_add_f32 v[152:153], v[152:153], v[172:173]
  v_pk_add_f32 v[114:115], v[114:115], v[134:135]
  v_pk_add_f32 v[154:155], v[154:155], v[174:175]
  v_pk_add_f32 v[112:113], v[112:113], v[152:153]
  v_pk_add_f32 v[114:115], v[114:115], v[154:155]
  v_cvt_pk_bf16_f32 v112, v112, v113
  v_cvt_pk_bf16_f32 v113, v114, v115
  v_pk_add_f32 v[116:117], v[116:117], v[136:137]
  v_pk_add_f32 v[156:157], v[156:157], v[176:177]
  v_pk_add_f32 v[118:119], v[118:119], v[138:139]
  v_pk_add_f32 v[158:159], v[158:159], v[178:179]
  v_pk_add_f32 v[116:117], v[116:117], v[156:157]
  v_pk_add_f32 v[118:119], v[118:119], v[158:159]
  v_cvt_pk_bf16_f32 v116, v116, v117
  v_cvt_pk_bf16_f32 v117, v118, v119
  v_pk_add_f32 v[120:121], v[120:121], v[140:141]
  v_pk_add_f32 v[160:161], v[160:161], v[180:181]
  v_pk_add_f32 v[122:123], v[122:123], v[142:143]
  v_pk_add_f32 v[162:163], v[162:163], v[182:183]
  v_pk_add_f32 v[120:121], v[120:121], v[160:161]
  v_pk_add_f32 v[122:123], v[122:123], v[162:163]
  v_cvt_pk_bf16_f32 v120, v120, v121
  v_cvt_pk_bf16_f32 v121, v122, v123
  v_pk_add_f32 v[124:125], v[124:125], v[144:145]
  v_pk_add_f32 v[164:165], v[164:165], v[184:185]
  v_pk_add_f32 v[126:127], v[126:127], v[146:147]
  v_pk_add_f32 v[166:167], v[166:167], v[186:187]
  v_pk_add_f32 v[124:125], v[124:125], v[164:165]
  v_pk_add_f32 v[126:127], v[126:127], v[166:167]
  v_cvt_pk_bf16_f32 v124, v124, v125
  v_cvt_pk_bf16_f32 v125, v126, v127
  v_pk_add_f32 v[128:129], v[128:129], v[148:149]
  v_pk_add_f32 v[168:169], v[168:169], v[188:189]
  v_pk_add_f32 v[130:131], v[130:131], v[150:151]
  v_pk_add_f32 v[170:171], v[170:171], v[190:191]
  v_pk_add_f32 v[128:129], v[128:129], v[168:169]
  v_pk_add_f32 v[130:131], v[130:131], v[170:171]
  v_cvt_pk_bf16_f32 v128, v128, v129
  v_cvt_pk_bf16_f32 v129, v130, v131
  v_mov_b32 v114, v116
  v_mov_b32 v115, v117
  s_nop 1
  v_permlane16_swap_b32 v112, v114
  v_permlane16_swap_b32 v113, v115
  buffer_store_dwordx4 v[112:115], v23, s[44:47], 0 offen offset:1280
  v_mov_b32 v122, v124
  v_mov_b32 v123, v125
  s_nop 1
  v_permlane16_swap_b32 v120, v122
  v_permlane16_swap_b32 v121, v123
  buffer_store_dwordx4 v[120:123], v23, s[44:47], 0 offen offset:1344
  buffer_store_dwordx2 v[128:129], v20, s[44:47], 0 offen offset:1408
  s_waitcnt vmcnt(9)
  v_lshlrev_b32 v90, 16, v52
  v_and_b32 v91, 0xffff0000, v52
  v_lshlrev_b32 v92, 16, v53
  v_and_b32 v93, 0xffff0000, v53
  v_lshlrev_b32 v94, 16, v54
  v_and_b32 v95, 0xffff0000, v54
  v_lshlrev_b32 v96, 16, v55
  v_and_b32 v97, 0xffff0000, v55
  v_lshlrev_b32 v98, 16, v56
  v_and_b32 v99, 0xffff0000, v56
  v_lshlrev_b32 v100, 16, v57
  v_and_b32 v101, 0xffff0000, v57
  v_lshlrev_b32 v102, 16, v58
  v_and_b32 v103, 0xffff0000, v58
  v_lshlrev_b32 v104, 16, v59
  v_and_b32 v105, 0xffff0000, v59
  v_lshlrev_b32 v106, 16, v60
  v_and_b32 v107, 0xffff0000, v60
  v_lshlrev_b32 v108, 16, v61
  v_and_b32 v109, 0xffff0000, v61
  v_pk_add_f32 v[32:33], v[32:33], v[90:91]
  v_pk_add_f32 v[34:35], v[34:35], v[92:93]
  v_pk_add_f32 v[36:37], v[36:37], v[94:95]
  v_pk_add_f32 v[38:39], v[38:39], v[96:97]
  v_pk_add_f32 v[40:41], v[40:41], v[98:99]
  v_pk_add_f32 v[42:43], v[42:43], v[100:101]
  v_pk_add_f32 v[44:45], v[44:45], v[102:103]
  v_pk_add_f32 v[46:47], v[46:47], v[104:105]
  v_pk_add_f32 v[48:49], v[48:49], v[106:107]
  v_pk_add_f32 v[50:51], v[50:51], v[108:109]
  s_waitcnt vmcnt(6)
  v_lshlrev_b32 v90, 16, v64
  v_and_b32 v91, 0xffff0000, v64
  v_lshlrev_b32 v92, 16, v65
  v_and_b32 v93, 0xffff0000, v65
  v_lshlrev_b32 v94, 16, v66
  v_and_b32 v95, 0xffff0000, v66
  v_lshlrev_b32 v96, 16, v67
  v_and_b32 v97, 0xffff0000, v67
  v_lshlrev_b32 v98, 16, v68
  v_and_b32 v99, 0xffff0000, v68
  v_lshlrev_b32 v100, 16, v69
  v_and_b32 v101, 0xffff0000, v69
  v_lshlrev_b32 v102, 16, v70
  v_and_b32 v103, 0xffff0000, v70
  v_lshlrev_b32 v104, 16, v71
  v_and_b32 v105, 0xffff0000, v71
  v_lshlrev_b32 v106, 16, v72
  v_and_b32 v107, 0xffff0000, v72
  v_lshlrev_b32 v108, 16, v73
  v_and_b32 v109, 0xffff0000, v73
  v_pk_add_f32 v[32:33], v[32:33], v[90:91]
  v_pk_add_f32 v[34:35], v[34:35], v[92:93]
  v_pk_add_f32 v[36:37], v[36:37], v[94:95]
  v_pk_add_f32 v[38:39], v[38:39], v[96:97]
  v_pk_add_f32 v[40:41], v[40:41], v[98:99]
  v_pk_add_f32 v[42:43], v[42:43], v[100:101]
  v_pk_add_f32 v[44:45], v[44:45], v[102:103]
  v_pk_add_f32 v[46:47], v[46:47], v[104:105]
  v_pk_add_f32 v[48:49], v[48:49], v[106:107]
  v_pk_add_f32 v[50:51], v[50:51], v[108:109]
  s_waitcnt vmcnt(3)
  v_lshlrev_b32 v90, 16, v76
  v_and_b32 v91, 0xffff0000, v76
  v_lshlrev_b32 v92, 16, v77
  v_and_b32 v93, 0xffff0000, v77
  v_lshlrev_b32 v94, 16, v78
  v_and_b32 v95, 0xffff0000, v78
  v_lshlrev_b32 v96, 16, v79
  v_and_b32 v97, 0xffff0000, v79
  v_lshlrev_b32 v98, 16, v80
  v_and_b32 v99, 0xffff0000, v80
  v_lshlrev_b32 v100, 16, v81
  v_and_b32 v101, 0xffff0000, v81
  v_lshlrev_b32 v102, 16, v82
  v_and_b32 v103, 0xffff0000, v82
  v_lshlrev_b32 v104, 16, v83
  v_and_b32 v105, 0xffff0000, v83
  v_lshlrev_b32 v106, 16, v84
  v_and_b32 v107, 0xffff0000, v84
  v_lshlrev_b32 v108, 16, v85
  v_and_b32 v109, 0xffff0000, v85
  v_pk_add_f32 v[32:33], v[32:33], v[90:91]
  v_pk_add_f32 v[34:35], v[34:35], v[92:93]
  v_pk_add_f32 v[36:37], v[36:37], v[94:95]
  v_pk_add_f32 v[38:39], v[38:39], v[96:97]
  v_pk_add_f32 v[40:41], v[40:41], v[98:99]
  v_pk_add_f32 v[42:43], v[42:43], v[100:101]
  v_pk_add_f32 v[44:45], v[44:45], v[102:103]
  v_pk_add_f32 v[46:47], v[46:47], v[104:105]
  v_pk_add_f32 v[48:49], v[48:49], v[106:107]
  v_pk_add_f32 v[50:51], v[50:51], v[108:109]
  v_cvt_pk_bf16_f32 v32, v32, v33
  v_cvt_pk_bf16_f32 v33, v34, v35
  v_cvt_pk_bf16_f32 v36, v36, v37
  v_cvt_pk_bf16_f32 v37, v38, v39
  v_cvt_pk_bf16_f32 v40, v40, v41
  v_cvt_pk_bf16_f32 v41, v42, v43
  v_cvt_pk_bf16_f32 v44, v44, v45
  v_cvt_pk_bf16_f32 v45, v46, v47
  v_cvt_pk_bf16_f32 v48, v48, v49
  v_cvt_pk_bf16_f32 v49, v50, v51
  v_mov_b32 v34, v36
  v_mov_b32 v35, v37
  s_nop 1
  v_permlane16_swap_b32 v32, v34
  v_permlane16_swap_b32 v33, v35
  buffer_store_dwordx4 v[32:35], v24, s[44:47], 0 offen offset:0
  v_mov_b32 v42, v44
  v_mov_b32 v43, v45
  s_nop 1
  v_permlane16_swap_b32 v40, v42
  v_permlane16_swap_b32 v41, v43
  buffer_store_dwordx4 v[40:43], v24, s[44:47], 0 offen offset:64
  buffer_store_dwordx2 v[48:49], v253, s[44:47], 0 offen offset:128
L_end:
  s_endpgm
LA_ws:
  s_mov_b32 s54, 0x10000
LA_ws_l:
  s_sleep 2
  buffer_load_dwordx2 v[10:11], v13, s[40:43], s39 offen sc1
  s_sub_u32 s54, s54, 1
  s_cmp_eq_u32 s54, 0
  s_waitcnt vmcnt(0)
  s_cbranch_scc1 LA_ws_ret
  v_cmp_ne_u64 vcc, s[0:1], v[10:11]
  s_nop 1
  s_cbranch_vccnz LA_ws_l
  s_branch LA_ws_ret
LA_slowA:
  s_mov_b32 s37, s50
  s_waitcnt vmcnt(0) lgkmcnt(0)
  s_mul_i32 s38, s29, 1048576
  s_mov_b32 s36, 0
  s_nop 7
  v_mov_b32 v240, v255
  v_mov_b32 v241, v255
  v_mov_b32 v16, 0
  v_mov_b32 v17, 0
  v_mov_b32 v18, 0
  v_mov_b32 v19, 0
  v_mov_b32 v20, 0
  v_mov_b32 v21, 0
  v_mov_b32 v22, 0
  v_mov_b32 v23, 0
  v_mov_b32 v24, 0
  v_mov_b32 v25, 0
  v_mov_b32 v26, 0
  v_mov_b32 v27, 0
  v_mov_b32 v28, 0
  v_mov_b32 v29, 0
  v_mov_b32 v30, 0
  v_mov_b32 v31, 0
  v_mov_b32 v32, 0
  v_mov_b32 v33, 0
  v_mov_b32 v34, 0
  v_mov_b32 v35, 0
  v_mov_b32 v36, 0
  v_mov_b32 v37, 0
  v_mov_b32 v38, 0
  v_mov_b32 v39, 0
  v_mov_b32 v40, 0
  v_mov_b32 v41, 0
  v_mov_b32 v42, 0
  v_mov_b32 v43, 0
  v_mov_b32 v44, 0
  v_mov_b32 v45, 0
  v_mov_b32 v46, 0
  v_mov_b32 v47, 0
  v_mov_b32 v48, 0
  v_mov_b32 v49, 0
  v_mov_b32 v50, 0
  v_mov_b32 v51, 0
  v_mov_b32 v52, 0
  v_mov_b32 v53, 0
  v_mov_b32 v54, 0
  v_mov_b32 v55, 0
  v_mov_b32 v56, 0
  v_mov_b32 v57, 0
  v_mov_b32 v58, 0
  v_mov_b32 v59, 0
  v_mov_b32 v60, 0
  v_mov_b32 v61, 0
  v_mov_b32 v62, 0
  v_mov_b32 v63, 0
  v_mov_b32 v64, 0
  v_mov_b32 v65, 0
  v_mov_b32 v66, 0
  v_mov_b32 v67, 0
  v_mov_b32 v68, 0
  v_mov_b32 v69, 0
  v_mov_b32 v70, 0
  v_mov_b32 v71, 0
  v_mov_b32 v72, 0
  v_mov_b32 v73, 0
  v_mov_b32 v74, 0
  v_mov_b32 v75, 0
  v_mov_b32 v76, 0
  v_mov_b32 v77, 0
  v_mov_b32 v78, 0
  v_mov_b32 v79, 0
  v_mov_b32 v144, 0
  v_mov_b32 v145, 0
  v_mov_b32 v146, 0
  v_mov_b32 v147, 0
  v_mov_b32 v148, 0
  v_mov_b32 v149, 0
  v_mov_b32 v150, 0
  v_mov_b32 v151, 0
  v_mov_b32 v208, 0
  v_mov_b32 v209, 0
  v_mov_b32 v210, 0
  v_mov_b32 v211, 0
  v_mov_b32 v212, 0
  v_mov_b32 v213, 0
  v_mov_b32 v214, 0
  v_mov_b32 v215, 0
  v_mov_b32 v216, 0
  v_mov_b32 v217, 0
  v_mov_b32 v218, 0
  v_mov_b32 v219, 0
  v_mov_b32 v220, 0
  v_mov_b32 v221, 0
  v_mov_b32 v222, 0
  v_mov_b32 v223, 0
LA_slowA_l:
  s_add_u32 s54, s38, 0
  s_add_u32 s55, s54, 32768
  buffer_load_dwordx4 a[64:67], v4, s[40:43], s54 offen offset:0 sc1
  buffer_load_dwordx4 a[96:99], v4, s[40:43], s55 offen offset:2048 sc1
  buffer_load_dwordx4 a[68:71], v4, s[40:43], s54 offen offset:1024 sc1
  buffer_load_dwordx4 a[100:103], v4, s[40:43], s55 offen offset:3072 sc1
  s_add_u32 s54, s38, 4096
  s_add_u32 s55, s54, 32768
  buffer_load_dwordx4 a[72:75], v4, s[40:43], s54 offen offset:0 sc1
  buffer_load_dwordx4 a[104:107], v4, s[40:43], s55 offen offset:2048 sc1
  buffer_load_dwordx4 a[76:79], v4, s[40:43], s54 offen offset:1024 sc1
  buffer_load_dwordx4 a[108:111], v4, s[40:43], s55 offen offset:3072 sc1
  s_add_u32 s54, s38, 8192
  s_add_u32 s55, s54, 32768
  buffer_load_dwordx4 a[80:83], v4, s[40:43], s54 offen offset:0 sc1
  buffer_load_dwordx4 a[112:115], v4, s[40:43], s55 offen offset:2048 sc1
  buffer_load_dwordx4 a[84:87], v4, s[40:43], s54 offen offset:1024 sc1
  buffer_load_dwordx4 a[116:119], v4, s[40:43], s55 offen offset:3072 sc1
  s_add_u32 s54, s38, 12288
  s_add_u32 s55, s54, 32768
  buffer_load_dwordx4 a[88:91], v4, s[40:43], s54 offen offset:0 sc1
  buffer_load_dwordx4 a[120:123], v4, s[40:43], s55 offen offset:2048 sc1
  buffer_load_dwordx4 a[92:95], v4, s[40:43], s54 offen offset:1024 sc1
  buffer_load_dwordx4 a[124:127], v4, s[40:43], s55 offen offset:3072 sc1
  s_cmp_lg_u32 s36, s37
  s_cbranch_scc1 LA_slowA_nm
  v_mov_b32 v244, 0
  v_cndmask_b32 v208, v244, v255, s[92:93]
  v_cndmask_b32 v220, v244, v255, s[92:93]
  v_mov_b32 v212, v255
  v_cndmask_b32 v209, v244, v255, s[94:95]
  v_cndmask_b32 v221, v244, v255, s[94:95]
  v_mov_b32 v213, v255
  v_cndmask_b32 v210, v244, v255, s[96:97]
  v_cndmask_b32 v222, v244, v255, s[96:97]
  v_mov_b32 v214, v255
  v_cndmask_b32 v211, v244, v255, s[98:99]
  v_cndmask_b32 v223, v244, v255, s[98:99]
  v_mov_b32 v215, v255
LA_slowA_nm:
  s_waitcnt vmcnt(0)
  v_mfma_f32_16x16x32_bf16 v[160:163], a[64:67], a[0:3], v[208:211]
  v_mfma_f32_16x16x32_bf16 v[160:163], a[68:71], a[4:7], v[160:163]
  v_mfma_f32_16x16x32_bf16 v[160:163], a[72:75], a[8:11], v[160:163]
  v_mfma_f32_16x16x32_bf16 v[160:163], a[76:79], a[12:15], v[160:163]
  v_mfma_f32_16x16x32_bf16 v[168:171], a[64:67], a[16:19], v[216:219]
  v_mfma_f32_16x16x32_bf16 v[168:171], a[68:71], a[20:23], v[168:171]
  v_mfma_f32_16x16x32_bf16 v[168:171], a[72:75], a[24:27], v[168:171]
  v_mfma_f32_16x16x32_bf16 v[168:171], a[76:79], a[28:31], v[168:171]
  v_mfma_f32_16x16x32_bf16 v[164:167], a[80:83], a[0:3], v[212:215]
  v_mfma_f32_16x16x32_bf16 v[164:167], a[84:87], a[4:7], v[164:167]
  v_mfma_f32_16x16x32_bf16 v[164:167], a[88:91], a[8:11], v[164:167]
  v_mfma_f32_16x16x32_bf16 v[164:167], a[92:95], a[12:15], v[164:167]
  v_mfma_f32_16x16x32_bf16 v[172:175], a[80:83], a[16:19], v[220:223]
  v_mfma_f32_16x16x32_bf16 v[172:175], a[84:87], a[20:23], v[172:175]
  v_mfma_f32_16x16x32_bf16 v[172:175], a[88:91], a[24:27], v[172:175]
  v_mfma_f32_16x16x32_bf16 v[172:175], a[92:95], a[28:31], v[172:175]
  s_nop 7
  v_max3_f32 v244, v160, v161, v162
  v_max3_f32 v245, v163, v164, v165
  v_max3_f32 v244, v244, v166, v167
  v_max3_f32 v244, v244, v245, v240
  v_mov_b32 v245, v244
  v_max3_f32 v246, v168, v169, v170
  v_max3_f32 v247, v171, v172, v173
  v_max3_f32 v246, v246, v174, v175
  v_max3_f32 v246, v246, v247, v241
  v_mov_b32 v247, v246
  s_nop 1
  v_permlane32_swap_b32 v244, v245
  v_permlane32_swap_b32 v246, v247
  v_max_f32 v244, v244, v245
  v_mov_b32 v245, v244
  v_max_f32 v246, v246, v247
  v_mov_b32 v247, v246
  s_nop 1
  v_permlane16_swap_b32 v244, v245
  v_permlane16_swap_b32 v246, v247
  v_max_f32 v244, v244, v245
  v_mov_b32 v245, v244
  v_max_f32 v246, v246, v247
  v_mov_b32 v247, v246
  v_sub_f32 v248, v240, v244
  v_mov_b32 v240, v244
  v_exp_f32 v248, v248
  v_sub_f32 v160, v160, v240
  v_sub_f32 v161, v161, v240
  v_sub_f32 v162, v162, v240
  v_sub_f32 v163, v163, v240
  v_sub_f32 v164, v164, v240
  v_sub_f32 v165, v165, v240
  v_sub_f32 v166, v166, v240
  v_sub_f32 v167, v167, v240
  v_sub_f32 v250, v241, v246
  v_mov_b32 v241, v246
  v_exp_f32 v250, v250
  v_sub_f32 v168, v168, v241
  v_sub_f32 v169, v169, v241
  v_sub_f32 v170, v170, v241
  v_sub_f32 v171, v171, v241
  v_sub_f32 v172, v172, v241
  v_sub_f32 v173, v173, v241
  v_sub_f32 v174, v174, v241
  v_sub_f32 v175, v175, v241
  v_exp_f32 v160, v160
  v_exp_f32 v161, v161
  v_exp_f32 v162, v162
  v_exp_f32 v163, v163
  v_exp_f32 v168, v168
  v_exp_f32 v169, v169
  v_exp_f32 v170, v170
  v_exp_f32 v171, v171
  v_exp_f32 v164, v164
  v_exp_f32 v165, v165
  v_exp_f32 v166, v166
  v_exp_f32 v167, v167
  v_exp_f32 v172, v172
  v_exp_f32 v173, v173
  v_exp_f32 v174, v174
  v_exp_f32 v175, v175
  v_cvt_pk_bf16_f32 v192, v160, v161
  v_cvt_pk_bf16_f32 v193, v162, v163
  v_cvt_pk_bf16_f32 v196, v168, v169
  v_cvt_pk_bf16_f32 v197, v170, v171
  v_cvt_pk_bf16_f32 v194, v164, v165
  v_cvt_pk_bf16_f32 v195, v166, v167
  v_cvt_pk_bf16_f32 v198, v172, v173
  v_cvt_pk_bf16_f32 v199, v174, v175
  v_mul_f32 v16, v16, v248
  v_mul_f32 v17, v17, v248
  v_mul_f32 v18, v18, v248
  v_mul_f32 v19, v19, v248
  v_mul_f32 v20, v20, v248
  v_mul_f32 v21, v21, v248
  v_mul_f32 v22, v22, v248
  v_mul_f32 v23, v23, v248
  v_mul_f32 v24, v24, v248
  v_mul_f32 v25, v25, v248
  v_mul_f32 v26, v26, v248
  v_mul_f32 v27, v27, v248
  v_mul_f32 v28, v28, v248
  v_mul_f32 v29, v29, v248
  v_mul_f32 v30, v30, v248
  v_mul_f32 v31, v31, v248
  v_mul_f32 v32, v32, v248
  v_mul_f32 v33, v33, v248
  v_mul_f32 v34, v34, v248
  v_mul_f32 v35, v35, v248
  v_mul_f32 v36, v36, v248
  v_mul_f32 v37, v37, v248
  v_mul_f32 v38, v38, v248
  v_mul_f32 v39, v39, v248
  v_mul_f32 v40, v40, v248
  v_mul_f32 v41, v41, v248
  v_mul_f32 v42, v42, v248
  v_mul_f32 v43, v43, v248
  v_mul_f32 v44, v44, v248
  v_mul_f32 v45, v45, v248
  v_mul_f32 v46, v46, v248
  v_mul_f32 v47, v47, v248
  v_mul_f32 v144, v144, v248
  v_mul_f32 v145, v145, v248
  v_mul_f32 v146, v146, v248
  v_mul_f32 v147, v147, v248
  v_mul_f32 v48, v48, v250
  v_mul_f32 v49, v49, v250
  v_mul_f32 v50, v50, v250
  v_mul_f32 v51, v51, v250
  v_mul_f32 v52, v52, v250
  v_mul_f32 v53, v53, v250
  v_mul_f32 v54, v54, v250
  v_mul_f32 v55, v55, v250
  v_mul_f32 v56, v56, v250
  v_mul_f32 v57, v57, v250
  v_mul_f32 v58, v58, v250
  v_mul_f32 v59, v59, v250
  v_mul_f32 v60, v60, v250
  v_mul_f32 v61, v61, v250
  v_mul_f32 v62, v62, v250
  v_mul_f32 v63, v63, v250
  v_mul_f32 v64, v64, v250
  v_mul_f32 v65, v65, v250
  v_mul_f32 v66, v66, v250
  v_mul_f32 v67, v67, v250
  v_mul_f32 v68, v68, v250
  v_mul_f32 v69, v69, v250
  v_mul_f32 v70, v70, v250
  v_mul_f32 v71, v71, v250
  v_mul_f32 v72, v72, v250
  v_mul_f32 v73, v73, v250
  v_mul_f32 v74, v74, v250
  v_mul_f32 v75, v75, v250
  v_mul_f32 v76, v76, v250
  v_mul_f32 v77, v77, v250
  v_mul_f32 v78, v78, v250
  v_mul_f32 v79, v79, v250
  v_mul_f32 v148, v148, v250
  v_mul_f32 v149, v149, v250
  v_mul_f32 v150, v150, v250
  v_mul_f32 v151, v151, v250
  s_nop 1
  v_mfma_f32_16x16x32_bf16 v[16:19], a[96:99], v[192:195], v[16:19]
  v_mfma_f32_16x16x32_bf16 v[48:51], a[96:99], v[196:199], v[48:51]
  v_mfma_f32_16x16x32_bf16 v[20:23], a[100:103], v[192:195], v[20:23]
  v_mfma_f32_16x16x32_bf16 v[52:55], a[100:103], v[196:199], v[52:55]
  v_mfma_f32_16x16x32_bf16 v[24:27], a[104:107], v[192:195], v[24:27]
  v_mfma_f32_16x16x32_bf16 v[56:59], a[104:107], v[196:199], v[56:59]
  v_mfma_f32_16x16x32_bf16 v[28:31], a[108:111], v[192:195], v[28:31]
  v_mfma_f32_16x16x32_bf16 v[60:63], a[108:111], v[196:199], v[60:63]
  v_mfma_f32_16x16x32_bf16 v[32:35], a[112:115], v[192:195], v[32:35]
  v_mfma_f32_16x16x32_bf16 v[64:67], a[112:115], v[196:199], v[64:67]
  v_mfma_f32_16x16x32_bf16 v[36:39], a[116:119], v[192:195], v[36:39]
  v_mfma_f32_16x16x32_bf16 v[68:71], a[116:119], v[196:199], v[68:71]
  v_mfma_f32_16x16x32_bf16 v[40:43], a[120:123], v[192:195], v[40:43]
  v_mfma_f32_16x16x32_bf16 v[72:75], a[120:123], v[196:199], v[72:75]
  v_mfma_f32_16x16x32_bf16 v[44:47], a[124:127], v[192:195], v[44:47]
  v_mfma_f32_16x16x32_bf16 v[76:79], a[124:127], v[196:199], v[76:79]
  v_mfma_f32_16x16x32_bf16 v[144:147], a[128:131], v[192:195], v[144:147]
  v_mfma_f32_16x16x32_bf16 v[148:151], a[128:131], v[196:199], v[148:151]
  s_add_u32 s38, s38, 16384
  s_add_u32 s36, s36, 1
  s_cmp_le_u32 s36, s37
  s_nop 7
  s_cbranch_scc1 LA_slowA_l
  s_lshl_b32 s54, s29, 12
  s_add_u32 s54, s54, 41943040
  s_mul_i32 s55, s50, 264192
  s_add_u32 s54, s54, s55
  v_rcp_f32 v248, v144
  v_rcp_f32 v250, v148
  v_mov_b32 v249, v248
  v_mov_b32 v251, v250
  v_pk_mul_f32 v[16:17], v[16:17], v[248:249]
  v_pk_mul_f32 v[18:19], v[18:19], v[248:249]
  v_pk_mul_f32 v[20:21], v[20:21], v[248:249]
  v_pk_mul_f32 v[22:23], v[22:23], v[248:249]
  v_cvt_pk_bf16_f32 v16, v16, v17
  v_cvt_pk_bf16_f32 v17, v18, v19
  v_cvt_pk_bf16_f32 v18, v20, v21
  v_cvt_pk_bf16_f32 v19, v22, v23
  buffer_store_dwordx4 v[16:19], v4, s[40:43], s54 offen offset:0 sc1
  v_pk_mul_f32 v[24:25], v[24:25], v[248:249]
  v_pk_mul_f32 v[26:27], v[26:27], v[248:249]
  v_pk_mul_f32 v[28:29], v[28:29], v[248:249]
  v_pk_mul_f32 v[30:31], v[30:31], v[248:249]
  v_cvt_pk_bf16_f32 v20, v24, v25
  v_cvt_pk_bf16_f32 v21, v26, v27
  v_cvt_pk_bf16_f32 v22, v28, v29
  v_cvt_pk_bf16_f32 v23, v30, v31
  buffer_store_dwordx4 v[20:23], v4, s[40:43], s54 offen offset:1024 sc1
  v_pk_mul_f32 v[32:33], v[32:33], v[248:249]
  v_pk_mul_f32 v[34:35], v[34:35], v[248:249]
  v_pk_mul_f32 v[36:37], v[36:37], v[248:249]
  v_pk_mul_f32 v[38:39], v[38:39], v[248:249]
  v_cvt_pk_bf16_f32 v24, v32, v33
  v_cvt_pk_bf16_f32 v25, v34, v35
  v_cvt_pk_bf16_f32 v26, v36, v37
  v_cvt_pk_bf16_f32 v27, v38, v39
  buffer_store_dwordx4 v[24:27], v4, s[40:43], s54 offen offset:2048 sc1
  v_pk_mul_f32 v[40:41], v[40:41], v[248:249]
  v_pk_mul_f32 v[42:43], v[42:43], v[248:249]
  v_pk_mul_f32 v[44:45], v[44:45], v[248:249]
  v_pk_mul_f32 v[46:47], v[46:47], v[248:249]
  v_cvt_pk_bf16_f32 v28, v40, v41
  v_cvt_pk_bf16_f32 v29, v42, v43
  v_cvt_pk_bf16_f32 v30, v44, v45
  v_cvt_pk_bf16_f32 v31, v46, v47
  buffer_store_dwordx4 v[28:31], v4, s[40:43], s54 offen offset:3072 sc1
  s_add_u32 s54, s54, 132096
  v_pk_mul_f32 v[48:49], v[48:49], v[250:251]
  v_pk_mul_f32 v[50:51], v[50:51], v[250:251]
  v_pk_mul_f32 v[52:53], v[52:53], v[250:251]
  v_pk_mul_f32 v[54:55], v[54:55], v[250:251]
  v_cvt_pk_bf16_f32 v32, v48, v49
  v_cvt_pk_bf16_f32 v33, v50, v51
  v_cvt_pk_bf16_f32 v34, v52, v53
  v_cvt_pk_bf16_f32 v35, v54, v55
  buffer_store_dwordx4 v[32:35], v4, s[40:43], s54 offen offset:0 sc1
  v_pk_mul_f32 v[56:57], v[56:57], v[250:251]
  v_pk_mul_f32 v[58:59], v[58:59], v[250:251]
  v_pk_mul_f32 v[60:61], v[60:61], v[250:251]
  v_pk_mul_f32 v[62:63], v[62:63], v[250:251]
  v_cvt_pk_bf16_f32 v36, v56, v57
  v_cvt_pk_bf16_f32 v37, v58, v59
  v_cvt_pk_bf16_f32 v38, v60, v61
  v_cvt_pk_bf16_f32 v39, v62, v63
  buffer_store_dwordx4 v[36:39], v4, s[40:43], s54 offen offset:1024 sc1
  v_pk_mul_f32 v[64:65], v[64:65], v[250:251]
  v_pk_mul_f32 v[66:67], v[66:67], v[250:251]
  v_pk_mul_f32 v[68:69], v[68:69], v[250:251]
  v_pk_mul_f32 v[70:71], v[70:71], v[250:251]
  v_cvt_pk_bf16_f32 v40, v64, v65
  v_cvt_pk_bf16_f32 v41, v66, v67
  v_cvt_pk_bf16_f32 v42, v68, v69
  v_cvt_pk_bf16_f32 v43, v70, v71
  buffer_store_dwordx4 v[40:43], v4, s[40:43], s54 offen offset:2048 sc1
  v_pk_mul_f32 v[72:73], v[72:73], v[250:251]
  v_pk_mul_f32 v[74:75], v[74:75], v[250:251]
  v_pk_mul_f32 v[76:77], v[76:77], v[250:251]
  v_pk_mul_f32 v[78:79], v[78:79], v[250:251]
  v_cvt_pk_bf16_f32 v44, v72, v73
  v_cvt_pk_bf16_f32 v45, v74, v75
  v_cvt_pk_bf16_f32 v46, v76, v77
  v_cvt_pk_bf16_f32 v47, v78, v79
  buffer_store_dwordx4 v[44:47], v4, s[40:43], s54 offen offset:3072 sc1
  s_branch LA_slowA_ret
LA_slowB:
  s_sub_u32 s37, 63, s50
  s_waitcnt vmcnt(0) lgkmcnt(0)
  s_mul_i32 s38, s29, 1048576
  s_mov_b32 s36, 0
  s_nop 7
  v_mov_b32 v240, v255
  v_mov_b32 v241, v255
  v_mov_b32 v80, 0
  v_mov_b32 v81, 0
  v_mov_b32 v82, 0
  v_mov_b32 v83, 0
  v_mov_b32 v84, 0
  v_mov_b32 v85, 0
  v_mov_b32 v86, 0
  v_mov_b32 v87, 0
  v_mov_b32 v88, 0
  v_mov_b32 v89, 0
  v_mov_b32 v90, 0
  v_mov_b32 v91, 0
  v_mov_b32 v92, 0
  v_mov_b32 v93, 0
  v_mov_b32 v94, 0
  v_mov_b32 v95, 0
  v_mov_b32 v96, 0
  v_mov_b32 v97, 0
  v_mov_b32 v98, 0
  v_mov_b32 v99, 0
  v_mov_b32 v100, 0
  v_mov_b32 v101, 0
  v_mov_b32 v102, 0
  v_mov_b32 v103, 0
  v_mov_b32 v104, 0
  v_mov_b32 v105, 0
  v_mov_b32 v106, 0
  v_mov_b32 v107, 0
  v_mov_b32 v108, 0
  v_mov_b32 v109, 0
  v_mov_b32 v110, 0
  v_mov_b32 v111, 0
  v_mov_b32 v112, 0
  v_mov_b32 v113, 0
  v_mov_b32 v114, 0
  v_mov_b32 v115, 0
  v_mov_b32 v116, 0
  v_mov_b32 v117, 0
  v_mov_b32 v118, 0
  v_mov_b32 v119, 0
  v_mov_b32 v120, 0
  v_mov_b32 v121, 0
  v_mov_b32 v122, 0
  v_mov_b32 v123, 0
  v_mov_b32 v124, 0
  v_mov_b32 v125, 0
  v_mov_b32 v126, 0
  v_mov_b32 v127, 0
  v_mov_b32 v128, 0
  v_mov_b32 v129, 0
  v_mov_b32 v130, 0
  v_mov_b32 v131, 0
  v_mov_b32 v132, 0
  v_mov_b32 v133, 0
  v_mov_b32 v134, 0
  v_mov_b32 v135, 0
  v_mov_b32 v136, 0
  v_mov_b32 v137, 0
  v_mov_b32 v138, 0
  v_mov_b32 v139, 0
  v_mov_b32 v140, 0
  v_mov_b32 v141, 0
  v_mov_b32 v142, 0
  v_mov_b32 v143, 0
  v_mov_b32 v152, 0
  v_mov_b32 v153, 0
  v_mov_b32 v154, 0
  v_mov_b32 v155, 0
  v_mov_b32 v156, 0
  v_mov_b32 v157, 0
  v_mov_b32 v158, 0
  v_mov_b32 v159, 0
  v_mov_b32 v208, 0
  v_mov_b32 v209, 0
  v_mov_b32 v210, 0
  v_mov_b32 v211, 0
  v_mov_b32 v212, 0
  v_mov_b32 v213, 0
  v_mov_b32 v214, 0
  v_mov_b32 v215, 0
  v_mov_b32 v216, 0
  v_mov_b32 v217, 0
  v_mov_b32 v218, 0
  v_mov_b32 v219, 0
  v_mov_b32 v220, 0
  v_mov_b32 v221, 0
  v_mov_b32 v222, 0
  v_mov_b32 v223, 0
LA_slowB_l:
  s_add_u32 s54, s38, 0
  s_add_u32 s55, s54, 32768
  buffer_load_dwordx4 a[64:67], v4, s[40:43], s54 offen offset:0 sc1
  buffer_load_dwordx4 a[96:99], v4, s[40:43], s55 offen offset:2048 sc1
  buffer_load_dwordx4 a[68:71], v4, s[40:43], s54 offen offset:1024 sc1
  buffer_load_dwordx4 a[100:103], v4, s[40:43], s55 offen offset:3072 sc1
  s_add_u32 s54, s38, 4096
  s_add_u32 s55, s54, 32768
  buffer_load_dwordx4 a[72:75], v4, s[40:43], s54 offen offset:0 sc1
  buffer_load_dwordx4 a[104:107], v4, s[40:43], s55 offen offset:2048 sc1
  buffer_load_dwordx4 a[76:79], v4, s[40:43], s54 offen offset:1024 sc1
  buffer_load_dwordx4 a[108:111], v4, s[40:43], s55 offen offset:3072 sc1
  s_add_u32 s54, s38, 8192
  s_add_u32 s55, s54, 32768
  buffer_load_dwordx4 a[80:83], v4, s[40:43], s54 offen offset:0 sc1
  buffer_load_dwordx4 a[112:115], v4, s[40:43], s55 offen offset:2048 sc1
  buffer_load_dwordx4 a[84:87], v4, s[40:43], s54 offen offset:1024 sc1
  buffer_load_dwordx4 a[116:119], v4, s[40:43], s55 offen offset:3072 sc1
  s_add_u32 s54, s38, 12288
  s_add_u32 s55, s54, 32768
  buffer_load_dwordx4 a[88:91], v4, s[40:43], s54 offen offset:0 sc1
  buffer_load_dwordx4 a[120:123], v4, s[40:43], s55 offen offset:2048 sc1
  buffer_load_dwordx4 a[92:95], v4, s[40:43], s54 offen offset:1024 sc1
  buffer_load_dwordx4 a[124:127], v4, s[40:43], s55 offen offset:3072 sc1
  s_cmp_lg_u32 s36, s37
  s_cbranch_scc1 LA_slowB_nm
  v_mov_b32 v244, 0
  v_cndmask_b32 v208, v244, v255, s[92:93]
  v_cndmask_b32 v220, v244, v255, s[92:93]
  v_mov_b32 v212, v255
  v_cndmask_b32 v209, v244, v255, s[94:95]
  v_cndmask_b32 v221, v244, v255, s[94:95]
  v_mov_b32 v213, v255
  v_cndmask_b32 v210, v244, v255, s[96:97]
  v_cndmask_b32 v222, v244, v255, s[96:97]
  v_mov_b32 v214, v255
  v_cndmask_b32 v211, v244, v255, s[98:99]
  v_cndmask_b32 v223, v244, v255, s[98:99]
  v_mov_b32 v215, v255
LA_slowB_nm:
  s_waitcnt vmcnt(0)
  v_mfma_f32_16x16x32_bf16 v[160:163], a[64:67], a[32:35], v[208:211]
  v_mfma_f32_16x16x32_bf16 v[160:163], a[68:71], a[36:39], v[160:163]
  v_mfma_f32_16x16x32_bf16 v[160:163], a[72:75], a[40:43], v[160:163]
  v_mfma_f32_16x16x32_bf16 v[160:163], a[76:79], a[44:47], v[160:163]
  v_mfma_f32_16x16x32_bf16 v[168:171], a[64:67], a[48:51], v[216:219]
  v_mfma_f32_16x16x32_bf16 v[168:171], a[68:71], a[52:55], v[168:171]
  v_mfma_f32_16x16x32_bf16 v[168:171], a[72:75], a[56:59], v[168:171]
  v_mfma_f32_16x16x32_bf16 v[168:171], a[76:79], a[60:63], v[168:171]
  v_mfma_f32_16x16x32_bf16 v[164:167], a[80:83], a[32:35], v[212:215]
  v_mfma_f32_16x16x32_bf16 v[164:167], a[84:87], a[36:39], v[164:167]
  v_mfma_f32_16x16x32_bf16 v[164:167], a[88:91], a[40:43], v[164:167]
  v_mfma_f32_16x16x32_bf16 v[164:167], a[92:95], a[44:47], v[164:167]
  v_mfma_f32_16x16x32_bf16 v[172:175], a[80:83], a[48:51], v[220:223]
  v_mfma_f32_16x16x32_bf16 v[172:175], a[84:87], a[52:55], v[172:175]
  v_mfma_f32_16x16x32_bf16 v[172:175], a[88:91], a[56:59], v[172:175]
  v_mfma_f32_16x16x32_bf16 v[172:175], a[92:95], a[60:63], v[172:175]
  s_nop 7
  v_max3_f32 v244, v160, v161, v162
  v_max3_f32 v245, v163, v164, v165
  v_max3_f32 v244, v244, v166, v167
  v_max3_f32 v244, v244, v245, v240
  v_mov_b32 v245, v244
  v_max3_f32 v246, v168, v169, v170
  v_max3_f32 v247, v171, v172, v173
  v_max3_f32 v246, v246, v174, v175
  v_max3_f32 v246, v246, v247, v241
  v_mov_b32 v247, v246
  s_nop 1
  v_permlane32_swap_b32 v244, v245
  v_permlane32_swap_b32 v246, v247
  v_max_f32 v244, v244, v245
  v_mov_b32 v245, v244
  v_max_f32 v246, v246, v247
  v_mov_b32 v247, v246
  s_nop 1
  v_permlane16_swap_b32 v244, v245
  v_permlane16_swap_b32 v246, v247
  v_max_f32 v244, v244, v245
  v_mov_b32 v245, v244
  v_max_f32 v246, v246, v247
  v_mov_b32 v247, v246
  v_sub_f32 v248, v240, v244
  v_mov_b32 v240, v244
  v_exp_f32 v248, v248
  v_sub_f32 v160, v160, v240
  v_sub_f32 v161, v161, v240
  v_sub_f32 v162, v162, v240
  v_sub_f32 v163, v163, v240
  v_sub_f32 v164, v164, v240
  v_sub_f32 v165, v165, v240
  v_sub_f32 v166, v166, v240
  v_sub_f32 v167, v167, v240
  v_sub_f32 v250, v241, v246
  v_mov_b32 v241, v246
  v_exp_f32 v250, v250
  v_sub_f32 v168, v168, v241
  v_sub_f32 v169, v169, v241
  v_sub_f32 v170, v170, v241
  v_sub_f32 v171, v171, v241
  v_sub_f32 v172, v172, v241
  v_sub_f32 v173, v173, v241
  v_sub_f32 v174, v174, v241
  v_sub_f32 v175, v175, v241
  v_exp_f32 v160, v160
  v_exp_f32 v161, v161
  v_exp_f32 v162, v162
  v_exp_f32 v163, v163
  v_exp_f32 v168, v168
  v_exp_f32 v169, v169
  v_exp_f32 v170, v170
  v_exp_f32 v171, v171
  v_exp_f32 v164, v164
  v_exp_f32 v165, v165
  v_exp_f32 v166, v166
  v_exp_f32 v167, v167
  v_exp_f32 v172, v172
  v_exp_f32 v173, v173
  v_exp_f32 v174, v174
  v_exp_f32 v175, v175
  v_cvt_pk_bf16_f32 v192, v160, v161
  v_cvt_pk_bf16_f32 v193, v162, v163
  v_cvt_pk_bf16_f32 v196, v168, v169
  v_cvt_pk_bf16_f32 v197, v170, v171
  v_cvt_pk_bf16_f32 v194, v164, v165
  v_cvt_pk_bf16_f32 v195, v166, v167
  v_cvt_pk_bf16_f32 v198, v172, v173
  v_cvt_pk_bf16_f32 v199, v174, v175
  v_mul_f32 v80, v80, v248
  v_mul_f32 v81, v81, v248
  v_mul_f32 v82, v82, v248
  v_mul_f32 v83, v83, v248
  v_mul_f32 v84, v84, v248
  v_mul_f32 v85, v85, v248
  v_mul_f32 v86, v86, v248
  v_mul_f32 v87, v87, v248
  v_mul_f32 v88, v88, v248
  v_mul_f32 v89, v89, v248
  v_mul_f32 v90, v90, v248
  v_mul_f32 v91, v91, v248
  v_mul_f32 v92, v92, v248
  v_mul_f32 v93, v93, v248
  v_mul_f32 v94, v94, v248
  v_mul_f32 v95, v95, v248
  v_mul_f32 v96, v96, v248
  v_mul_f32 v97, v97, v248
  v_mul_f32 v98, v98, v248
  v_mul_f32 v99, v99, v248
  v_mul_f32 v100, v100, v248
  v_mul_f32 v101, v101, v248
  v_mul_f32 v102, v102, v248
  v_mul_f32 v103, v103, v248
  v_mul_f32 v104, v104, v248
  v_mul_f32 v105, v105, v248
  v_mul_f32 v106, v106, v248
  v_mul_f32 v107, v107, v248
  v_mul_f32 v108, v108, v248
  v_mul_f32 v109, v109, v248
  v_mul_f32 v110, v110, v248
  v_mul_f32 v111, v111, v248
  v_mul_f32 v152, v152, v248
  v_mul_f32 v153, v153, v248
  v_mul_f32 v154, v154, v248
  v_mul_f32 v155, v155, v248
  v_mul_f32 v112, v112, v250
  v_mul_f32 v113, v113, v250
  v_mul_f32 v114, v114, v250
  v_mul_f32 v115, v115, v250
  v_mul_f32 v116, v116, v250
  v_mul_f32 v117, v117, v250
  v_mul_f32 v118, v118, v250
  v_mul_f32 v119, v119, v250
  v_mul_f32 v120, v120, v250
  v_mul_f32 v121, v121, v250
  v_mul_f32 v122, v122, v250
  v_mul_f32 v123, v123, v250
  v_mul_f32 v124, v124, v250
  v_mul_f32 v125, v125, v250
  v_mul_f32 v126, v126, v250
  v_mul_f32 v127, v127, v250
  v_mul_f32 v128, v128, v250
  v_mul_f32 v129, v129, v250
  v_mul_f32 v130, v130, v250
  v_mul_f32 v131, v131, v250
  v_mul_f32 v132, v132, v250
  v_mul_f32 v133, v133, v250
  v_mul_f32 v134, v134, v250
  v_mul_f32 v135, v135, v250
  v_mul_f32 v136, v136, v250
  v_mul_f32 v137, v137, v250
  v_mul_f32 v138, v138, v250
  v_mul_f32 v139, v139, v250
  v_mul_f32 v140, v140, v250
  v_mul_f32 v141, v141, v250
  v_mul_f32 v142, v142, v250
  v_mul_f32 v143, v143, v250
  v_mul_f32 v156, v156, v250
  v_mul_f32 v157, v157, v250
  v_mul_f32 v158, v158, v250
  v_mul_f32 v159, v159, v250
  s_nop 1
  v_mfma_f32_16x16x32_bf16 v[80:83], a[96:99], v[192:195], v[80:83]
  v_mfma_f32_16x16x32_bf16 v[112:115], a[96:99], v[196:199], v[112:115]
  v_mfma_f32_16x16x32_bf16 v[84:87], a[100:103], v[192:195], v[84:87]
  v_mfma_f32_16x16x32_bf16 v[116:119], a[100:103], v[196:199], v[116:119]
  v_mfma_f32_16x16x32_bf16 v[88:91], a[104:107], v[192:195], v[88:91]
  v_mfma_f32_16x16x32_bf16 v[120:123], a[104:107], v[196:199], v[120:123]
  v_mfma_f32_16x16x32_bf16 v[92:95], a[108:111], v[192:195], v[92:95]
  v_mfma_f32_16x16x32_bf16 v[124:127], a[108:111], v[196:199], v[124:127]
  v_mfma_f32_16x16x32_bf16 v[96:99], a[112:115], v[192:195], v[96:99]
  v_mfma_f32_16x16x32_bf16 v[128:131], a[112:115], v[196:199], v[128:131]
  v_mfma_f32_16x16x32_bf16 v[100:103], a[116:119], v[192:195], v[100:103]
  v_mfma_f32_16x16x32_bf16 v[132:135], a[116:119], v[196:199], v[132:135]
  v_mfma_f32_16x16x32_bf16 v[104:107], a[120:123], v[192:195], v[104:107]
  v_mfma_f32_16x16x32_bf16 v[136:139], a[120:123], v[196:199], v[136:139]
  v_mfma_f32_16x16x32_bf16 v[108:111], a[124:127], v[192:195], v[108:111]
  v_mfma_f32_16x16x32_bf16 v[140:143], a[124:127], v[196:199], v[140:143]
  v_mfma_f32_16x16x32_bf16 v[152:155], a[128:131], v[192:195], v[152:155]
  v_mfma_f32_16x16x32_bf16 v[156:159], a[128:131], v[196:199], v[156:159]
  s_add_u32 s38, s38, 16384
  s_add_u32 s36, s36, 1
  s_cmp_le_u32 s36, s37
  s_nop 7
  s_cbranch_scc1 LA_slowB_l
  s_branch LA_slowB_ret
LO_s2:
  s_mov_b32 s3, 0x10000
LO_s2_l:
  s_sleep 2
  buffer_load_dwordx2 v[250:251], v247, s[40:43], s95 offen sc1
  s_sub_u32 s3, s3, 1
  s_cmp_eq_u32 s3, 0
  s_waitcnt vmcnt(0)
  s_cbranch_scc1 LO_s2_ret
  v_cmp_ne_u64 vcc, s[0:1], v[250:251]
  s_nop 1
  s_cbranch_vccnz LO_s2_l
  s_branch LO_s2_ret
LO_s3:
  s_mov_b32 s3, 0x10000
LO_s3_l:
  s_sleep 2
  buffer_load_dwordx2 v[248:249], v247, s[40:43], s96 offen sc1
  s_sub_u32 s3, s3, 1
  s_cmp_eq_u32 s3, 0
  s_waitcnt vmcnt(0)
  s_cbranch_scc1 LO_s3_ret
  v_cmp_ne_u64 vcc, s[0:1], v[248:249]
  s_nop 1
  s_cbranch_vccnz LO_s3_l
  s_branch LO_s3_ret
LO_s4:
  s_mov_b32 s54, 0x10000
LO_s4_l:
  s_sleep 1
  buffer_load_dwordx2 v[248:249], v246, s[40:43], s99 offen sc1
  s_sub_u32 s54, s54, 1
  s_cmp_eq_u32 s54, 0
  s_waitcnt vmcnt(0)
  s_cbranch_scc1 LO_s4_ret
  v_cmp_ne_u64 vcc, s[0:1], v[248:249]
  s_nop 1
  s_cbranch_vccnz LO_s4_l
  s_branch LO_s4_ret
L_codeend:
  s_endpgm
.section .rodata,"a"
.p2align 6
.amdhsa_kernel concat_heads__compressed_kv_cla__sliding_local_dilated__prompt_kernel
  .amdhsa_next_free_vgpr 512
  .amdhsa_next_free_sgpr 102
  .amdhsa_accum_offset 256
  .amdhsa_group_segment_fixed_size 0
  .amdhsa_kernarg_size 96
  .amdhsa_user_sgpr_count 2
  .amdhsa_user_sgpr_kernarg_segment_ptr 1
  .amdhsa_system_sgpr_workgroup_id_x 1
.end_amdhsa_kernel
```
